```python
import torch

def _softmax(x, axis=-1):
    return torch.softmax(x, dim=axis)
def _gelu(x):
    return torch.nn.functional.gelu(x, approximate="tanh")
def _silu(x):
    return torch.nn.functional.silu(x)
def _sigmoid(x):
    return torch.sigmoid(x)
def _layernorm(x, axis=-1, eps=1e-5):
    m = x.mean(dim=axis, keepdim=True)
    v = x.var(dim=axis, keepdim=True, unbiased=False)
    return (x - m) / torch.sqrt(v + eps)
def _scatter_add(tgt, idx, src, axis=0):
    return tgt.clone().index_add_(axis, idx, src)
def _segment_sum(src, seg, n):
    out = torch.zeros((n,) + src.shape[1:], dtype=src.dtype)
    return out.index_add_(0, seg, src)
def _pad(x, pw):
    flat = tuple(v for pair in reversed(pw) for v in pair)
    return torch.nn.functional.pad(x, flat)

kernel_name = 'recurrent_scan__softmax_full_mha__glu_gated_reglu__prompt'

def setup_inputs():

    _w = (lambda a: (lambda t: t.to(torch.bfloat16) if t.is_floating_point() else t)(torch.as_tensor(a)))
    def _A_setup():
        B, S, D = 1, 2048, 1024
        return {
            "x": _w((lambda *s: torch.randn(*s, dtype=torch.bfloat16) * 0.05)(B, S, D)),
            "wqkv": _w((lambda *s: torch.randn(*s, dtype=torch.bfloat16) * 0.2)(D, 3 * D)),
            "wo": _w((lambda *s: torch.randn(*s, dtype=torch.bfloat16) * 0.2)(D, D)),
        }
    _A_in = _A_setup()

    def _B_setup():
        B, S, D, F = 1, 2048, 1024, 3584
        return {
            "x": _w((lambda *s: torch.randn(*s, dtype=torch.bfloat16) * 0.05)(B, S, D)),
            "W_gate": _w((lambda *s: torch.randn(*s, dtype=torch.bfloat16) * 0.1)(D, F) * (2.0 / D) ** 0.5),
            "W_up": _w((lambda *s: torch.randn(*s, dtype=torch.bfloat16) * 0.1)(D, F) * (2.0 / D) ** 0.5),
            "W_down": _w((lambda *s: torch.randn(*s, dtype=torch.bfloat16) * 0.1)(F, D) * (1.0 / F) ** 0.5),
        }
    _B_in = _B_setup()

    return {
        "A_x": _A_in["x"],
        "A_wqkv": _A_in["wqkv"],
        "A_wo": _A_in["wo"],
        "B_x": _B_in["x"],
        "B_W_gate": _B_in["W_gate"],
        "B_W_up": _B_in["W_up"],
        "B_W_down": _B_in["W_down"],
    }

def reference(A_x, A_wqkv, A_wo, B_x, B_W_gate, B_W_up, B_W_down):
    def _A_ref(x, wqkv, wo):
        B, S, D = x.shape
        H = 32; Dh = D // H
        qkv = (lambda x, *d: x.permute(*d))((x @ wqkv).reshape(B, S, 3, H, Dh), 2, 0, 3, 1, 4)
        q, k, v = qkv[0], qkv[1], qkv[2]
        scale = Dh ** -0.5
        scores = torch.einsum("bhqd,bhkd->bhqk", q, k) * scale
        p = _softmax(scores, axis=-1)
        o = torch.einsum("bhqk,bhkd->bhqd", p, v)
        return (lambda x, *d: x.permute(*d))(o, 0, 2, 1, 3).reshape(B, S, D) @ wo

    def _B_ref(x, W_gate, W_up, W_down):
        gate = torch.einsum("bsd,df->bsf", x, W_gate)
        up = torch.einsum("bsd,df->bsf", x, W_up)
        gate = gate * (lambda x, dt: x.to(dt))(gate > 0, gate.dtype)
        h = gate * up
        return torch.einsum("bsf,fd->bsd", h, W_down)

    x = A_x
    xn = _layernorm(x, axis=-1)
    s = _A_ref(xn, A_wqkv, A_wo)
    g = _silu(_B_ref(xn, B_W_gate, B_W_up, B_W_down))
    return x + s * g
```

```asm
; @launch kernel=gemm1_kernel grid=(256,1,1) block=(256,1,1) lds=155648
; @launch kernel=attn_out_kernel grid=(256,1,1) block=(512,1,1) lds=163840
.amdgcn_target "amdgcn-amd-amdhsa--gfx950"
.text
.globl gemm1_kernel
.p2align 8
.type gemm1_kernel,@function
gemm1_kernel:
    s_cmp_ge_u32 s2, 256
    s_cbranch_scc1 gemm1_kernel_end
    s_load_dwordx4 s[4:7], s[0:1], 0
    s_load_dwordx4 s[8:11], s[0:1], 32
    s_load_dwordx4 s[12:15], s[0:1], 64
    s_load_dwordx2 s[96:97], s[0:1], 48
    s_load_dwordx2 s[92:93], s[0:1], 16
    v_lshrrev_b32 v2, 6, v0
    v_and_b32 v0, 63, v0
    s_lshr_b32 s55, s2, 3
    v_readfirstlane_b32 s50, v2
    s_and_b32 s71, s55, 7
    s_lshr_b32 s55, s55, 3
    s_lshl_b32 s55, s55, 3
    s_and_b32 s70, s2, 7
    s_add_u32 s70, s70, s55
    s_lshl_b32 s51, s71, 1
    s_lshl_b32 s55, s71, 8
    s_lshl_b32 s76, s70, 3
    s_add_u32 s55, s55, s76
    s_lshl_b32 s76, s50, 1
    s_add_u32 s55, s55, s76
    v_lshrrev_b32 v2, 5, v0
    v_add_u32 v14, s55, v2
    v_and_b32 v3, 31, v0
    v_lshlrev_b32 v15, 11, v14
    v_lshl_add_u32 v15, v3, 4, v15
    s_lshl_b32 s55, s71, 2
    s_add_u32 s55, s55, s50
    s_lshl_b32 s55, s55, 17
    v_lshrrev_b32 v2, 3, v0
    v_and_b32 v3, 6, v2
    v_and_b32 v13, 7, v0
    v_xor_b32 v13, v13, v3
    v_lshlrev_b32 v13, 4, v13
    v_lshl_add_u32 v13, v2, 11, v13
    v_add_u32 v13, s55, v13
    s_cmp_le_u32 s51, 0
    s_cselect_b32 s48, 2, 0
    s_mov_b32 s49, s48
    s_lshl_b32 s82, s48, 7
    v_add_u32 v13, s82, v13
    s_mov_b32 s40, 0
    s_mov_b32 s41, 15360
    s_mov_b32 s42, 30720
    s_mov_b32 s43, 46080
    s_mov_b32 s84, 65536
    s_mov_b32 s85, 80896
    s_mov_b32 s86, 96256
    s_mov_b32 s87, 111616
    s_lshl_b32 s58, s50, 13
    s_waitcnt lgkmcnt(0)
    s_mov_b32 s20, s4
    s_and_b32 s21, s5, 0xffff
    s_mov_b32 s22, 4194304
    s_mov_b32 s23, 0x20000
    s_add_u32 m0, s58, 122880
    s_nop 0
    buffer_load_dwordx4 v13, s[20:23], s40 offen offset:0 lds
    s_mul_i32 s78, s70, 320
    s_cmp_eq_u32 s70, 9
    s_cselect_b32 s78, 2752, s78
    s_sub_u32 s55, s70, 10
    s_mul_i32 s79, s55, 160
    s_add_u32 s79, s79, 64
    s_add_u32 s80, s79, 128
    s_and_b32 s55, s55, 1
    s_cselect_b32 s80, s79, s80
    s_cselect_b32 s55, 32, 0
    s_add_u32 s79, s79, s55
    s_cmp_eq_u32 s70, 9
    s_cselect_b32 s79, 0, s79
    buffer_load_dwordx4 v13, s[20:23], s41 offen offset:1024 lds
    s_lshr_b32 s55, s50, 1
    s_add_u32 s76, s70, s70
    s_xor_b32 s16, s55, 1
    s_add_u32 s76, s76, s16
    s_and_b32 s16, s50, 1
    s_cselect_b32 s16, s10, s8
    s_cselect_b32 s17, s11, s9
    s_lshl_b32 s72, s55, 6
    s_add_u32 s72, s72, s79
    s_lshl_b32 s18, s50, 6
    s_add_u32 s18, s18, s78
    buffer_load_dwordx4 v13, s[20:23], s42 offen offset:2048 lds
    s_cmp_le_u32 s76, 18
    s_cselect_b32 s24, s6, s16
    s_cselect_b32 s25, s7, s17
    s_cselect_b32 s72, s18, s72
    s_movk_i32 s73, 7168
    s_cselect_b32 s73, 6144, s73
    s_and_b32 s25, s25, 0xffff
    s_mul_i32 s26, s73, 1024
    s_mov_b32 s27, 0x20000
    s_lshl_b32 s72, s72, 1
    buffer_load_dwordx4 v13, s[20:23], s43 offen offset:3072 lds
    s_add_u32 s16, s78, 256
    s_cmp_le_u32 s70, 9
    s_cselect_b32 s28, s6, s8
    s_cselect_b32 s29, s7, s9
    s_cselect_b32 s32, s6, s10
    s_cselect_b32 s33, s7, s11
    s_cselect_b32 s74, s16, s80
    s_cselect_b32 s53, 64, 0
    s_movk_i32 s75, 7168
    s_cselect_b32 s75, 6144, s75
    s_add_u32 m0, s58, 126976
    s_nop 0
    buffer_load_dwordx4 v13, s[20:23], s84 offen offset:0 lds
    s_and_b32 s29, s29, 0xffff
    s_and_b32 s33, s33, 0xffff
    s_mul_i32 s30, s75, 1024
    s_mov_b32 s34, s30
    s_mov_b32 s31, 0x20000
    s_mov_b32 s35, 0x20000
    s_lshl_b32 s74, s74, 1
    s_mov_b32 s52, 0
    buffer_load_dwordx4 v13, s[20:23], s85 offen offset:1024 lds
    v_lshrrev_b32 v2, 3, v0
    v_and_b32 v3, 7, v0
    v_lshrrev_b32 v11, 4, v0
    v_and_b32 v11, 1, v11
    v_lshlrev_b32 v11, 1, v11
    v_xor_b32 v11, v11, v3
    v_lshlrev_b32 v11, 4, v11
    v_mul_lo_u32 v10, v2, s73
    v_add_u32 v10, v10, v11
    v_add_u32 v10, s72, v10
    v_xor_b32 v11, 64, v10
    s_mul_i32 s62, s73, 0
    s_mul_i32 s63, s73, 8
    s_sub_u32 s63, s63, 1024
    s_mul_i32 s64, s73, 16
    s_sub_u32 s64, s64, 2048
    s_mul_i32 s65, s73, 24
    s_sub_u32 s65, s65, 3072
    s_mul_i32 s66, s73, 32
    s_mul_i32 s67, s73, 40
    s_sub_u32 s67, s67, 1024
    s_mul_i32 s68, s73, 48
    buffer_load_dwordx4 v13, s[20:23], s86 offen offset:2048 lds
    s_sub_u32 s68, s68, 2048
    s_mul_i32 s69, s73, 56
    s_sub_u32 s69, s69, 3072
    s_mul_i32 s56, s73, 64
    s_mul_i32 s58, s50, 8192
    v_lshrrev_b32 v2, 2, v0
    s_lshl_b32 s55, s50, 4
    v_add_u32 v2, s55, v2
    v_mul_lo_u32 v12, v2, s75
    v_lshrrev_b32 v2, 5, v0
    v_lshlrev_b32 v2, 1, v2
    v_and_b32 v3, 3, v0
    v_xor_b32 v3, v3, v2
    v_lshl_add_u32 v12, v3, 4, v12
    v_add_u32 v12, s74, v12
    s_lshl_b32 s57, s75, 6
    s_lshl_b32 s59, s50, 11
    s_add_u32 s59, s59, 32768
    s_mul_i32 s82, s48, s56
    s_mul_i32 s83, s48, s57
    v_add_u32 v10, s82, v10
    v_add_u32 v11, s82, v11
    v_add_u32 v12, s83, v12
    buffer_load_dwordx4 v13, s[20:23], s87 offen offset:3072 lds
    s_cmp_le_u32 s51, 1
    s_cselect_b32 s82, 3, 1
    s_sub_i32 s54, s82, s49
    s_mov_b32 s49, s82
    s_lshl_b32 s82, s54, 7
    v_add_u32 v13, s82, v13
    s_mov_b32 s44, s12
    s_and_b32 s45, s13, 0xffff
    s_mov_b32 s46, 256
    s_mov_b32 s47, 0x20000
    s_add_u32 m0, s58, 0
    s_nop 0
    buffer_load_dwordx4 v10, s[24:27], s62 offen offset:0 lds
    s_add_u32 s36, s14, 41943040
    s_addc_u32 s37, s15, 0
    s_and_b32 s37, s37, 0xffff
    s_mov_b32 s38, 2097152
    buffer_load_dwordx4 v11, s[24:27], s63 offen offset:1024 lds
    s_mov_b32 s39, 0x20000
    v_lshrrev_b32 v2, 4, v0
    v_bfe_u32 v3, v0, 2, 2
    v_and_b32 v9, 1, v2
    buffer_load_dwordx4 v10, s[24:27], s64 offen offset:2048 lds
    v_lshl_add_u32 v8, v9, 3, v3
    v_lshlrev_b32 v8, 6, v8
    v_lshrrev_b32 v4, 1, v2
    v_lshl_add_u32 v8, v4, 11, v8
    buffer_load_dwordx4 v11, s[24:27], s65 offen offset:3072 lds
    v_and_b32 v4, 3, v0
    v_lshl_add_u32 v8, v4, 3, v8
    v_add_u32 v8, 32768, v8
    v_lshlrev_b32 v4, 5, v9
    s_add_u32 m0, s58, 4096
    s_nop 0
    buffer_load_dwordx4 v10, s[24:27], s66 offen offset:0 lds
    v_xor_b32 v9, 32, v4
    v_add_u32 v9, v9, v8
    v_add_u32 v8, v4, v8
    v_mul_u32_u24 v4, 8, v2
    buffer_load_dwordx4 v11, s[24:27], s67 offen offset:1024 lds
    v_add_u32 v4, v4, v3
    v_lshlrev_b32 v4, 7, v4
    v_lshrrev_b32 v3, 1, v3
    v_and_b32 v2, 1, v2
    buffer_load_dwordx4 v10, s[24:27], s68 offen offset:2048 lds
    v_lshl_or_b32 v3, v2, 1, v3
    v_and_b32 v2, 3, v0
    v_lshl_add_u32 v4, v2, 3, v4
    v_xor_b32 v2, 3, v3
    buffer_load_dwordx4 v11, s[24:27], s69 offen offset:3072 lds
    v_lshl_add_u32 v7, v2, 5, v4
    v_xor_b32 v2, 2, v3
    v_lshl_add_u32 v6, v2, 5, v4
    v_xor_b32 v2, 1, v3
    s_add_u32 m0, s59, 0
    s_nop 0
    buffer_load_dwordx4 v12, s[28:31], s52 offen lds
    v_lshl_add_u32 v5, v2, 5, v4
    v_xor_b32 v2, 0, v3
    v_lshl_add_u32 v4, v2, 5, v4
    v_and_b32 v2, 15, v0
    s_add_u32 m0, s59, 1024
    s_nop 0
    buffer_load_dwordx4 v12, s[32:35], s53 offen lds
    s_cmp_le_u32 s51, 1
    s_cselect_b32 s82, 3, 1
    s_sub_i32 s54, s82, s48
    s_mov_b32 s48, s82
    s_mul_i32 s82, s54, s56
    s_mul_i32 s83, s54, s57
    v_add_u32 v10, s82, v10
    v_add_u32 v11, s82, v11
    v_add_u32 v12, s83, v12
    v_lshrrev_b32 v3, 4, v0
    v_and_b32 v252, 6, v0
    v_xor_b32 v252, v252, v3
    v_lshlrev_b32 v252, 4, v252
    v_lshl_add_u32 v252, v2, 7, v252
    s_add_u32 s55, s58, 81920
    v_add_u32 v252, s55, v252
    v_xor_b32 v253, 64, v252
    s_lshl_b32 s81, s50, 13
    s_lshl_b32 s60, s50, 12
    s_lshl_b32 s61, s50, 10
    s_add_u32 s61, s61, 16384
    v_mov_b32 v2, 0x3f803f80
    v_accvgpr_write_b32 a220, v2
    v_accvgpr_write_b32 a221, v2
    v_accvgpr_write_b32 a222, v2
    v_accvgpr_write_b32 a223, v2
    buffer_load_dwordx4 a[224:227], v15, s[20:23], 0 offen offset:0
    buffer_load_dwordx4 a[228:231], v15, s[20:23], 0 offen offset:512
    buffer_load_dwordx4 a[232:235], v15, s[20:23], 0 offen offset:1024
    buffer_load_dwordx4 a[236:239], v15, s[20:23], 0 offen offset:1536
    s_add_u32 m0, s58, 81920
    s_nop 0
    buffer_load_dwordx4 v13, s[20:23], s40 offen offset:0 lds
    buffer_load_dwordx4 v13, s[20:23], s41 offen offset:1024 lds
    s_waitcnt vmcnt(16)
    ds_read_b128 a[84:87], v252 offset:40960
    ds_read_b128 a[88:91], v252 offset:43008
    ds_read_b128 a[92:95], v252 offset:45056
    ds_read_b128 a[96:99], v252 offset:47104
    ds_read_b128 a[100:103], v253 offset:40960
    ds_read_b128 a[104:107], v253 offset:43008
    ds_read_b128 a[108:111], v253 offset:45056
    ds_read_b128 a[112:115], v253 offset:47104
    s_waitcnt vmcnt(6) lgkmcnt(0)
    s_barrier
    ds_read_b64_tr_b16 a[148:149], v4 offset:0
    ds_read_b64_tr_b16 a[150:151], v4 offset:512
    ds_read_b64_tr_b16 a[152:153], v4 offset:4096
    ds_read_b64_tr_b16 a[154:155], v4 offset:4608
    ds_read_b64_tr_b16 a[156:157], v5 offset:0
    ds_read_b64_tr_b16 a[158:159], v5 offset:512
    ds_read_b64_tr_b16 a[160:161], v5 offset:4096
    ds_read_b64_tr_b16 a[162:163], v5 offset:4608
    ds_read_b64_tr_b16 a[164:165], v6 offset:0
    ds_read_b64_tr_b16 a[166:167], v6 offset:512
    ds_read_b64_tr_b16 a[168:169], v6 offset:4096
    ds_read_b64_tr_b16 a[170:171], v6 offset:4608
    s_waitcnt lgkmcnt(8)
    v_mfma_f32_16x16x32_bf16 v[16:19], a[148:151], a[84:87], 0
    ds_read_b64_tr_b16 a[172:173], v7 offset:0
    buffer_load_dwordx4 v13, s[20:23], s42 offen offset:2048 lds
    v_mfma_f32_16x16x32_bf16 v[16:19], a[152:155], a[100:103], v[16:19]
    v_mfma_f32_16x16x32_bf16 v[20:23], a[148:151], a[88:91], 0
    ds_read_b64_tr_b16 a[174:175], v7 offset:512
    v_mfma_f32_16x16x32_bf16 v[20:23], a[152:155], a[104:107], v[20:23]
    v_mfma_f32_16x16x32_bf16 v[24:27], a[148:151], a[92:95], 0
    ds_read_b64_tr_b16 a[176:177], v7 offset:4096
    buffer_load_dwordx4 v13, s[20:23], s43 offen offset:3072 lds
    v_mfma_f32_16x16x32_bf16 v[24:27], a[152:155], a[108:111], v[24:27]
    s_add_u32 m0, s58, 86016
    v_mfma_f32_16x16x32_bf16 a[0:3], a[148:151], a[96:99], 0
    ds_read_b64_tr_b16 a[178:179], v7 offset:4608
    v_mfma_f32_16x16x32_bf16 a[0:3], a[152:155], a[112:115], a[0:3]
    s_waitcnt lgkmcnt(8)
    v_mfma_f32_16x16x32_bf16 v[28:31], a[156:159], a[84:87], 0
    ds_read_b64_tr_b16 a[148:149], v4 offset:8192
    buffer_load_dwordx4 v13, s[20:23], s84 offen offset:0 lds
    v_mfma_f32_16x16x32_bf16 v[28:31], a[160:163], a[100:103], v[28:31]
    v_mfma_f32_16x16x32_bf16 v[32:35], a[156:159], a[88:91], 0
    ds_read_b64_tr_b16 a[150:151], v4 offset:8704
    v_mfma_f32_16x16x32_bf16 v[32:35], a[160:163], a[104:107], v[32:35]
    v_mfma_f32_16x16x32_bf16 v[36:39], a[156:159], a[92:95], 0
    ds_read_b64_tr_b16 a[152:153], v4 offset:12288
    buffer_load_dwordx4 v13, s[20:23], s85 offen offset:1024 lds
    v_mfma_f32_16x16x32_bf16 v[36:39], a[160:163], a[108:111], v[36:39]
    v_mfma_f32_16x16x32_bf16 a[4:7], a[156:159], a[96:99], 0
    ds_read_b64_tr_b16 a[154:155], v4 offset:12800
    v_mfma_f32_16x16x32_bf16 a[4:7], a[160:163], a[112:115], a[4:7]
    s_waitcnt lgkmcnt(8)
    v_mfma_f32_16x16x32_bf16 v[40:43], a[164:167], a[84:87], 0
    ds_read_b64_tr_b16 a[156:157], v5 offset:8192
    buffer_load_dwordx4 v13, s[20:23], s86 offen offset:2048 lds
    v_mfma_f32_16x16x32_bf16 v[40:43], a[168:171], a[100:103], v[40:43]
    s_waitcnt vmcnt(7)
    v_mov_b32 v1, 0
    v_mfma_f32_16x16x32_bf16 v[44:47], a[164:167], a[88:91], 0
    ds_read_b64_tr_b16 a[158:159], v5 offset:8704
    v_accvgpr_read_b32 v3, a224
    v_mfma_f32_16x16x32_bf16 v[44:47], a[168:171], a[104:107], v[44:47]
    v_dot2c_f32_bf16 v1, 0x3f803f80, v3
    v_mfma_f32_16x16x32_bf16 v[48:51], a[164:167], a[92:95], 0
    ds_read_b64_tr_b16 a[160:161], v5 offset:12288
    buffer_load_dwordx4 v13, s[20:23], s87 offen offset:3072 lds
    v_mfma_f32_16x16x32_bf16 v[48:51], a[168:171], a[108:111], v[48:51]
    s_cmp_le_u32 s51, 2
    s_cselect_b32 s82, 4, 2
    v_mfma_f32_16x16x32_bf16 a[8:11], a[164:167], a[96:99], 0
    ds_read_b64_tr_b16 a[162:163], v5 offset:12800
    s_sub_i32 s54, s82, s49
    v_mfma_f32_16x16x32_bf16 a[8:11], a[168:171], a[112:115], a[8:11]
    s_mov_b32 s49, s82
    s_waitcnt lgkmcnt(8)
    v_mfma_f32_16x16x32_bf16 v[52:55], a[172:175], a[84:87], 0
    ds_read_b64_tr_b16 a[164:165], v6 offset:8192
    s_lshl_b32 s82, s54, 7
    v_mfma_f32_16x16x32_bf16 v[52:55], a[176:179], a[100:103], v[52:55]
    v_add_u32 v13, s82, v13
    s_add_u32 m0, s58, 40960
    v_mfma_f32_16x16x32_bf16 v[56:59], a[172:175], a[88:91], 0
    ds_read_b64_tr_b16 a[166:167], v6 offset:8704
    v_accvgpr_read_b32 v15, a225
    v_mfma_f32_16x16x32_bf16 v[56:59], a[176:179], a[104:107], v[56:59]
    v_dot2c_f32_bf16 v1, 0x3f803f80, v15
    buffer_load_dwordx4 v10, s[24:27], s62 offen offset:0 lds
    v_mfma_f32_16x16x32_bf16 v[60:63], a[172:175], a[92:95], 0
    ds_read_b64_tr_b16 a[168:169], v6 offset:12288
    v_accvgpr_read_b32 v3, a226
    v_mfma_f32_16x16x32_bf16 v[60:63], a[176:179], a[108:111], v[60:63]
    v_dot2c_f32_bf16 v1, 0x3f803f80, v3
    buffer_load_dwordx4 v11, s[24:27], s63 offen offset:1024 lds
    v_mfma_f32_16x16x32_bf16 a[12:15], a[172:175], a[96:99], 0
    ds_read_b64_tr_b16 a[170:171], v6 offset:12800
    v_accvgpr_read_b32 v15, a227
    v_mfma_f32_16x16x32_bf16 a[12:15], a[176:179], a[112:115], a[12:15]
    v_dot2c_f32_bf16 v1, 0x3f803f80, v15
    s_waitcnt lgkmcnt(8)
    v_mfma_f32_16x16x32_bf16 v[64:67], a[148:151], a[84:87], 0
    ds_read_b64_tr_b16 a[172:173], v7 offset:8192
    buffer_load_dwordx4 v10, s[24:27], s64 offen offset:2048 lds
    v_mfma_f32_16x16x32_bf16 v[64:67], a[152:155], a[100:103], v[64:67]
    v_accvgpr_read_b32 v3, a228
    v_dot2c_f32_bf16 v1, 0x3f803f80, v3
    v_mfma_f32_16x16x32_bf16 v[68:71], a[148:151], a[88:91], 0
    ds_read_b64_tr_b16 a[174:175], v7 offset:8704
    v_mfma_f32_16x16x32_bf16 v[68:71], a[152:155], a[104:107], v[68:71]
    v_mfma_f32_16x16x32_bf16 v[72:75], a[148:151], a[92:95], 0
    ds_read_b64_tr_b16 a[176:177], v7 offset:12288
    buffer_load_dwordx4 v11, s[24:27], s65 offen offset:3072 lds
    v_mfma_f32_16x16x32_bf16 v[72:75], a[152:155], a[108:111], v[72:75]
    s_add_u32 m0, s58, 45056
    v_accvgpr_read_b32 v15, a229
    v_mfma_f32_16x16x32_bf16 a[16:19], a[148:151], a[96:99], 0
    ds_read_b64_tr_b16 a[178:179], v7 offset:12800
    v_dot2c_f32_bf16 v1, 0x3f803f80, v15
    v_mfma_f32_16x16x32_bf16 a[16:19], a[152:155], a[112:115], a[16:19]
    s_waitcnt lgkmcnt(8)
    v_mfma_f32_16x16x32_bf16 v[76:79], a[156:159], a[84:87], 0
    ds_read_b64_tr_b16 a[148:149], v4 offset:16384
    buffer_load_dwordx4 v10, s[24:27], s66 offen offset:0 lds
    v_mfma_f32_16x16x32_bf16 v[76:79], a[160:163], a[100:103], v[76:79]
    v_accvgpr_read_b32 v3, a230
    v_dot2c_f32_bf16 v1, 0x3f803f80, v3
    v_mfma_f32_16x16x32_bf16 v[80:83], a[156:159], a[88:91], 0
    ds_read_b64_tr_b16 a[150:151], v4 offset:16896
    v_mfma_f32_16x16x32_bf16 v[80:83], a[160:163], a[104:107], v[80:83]
    v_mfma_f32_16x16x32_bf16 a[64:67], a[156:159], a[92:95], 0
    ds_read_b64_tr_b16 a[152:153], v4 offset:20480
    buffer_load_dwordx4 v11, s[24:27], s67 offen offset:1024 lds
    v_mfma_f32_16x16x32_bf16 a[64:67], a[160:163], a[108:111], a[64:67]
    v_accvgpr_read_b32 v15, a231
    v_dot2c_f32_bf16 v1, 0x3f803f80, v15
    v_mfma_f32_16x16x32_bf16 a[20:23], a[156:159], a[96:99], 0
    ds_read_b64_tr_b16 a[154:155], v4 offset:20992
    v_mfma_f32_16x16x32_bf16 a[20:23], a[160:163], a[112:115], a[20:23]
    s_waitcnt lgkmcnt(8)
    v_mfma_f32_16x16x32_bf16 v[84:87], a[164:167], a[84:87], 0
    ds_read_b64_tr_b16 a[156:157], v5 offset:16384
    buffer_load_dwordx4 v10, s[24:27], s68 offen offset:2048 lds
    v_mfma_f32_16x16x32_bf16 v[84:87], a[168:171], a[100:103], v[84:87]
    v_accvgpr_read_b32 v3, a232
    v_dot2c_f32_bf16 v1, 0x3f803f80, v3
    v_mfma_f32_16x16x32_bf16 v[88:91], a[164:167], a[88:91], 0
    ds_read_b64_tr_b16 a[158:159], v5 offset:16896
    v_mfma_f32_16x16x32_bf16 v[88:91], a[168:171], a[104:107], v[88:91]
    v_mfma_f32_16x16x32_bf16 v[92:95], a[164:167], a[92:95], 0
    ds_read_b64_tr_b16 a[160:161], v5 offset:20480
    buffer_load_dwordx4 v11, s[24:27], s69 offen offset:3072 lds
    v_mfma_f32_16x16x32_bf16 v[92:95], a[168:171], a[108:111], v[92:95]
    s_add_u32 m0, s59, 40960
    v_accvgpr_read_b32 v15, a233
    v_mfma_f32_16x16x32_bf16 a[24:27], a[164:167], a[96:99], 0
    ds_read_b64_tr_b16 a[162:163], v5 offset:20992
    v_dot2c_f32_bf16 v1, 0x3f803f80, v15
    v_mfma_f32_16x16x32_bf16 a[24:27], a[168:171], a[112:115], a[24:27]
    s_waitcnt lgkmcnt(8)
    v_mfma_f32_16x16x32_bf16 v[96:99], a[172:175], a[84:87], 0
    ds_read_b64_tr_b16 a[164:165], v6 offset:16384
    buffer_load_dwordx4 v12, s[28:31], s52 offen lds
    v_mfma_f32_16x16x32_bf16 v[96:99], a[176:179], a[100:103], v[96:99]
    s_add_u32 m0, s59, 41984
    v_accvgpr_read_b32 v3, a234
    v_mfma_f32_16x16x32_bf16 v[100:103], a[172:175], a[88:91], 0
    ds_read_b64_tr_b16 a[166:167], v6 offset:16896
    v_dot2c_f32_bf16 v1, 0x3f803f80, v3
    v_mfma_f32_16x16x32_bf16 v[100:103], a[176:179], a[104:107], v[100:103]
    v_mfma_f32_16x16x32_bf16 a[68:71], a[172:175], a[92:95], 0
    ds_read_b64_tr_b16 a[168:169], v6 offset:20480
    buffer_load_dwordx4 v12, s[32:35], s53 offen lds
    v_mfma_f32_16x16x32_bf16 a[68:71], a[176:179], a[108:111], a[68:71]
    s_cmp_le_u32 s51, 2
    s_cselect_b32 s82, 4, 2
    v_mfma_f32_16x16x32_bf16 a[28:31], a[172:175], a[96:99], 0
    ds_read_b64_tr_b16 a[170:171], v6 offset:20992
    s_sub_i32 s54, s82, s48
    v_mfma_f32_16x16x32_bf16 a[28:31], a[176:179], a[112:115], a[28:31]
    s_mov_b32 s48, s82
    s_waitcnt lgkmcnt(8)
    v_mfma_f32_16x16x32_bf16 v[104:107], a[148:151], a[84:87], 0
    ds_read_b64_tr_b16 a[172:173], v7 offset:16384
    s_mul_i32 s82, s54, s56
    v_mfma_f32_16x16x32_bf16 v[104:107], a[152:155], a[100:103], v[104:107]
    s_mul_i32 s83, s54, s57
    v_add_u32 v10, s82, v10
    v_mfma_f32_16x16x32_bf16 v[108:111], a[148:151], a[88:91], 0
    ds_read_b64_tr_b16 a[174:175], v7 offset:16896
    v_add_u32 v11, s82, v11
    v_mfma_f32_16x16x32_bf16 v[108:111], a[152:155], a[104:107], v[108:111]
    v_add_u32 v12, s83, v12
    s_add_u32 m0, s58, 122880
    v_mfma_f32_16x16x32_bf16 v[112:115], a[148:151], a[92:95], 0
    ds_read_b64_tr_b16 a[176:177], v7 offset:20480
    v_accvgpr_read_b32 v15, a235
    v_mfma_f32_16x16x32_bf16 v[112:115], a[152:155], a[108:111], v[112:115]
    v_dot2c_f32_bf16 v1, 0x3f803f80, v15
    buffer_load_dwordx4 v13, s[20:23], s40 offen offset:0 lds
    v_mfma_f32_16x16x32_bf16 a[32:35], a[148:151], a[96:99], 0
    ds_read_b64_tr_b16 a[178:179], v7 offset:20992
    v_accvgpr_read_b32 v3, a236
    v_mfma_f32_16x16x32_bf16 a[32:35], a[152:155], a[112:115], a[32:35]
    v_dot2c_f32_bf16 v1, 0x3f803f80, v3
    s_waitcnt lgkmcnt(8)
    v_mfma_f32_16x16x32_bf16 v[116:119], a[156:159], a[84:87], 0
    ds_read_b64_tr_b16 a[148:149], v4 offset:24576
    buffer_load_dwordx4 v13, s[20:23], s41 offen offset:1024 lds
    v_mfma_f32_16x16x32_bf16 v[116:119], a[160:163], a[100:103], v[116:119]
    v_accvgpr_read_b32 v15, a237
    v_dot2c_f32_bf16 v1, 0x3f803f80, v15
    v_mfma_f32_16x16x32_bf16 v[120:123], a[156:159], a[88:91], 0
    ds_read_b64_tr_b16 a[150:151], v4 offset:25088
    buffer_load_dwordx4 v13, s[20:23], s42 offen offset:2048 lds
    v_mfma_f32_16x16x32_bf16 v[120:123], a[160:163], a[104:107], v[120:123]
    v_accvgpr_read_b32 v3, a238
    v_dot2c_f32_bf16 v1, 0x3f803f80, v3
    v_mfma_f32_16x16x32_bf16 v[124:127], a[156:159], a[92:95], 0
    ds_read_b64_tr_b16 a[152:153], v4 offset:28672
    buffer_load_dwordx4 v13, s[20:23], s43 offen offset:3072 lds
    v_mfma_f32_16x16x32_bf16 v[124:127], a[160:163], a[108:111], v[124:127]
    s_add_u32 m0, s58, 126976
    v_accvgpr_read_b32 v15, a239
    v_mfma_f32_16x16x32_bf16 a[36:39], a[156:159], a[96:99], 0
    ds_read_b64_tr_b16 a[154:155], v4 offset:29184
    v_dot2c_f32_bf16 v1, 0x3f803f80, v15
    v_mfma_f32_16x16x32_bf16 a[36:39], a[160:163], a[112:115], a[36:39]
    s_nop 2
    s_waitcnt lgkmcnt(8)
    v_mfma_f32_16x16x32_bf16 v[128:131], a[164:167], a[84:87], 0
    ds_read_b64_tr_b16 a[156:157], v5 offset:24576
    buffer_load_dwordx4 v13, s[20:23], s84 offen offset:0 lds
    v_mfma_f32_16x16x32_bf16 v[128:131], a[168:171], a[100:103], v[128:131]
    v_add_u32 v4, 40960, v4
    s_nop 1
    v_mfma_f32_16x16x32_bf16 v[132:135], a[164:167], a[88:91], 0
    ds_read_b64_tr_b16 a[158:159], v5 offset:25088
    v_add_f32_dpp v1, v1, v1 row_ror:8 row_mask:0xf bank_mask:0xf
    v_mfma_f32_16x16x32_bf16 v[132:135], a[168:171], a[104:107], v[132:135]
    v_mfma_f32_16x16x32_bf16 v[136:139], a[164:167], a[92:95], 0
    ds_read_b64_tr_b16 a[160:161], v5 offset:28672
    buffer_load_dwordx4 v13, s[20:23], s85 offen offset:1024 lds
    v_mfma_f32_16x16x32_bf16 v[136:139], a[168:171], a[108:111], v[136:139]
    s_nop 1
    v_add_f32_dpp v1, v1, v1 row_ror:4 row_mask:0xf bank_mask:0xf
    v_mfma_f32_16x16x32_bf16 a[40:43], a[164:167], a[96:99], 0
    ds_read_b64_tr_b16 a[162:163], v5 offset:29184
    v_mfma_f32_16x16x32_bf16 a[40:43], a[168:171], a[112:115], a[40:43]
    s_waitcnt lgkmcnt(8)
    v_mfma_f32_16x16x32_bf16 v[140:143], a[172:175], a[84:87], 0
    ds_read_b64_tr_b16 a[164:165], v6 offset:24576
    buffer_load_dwordx4 v13, s[20:23], s86 offen offset:2048 lds
    v_mfma_f32_16x16x32_bf16 v[140:143], a[176:179], a[100:103], v[140:143]
    v_add_u32 v5, 40960, v5
    s_nop 1
    v_mfma_f32_16x16x32_bf16 v[144:147], a[172:175], a[88:91], 0
    ds_read_b64_tr_b16 a[166:167], v6 offset:25088
    v_add_f32_dpp v1, v1, v1 row_ror:2 row_mask:0xf bank_mask:0xf
    v_mfma_f32_16x16x32_bf16 v[144:147], a[176:179], a[104:107], v[144:147]
    v_mfma_f32_16x16x32_bf16 a[80:83], a[172:175], a[92:95], 0
    ds_read_b64_tr_b16 a[168:169], v6 offset:28672
    buffer_load_dwordx4 v13, s[20:23], s87 offen offset:3072 lds
    v_mfma_f32_16x16x32_bf16 a[80:83], a[176:179], a[108:111], a[80:83]
    s_cmp_le_u32 s51, 3
    s_cselect_b32 s82, 5, 3
    v_mfma_f32_16x16x32_bf16 a[44:47], a[172:175], a[96:99], 0
    ds_read_b64_tr_b16 a[170:171], v6 offset:29184
    s_sub_i32 s54, s82, s49
    v_mfma_f32_16x16x32_bf16 a[44:47], a[176:179], a[112:115], a[44:47]
    s_mov_b32 s49, s82
    s_waitcnt lgkmcnt(8)
    v_mfma_f32_16x16x32_bf16 v[148:151], a[148:151], a[84:87], 0
    ds_read_b64_tr_b16 a[172:173], v7 offset:24576
    s_lshl_b32 s82, s54, 7
    v_mfma_f32_16x16x32_bf16 v[148:151], a[152:155], a[100:103], v[148:151]
    v_add_u32 v6, 40960, v6
    v_add_u32 v13, s82, v13
    v_mfma_f32_16x16x32_bf16 v[152:155], a[148:151], a[88:91], 0
    ds_read_b64_tr_b16 a[174:175], v7 offset:25088
    s_nop 1
    v_mfma_f32_16x16x32_bf16 v[152:155], a[152:155], a[104:107], v[152:155]
    v_add_f32_dpp v1, v1, v1 row_ror:1 row_mask:0xf bank_mask:0xf
    v_mov_b32 v3, v1
    v_mfma_f32_16x16x32_bf16 v[156:159], a[148:151], a[92:95], 0
    ds_read_b64_tr_b16 a[176:177], v7 offset:28672
    s_nop 1
    v_mfma_f32_16x16x32_bf16 v[156:159], a[152:155], a[108:111], v[156:159]
    v_permlane16_swap_b32 v3, v1
    s_nop 1
    v_mfma_f32_16x16x32_bf16 a[48:51], a[148:151], a[96:99], 0
    ds_read_b64_tr_b16 a[178:179], v7 offset:29184
    v_mfma_f32_16x16x32_bf16 a[48:51], a[152:155], a[112:115], a[48:51]
    s_waitcnt lgkmcnt(8)
    v_mfma_f32_16x16x32_bf16 v[160:163], a[156:159], a[84:87], 0
    ds_read_b64_tr_b16 a[148:149], v8 offset:0
    s_waitcnt vmcnt(24)
    v_mfma_f32_16x16x32_bf16 v[160:163], a[160:163], a[100:103], v[160:163]
    v_add_u32 v7, 40960, v7
    ds_read_b128 a[116:119], v252 offset:0
    v_mfma_f32_16x16x32_bf16 v[164:167], a[156:159], a[88:91], 0
    ds_read_b64_tr_b16 a[150:151], v8 offset:256
    v_add_f32 v1, v1, v3
    v_mfma_f32_16x16x32_bf16 v[164:167], a[160:163], a[104:107], v[164:167]
    v_mul_f32 v2, 0xba800000, v1
    v_mfma_f32_16x16x32_bf16 a[72:75], a[156:159], a[92:95], 0
    ds_read_b64_tr_b16 a[152:153], v8 offset:4096
    ds_read_b128 a[132:135], v253 offset:0
    v_mfma_f32_16x16x32_bf16 a[72:75], a[160:163], a[108:111], a[72:75]
    v_accvgpr_read_b32 v3, a224
    v_lshlrev_b32 v15, 16, v3
    v_mfma_f32_16x16x32_bf16 a[52:55], a[156:159], a[96:99], 0
    ds_read_b64_tr_b16 a[154:155], v8 offset:4352
    v_mfma_f32_16x16x32_bf16 a[52:55], a[160:163], a[112:115], a[52:55]
    s_waitcnt lgkmcnt(10)
    v_mfma_f32_16x16x32_bf16 v[168:171], a[164:167], a[84:87], 0
    ds_read_b64_tr_b16 a[156:157], v9 offset:0
    s_waitcnt vmcnt(22)
    v_mfma_f32_16x16x32_bf16 v[168:171], a[168:171], a[100:103], v[168:171]
    ds_read_b128 a[120:123], v252 offset:2048
    v_and_b32 v3, 0xffff0000, v3
    v_mfma_f32_16x16x32_bf16 v[172:175], a[164:167], a[88:91], 0
    ds_read_b64_tr_b16 a[158:159], v9 offset:256
    v_add_f32 v15, v15, v2
    v_mfma_f32_16x16x32_bf16 v[172:175], a[168:171], a[104:107], v[172:175]
    v_mfma_f32_16x16x32_bf16 v[176:179], a[164:167], a[92:95], 0
    ds_read_b64_tr_b16 a[160:161], v9 offset:4096
    ds_read_b128 a[136:139], v253 offset:2048
    v_mfma_f32_16x16x32_bf16 v[176:179], a[168:171], a[108:111], v[176:179]
    v_add_f32 v3, v3, v2
    v_mul_f32 v1, v15, v15
    v_mfma_f32_16x16x32_bf16 a[56:59], a[164:167], a[96:99], 0
    ds_read_b64_tr_b16 a[162:163], v9 offset:4352
    v_mfma_f32_16x16x32_bf16 a[56:59], a[168:171], a[112:115], a[56:59]
    s_waitcnt lgkmcnt(12)
    v_mfma_f32_16x16x32_bf16 v[180:183], a[172:175], a[84:87], 0
    ds_read_b64_tr_b16 a[164:165], v8 offset:1024
    s_waitcnt vmcnt(20)
    v_mfma_f32_16x16x32_bf16 v[180:183], a[176:179], a[100:103], v[180:183]
    ds_read_b128 a[124:127], v252 offset:4096
    v_mul_f32 v14, v3, v3
    v_mfma_f32_16x16x32_bf16 v[184:187], a[172:175], a[88:91], 0
    ds_read_b64_tr_b16 a[166:167], v8 offset:1280
    v_accvgpr_read_b32 v3, a225
    v_mfma_f32_16x16x32_bf16 v[184:187], a[176:179], a[104:107], v[184:187]
    v_mfma_f32_16x16x32_bf16 a[76:79], a[172:175], a[92:95], 0
    ds_read_b64_tr_b16 a[168:169], v8 offset:5120
    ds_read_b128 a[140:143], v253 offset:4096
    v_mfma_f32_16x16x32_bf16 a[76:79], a[176:179], a[108:111], a[76:79]
    v_lshlrev_b32 v15, 16, v3
    v_and_b32 v3, 0xffff0000, v3
    v_mfma_f32_16x16x32_bf16 a[60:63], a[172:175], a[96:99], 0
    ds_read_b64_tr_b16 a[170:171], v8 offset:5376
    v_mfma_f32_16x16x32_bf16 a[60:63], a[176:179], a[112:115], a[60:63]
    s_waitcnt lgkmcnt(12)
    v_mfma_f32_16x16x32_bf16 v[188:191], a[148:151], a[84:87], 0
    ds_read_b64_tr_b16 a[172:173], v9 offset:1024
    s_waitcnt vmcnt(18)
    v_mfma_f32_16x16x32_bf16 v[188:191], a[152:155], a[100:103], v[188:191]
    v_add_u32 v8, 40960, v8
    ds_read_b128 a[128:131], v252 offset:6144
    v_mfma_f32_16x16x32_bf16 v[192:195], a[148:151], a[88:91], 0
    ds_read_b64_tr_b16 a[174:175], v9 offset:1280
    v_add_f32 v15, v15, v2
    v_mfma_f32_16x16x32_bf16 v[192:195], a[152:155], a[104:107], v[192:195]
    v_add_f32 v3, v3, v2
    v_mfma_f32_16x16x32_bf16 v[196:199], a[148:151], a[92:95], 0
    ds_read_b64_tr_b16 a[176:177], v9 offset:5120
    ds_read_b128 a[144:147], v253 offset:6144
    v_mfma_f32_16x16x32_bf16 v[196:199], a[152:155], a[108:111], v[196:199]
    v_fmac_f32 v1, v15, v15
    v_fmac_f32 v14, v3, v3
    v_mfma_f32_16x16x32_bf16 v[200:203], a[148:151], a[96:99], 0
    ds_read_b64_tr_b16 a[178:179], v9 offset:5376
    v_mfma_f32_16x16x32_bf16 v[200:203], a[152:155], a[112:115], v[200:203]
    s_waitcnt lgkmcnt(12)
    v_mfma_f32_16x16x32_bf16 v[204:207], a[156:159], a[84:87], 0
    v_accvgpr_read_b32 v3, a226
    v_lshlrev_b32 v15, 16, v3
    v_mfma_f32_16x16x32_bf16 v[204:207], a[160:163], a[100:103], v[204:207]
    v_add_u32 v9, 40960, v9
    v_and_b32 v3, 0xffff0000, v3
    v_mfma_f32_16x16x32_bf16 v[208:211], a[156:159], a[88:91], 0
    v_mfma_f32_16x16x32_bf16 v[208:211], a[160:163], a[104:107], v[208:211]
    v_mfma_f32_16x16x32_bf16 v[212:215], a[156:159], a[92:95], 0
    s_add_u32 m0, s58, 81920
    v_add_f32 v15, v15, v2
    v_mfma_f32_16x16x32_bf16 v[212:215], a[160:163], a[108:111], v[212:215]
    v_add_f32 v3, v3, v2
    v_mfma_f32_16x16x32_bf16 v[216:219], a[156:159], a[96:99], 0
    v_mfma_f32_16x16x32_bf16 v[216:219], a[160:163], a[112:115], v[216:219]
    s_waitcnt vmcnt(8) lgkmcnt(0)
    s_barrier
    v_mfma_f32_16x16x32_bf16 v[220:223], a[164:167], a[84:87], 0
    ds_read_b64_tr_b16 a[148:149], v4 offset:0
    v_mfma_f32_16x16x32_bf16 v[220:223], a[168:171], a[100:103], v[220:223]
    ds_read_b64_tr_b16 a[150:151], v4 offset:512
    buffer_load_dwordx4 v10, s[24:27], s62 offen offset:0 lds
    v_mfma_f32_16x16x32_bf16 v[224:227], a[164:167], a[88:91], 0
    ds_read_b64_tr_b16 a[152:153], v4 offset:4096
    v_fmac_f32 v1, v15, v15
    v_mfma_f32_16x16x32_bf16 v[224:227], a[168:171], a[104:107], v[224:227]
    ds_read_b64_tr_b16 a[154:155], v4 offset:4608
    v_fmac_f32 v14, v3, v3
    v_mfma_f32_16x16x32_bf16 v[228:231], a[164:167], a[92:95], 0
    ds_read_b64_tr_b16 a[156:157], v5 offset:0
    buffer_load_dwordx4 v11, s[24:27], s63 offen offset:1024 lds
    v_mfma_f32_16x16x32_bf16 v[228:231], a[168:171], a[108:111], v[228:231]
    ds_read_b64_tr_b16 a[158:159], v5 offset:512
    v_accvgpr_read_b32 v3, a227
    v_mfma_f32_16x16x32_bf16 v[232:235], a[164:167], a[96:99], 0
    ds_read_b64_tr_b16 a[160:161], v5 offset:4096
    v_lshlrev_b32 v15, 16, v3
    v_mfma_f32_16x16x32_bf16 v[232:235], a[168:171], a[112:115], v[232:235]
    ds_read_b64_tr_b16 a[162:163], v5 offset:4608
    v_mfma_f32_16x16x32_bf16 v[236:239], a[172:175], a[84:87], 0
    ds_read_b64_tr_b16 a[164:165], v6 offset:0
    buffer_load_dwordx4 v10, s[24:27], s64 offen offset:2048 lds
    v_mfma_f32_16x16x32_bf16 v[236:239], a[176:179], a[100:103], v[236:239]
    v_and_b32 v3, 0xffff0000, v3
    v_add_f32 v15, v15, v2
    v_mfma_f32_16x16x32_bf16 v[240:243], a[172:175], a[88:91], 0
    ds_read_b64_tr_b16 a[166:167], v6 offset:512
    v_mfma_f32_16x16x32_bf16 v[240:243], a[176:179], a[104:107], v[240:243]
    v_mfma_f32_16x16x32_bf16 v[244:247], a[172:175], a[92:95], 0
    ds_read_b64_tr_b16 a[168:169], v6 offset:4096
    buffer_load_dwordx4 v11, s[24:27], s65 offen offset:3072 lds
    v_mfma_f32_16x16x32_bf16 v[244:247], a[176:179], a[108:111], v[244:247]
    v_add_f32 v3, v3, v2
    v_fmac_f32 v1, v15, v15
    v_mfma_f32_16x16x32_bf16 v[248:251], a[172:175], a[96:99], 0
    ds_read_b64_tr_b16 a[170:171], v6 offset:4608
    v_mfma_f32_16x16x32_bf16 v[248:251], a[176:179], a[112:115], v[248:251]
    s_waitcnt lgkmcnt(8)
    v_mfma_f32_16x16x32_bf16 v[16:19], a[148:151], a[116:119], v[16:19]
    ds_read_b64_tr_b16 a[172:173], v7 offset:0
    s_add_u32 m0, s58, 86016
    v_mfma_f32_16x16x32_bf16 v[16:19], a[152:155], a[132:135], v[16:19]
    buffer_load_dwordx4 v10, s[24:27], s66 offen offset:0 lds
    v_fmac_f32 v14, v3, v3
    v_mfma_f32_16x16x32_bf16 v[20:23], a[148:151], a[120:123], v[20:23]
    ds_read_b64_tr_b16 a[174:175], v7 offset:512
    v_accvgpr_read_b32 v3, a228
    v_mfma_f32_16x16x32_bf16 v[20:23], a[152:155], a[136:139], v[20:23]
    v_mfma_f32_16x16x32_bf16 v[24:27], a[148:151], a[124:127], v[24:27]
    ds_read_b64_tr_b16 a[176:177], v7 offset:4096
    buffer_load_dwordx4 v11, s[24:27], s67 offen offset:1024 lds
    v_mfma_f32_16x16x32_bf16 v[24:27], a[152:155], a[140:143], v[24:27]
    v_lshlrev_b32 v15, 16, v3
    v_and_b32 v3, 0xffff0000, v3
    v_mfma_f32_16x16x32_bf16 a[0:3], a[148:151], a[128:131], a[0:3]
    ds_read_b64_tr_b16 a[178:179], v7 offset:4608
    v_mfma_f32_16x16x32_bf16 a[0:3], a[152:155], a[144:147], a[0:3]
    s_waitcnt lgkmcnt(8)
    v_mfma_f32_16x16x32_bf16 v[28:31], a[156:159], a[116:119], v[28:31]
    ds_read_b64_tr_b16 a[148:149], v4 offset:8192
    buffer_load_dwordx4 v10, s[24:27], s68 offen offset:2048 lds
    v_mfma_f32_16x16x32_bf16 v[28:31], a[160:163], a[132:135], v[28:31]
    v_add_f32 v15, v15, v2
    v_add_f32 v3, v3, v2
    v_mfma_f32_16x16x32_bf16 v[32:35], a[156:159], a[120:123], v[32:35]
    ds_read_b64_tr_b16 a[150:151], v4 offset:8704
    v_mfma_f32_16x16x32_bf16 v[32:35], a[160:163], a[136:139], v[32:35]
    v_mfma_f32_16x16x32_bf16 v[36:39], a[156:159], a[124:127], v[36:39]
    ds_read_b64_tr_b16 a[152:153], v4 offset:12288
    buffer_load_dwordx4 v11, s[24:27], s69 offen offset:3072 lds
    v_mfma_f32_16x16x32_bf16 v[36:39], a[160:163], a[140:143], v[36:39]
    s_add_u32 m0, s59, 81920
    v_fmac_f32 v1, v15, v15
    v_mfma_f32_16x16x32_bf16 a[4:7], a[156:159], a[128:131], a[4:7]
    ds_read_b64_tr_b16 a[154:155], v4 offset:12800
    v_fmac_f32 v14, v3, v3
    v_mfma_f32_16x16x32_bf16 a[4:7], a[160:163], a[144:147], a[4:7]
    s_waitcnt lgkmcnt(8)
    v_mfma_f32_16x16x32_bf16 v[40:43], a[164:167], a[116:119], v[40:43]
    ds_read_b64_tr_b16 a[156:157], v5 offset:8192
    buffer_load_dwordx4 v12, s[28:31], s52 offen lds
    v_mfma_f32_16x16x32_bf16 v[40:43], a[168:171], a[132:135], v[40:43]
    s_add_u32 m0, s59, 82944
    s_waitcnt vmcnt(15)
    v_mfma_f32_16x16x32_bf16 v[44:47], a[164:167], a[120:123], v[44:47]
    ds_read_b64_tr_b16 a[158:159], v5 offset:8704
    ds_read_b128 a[84:87], v252 offset:40960
    v_mfma_f32_16x16x32_bf16 v[44:47], a[168:171], a[136:139], v[44:47]
    v_accvgpr_read_b32 v3, a229
    v_lshlrev_b32 v15, 16, v3
    v_mfma_f32_16x16x32_bf16 v[48:51], a[164:167], a[124:127], v[48:51]
    ds_read_b64_tr_b16 a[160:161], v5 offset:12288
    buffer_load_dwordx4 v12, s[32:35], s53 offen lds
    v_mfma_f32_16x16x32_bf16 v[48:51], a[168:171], a[140:143], v[48:51]
    s_cmp_le_u32 s51, 3
    s_cselect_b32 s82, 5, 3
    v_mfma_f32_16x16x32_bf16 a[8:11], a[164:167], a[128:131], a[8:11]
    ds_read_b64_tr_b16 a[162:163], v5 offset:12800
    s_sub_i32 s54, s82, s48
    v_mfma_f32_16x16x32_bf16 a[8:11], a[168:171], a[144:147], a[8:11]
    s_mov_b32 s48, s82
    s_waitcnt lgkmcnt(9)
    v_mfma_f32_16x16x32_bf16 v[52:55], a[172:175], a[116:119], v[52:55]
    ds_read_b64_tr_b16 a[164:165], v6 offset:8192
    s_mul_i32 s82, s54, s56
    v_mfma_f32_16x16x32_bf16 v[52:55], a[176:179], a[132:135], v[52:55]
    s_mul_i32 s83, s54, s57
    v_add_u32 v10, s82, v10
    v_mfma_f32_16x16x32_bf16 v[56:59], a[172:175], a[120:123], v[56:59]
    ds_read_b64_tr_b16 a[166:167], v6 offset:8704
    v_add_u32 v11, s82, v11
    v_mfma_f32_16x16x32_bf16 v[56:59], a[176:179], a[136:139], v[56:59]
    v_add_u32 v12, s83, v12
    ds_read_b128 a[100:103], v253 offset:40960
    v_mfma_f32_16x16x32_bf16 v[60:63], a[172:175], a[124:127], v[60:63]
    ds_read_b64_tr_b16 a[168:169], v6 offset:12288
    v_and_b32 v3, 0xffff0000, v3
    v_mfma_f32_16x16x32_bf16 v[60:63], a[176:179], a[140:143], v[60:63]
    v_add_f32 v15, v15, v2
    s_waitcnt vmcnt(14)
    v_mfma_f32_16x16x32_bf16 a[12:15], a[172:175], a[128:131], a[12:15]
    ds_read_b64_tr_b16 a[170:171], v6 offset:12800
    ds_read_b128 a[88:91], v252 offset:43008
    v_mfma_f32_16x16x32_bf16 a[12:15], a[176:179], a[144:147], a[12:15]
    v_add_f32 v3, v3, v2
    s_waitcnt lgkmcnt(11)
    v_mfma_f32_16x16x32_bf16 v[64:67], a[148:151], a[116:119], v[64:67]
    ds_read_b64_tr_b16 a[172:173], v7 offset:8192
    v_fmac_f32 v1, v15, v15
    v_mfma_f32_16x16x32_bf16 v[64:67], a[152:155], a[132:135], v[64:67]
    ds_read_b128 a[104:107], v253 offset:43008
    v_fmac_f32 v14, v3, v3
    v_mfma_f32_16x16x32_bf16 v[68:71], a[148:151], a[120:123], v[68:71]
    ds_read_b64_tr_b16 a[174:175], v7 offset:8704
    v_accvgpr_read_b32 v3, a230
    v_mfma_f32_16x16x32_bf16 v[68:71], a[152:155], a[136:139], v[68:71]
    s_waitcnt vmcnt(12)
    ds_read_b128 a[92:95], v252 offset:45056
    v_mfma_f32_16x16x32_bf16 v[72:75], a[148:151], a[124:127], v[72:75]
    ds_read_b64_tr_b16 a[176:177], v7 offset:12288
    v_lshlrev_b32 v15, 16, v3
    v_mfma_f32_16x16x32_bf16 v[72:75], a[152:155], a[140:143], v[72:75]
    v_and_b32 v3, 0xffff0000, v3
    ds_read_b128 a[108:111], v253 offset:45056
    v_mfma_f32_16x16x32_bf16 a[16:19], a[148:151], a[128:131], a[16:19]
    ds_read_b64_tr_b16 a[178:179], v7 offset:12800
    v_add_f32 v15, v15, v2
    v_mfma_f32_16x16x32_bf16 a[16:19], a[152:155], a[144:147], a[16:19]
    v_add_f32 v3, v3, v2
    s_waitcnt lgkmcnt(13)
    v_mfma_f32_16x16x32_bf16 v[76:79], a[156:159], a[116:119], v[76:79]
    ds_read_b64_tr_b16 a[148:149], v4 offset:16384
    s_waitcnt vmcnt(10)
    v_mfma_f32_16x16x32_bf16 v[76:79], a[160:163], a[132:135], v[76:79]
    ds_read_b128 a[96:99], v252 offset:47104
    v_fmac_f32 v1, v15, v15
    v_mfma_f32_16x16x32_bf16 v[80:83], a[156:159], a[120:123], v[80:83]
    ds_read_b64_tr_b16 a[150:151], v4 offset:16896
    v_fmac_f32 v14, v3, v3
    v_mfma_f32_16x16x32_bf16 v[80:83], a[160:163], a[136:139], v[80:83]
    v_accvgpr_read_b32 v3, a231
    v_mfma_f32_16x16x32_bf16 a[64:67], a[156:159], a[124:127], a[64:67]
    ds_read_b64_tr_b16 a[152:153], v4 offset:20480
    ds_read_b128 a[112:115], v253 offset:47104
    v_mfma_f32_16x16x32_bf16 a[64:67], a[160:163], a[140:143], a[64:67]
    v_lshlrev_b32 v15, 16, v3
    v_and_b32 v3, 0xffff0000, v3
    v_mfma_f32_16x16x32_bf16 a[20:23], a[156:159], a[128:131], a[20:23]
    ds_read_b64_tr_b16 a[154:155], v4 offset:20992
    v_mfma_f32_16x16x32_bf16 a[20:23], a[160:163], a[144:147], a[20:23]
    s_waitcnt lgkmcnt(14)
    v_mfma_f32_16x16x32_bf16 v[84:87], a[164:167], a[116:119], v[84:87]
    ds_read_b64_tr_b16 a[156:157], v5 offset:16384
    s_add_u32 m0, s58, 122880
    v_mfma_f32_16x16x32_bf16 v[84:87], a[168:171], a[132:135], v[84:87]
    v_add_f32 v15, v15, v2
    v_add_f32 v3, v3, v2
    v_mfma_f32_16x16x32_bf16 v[88:91], a[164:167], a[120:123], v[88:91]
    ds_read_b64_tr_b16 a[158:159], v5 offset:16896
    v_mfma_f32_16x16x32_bf16 v[88:91], a[168:171], a[136:139], v[88:91]
    v_mfma_f32_16x16x32_bf16 v[92:95], a[164:167], a[124:127], v[92:95]
    ds_read_b64_tr_b16 a[160:161], v5 offset:20480
    buffer_load_dwordx4 v13, s[20:23], s40 offen offset:0 lds
    v_mfma_f32_16x16x32_bf16 v[92:95], a[168:171], a[140:143], v[92:95]
    v_fmac_f32 v1, v15, v15
    v_fmac_f32 v14, v3, v3
    v_mfma_f32_16x16x32_bf16 a[24:27], a[164:167], a[128:131], a[24:27]
    ds_read_b64_tr_b16 a[162:163], v5 offset:20992
    v_mfma_f32_16x16x32_bf16 a[24:27], a[168:171], a[144:147], a[24:27]
    s_waitcnt lgkmcnt(10)
    v_mfma_f32_16x16x32_bf16 v[96:99], a[172:175], a[116:119], v[96:99]
    ds_read_b64_tr_b16 a[164:165], v6 offset:16384
    buffer_load_dwordx4 v13, s[20:23], s41 offen offset:1024 lds
    v_mfma_f32_16x16x32_bf16 v[96:99], a[176:179], a[132:135], v[96:99]
    v_accvgpr_read_b32 v3, a232
    v_lshlrev_b32 v15, 16, v3
    v_mfma_f32_16x16x32_bf16 v[100:103], a[172:175], a[120:123], v[100:103]
    ds_read_b64_tr_b16 a[166:167], v6 offset:16896
    v_mfma_f32_16x16x32_bf16 v[100:103], a[176:179], a[136:139], v[100:103]
    v_mfma_f32_16x16x32_bf16 a[68:71], a[172:175], a[124:127], a[68:71]
    ds_read_b64_tr_b16 a[168:169], v6 offset:20480
    buffer_load_dwordx4 v13, s[20:23], s42 offen offset:2048 lds
    v_mfma_f32_16x16x32_bf16 a[68:71], a[176:179], a[140:143], a[68:71]
    v_and_b32 v3, 0xffff0000, v3
    v_add_f32 v15, v15, v2
    v_mfma_f32_16x16x32_bf16 a[28:31], a[172:175], a[128:131], a[28:31]
    ds_read_b64_tr_b16 a[170:171], v6 offset:20992
    v_mfma_f32_16x16x32_bf16 a[28:31], a[176:179], a[144:147], a[28:31]
    s_waitcnt lgkmcnt(8)
    v_mfma_f32_16x16x32_bf16 v[104:107], a[148:151], a[116:119], v[104:107]
    ds_read_b64_tr_b16 a[172:173], v7 offset:16384
    buffer_load_dwordx4 v13, s[20:23], s43 offen offset:3072 lds
    v_mfma_f32_16x16x32_bf16 v[104:107], a[152:155], a[132:135], v[104:107]
    s_add_u32 m0, s58, 126976
    v_add_f32 v3, v3, v2
    v_mfma_f32_16x16x32_bf16 v[108:111], a[148:151], a[120:123], v[108:111]
    ds_read_b64_tr_b16 a[174:175], v7 offset:16896
    v_fmac_f32 v1, v15, v15
    v_mfma_f32_16x16x32_bf16 v[108:111], a[152:155], a[136:139], v[108:111]
    v_mfma_f32_16x16x32_bf16 v[112:115], a[148:151], a[124:127], v[112:115]
    ds_read_b64_tr_b16 a[176:177], v7 offset:20480
    buffer_load_dwordx4 v13, s[20:23], s84 offen offset:0 lds
    v_mfma_f32_16x16x32_bf16 v[112:115], a[152:155], a[140:143], v[112:115]
    v_fmac_f32 v14, v3, v3
    v_accvgpr_read_b32 v3, a233
    v_mfma_f32_16x16x32_bf16 a[32:35], a[148:151], a[128:131], a[32:35]
    ds_read_b64_tr_b16 a[178:179], v7 offset:20992
    v_mfma_f32_16x16x32_bf16 a[32:35], a[152:155], a[144:147], a[32:35]
    s_waitcnt lgkmcnt(8)
    v_mfma_f32_16x16x32_bf16 v[116:119], a[156:159], a[116:119], v[116:119]
    ds_read_b64_tr_b16 a[148:149], v4 offset:24576
    buffer_load_dwordx4 v13, s[20:23], s85 offen offset:1024 lds
    v_mfma_f32_16x16x32_bf16 v[116:119], a[160:163], a[132:135], v[116:119]
    v_lshlrev_b32 v15, 16, v3
    v_and_b32 v3, 0xffff0000, v3
    v_mfma_f32_16x16x32_bf16 v[120:123], a[156:159], a[120:123], v[120:123]
    ds_read_b64_tr_b16 a[150:151], v4 offset:25088
    v_mfma_f32_16x16x32_bf16 v[120:123], a[160:163], a[136:139], v[120:123]
    v_mfma_f32_16x16x32_bf16 v[124:127], a[156:159], a[124:127], v[124:127]
    ds_read_b64_tr_b16 a[152:153], v4 offset:28672
    buffer_load_dwordx4 v13, s[20:23], s86 offen offset:2048 lds
    v_mfma_f32_16x16x32_bf16 v[124:127], a[160:163], a[140:143], v[124:127]
    v_add_f32 v15, v15, v2
    v_add_f32 v3, v3, v2
    v_mfma_f32_16x16x32_bf16 a[36:39], a[156:159], a[128:131], a[36:39]
    ds_read_b64_tr_b16 a[154:155], v4 offset:29184
    v_mfma_f32_16x16x32_bf16 a[36:39], a[160:163], a[144:147], a[36:39]
    s_waitcnt lgkmcnt(8)
    v_mfma_f32_16x16x32_bf16 v[128:131], a[164:167], a[116:119], v[128:131]
    ds_read_b64_tr_b16 a[156:157], v5 offset:24576
    buffer_load_dwordx4 v13, s[20:23], s87 offen offset:3072 lds
    v_mfma_f32_16x16x32_bf16 v[128:131], a[168:171], a[132:135], v[128:131]
    v_add_u32 v4, 40960, v4
    s_mov_b32 s82, s51
    v_mfma_f32_16x16x32_bf16 v[132:135], a[164:167], a[120:123], v[132:135]
    ds_read_b64_tr_b16 a[158:159], v5 offset:25088
    s_sub_i32 s54, s82, s49
    v_mfma_f32_16x16x32_bf16 v[132:135], a[168:171], a[136:139], v[132:135]
    s_mov_b32 s49, s82
    s_lshl_b32 s82, s54, 7
    v_mfma_f32_16x16x32_bf16 v[136:139], a[164:167], a[124:127], v[136:139]
    ds_read_b64_tr_b16 a[160:161], v5 offset:28672
    v_add_u32 v13, s82, v13
    v_mfma_f32_16x16x32_bf16 v[136:139], a[168:171], a[140:143], v[136:139]
    v_fmac_f32 v1, v15, v15
    v_fmac_f32 v14, v3, v3
    v_mfma_f32_16x16x32_bf16 a[40:43], a[164:167], a[128:131], a[40:43]
    ds_read_b64_tr_b16 a[162:163], v5 offset:29184
    s_add_u32 m0, s58, 0
    v_mfma_f32_16x16x32_bf16 a[40:43], a[168:171], a[144:147], a[40:43]
    v_accvgpr_read_b32 v3, a234
    s_waitcnt lgkmcnt(8)
    v_mfma_f32_16x16x32_bf16 v[140:143], a[172:175], a[116:119], v[140:143]
    ds_read_b64_tr_b16 a[164:165], v6 offset:24576
    v_lshlrev_b32 v15, 16, v3
    v_mfma_f32_16x16x32_bf16 v[140:143], a[176:179], a[132:135], v[140:143]
    v_add_u32 v5, 40960, v5
    buffer_load_dwordx4 v10, s[24:27], s62 offen offset:0 lds
    v_mfma_f32_16x16x32_bf16 v[144:147], a[172:175], a[120:123], v[144:147]
    ds_read_b64_tr_b16 a[166:167], v6 offset:25088
    v_and_b32 v3, 0xffff0000, v3
    v_mfma_f32_16x16x32_bf16 v[144:147], a[176:179], a[136:139], v[144:147]
    v_add_f32 v15, v15, v2
    v_mfma_f32_16x16x32_bf16 a[80:83], a[172:175], a[124:127], a[80:83]
    ds_read_b64_tr_b16 a[168:169], v6 offset:28672
    v_add_f32 v3, v3, v2
    v_mfma_f32_16x16x32_bf16 a[80:83], a[176:179], a[140:143], a[80:83]
    v_fmac_f32 v1, v15, v15
    v_mfma_f32_16x16x32_bf16 a[44:47], a[172:175], a[128:131], a[44:47]
    ds_read_b64_tr_b16 a[170:171], v6 offset:29184
    v_mfma_f32_16x16x32_bf16 a[44:47], a[176:179], a[144:147], a[44:47]
    s_waitcnt lgkmcnt(8)
    v_mfma_f32_16x16x32_bf16 v[148:151], a[148:151], a[116:119], v[148:151]
    ds_read_b64_tr_b16 a[172:173], v7 offset:24576
    buffer_load_dwordx4 v11, s[24:27], s63 offen offset:1024 lds
    v_mfma_f32_16x16x32_bf16 v[148:151], a[152:155], a[132:135], v[148:151]
    v_add_u32 v6, 40960, v6
    v_fmac_f32 v14, v3, v3
    v_mfma_f32_16x16x32_bf16 v[152:155], a[148:151], a[120:123], v[152:155]
    ds_read_b64_tr_b16 a[174:175], v7 offset:25088
    v_accvgpr_read_b32 v3, a235
    v_mfma_f32_16x16x32_bf16 v[152:155], a[152:155], a[136:139], v[152:155]
    v_mfma_f32_16x16x32_bf16 v[156:159], a[148:151], a[124:127], v[156:159]
    ds_read_b64_tr_b16 a[176:177], v7 offset:28672
    v_lshlrev_b32 v15, 16, v3
    v_mfma_f32_16x16x32_bf16 v[156:159], a[152:155], a[140:143], v[156:159]
    v_and_b32 v3, 0xffff0000, v3
    v_add_f32 v15, v15, v2
    v_mfma_f32_16x16x32_bf16 a[48:51], a[148:151], a[128:131], a[48:51]
    ds_read_b64_tr_b16 a[178:179], v7 offset:29184
    v_mfma_f32_16x16x32_bf16 a[48:51], a[152:155], a[144:147], a[48:51]
    s_waitcnt lgkmcnt(8)
    v_mfma_f32_16x16x32_bf16 v[160:163], a[156:159], a[116:119], v[160:163]
    ds_read_b64_tr_b16 a[148:149], v8 offset:0
    buffer_load_dwordx4 v10, s[24:27], s64 offen offset:2048 lds
    v_mfma_f32_16x16x32_bf16 v[160:163], a[160:163], a[132:135], v[160:163]
    v_add_u32 v7, 40960, v7
    v_add_f32 v3, v3, v2
    v_mfma_f32_16x16x32_bf16 v[164:167], a[156:159], a[120:123], v[164:167]
    ds_read_b64_tr_b16 a[150:151], v8 offset:256
    v_fmac_f32 v1, v15, v15
    v_mfma_f32_16x16x32_bf16 v[164:167], a[160:163], a[136:139], v[164:167]
    v_mfma_f32_16x16x32_bf16 a[72:75], a[156:159], a[124:127], a[72:75]
    ds_read_b64_tr_b16 a[152:153], v8 offset:4096
    v_fmac_f32 v14, v3, v3
    v_mfma_f32_16x16x32_bf16 a[72:75], a[160:163], a[140:143], a[72:75]
    v_accvgpr_read_b32 v3, a236
    v_mfma_f32_16x16x32_bf16 a[52:55], a[156:159], a[128:131], a[52:55]
    ds_read_b64_tr_b16 a[154:155], v8 offset:4352
    v_mfma_f32_16x16x32_bf16 a[52:55], a[160:163], a[144:147], a[52:55]
    s_waitcnt lgkmcnt(8)
    v_mfma_f32_16x16x32_bf16 v[168:171], a[164:167], a[116:119], v[168:171]
    ds_read_b64_tr_b16 a[156:157], v9 offset:0
    buffer_load_dwordx4 v11, s[24:27], s65 offen offset:3072 lds
    v_mfma_f32_16x16x32_bf16 v[168:171], a[168:171], a[132:135], v[168:171]
    v_lshlrev_b32 v15, 16, v3
    v_and_b32 v3, 0xffff0000, v3
    v_mfma_f32_16x16x32_bf16 v[172:175], a[164:167], a[120:123], v[172:175]
    ds_read_b64_tr_b16 a[158:159], v9 offset:256
    v_mfma_f32_16x16x32_bf16 v[172:175], a[168:171], a[136:139], v[172:175]
    v_mfma_f32_16x16x32_bf16 v[176:179], a[164:167], a[124:127], v[176:179]
    ds_read_b64_tr_b16 a[160:161], v9 offset:4096
    s_add_u32 m0, s58, 4096
    v_mfma_f32_16x16x32_bf16 v[176:179], a[168:171], a[140:143], v[176:179]
    v_add_f32 v15, v15, v2
    v_add_f32 v3, v3, v2
    v_mfma_f32_16x16x32_bf16 a[56:59], a[164:167], a[128:131], a[56:59]
    ds_read_b64_tr_b16 a[162:163], v9 offset:4352
    v_mfma_f32_16x16x32_bf16 a[56:59], a[168:171], a[144:147], a[56:59]
    s_waitcnt lgkmcnt(8)
    v_mfma_f32_16x16x32_bf16 v[180:183], a[172:175], a[116:119], v[180:183]
    ds_read_b64_tr_b16 a[164:165], v8 offset:1024
    buffer_load_dwordx4 v10, s[24:27], s66 offen offset:0 lds
    v_mfma_f32_16x16x32_bf16 v[180:183], a[176:179], a[132:135], v[180:183]
    v_fmac_f32 v1, v15, v15
    v_fmac_f32 v14, v3, v3
    v_mfma_f32_16x16x32_bf16 v[184:187], a[172:175], a[120:123], v[184:187]
    ds_read_b64_tr_b16 a[166:167], v8 offset:1280
    v_mfma_f32_16x16x32_bf16 v[184:187], a[176:179], a[136:139], v[184:187]
    v_mfma_f32_16x16x32_bf16 a[76:79], a[172:175], a[124:127], a[76:79]
    ds_read_b64_tr_b16 a[168:169], v8 offset:5120
    v_accvgpr_read_b32 v3, a237
    v_mfma_f32_16x16x32_bf16 a[76:79], a[176:179], a[140:143], a[76:79]
    v_lshlrev_b32 v15, 16, v3
    v_mfma_f32_16x16x32_bf16 a[60:63], a[172:175], a[128:131], a[60:63]
    ds_read_b64_tr_b16 a[170:171], v8 offset:5376
    v_mfma_f32_16x16x32_bf16 a[60:63], a[176:179], a[144:147], a[60:63]
    s_waitcnt lgkmcnt(8)
    v_mfma_f32_16x16x32_bf16 v[188:191], a[148:151], a[116:119], v[188:191]
    ds_read_b64_tr_b16 a[172:173], v9 offset:1024
    buffer_load_dwordx4 v11, s[24:27], s67 offen offset:1024 lds
    v_mfma_f32_16x16x32_bf16 v[188:191], a[152:155], a[132:135], v[188:191]
    v_add_u32 v8, 40960, v8
    v_and_b32 v3, 0xffff0000, v3
    v_mfma_f32_16x16x32_bf16 v[192:195], a[148:151], a[120:123], v[192:195]
    ds_read_b64_tr_b16 a[174:175], v9 offset:1280
    v_add_f32 v15, v15, v2
    v_mfma_f32_16x16x32_bf16 v[192:195], a[152:155], a[136:139], v[192:195]
    v_mfma_f32_16x16x32_bf16 v[196:199], a[148:151], a[124:127], v[196:199]
    ds_read_b64_tr_b16 a[176:177], v9 offset:5120
    v_add_f32 v3, v3, v2
    v_mfma_f32_16x16x32_bf16 v[196:199], a[152:155], a[140:143], v[196:199]
    v_fmac_f32 v1, v15, v15
    v_mfma_f32_16x16x32_bf16 v[200:203], a[148:151], a[128:131], v[200:203]
    ds_read_b64_tr_b16 a[178:179], v9 offset:5376
    v_mfma_f32_16x16x32_bf16 v[200:203], a[152:155], a[144:147], v[200:203]
    s_waitcnt lgkmcnt(8)
    v_mfma_f32_16x16x32_bf16 v[204:207], a[156:159], a[116:119], v[204:207]
    buffer_load_dwordx4 v10, s[24:27], s68 offen offset:2048 lds
    v_fmac_f32 v14, v3, v3
    v_mfma_f32_16x16x32_bf16 v[204:207], a[160:163], a[132:135], v[204:207]
    v_add_u32 v9, 40960, v9
    v_accvgpr_read_b32 v3, a238
    v_mfma_f32_16x16x32_bf16 v[208:211], a[156:159], a[120:123], v[208:211]
    v_mfma_f32_16x16x32_bf16 v[208:211], a[160:163], a[136:139], v[208:211]
    v_mfma_f32_16x16x32_bf16 v[212:215], a[156:159], a[124:127], v[212:215]
    v_lshlrev_b32 v15, 16, v3
    v_and_b32 v3, 0xffff0000, v3
    v_mfma_f32_16x16x32_bf16 v[212:215], a[160:163], a[140:143], v[212:215]
    v_mfma_f32_16x16x32_bf16 v[216:219], a[156:159], a[128:131], v[216:219]
    v_mfma_f32_16x16x32_bf16 v[216:219], a[160:163], a[144:147], v[216:219]
    s_waitcnt vmcnt(15) lgkmcnt(0)
    s_barrier
    v_mfma_f32_16x16x32_bf16 v[220:223], a[164:167], a[116:119], v[220:223]
    ds_read_b64_tr_b16 a[148:149], v4 offset:0
    buffer_load_dwordx4 v11, s[24:27], s69 offen offset:3072 lds
    v_mfma_f32_16x16x32_bf16 v[220:223], a[168:171], a[132:135], v[220:223]
    ds_read_b64_tr_b16 a[150:151], v4 offset:512
    v_add_f32 v15, v15, v2
    v_mfma_f32_16x16x32_bf16 v[224:227], a[164:167], a[120:123], v[224:227]
    ds_read_b64_tr_b16 a[152:153], v4 offset:4096
    v_add_f32 v3, v3, v2
    v_mfma_f32_16x16x32_bf16 v[224:227], a[168:171], a[136:139], v[224:227]
    ds_read_b64_tr_b16 a[154:155], v4 offset:4608
    v_mfma_f32_16x16x32_bf16 v[228:231], a[164:167], a[124:127], v[228:231]
    ds_read_b64_tr_b16 a[156:157], v5 offset:0
    s_add_u32 m0, s59, 0
    v_mfma_f32_16x16x32_bf16 v[228:231], a[168:171], a[140:143], v[228:231]
    ds_read_b64_tr_b16 a[158:159], v5 offset:512
    v_fmac_f32 v1, v15, v15
    v_mfma_f32_16x16x32_bf16 v[232:235], a[164:167], a[128:131], v[232:235]
    ds_read_b64_tr_b16 a[160:161], v5 offset:4096
    v_fmac_f32 v14, v3, v3
    v_mfma_f32_16x16x32_bf16 v[232:235], a[168:171], a[144:147], v[232:235]
    ds_read_b64_tr_b16 a[162:163], v5 offset:4608
    v_mfma_f32_16x16x32_bf16 v[236:239], a[172:175], a[116:119], v[236:239]
    ds_read_b64_tr_b16 a[164:165], v6 offset:0
    buffer_load_dwordx4 v12, s[28:31], s52 offen lds
    v_mfma_f32_16x16x32_bf16 v[236:239], a[176:179], a[132:135], v[236:239]
    v_accvgpr_read_b32 v3, a239
    v_lshlrev_b32 v15, 16, v3
    v_mfma_f32_16x16x32_bf16 v[240:243], a[172:175], a[120:123], v[240:243]
    ds_read_b64_tr_b16 a[166:167], v6 offset:512
    v_mfma_f32_16x16x32_bf16 v[240:243], a[176:179], a[136:139], v[240:243]
    v_mfma_f32_16x16x32_bf16 v[244:247], a[172:175], a[124:127], v[244:247]
    ds_read_b64_tr_b16 a[168:169], v6 offset:4096
    v_and_b32 v3, 0xffff0000, v3
    v_mfma_f32_16x16x32_bf16 v[244:247], a[176:179], a[140:143], v[244:247]
    v_add_f32 v15, v15, v2
    v_mfma_f32_16x16x32_bf16 v[248:251], a[172:175], a[128:131], v[248:251]
    ds_read_b64_tr_b16 a[170:171], v6 offset:4608
    v_mfma_f32_16x16x32_bf16 v[248:251], a[176:179], a[144:147], v[248:251]
    s_waitcnt lgkmcnt(8)
    v_mfma_f32_16x16x32_bf16 v[16:19], a[148:151], a[84:87], v[16:19]
    ds_read_b64_tr_b16 a[172:173], v7 offset:0
    s_add_u32 m0, s59, 1024
    v_mfma_f32_16x16x32_bf16 v[16:19], a[152:155], a[100:103], v[16:19]
    buffer_load_dwordx4 v12, s[32:35], s53 offen lds
    s_mov_b32 s82, s51
    v_mfma_f32_16x16x32_bf16 v[20:23], a[148:151], a[88:91], v[20:23]
    ds_read_b64_tr_b16 a[174:175], v7 offset:512
    s_sub_i32 s54, s82, s48
    v_mfma_f32_16x16x32_bf16 v[20:23], a[152:155], a[104:107], v[20:23]
    s_mov_b32 s48, s82
    s_mul_i32 s82, s54, s56
    v_mfma_f32_16x16x32_bf16 v[24:27], a[148:151], a[92:95], v[24:27]
    ds_read_b64_tr_b16 a[176:177], v7 offset:4096
    s_mul_i32 s83, s54, s57
    v_mfma_f32_16x16x32_bf16 v[24:27], a[152:155], a[108:111], v[24:27]
    v_add_u32 v10, s82, v10
    v_add_u32 v11, s82, v11
    v_mfma_f32_16x16x32_bf16 a[0:3], a[148:151], a[96:99], a[0:3]
    ds_read_b64_tr_b16 a[178:179], v7 offset:4608
    v_add_u32 v12, s83, v12
    v_mfma_f32_16x16x32_bf16 a[0:3], a[152:155], a[112:115], a[0:3]
    s_waitcnt vmcnt(16)
    s_waitcnt lgkmcnt(8)
    v_mfma_f32_16x16x32_bf16 v[28:31], a[156:159], a[84:87], v[28:31]
    ds_read_b64_tr_b16 a[148:149], v4 offset:8192
    ds_read_b128 a[116:119], v252 offset:40960
    v_mfma_f32_16x16x32_bf16 v[28:31], a[160:163], a[100:103], v[28:31]
    v_add_f32 v3, v3, v2
    v_fmac_f32 v1, v15, v15
    v_mfma_f32_16x16x32_bf16 v[32:35], a[156:159], a[88:91], v[32:35]
    ds_read_b64_tr_b16 a[150:151], v4 offset:8704
    v_fmac_f32 v14, v3, v3
    v_mfma_f32_16x16x32_bf16 v[32:35], a[160:163], a[104:107], v[32:35]
    ds_read_b128 a[132:135], v253 offset:40960
    v_add_f32 v1, v1, v14
    v_mfma_f32_16x16x32_bf16 v[36:39], a[156:159], a[92:95], v[36:39]
    ds_read_b64_tr_b16 a[152:153], v4 offset:12288
    s_nop 1
    v_mfma_f32_16x16x32_bf16 v[36:39], a[160:163], a[108:111], v[36:39]
    s_waitcnt vmcnt(14)
    ds_read_b128 a[120:123], v252 offset:43008
    v_mfma_f32_16x16x32_bf16 a[4:7], a[156:159], a[96:99], a[4:7]
    ds_read_b64_tr_b16 a[154:155], v4 offset:12800
    v_add_f32_dpp v1, v1, v1 row_ror:8 row_mask:0xf bank_mask:0xf
    v_mfma_f32_16x16x32_bf16 a[4:7], a[160:163], a[112:115], a[4:7]
    s_nop 1
    s_waitcnt lgkmcnt(11)
    v_mfma_f32_16x16x32_bf16 v[40:43], a[164:167], a[84:87], v[40:43]
    ds_read_b64_tr_b16 a[156:157], v5 offset:8192
    ds_read_b128 a[136:139], v253 offset:43008
    v_mfma_f32_16x16x32_bf16 v[40:43], a[168:171], a[100:103], v[40:43]
    v_add_f32_dpp v1, v1, v1 row_ror:4 row_mask:0xf bank_mask:0xf
    s_nop 1
    v_mfma_f32_16x16x32_bf16 v[44:47], a[164:167], a[88:91], v[44:47]
    ds_read_b64_tr_b16 a[158:159], v5 offset:8704
    s_waitcnt vmcnt(12)
    v_mfma_f32_16x16x32_bf16 v[44:47], a[168:171], a[104:107], v[44:47]
    ds_read_b128 a[124:127], v252 offset:45056
    v_add_f32_dpp v1, v1, v1 row_ror:2 row_mask:0xf bank_mask:0xf
    v_mfma_f32_16x16x32_bf16 v[48:51], a[164:167], a[92:95], v[48:51]
    ds_read_b64_tr_b16 a[160:161], v5 offset:12288
    s_nop 1
    v_mfma_f32_16x16x32_bf16 v[48:51], a[168:171], a[108:111], v[48:51]
    ds_read_b128 a[140:143], v253 offset:45056
    v_add_f32_dpp v1, v1, v1 row_ror:1 row_mask:0xf bank_mask:0xf
    v_mfma_f32_16x16x32_bf16 a[8:11], a[164:167], a[96:99], a[8:11]
    ds_read_b64_tr_b16 a[162:163], v5 offset:12800
    v_mov_b32 v3, v1
    v_mfma_f32_16x16x32_bf16 a[8:11], a[168:171], a[112:115], a[8:11]
    s_waitcnt lgkmcnt(14)
    v_mfma_f32_16x16x32_bf16 v[52:55], a[172:175], a[84:87], v[52:55]
    ds_read_b64_tr_b16 a[164:165], v6 offset:8192
    s_waitcnt vmcnt(10)
    v_mfma_f32_16x16x32_bf16 v[52:55], a[176:179], a[100:103], v[52:55]
    ds_read_b128 a[128:131], v252 offset:47104
    s_nop 1
    v_mfma_f32_16x16x32_bf16 v[56:59], a[172:175], a[88:91], v[56:59]
    ds_read_b64_tr_b16 a[166:167], v6 offset:8704
    v_permlane16_swap_b32 v3, v1
    v_mfma_f32_16x16x32_bf16 v[56:59], a[176:179], a[104:107], v[56:59]
    v_mfma_f32_16x16x32_bf16 v[60:63], a[172:175], a[92:95], v[60:63]
    ds_read_b64_tr_b16 a[168:169], v6 offset:12288
    ds_read_b128 a[144:147], v253 offset:47104
    v_mfma_f32_16x16x32_bf16 v[60:63], a[176:179], a[108:111], v[60:63]
    s_nop 1
    v_add_f32 v1, v1, v3
    v_mfma_f32_16x16x32_bf16 a[12:15], a[172:175], a[96:99], a[12:15]
    ds_read_b64_tr_b16 a[170:171], v6 offset:12800
    v_mfma_f32_16x16x32_bf16 a[12:15], a[176:179], a[112:115], a[12:15]
    s_waitcnt lgkmcnt(13)
    v_mfma_f32_16x16x32_bf16 v[64:67], a[148:151], a[84:87], v[64:67]
    ds_read_b64_tr_b16 a[172:173], v7 offset:8192
    s_add_u32 m0, s58, 122880
    v_mfma_f32_16x16x32_bf16 v[64:67], a[152:155], a[100:103], v[64:67]
    v_mov_b32 v3, 0x3727c5ac
    v_fmac_f32 v3, 0x3a800000, v1
    v_mfma_f32_16x16x32_bf16 v[68:71], a[148:151], a[88:91], v[68:71]
    ds_read_b64_tr_b16 a[174:175], v7 offset:8704
    v_mfma_f32_16x16x32_bf16 v[68:71], a[152:155], a[104:107], v[68:71]
    v_mfma_f32_16x16x32_bf16 v[72:75], a[148:151], a[92:95], v[72:75]
    ds_read_b64_tr_b16 a[176:177], v7 offset:12288
    buffer_load_dwordx4 v13, s[20:23], s40 offen offset:0 lds
    v_mfma_f32_16x16x32_bf16 v[72:75], a[152:155], a[108:111], v[72:75]
    v_rsq_f32 v14, v3
    s_lshl_b32 s16, s71, 8
    v_mfma_f32_16x16x32_bf16 a[16:19], a[148:151], a[96:99], a[16:19]
    ds_read_b64_tr_b16 a[178:179], v7 offset:12800
    s_lshl_b32 s17, s70, 3
    v_mfma_f32_16x16x32_bf16 a[16:19], a[152:155], a[112:115], a[16:19]
    s_add_u32 s16, s16, s17
    s_waitcnt lgkmcnt(10)
    v_mfma_f32_16x16x32_bf16 v[76:79], a[156:159], a[84:87], v[76:79]
    ds_read_b64_tr_b16 a[148:149], v4 offset:16384
    s_lshl_b32 s17, s50, 1
    v_mfma_f32_16x16x32_bf16 v[76:79], a[160:163], a[100:103], v[76:79]
    s_add_u32 s16, s16, s17
    v_lshrrev_b32 v1, 5, v0
    v_mfma_f32_16x16x32_bf16 v[80:83], a[156:159], a[88:91], v[80:83]
    ds_read_b64_tr_b16 a[150:151], v4 offset:16896
    v_add_u32 v1, s16, v1
    v_mfma_f32_16x16x32_bf16 v[80:83], a[160:163], a[104:107], v[80:83]
    buffer_load_dwordx4 v13, s[20:23], s41 offen offset:1024 lds
    v_lshlrev_b32 v15, 4, v1
    v_mfma_f32_16x16x32_bf16 a[64:67], a[156:159], a[92:95], a[64:67]
    ds_read_b64_tr_b16 a[152:153], v4 offset:20480
    v_add_u32 v15, 1048576, v15
    v_mfma_f32_16x16x32_bf16 a[64:67], a[160:163], a[108:111], a[64:67]
    buffer_load_dwordx4 v13, s[20:23], s42 offen offset:2048 lds
    v_lshlrev_b32 v1, 2, v1
    v_mfma_f32_16x16x32_bf16 a[20:23], a[156:159], a[96:99], a[20:23]
    ds_read_b64_tr_b16 a[154:155], v4 offset:20992
    v_add_u32 v1, 1114112, v1
    v_mfma_f32_16x16x32_bf16 a[20:23], a[160:163], a[112:115], a[20:23]
    s_waitcnt lgkmcnt(8)
    v_mfma_f32_16x16x32_bf16 v[84:87], a[164:167], a[84:87], v[84:87]
    ds_read_b64_tr_b16 a[156:157], v5 offset:16384
    buffer_load_dwordx4 v13, s[20:23], s43 offen offset:3072 lds
    v_mfma_f32_16x16x32_bf16 v[84:87], a[168:171], a[100:103], v[84:87]
    s_add_u32 m0, s58, 126976
    v_and_b32 v3, 31, v0
    v_mfma_f32_16x16x32_bf16 v[88:91], a[164:167], a[88:91], v[88:91]
    ds_read_b64_tr_b16 a[158:159], v5 offset:16896
    v_lshl_add_u32 v15, v3, 26, v15
    v_mfma_f32_16x16x32_bf16 v[88:91], a[168:171], a[104:107], v[88:91]
    v_mfma_f32_16x16x32_bf16 v[92:95], a[164:167], a[92:95], v[92:95]
    ds_read_b64_tr_b16 a[160:161], v5 offset:20480
    buffer_load_dwordx4 v13, s[20:23], s84 offen offset:0 lds
    v_mfma_f32_16x16x32_bf16 v[92:95], a[168:171], a[108:111], v[92:95]
    v_lshl_add_u32 v1, v3, 26, v1
    v_cvt_pk_bf16_f32 v3, v2, v2
    v_mfma_f32_16x16x32_bf16 a[24:27], a[164:167], a[96:99], a[24:27]
    ds_read_b64_tr_b16 a[162:163], v5 offset:20992
    v_mfma_f32_16x16x32_bf16 a[24:27], a[168:171], a[112:115], a[24:27]
    s_waitcnt lgkmcnt(8)
    v_mfma_f32_16x16x32_bf16 v[96:99], a[172:175], a[84:87], v[96:99]
    ds_read_b64_tr_b16 a[164:165], v6 offset:16384
    buffer_load_dwordx4 v13, s[20:23], s85 offen offset:1024 lds
    v_mfma_f32_16x16x32_bf16 v[96:99], a[176:179], a[100:103], v[96:99]
    v_and_b32 v3, 0xffff0000, v3
    v_sub_f32 v3, v2, v3
    v_mfma_f32_16x16x32_bf16 v[100:103], a[172:175], a[88:91], v[100:103]
    ds_read_b64_tr_b16 a[166:167], v6 offset:16896
    v_mfma_f32_16x16x32_bf16 v[100:103], a[176:179], a[104:107], v[100:103]
    v_mfma_f32_16x16x32_bf16 a[68:71], a[172:175], a[92:95], a[68:71]
    ds_read_b64_tr_b16 a[168:169], v6 offset:20480
    buffer_load_dwordx4 v13, s[20:23], s86 offen offset:2048 lds
    v_mfma_f32_16x16x32_bf16 a[68:71], a[176:179], a[108:111], a[68:71]
    v_cvt_pk_bf16_f32 v2, v2, v3
    v_mov_b32 v3, v2
    v_mfma_f32_16x16x32_bf16 a[28:31], a[172:175], a[96:99], a[28:31]
    ds_read_b64_tr_b16 a[170:171], v6 offset:20992
    v_mfma_f32_16x16x32_bf16 a[28:31], a[176:179], a[112:115], a[28:31]
    s_waitcnt lgkmcnt(8)
    v_mfma_f32_16x16x32_bf16 v[104:107], a[148:151], a[84:87], v[104:107]
    ds_read_b64_tr_b16 a[172:173], v7 offset:16384
    buffer_load_dwordx4 v13, s[20:23], s87 offen offset:3072 lds
    v_mfma_f32_16x16x32_bf16 v[104:107], a[152:155], a[100:103], v[104:107]
    s_add_u32 s82, s51, 1
    s_sub_i32 s54, s82, s49
    v_mfma_f32_16x16x32_bf16 v[108:111], a[148:151], a[88:91], v[108:111]
    ds_read_b64_tr_b16 a[174:175], v7 offset:16896
    s_mov_b32 s49, s82
    v_mfma_f32_16x16x32_bf16 v[108:111], a[152:155], a[104:107], v[108:111]
    s_lshl_b32 s82, s54, 7
    v_add_u32 v13, s82, v13
    v_mfma_f32_16x16x32_bf16 v[112:115], a[148:151], a[92:95], v[112:115]
    ds_read_b64_tr_b16 a[176:177], v7 offset:20480
    s_add_u32 m0, s58, 40960
    v_mfma_f32_16x16x32_bf16 v[112:115], a[152:155], a[108:111], v[112:115]
    buffer_store_dwordx2 v[2:3], v15, s[36:39], 0 offen sc1
    buffer_store_dwordx2 v[2:3], v15, s[36:39], 0 offen offset:8 sc1
    v_mfma_f32_16x16x32_bf16 a[32:35], a[148:151], a[96:99], a[32:35]
    ds_read_b64_tr_b16 a[178:179], v7 offset:20992
    buffer_store_dword v14, v1, s[36:39], 0 offen sc1
    v_mfma_f32_16x16x32_bf16 a[32:35], a[152:155], a[112:115], a[32:35]
    v_lshlrev_b32 v15, 3, v0
    s_waitcnt lgkmcnt(8)
    v_mfma_f32_16x16x32_bf16 v[116:119], a[156:159], a[84:87], v[116:119]
    ds_read_b64_tr_b16 a[148:149], v4 offset:24576
    s_lshl_b32 s16, s2, 7
    v_mfma_f32_16x16x32_bf16 v[116:119], a[160:163], a[100:103], v[116:119]
    s_add_u32 s16, s16, 1179648
    v_add_u32 v15, s16, v15
    v_mfma_f32_16x16x32_bf16 v[120:123], a[156:159], a[88:91], v[120:123]
    ds_read_b64_tr_b16 a[150:151], v4 offset:25088
    s_cmp_eq_u32 s50, 0
    v_mfma_f32_16x16x32_bf16 v[120:123], a[160:163], a[104:107], v[120:123]
    s_cselect_b32 s16, 16, 0
    v_cmp_gt_u32 vcc, s16, v0
    v_mfma_f32_16x16x32_bf16 v[124:127], a[156:159], a[92:95], v[124:127]
    ds_read_b64_tr_b16 a[152:153], v4 offset:28672
    v_mov_b32 v1, 0x7ff00000
    v_mfma_f32_16x16x32_bf16 v[124:127], a[160:163], a[108:111], v[124:127]
    v_cndmask_b32 v1, v1, v15, vcc
    v_mov_b32 v14, 0
    v_mfma_f32_16x16x32_bf16 a[36:39], a[156:159], a[96:99], a[36:39]
    ds_read_b64_tr_b16 a[154:155], v4 offset:29184
    v_mov_b32 v15, 0
    v_mfma_f32_16x16x32_bf16 a[36:39], a[160:163], a[112:115], a[36:39]
    buffer_store_dwordx2 v[14:15], v1, s[36:39], 0 offen sc1
    s_waitcnt lgkmcnt(8)
    v_mfma_f32_16x16x32_bf16 v[128:131], a[164:167], a[84:87], v[128:131]
    ds_read_b64_tr_b16 a[156:157], v5 offset:24576
    buffer_load_dwordx4 v10, s[24:27], s62 offen offset:0 lds
    v_mfma_f32_16x16x32_bf16 v[128:131], a[168:171], a[100:103], v[128:131]
    v_subrev_u32 v4, 81920, v4
    buffer_load_dwordx4 v11, s[24:27], s63 offen offset:1024 lds
    v_mfma_f32_16x16x32_bf16 v[132:135], a[164:167], a[88:91], v[132:135]
    ds_read_b64_tr_b16 a[158:159], v5 offset:25088
    v_mfma_f32_16x16x32_bf16 v[132:135], a[168:171], a[104:107], v[132:135]
    v_mfma_f32_16x16x32_bf16 v[136:139], a[164:167], a[92:95], v[136:139]
    ds_read_b64_tr_b16 a[160:161], v5 offset:28672
    v_mfma_f32_16x16x32_bf16 v[136:139], a[168:171], a[108:111], v[136:139]
    v_mfma_f32_16x16x32_bf16 a[40:43], a[164:167], a[96:99], a[40:43]
    ds_read_b64_tr_b16 a[162:163], v5 offset:29184
    v_mfma_f32_16x16x32_bf16 a[40:43], a[168:171], a[112:115], a[40:43]
    s_waitcnt lgkmcnt(8)
    v_mfma_f32_16x16x32_bf16 v[140:143], a[172:175], a[84:87], v[140:143]
    ds_read_b64_tr_b16 a[164:165], v6 offset:24576
    buffer_load_dwordx4 v10, s[24:27], s64 offen offset:2048 lds
    v_mfma_f32_16x16x32_bf16 v[140:143], a[176:179], a[100:103], v[140:143]
    v_subrev_u32 v5, 81920, v5
    v_mfma_f32_16x16x32_bf16 v[144:147], a[172:175], a[88:91], v[144:147]
    ds_read_b64_tr_b16 a[166:167], v6 offset:25088
    v_mfma_f32_16x16x32_bf16 v[144:147], a[176:179], a[104:107], v[144:147]
    v_mfma_f32_16x16x32_bf16 a[80:83], a[172:175], a[92:95], a[80:83]
    ds_read_b64_tr_b16 a[168:169], v6 offset:28672
    v_mfma_f32_16x16x32_bf16 a[80:83], a[176:179], a[108:111], a[80:83]
    v_mfma_f32_16x16x32_bf16 a[44:47], a[172:175], a[96:99], a[44:47]
    ds_read_b64_tr_b16 a[170:171], v6 offset:29184
    v_mfma_f32_16x16x32_bf16 a[44:47], a[176:179], a[112:115], a[44:47]
    s_waitcnt lgkmcnt(8)
    v_mfma_f32_16x16x32_bf16 v[148:151], a[148:151], a[84:87], v[148:151]
    ds_read_b64_tr_b16 a[172:173], v7 offset:24576
    buffer_load_dwordx4 v11, s[24:27], s65 offen offset:3072 lds
    v_mfma_f32_16x16x32_bf16 v[148:151], a[152:155], a[100:103], v[148:151]
    v_subrev_u32 v6, 81920, v6
    v_mfma_f32_16x16x32_bf16 v[152:155], a[148:151], a[88:91], v[152:155]
    ds_read_b64_tr_b16 a[174:175], v7 offset:25088
    v_mfma_f32_16x16x32_bf16 v[152:155], a[152:155], a[104:107], v[152:155]
    v_mfma_f32_16x16x32_bf16 v[156:159], a[148:151], a[92:95], v[156:159]
    ds_read_b64_tr_b16 a[176:177], v7 offset:28672
    s_add_u32 m0, s58, 45056
    v_mfma_f32_16x16x32_bf16 v[156:159], a[152:155], a[108:111], v[156:159]
    v_mfma_f32_16x16x32_bf16 a[48:51], a[148:151], a[96:99], a[48:51]
    ds_read_b64_tr_b16 a[178:179], v7 offset:29184
    v_mfma_f32_16x16x32_bf16 a[48:51], a[152:155], a[112:115], a[48:51]
    s_waitcnt lgkmcnt(8)
    v_mfma_f32_16x16x32_bf16 v[160:163], a[156:159], a[84:87], v[160:163]
    ds_read_b64_tr_b16 a[148:149], v8 offset:0
    buffer_load_dwordx4 v10, s[24:27], s66 offen offset:0 lds
    v_mfma_f32_16x16x32_bf16 v[160:163], a[160:163], a[100:103], v[160:163]
    v_subrev_u32 v7, 81920, v7
    v_mfma_f32_16x16x32_bf16 v[164:167], a[156:159], a[88:91], v[164:167]
    ds_read_b64_tr_b16 a[150:151], v8 offset:256
    v_mfma_f32_16x16x32_bf16 v[164:167], a[160:163], a[104:107], v[164:167]
    v_mfma_f32_16x16x32_bf16 a[72:75], a[156:159], a[92:95], a[72:75]
    ds_read_b64_tr_b16 a[152:153], v8 offset:4096
    v_mfma_f32_16x16x32_bf16 a[72:75], a[160:163], a[108:111], a[72:75]
    v_mfma_f32_16x16x32_bf16 a[52:55], a[156:159], a[96:99], a[52:55]
    ds_read_b64_tr_b16 a[154:155], v8 offset:4352
    v_mfma_f32_16x16x32_bf16 a[52:55], a[160:163], a[112:115], a[52:55]
    s_waitcnt lgkmcnt(8)
    v_mfma_f32_16x16x32_bf16 v[168:171], a[164:167], a[84:87], v[168:171]
    ds_read_b64_tr_b16 a[156:157], v9 offset:0
    buffer_load_dwordx4 v11, s[24:27], s67 offen offset:1024 lds
    v_mfma_f32_16x16x32_bf16 v[168:171], a[168:171], a[100:103], v[168:171]
    v_mfma_f32_16x16x32_bf16 v[172:175], a[164:167], a[88:91], v[172:175]
    ds_read_b64_tr_b16 a[158:159], v9 offset:256
    v_mfma_f32_16x16x32_bf16 v[172:175], a[168:171], a[104:107], v[172:175]
    v_mfma_f32_16x16x32_bf16 v[176:179], a[164:167], a[92:95], v[176:179]
    ds_read_b64_tr_b16 a[160:161], v9 offset:4096
    v_mfma_f32_16x16x32_bf16 v[176:179], a[168:171], a[108:111], v[176:179]
    v_mfma_f32_16x16x32_bf16 a[56:59], a[164:167], a[96:99], a[56:59]
    ds_read_b64_tr_b16 a[162:163], v9 offset:4352
    v_mfma_f32_16x16x32_bf16 a[56:59], a[168:171], a[112:115], a[56:59]
    s_waitcnt lgkmcnt(8)
    v_mfma_f32_16x16x32_bf16 v[180:183], a[172:175], a[84:87], v[180:183]
    ds_read_b64_tr_b16 a[164:165], v8 offset:1024
    buffer_load_dwordx4 v10, s[24:27], s68 offen offset:2048 lds
    v_mfma_f32_16x16x32_bf16 v[180:183], a[176:179], a[100:103], v[180:183]
    s_mul_i32 s73, s56, 3
    s_mul_i32 s74, s57, 3
    v_mfma_f32_16x16x32_bf16 v[184:187], a[172:175], a[88:91], v[184:187]
    ds_read_b64_tr_b16 a[166:167], v8 offset:1280
    v_mfma_f32_16x16x32_bf16 v[184:187], a[176:179], a[104:107], v[184:187]
    v_mfma_f32_16x16x32_bf16 a[76:79], a[172:175], a[92:95], a[76:79]
    ds_read_b64_tr_b16 a[168:169], v8 offset:5120
    v_mfma_f32_16x16x32_bf16 a[76:79], a[176:179], a[108:111], a[76:79]
    v_mfma_f32_16x16x32_bf16 a[60:63], a[172:175], a[96:99], a[60:63]
    ds_read_b64_tr_b16 a[170:171], v8 offset:5376
    v_mfma_f32_16x16x32_bf16 a[60:63], a[176:179], a[112:115], a[60:63]
    s_waitcnt lgkmcnt(8)
    v_mfma_f32_16x16x32_bf16 v[188:191], a[148:151], a[84:87], v[188:191]
    ds_read_b64_tr_b16 a[172:173], v9 offset:1024
    buffer_load_dwordx4 v11, s[24:27], s69 offen offset:3072 lds
    v_mfma_f32_16x16x32_bf16 v[188:191], a[152:155], a[100:103], v[188:191]
    v_subrev_u32 v8, 81920, v8
    s_and_b32 s97, s97, 0xffff
    v_mfma_f32_16x16x32_bf16 v[192:195], a[148:151], a[88:91], v[192:195]
    ds_read_b64_tr_b16 a[174:175], v9 offset:1280
    s_mov_b32 s98, 7340032
    v_mfma_f32_16x16x32_bf16 v[192:195], a[152:155], a[104:107], v[192:195]
    s_mov_b32 s99, 0x20000
    s_and_b32 s93, s93, 0xffff
    v_mfma_f32_16x16x32_bf16 v[196:199], a[148:151], a[92:95], v[196:199]
    ds_read_b64_tr_b16 a[176:177], v9 offset:5120
    s_mov_b32 s94, 2097152
    v_mfma_f32_16x16x32_bf16 v[196:199], a[152:155], a[108:111], v[196:199]
    s_mov_b32 s95, 0x20000
    s_lshl_b32 s100, s2, 2
    v_mfma_f32_16x16x32_bf16 v[200:203], a[148:151], a[96:99], v[200:203]
    ds_read_b64_tr_b16 a[178:179], v9 offset:5376
    s_add_u32 s100, s100, s50
    v_mfma_f32_16x16x32_bf16 v[200:203], a[152:155], a[112:115], v[200:203]
    s_lshl_b32 s101, s100, 11
    s_waitcnt lgkmcnt(8)
    v_mfma_f32_16x16x32_bf16 v[204:207], a[156:159], a[84:87], v[204:207]
    s_mul_i32 s100, s100, 7168
    s_movk_i32 s89, 4096
    v_mfma_f32_16x16x32_bf16 v[204:207], a[160:163], a[100:103], v[204:207]
    v_subrev_u32 v9, 81920, v9
    s_add_u32 m0, s59, 40960
    v_mfma_f32_16x16x32_bf16 v[208:211], a[156:159], a[88:91], v[208:211]
    buffer_load_dwordx4 v12, s[28:31], s52 offen lds
    v_mfma_f32_16x16x32_bf16 v[208:211], a[160:163], a[104:107], v[208:211]
    v_mfma_f32_16x16x32_bf16 v[212:215], a[156:159], a[92:95], v[212:215]
    s_add_u32 m0, s59, 41984
    v_mfma_f32_16x16x32_bf16 v[212:215], a[160:163], a[108:111], v[212:215]
    v_mfma_f32_16x16x32_bf16 v[216:219], a[156:159], a[96:99], v[216:219]
    v_mfma_f32_16x16x32_bf16 v[216:219], a[160:163], a[112:115], v[216:219]
    s_waitcnt vmcnt(21) lgkmcnt(0)
    s_barrier
    v_mfma_f32_16x16x32_bf16 v[220:223], a[164:167], a[84:87], v[220:223]
    ds_read_b64_tr_b16 a[148:149], v4 offset:0
    buffer_load_dwordx4 v12, s[32:35], s53 offen lds
    v_mfma_f32_16x16x32_bf16 v[220:223], a[168:171], a[100:103], v[220:223]
    ds_read_b64_tr_b16 a[150:151], v4 offset:512
    s_add_u32 s82, s51, 1
    v_mfma_f32_16x16x32_bf16 v[224:227], a[164:167], a[88:91], v[224:227]
    ds_read_b64_tr_b16 a[152:153], v4 offset:4096
    s_sub_i32 s54, s82, s48
    v_mfma_f32_16x16x32_bf16 v[224:227], a[168:171], a[104:107], v[224:227]
    ds_read_b64_tr_b16 a[154:155], v4 offset:4608
    s_mov_b32 s48, s82
    v_mfma_f32_16x16x32_bf16 v[228:231], a[164:167], a[92:95], v[228:231]
    ds_read_b64_tr_b16 a[156:157], v5 offset:0
    s_mul_i32 s82, s54, s56
    v_mfma_f32_16x16x32_bf16 v[228:231], a[168:171], a[108:111], v[228:231]
    ds_read_b64_tr_b16 a[158:159], v5 offset:512
    s_mul_i32 s83, s54, s57
    v_mfma_f32_16x16x32_bf16 v[232:235], a[164:167], a[96:99], v[232:235]
    ds_read_b64_tr_b16 a[160:161], v5 offset:4096
    v_add_u32 v10, s82, v10
    v_mfma_f32_16x16x32_bf16 v[232:235], a[168:171], a[112:115], v[232:235]
    ds_read_b64_tr_b16 a[162:163], v5 offset:4608
    v_mfma_f32_16x16x32_bf16 v[236:239], a[172:175], a[84:87], v[236:239]
    ds_read_b64_tr_b16 a[164:165], v6 offset:0
    v_add_u32 v11, s82, v11
    v_mfma_f32_16x16x32_bf16 v[236:239], a[176:179], a[100:103], v[236:239]
    v_add_u32 v12, s83, v12
    v_mfma_f32_16x16x32_bf16 v[240:243], a[172:175], a[88:91], v[240:243]
    ds_read_b64_tr_b16 a[166:167], v6 offset:512
    v_mfma_f32_16x16x32_bf16 v[240:243], a[176:179], a[104:107], v[240:243]
    v_mfma_f32_16x16x32_bf16 v[244:247], a[172:175], a[92:95], v[244:247]
    ds_read_b64_tr_b16 a[168:169], v6 offset:4096
    v_mfma_f32_16x16x32_bf16 v[244:247], a[176:179], a[108:111], v[244:247]
    v_mfma_f32_16x16x32_bf16 v[248:251], a[172:175], a[96:99], v[248:251]
    ds_read_b64_tr_b16 a[170:171], v6 offset:4608
    v_mfma_f32_16x16x32_bf16 v[248:251], a[176:179], a[112:115], v[248:251]
    s_waitcnt lgkmcnt(8)
    v_mfma_f32_16x16x32_bf16 v[16:19], a[148:151], a[116:119], v[16:19]
    ds_read_b64_tr_b16 a[172:173], v7 offset:0
    s_waitcnt vmcnt(20)
    v_mfma_f32_16x16x32_bf16 v[16:19], a[152:155], a[132:135], v[16:19]
    ds_read_b128 a[84:87], v252 offset:40960
    v_mfma_f32_16x16x32_bf16 v[20:23], a[148:151], a[120:123], v[20:23]
    ds_read_b64_tr_b16 a[174:175], v7 offset:512
    v_mfma_f32_16x16x32_bf16 v[20:23], a[152:155], a[136:139], v[20:23]
    v_mfma_f32_16x16x32_bf16 v[24:27], a[148:151], a[124:127], v[24:27]
    ds_read_b64_tr_b16 a[176:177], v7 offset:4096
    ds_read_b128 a[100:103], v253 offset:40960
    v_mfma_f32_16x16x32_bf16 v[24:27], a[152:155], a[140:143], v[24:27]
    v_mfma_f32_16x16x32_bf16 a[0:3], a[148:151], a[128:131], a[0:3]
    ds_read_b64_tr_b16 a[178:179], v7 offset:4608
    v_mfma_f32_16x16x32_bf16 a[0:3], a[152:155], a[144:147], a[0:3]
    s_waitcnt lgkmcnt(10)
    v_mfma_f32_16x16x32_bf16 v[28:31], a[156:159], a[116:119], v[28:31]
    ds_read_b64_tr_b16 a[148:149], v4 offset:8192
    s_waitcnt vmcnt(18)
    v_mfma_f32_16x16x32_bf16 v[28:31], a[160:163], a[132:135], v[28:31]
    ds_read_b128 a[88:91], v252 offset:43008
    v_mfma_f32_16x16x32_bf16 v[32:35], a[156:159], a[120:123], v[32:35]
    ds_read_b64_tr_b16 a[150:151], v4 offset:8704
    v_mfma_f32_16x16x32_bf16 v[32:35], a[160:163], a[136:139], v[32:35]
    v_mfma_f32_16x16x32_bf16 v[36:39], a[156:159], a[124:127], v[36:39]
    ds_read_b64_tr_b16 a[152:153], v4 offset:12288
    ds_read_b128 a[104:107], v253 offset:43008
    v_mfma_f32_16x16x32_bf16 v[36:39], a[160:163], a[140:143], v[36:39]
    v_mfma_f32_16x16x32_bf16 a[4:7], a[156:159], a[128:131], a[4:7]
    ds_read_b64_tr_b16 a[154:155], v4 offset:12800
    v_mfma_f32_16x16x32_bf16 a[4:7], a[160:163], a[144:147], a[4:7]
    s_waitcnt lgkmcnt(12)
    v_mfma_f32_16x16x32_bf16 v[40:43], a[164:167], a[116:119], v[40:43]
    ds_read_b64_tr_b16 a[156:157], v5 offset:8192
    s_waitcnt vmcnt(16)
    v_mfma_f32_16x16x32_bf16 v[40:43], a[168:171], a[132:135], v[40:43]
    ds_read_b128 a[92:95], v252 offset:45056
    v_mfma_f32_16x16x32_bf16 v[44:47], a[164:167], a[120:123], v[44:47]
    ds_read_b64_tr_b16 a[158:159], v5 offset:8704
    v_mfma_f32_16x16x32_bf16 v[44:47], a[168:171], a[136:139], v[44:47]
    v_mfma_f32_16x16x32_bf16 v[48:51], a[164:167], a[124:127], v[48:51]
    ds_read_b64_tr_b16 a[160:161], v5 offset:12288
    ds_read_b128 a[108:111], v253 offset:45056
    v_mfma_f32_16x16x32_bf16 v[48:51], a[168:171], a[140:143], v[48:51]
    v_mfma_f32_16x16x32_bf16 a[8:11], a[164:167], a[128:131], a[8:11]
    ds_read_b64_tr_b16 a[162:163], v5 offset:12800
    v_mfma_f32_16x16x32_bf16 a[8:11], a[168:171], a[144:147], a[8:11]
    s_waitcnt lgkmcnt(12)
    v_mfma_f32_16x16x32_bf16 v[52:55], a[172:175], a[116:119], v[52:55]
    ds_read_b64_tr_b16 a[164:165], v6 offset:8192
    s_waitcnt vmcnt(14)
    v_mfma_f32_16x16x32_bf16 v[52:55], a[176:179], a[132:135], v[52:55]
    ds_read_b128 a[96:99], v252 offset:47104
    v_mfma_f32_16x16x32_bf16 v[56:59], a[172:175], a[120:123], v[56:59]
    ds_read_b64_tr_b16 a[166:167], v6 offset:8704
    v_mfma_f32_16x16x32_bf16 v[56:59], a[176:179], a[136:139], v[56:59]
    v_mfma_f32_16x16x32_bf16 v[60:63], a[172:175], a[124:127], v[60:63]
    ds_read_b64_tr_b16 a[168:169], v6 offset:12288
    ds_read_b128 a[112:115], v253 offset:47104
    v_mfma_f32_16x16x32_bf16 v[60:63], a[176:179], a[140:143], v[60:63]
    v_mfma_f32_16x16x32_bf16 a[12:15], a[172:175], a[128:131], a[12:15]
    ds_read_b64_tr_b16 a[170:171], v6 offset:12800
    v_mfma_f32_16x16x32_bf16 a[12:15], a[176:179], a[144:147], a[12:15]
    s_waitcnt lgkmcnt(12)
    v_mfma_f32_16x16x32_bf16 v[64:67], a[148:151], a[116:119], v[64:67]
    ds_read_b64_tr_b16 a[172:173], v7 offset:8192
    s_add_u32 m0, s58, 122880
    v_mfma_f32_16x16x32_bf16 v[64:67], a[152:155], a[132:135], v[64:67]
    v_mfma_f32_16x16x32_bf16 v[68:71], a[148:151], a[120:123], v[68:71]
    ds_read_b64_tr_b16 a[174:175], v7 offset:8704
    v_mfma_f32_16x16x32_bf16 v[68:71], a[152:155], a[136:139], v[68:71]
    v_mfma_f32_16x16x32_bf16 v[72:75], a[148:151], a[124:127], v[72:75]
    ds_read_b64_tr_b16 a[176:177], v7 offset:12288
    buffer_load_dwordx4 v13, s[20:23], s40 offen offset:0 lds
    v_mfma_f32_16x16x32_bf16 v[72:75], a[152:155], a[140:143], v[72:75]
    v_mfma_f32_16x16x32_bf16 a[16:19], a[148:151], a[128:131], a[16:19]
    ds_read_b64_tr_b16 a[178:179], v7 offset:12800
    v_mfma_f32_16x16x32_bf16 a[16:19], a[152:155], a[144:147], a[16:19]
    s_waitcnt lgkmcnt(10)
    v_mfma_f32_16x16x32_bf16 v[76:79], a[156:159], a[116:119], v[76:79]
    ds_read_b64_tr_b16 a[148:149], v4 offset:16384
    buffer_load_dwordx4 v13, s[20:23], s41 offen offset:1024 lds
    v_mfma_f32_16x16x32_bf16 v[76:79], a[160:163], a[132:135], v[76:79]
    v_mfma_f32_16x16x32_bf16 v[80:83], a[156:159], a[120:123], v[80:83]
    ds_read_b64_tr_b16 a[150:151], v4 offset:16896
    v_mfma_f32_16x16x32_bf16 v[80:83], a[160:163], a[136:139], v[80:83]
    v_mfma_f32_16x16x32_bf16 a[64:67], a[156:159], a[124:127], a[64:67]
    ds_read_b64_tr_b16 a[152:153], v4 offset:20480
    buffer_load_dwordx4 v13, s[20:23], s42 offen offset:2048 lds
    v_mfma_f32_16x16x32_bf16 a[64:67], a[160:163], a[140:143], a[64:67]
    v_mfma_f32_16x16x32_bf16 a[20:23], a[156:159], a[128:131], a[20:23]
    ds_read_b64_tr_b16 a[154:155], v4 offset:20992
    v_mfma_f32_16x16x32_bf16 a[20:23], a[160:163], a[144:147], a[20:23]
    s_waitcnt lgkmcnt(8)
    v_mfma_f32_16x16x32_bf16 v[84:87], a[164:167], a[116:119], v[84:87]
    ds_read_b64_tr_b16 a[156:157], v5 offset:16384
    buffer_load_dwordx4 v13, s[20:23], s43 offen offset:3072 lds
    v_mfma_f32_16x16x32_bf16 v[84:87], a[168:171], a[132:135], v[84:87]
    s_add_u32 m0, s58, 126976
    v_mfma_f32_16x16x32_bf16 v[88:91], a[164:167], a[120:123], v[88:91]
    ds_read_b64_tr_b16 a[158:159], v5 offset:16896
    v_mfma_f32_16x16x32_bf16 v[88:91], a[168:171], a[136:139], v[88:91]
    v_mfma_f32_16x16x32_bf16 v[92:95], a[164:167], a[124:127], v[92:95]
    ds_read_b64_tr_b16 a[160:161], v5 offset:20480
    buffer_load_dwordx4 v13, s[20:23], s84 offen offset:0 lds
    v_mfma_f32_16x16x32_bf16 v[92:95], a[168:171], a[140:143], v[92:95]
    v_mfma_f32_16x16x32_bf16 a[24:27], a[164:167], a[128:131], a[24:27]
    ds_read_b64_tr_b16 a[162:163], v5 offset:20992
    v_mfma_f32_16x16x32_bf16 a[24:27], a[168:171], a[144:147], a[24:27]
    s_waitcnt lgkmcnt(8)
    v_mfma_f32_16x16x32_bf16 v[96:99], a[172:175], a[116:119], v[96:99]
    ds_read_b64_tr_b16 a[164:165], v6 offset:16384
    buffer_load_dwordx4 v13, s[20:23], s85 offen offset:1024 lds
    v_mfma_f32_16x16x32_bf16 v[96:99], a[176:179], a[132:135], v[96:99]
    v_mfma_f32_16x16x32_bf16 v[100:103], a[172:175], a[120:123], v[100:103]
    ds_read_b64_tr_b16 a[166:167], v6 offset:16896
    v_mfma_f32_16x16x32_bf16 v[100:103], a[176:179], a[136:139], v[100:103]
    v_mfma_f32_16x16x32_bf16 a[68:71], a[172:175], a[124:127], a[68:71]
    ds_read_b64_tr_b16 a[168:169], v6 offset:20480
    buffer_load_dwordx4 v13, s[20:23], s86 offen offset:2048 lds
    v_mfma_f32_16x16x32_bf16 a[68:71], a[176:179], a[140:143], a[68:71]
    v_mfma_f32_16x16x32_bf16 a[28:31], a[172:175], a[128:131], a[28:31]
    ds_read_b64_tr_b16 a[170:171], v6 offset:20992
    v_mfma_f32_16x16x32_bf16 a[28:31], a[176:179], a[144:147], a[28:31]
    s_waitcnt lgkmcnt(8)
    v_mfma_f32_16x16x32_bf16 v[104:107], a[148:151], a[116:119], v[104:107]
    ds_read_b64_tr_b16 a[172:173], v7 offset:16384
    buffer_load_dwordx4 v13, s[20:23], s87 offen offset:3072 lds
    v_mfma_f32_16x16x32_bf16 v[104:107], a[152:155], a[132:135], v[104:107]
    s_cmp_le_u32 s51, 4
    s_cselect_b32 s82, 6, 4
    v_mfma_f32_16x16x32_bf16 v[108:111], a[148:151], a[120:123], v[108:111]
    ds_read_b64_tr_b16 a[174:175], v7 offset:16896
    s_sub_i32 s54, s82, s49
    v_mfma_f32_16x16x32_bf16 v[108:111], a[152:155], a[136:139], v[108:111]
    s_mov_b32 s49, s82
    s_lshl_b32 s82, s54, 7
    v_mfma_f32_16x16x32_bf16 v[112:115], a[148:151], a[124:127], v[112:115]
    ds_read_b64_tr_b16 a[176:177], v7 offset:20480
    v_add_u32 v13, s82, v13
    v_mfma_f32_16x16x32_bf16 v[112:115], a[152:155], a[140:143], v[112:115]
    s_add_u32 m0, s58, 81920
    v_mfma_f32_16x16x32_bf16 a[32:35], a[148:151], a[128:131], a[32:35]
    ds_read_b64_tr_b16 a[178:179], v7 offset:20992
    v_mfma_f32_16x16x32_bf16 a[32:35], a[152:155], a[144:147], a[32:35]
    s_waitcnt lgkmcnt(8)
    v_mfma_f32_16x16x32_bf16 v[116:119], a[156:159], a[116:119], v[116:119]
    ds_read_b64_tr_b16 a[148:149], v4 offset:24576
    buffer_load_dwordx4 v10, s[24:27], s62 offen offset:0 lds
    v_mfma_f32_16x16x32_bf16 v[116:119], a[160:163], a[132:135], v[116:119]
    v_mfma_f32_16x16x32_bf16 v[120:123], a[156:159], a[120:123], v[120:123]
    ds_read_b64_tr_b16 a[150:151], v4 offset:25088
    v_mfma_f32_16x16x32_bf16 v[120:123], a[160:163], a[136:139], v[120:123]
    v_mfma_f32_16x16x32_bf16 v[124:127], a[156:159], a[124:127], v[124:127]
    ds_read_b64_tr_b16 a[152:153], v4 offset:28672
    v_mfma_f32_16x16x32_bf16 v[124:127], a[160:163], a[140:143], v[124:127]
    v_mfma_f32_16x16x32_bf16 a[36:39], a[156:159], a[128:131], a[36:39]
    ds_read_b64_tr_b16 a[154:155], v4 offset:29184
    v_mfma_f32_16x16x32_bf16 a[36:39], a[160:163], a[144:147], a[36:39]
    s_waitcnt lgkmcnt(8)
    v_mfma_f32_16x16x32_bf16 v[128:131], a[164:167], a[116:119], v[128:131]
    ds_read_b64_tr_b16 a[156:157], v5 offset:24576
    buffer_load_dwordx4 v11, s[24:27], s63 offen offset:1024 lds
    v_mfma_f32_16x16x32_bf16 v[128:131], a[168:171], a[132:135], v[128:131]
    v_add_u32 v4, 40960, v4
    v_mfma_f32_16x16x32_bf16 v[132:135], a[164:167], a[120:123], v[132:135]
    ds_read_b64_tr_b16 a[158:159], v5 offset:25088
    v_mfma_f32_16x16x32_bf16 v[132:135], a[168:171], a[136:139], v[132:135]
    v_mfma_f32_16x16x32_bf16 v[136:139], a[164:167], a[124:127], v[136:139]
    ds_read_b64_tr_b16 a[160:161], v5 offset:28672
    v_mfma_f32_16x16x32_bf16 v[136:139], a[168:171], a[140:143], v[136:139]
    v_mfma_f32_16x16x32_bf16 a[40:43], a[164:167], a[128:131], a[40:43]
    ds_read_b64_tr_b16 a[162:163], v5 offset:29184
    v_mfma_f32_16x16x32_bf16 a[40:43], a[168:171], a[144:147], a[40:43]
    s_waitcnt lgkmcnt(8)
    v_mfma_f32_16x16x32_bf16 v[140:143], a[172:175], a[116:119], v[140:143]
    ds_read_b64_tr_b16 a[164:165], v6 offset:24576
    buffer_load_dwordx4 v10, s[24:27], s64 offen offset:2048 lds
    v_mfma_f32_16x16x32_bf16 v[140:143], a[176:179], a[132:135], v[140:143]
    v_add_u32 v5, 40960, v5
    v_mfma_f32_16x16x32_bf16 v[144:147], a[172:175], a[120:123], v[144:147]
    ds_read_b64_tr_b16 a[166:167], v6 offset:25088
    v_mfma_f32_16x16x32_bf16 v[144:147], a[176:179], a[136:139], v[144:147]
    v_mfma_f32_16x16x32_bf16 a[80:83], a[172:175], a[124:127], a[80:83]
    ds_read_b64_tr_b16 a[168:169], v6 offset:28672
    v_mfma_f32_16x16x32_bf16 a[80:83], a[176:179], a[140:143], a[80:83]
    v_mfma_f32_16x16x32_bf16 a[44:47], a[172:175], a[128:131], a[44:47]
    ds_read_b64_tr_b16 a[170:171], v6 offset:29184
    v_mfma_f32_16x16x32_bf16 a[44:47], a[176:179], a[144:147], a[44:47]
    s_waitcnt lgkmcnt(8)
    v_mfma_f32_16x16x32_bf16 v[148:151], a[148:151], a[116:119], v[148:151]
    ds_read_b64_tr_b16 a[172:173], v7 offset:24576
    buffer_load_dwordx4 v11, s[24:27], s65 offen offset:3072 lds
    v_mfma_f32_16x16x32_bf16 v[148:151], a[152:155], a[132:135], v[148:151]
    v_add_u32 v6, 40960, v6
    v_mfma_f32_16x16x32_bf16 v[152:155], a[148:151], a[120:123], v[152:155]
    ds_read_b64_tr_b16 a[174:175], v7 offset:25088
    v_mfma_f32_16x16x32_bf16 v[152:155], a[152:155], a[136:139], v[152:155]
    v_mfma_f32_16x16x32_bf16 v[156:159], a[148:151], a[124:127], v[156:159]
    ds_read_b64_tr_b16 a[176:177], v7 offset:28672
    s_add_u32 m0, s58, 86016
    v_mfma_f32_16x16x32_bf16 v[156:159], a[152:155], a[140:143], v[156:159]
    v_mfma_f32_16x16x32_bf16 a[48:51], a[148:151], a[128:131], a[48:51]
    ds_read_b64_tr_b16 a[178:179], v7 offset:29184
    v_mfma_f32_16x16x32_bf16 a[48:51], a[152:155], a[144:147], a[48:51]
    s_waitcnt lgkmcnt(8)
    v_mfma_f32_16x16x32_bf16 v[160:163], a[156:159], a[116:119], v[160:163]
    ds_read_b64_tr_b16 a[148:149], v8 offset:0
    buffer_load_dwordx4 v10, s[24:27], s66 offen offset:0 lds
    v_mfma_f32_16x16x32_bf16 v[160:163], a[160:163], a[132:135], v[160:163]
    v_add_u32 v7, 40960, v7
    v_mfma_f32_16x16x32_bf16 v[164:167], a[156:159], a[120:123], v[164:167]
    ds_read_b64_tr_b16 a[150:151], v8 offset:256
    v_mfma_f32_16x16x32_bf16 v[164:167], a[160:163], a[136:139], v[164:167]
    v_mfma_f32_16x16x32_bf16 a[72:75], a[156:159], a[124:127], a[72:75]
    ds_read_b64_tr_b16 a[152:153], v8 offset:4096
    v_mfma_f32_16x16x32_bf16 a[72:75], a[160:163], a[140:143], a[72:75]
    v_mfma_f32_16x16x32_bf16 a[52:55], a[156:159], a[128:131], a[52:55]
    ds_read_b64_tr_b16 a[154:155], v8 offset:4352
    v_mfma_f32_16x16x32_bf16 a[52:55], a[160:163], a[144:147], a[52:55]
    s_waitcnt lgkmcnt(8)
    v_mfma_f32_16x16x32_bf16 v[168:171], a[164:167], a[116:119], v[168:171]
    ds_read_b64_tr_b16 a[156:157], v9 offset:0
    buffer_load_dwordx4 v11, s[24:27], s67 offen offset:1024 lds
    v_mfma_f32_16x16x32_bf16 v[168:171], a[168:171], a[132:135], v[168:171]
    v_mfma_f32_16x16x32_bf16 v[172:175], a[164:167], a[120:123], v[172:175]
    ds_read_b64_tr_b16 a[158:159], v9 offset:256
    v_mfma_f32_16x16x32_bf16 v[172:175], a[168:171], a[136:139], v[172:175]
    v_mfma_f32_16x16x32_bf16 v[176:179], a[164:167], a[124:127], v[176:179]
    ds_read_b64_tr_b16 a[160:161], v9 offset:4096
    v_mfma_f32_16x16x32_bf16 v[176:179], a[168:171], a[140:143], v[176:179]
    v_mfma_f32_16x16x32_bf16 a[56:59], a[164:167], a[128:131], a[56:59]
    ds_read_b64_tr_b16 a[162:163], v9 offset:4352
    v_mfma_f32_16x16x32_bf16 a[56:59], a[168:171], a[144:147], a[56:59]
    s_waitcnt lgkmcnt(8)
    v_mfma_f32_16x16x32_bf16 v[180:183], a[172:175], a[116:119], v[180:183]
    ds_read_b64_tr_b16 a[164:165], v8 offset:1024
    buffer_load_dwordx4 v10, s[24:27], s68 offen offset:2048 lds
    v_mfma_f32_16x16x32_bf16 v[180:183], a[176:179], a[132:135], v[180:183]
    v_mfma_f32_16x16x32_bf16 v[184:187], a[172:175], a[120:123], v[184:187]
    ds_read_b64_tr_b16 a[166:167], v8 offset:1280
    v_mfma_f32_16x16x32_bf16 v[184:187], a[176:179], a[136:139], v[184:187]
    v_mfma_f32_16x16x32_bf16 a[76:79], a[172:175], a[124:127], a[76:79]
    ds_read_b64_tr_b16 a[168:169], v8 offset:5120
    v_mfma_f32_16x16x32_bf16 a[76:79], a[176:179], a[140:143], a[76:79]
    v_mfma_f32_16x16x32_bf16 a[60:63], a[172:175], a[128:131], a[60:63]
    ds_read_b64_tr_b16 a[170:171], v8 offset:5376
    v_mfma_f32_16x16x32_bf16 a[60:63], a[176:179], a[144:147], a[60:63]
    s_waitcnt lgkmcnt(8)
    v_mfma_f32_16x16x32_bf16 v[188:191], a[148:151], a[116:119], v[188:191]
    ds_read_b64_tr_b16 a[172:173], v9 offset:1024
    buffer_load_dwordx4 v11, s[24:27], s69 offen offset:3072 lds
    v_mfma_f32_16x16x32_bf16 v[188:191], a[152:155], a[132:135], v[188:191]
    v_add_u32 v8, 40960, v8
    v_mfma_f32_16x16x32_bf16 v[192:195], a[148:151], a[120:123], v[192:195]
    ds_read_b64_tr_b16 a[174:175], v9 offset:1280
    v_mfma_f32_16x16x32_bf16 v[192:195], a[152:155], a[136:139], v[192:195]
    v_mfma_f32_16x16x32_bf16 v[196:199], a[148:151], a[124:127], v[196:199]
    ds_read_b64_tr_b16 a[176:177], v9 offset:5120
    s_add_u32 m0, s59, 81920
    v_mfma_f32_16x16x32_bf16 v[196:199], a[152:155], a[140:143], v[196:199]
    v_mfma_f32_16x16x32_bf16 v[200:203], a[148:151], a[128:131], v[200:203]
    ds_read_b64_tr_b16 a[178:179], v9 offset:5376
    v_mfma_f32_16x16x32_bf16 v[200:203], a[152:155], a[144:147], v[200:203]
    s_waitcnt lgkmcnt(8)
    v_mfma_f32_16x16x32_bf16 v[204:207], a[156:159], a[116:119], v[204:207]
    buffer_load_dwordx4 v12, s[28:31], s52 offen lds
    v_mfma_f32_16x16x32_bf16 v[204:207], a[160:163], a[132:135], v[204:207]
    v_add_u32 v9, 40960, v9
    v_mfma_f32_16x16x32_bf16 v[208:211], a[156:159], a[120:123], v[208:211]
    v_mfma_f32_16x16x32_bf16 v[208:211], a[160:163], a[136:139], v[208:211]
    v_mfma_f32_16x16x32_bf16 v[212:215], a[156:159], a[124:127], v[212:215]
    s_add_u32 m0, s59, 82944
    v_mfma_f32_16x16x32_bf16 v[212:215], a[160:163], a[140:143], v[212:215]
    v_mfma_f32_16x16x32_bf16 v[216:219], a[156:159], a[128:131], v[216:219]
    v_mfma_f32_16x16x32_bf16 v[216:219], a[160:163], a[144:147], v[216:219]
    s_waitcnt vmcnt(17) lgkmcnt(0)
    s_barrier
    v_mfma_f32_16x16x32_bf16 v[220:223], a[164:167], a[116:119], v[220:223]
    ds_read_b64_tr_b16 a[148:149], v4 offset:0
    buffer_load_dwordx4 v12, s[32:35], s53 offen lds
    v_mfma_f32_16x16x32_bf16 v[220:223], a[168:171], a[132:135], v[220:223]
    ds_read_b64_tr_b16 a[150:151], v4 offset:512
    s_cmp_le_u32 s51, 4
    v_mfma_f32_16x16x32_bf16 v[224:227], a[164:167], a[120:123], v[224:227]
    ds_read_b64_tr_b16 a[152:153], v4 offset:4096
    s_cselect_b32 s82, 6, 4
    v_mfma_f32_16x16x32_bf16 v[224:227], a[168:171], a[136:139], v[224:227]
    ds_read_b64_tr_b16 a[154:155], v4 offset:4608
    s_sub_i32 s54, s82, s48
    v_mfma_f32_16x16x32_bf16 v[228:231], a[164:167], a[124:127], v[228:231]
    ds_read_b64_tr_b16 a[156:157], v5 offset:0
    s_mov_b32 s48, s82
    v_mfma_f32_16x16x32_bf16 v[228:231], a[168:171], a[140:143], v[228:231]
    ds_read_b64_tr_b16 a[158:159], v5 offset:512
    s_mul_i32 s82, s54, s56
    v_mfma_f32_16x16x32_bf16 v[232:235], a[164:167], a[128:131], v[232:235]
    ds_read_b64_tr_b16 a[160:161], v5 offset:4096
    s_mul_i32 s83, s54, s57
    v_mfma_f32_16x16x32_bf16 v[232:235], a[168:171], a[144:147], v[232:235]
    ds_read_b64_tr_b16 a[162:163], v5 offset:4608
    v_mfma_f32_16x16x32_bf16 v[236:239], a[172:175], a[116:119], v[236:239]
    ds_read_b64_tr_b16 a[164:165], v6 offset:0
    v_add_u32 v10, s82, v10
    v_mfma_f32_16x16x32_bf16 v[236:239], a[176:179], a[132:135], v[236:239]
    v_add_u32 v11, s82, v11
    v_add_u32 v12, s83, v12
    v_mfma_f32_16x16x32_bf16 v[240:243], a[172:175], a[120:123], v[240:243]
    ds_read_b64_tr_b16 a[166:167], v6 offset:512
    v_mfma_f32_16x16x32_bf16 v[240:243], a[176:179], a[136:139], v[240:243]
    v_mfma_f32_16x16x32_bf16 v[244:247], a[172:175], a[124:127], v[244:247]
    ds_read_b64_tr_b16 a[168:169], v6 offset:4096
    v_mfma_f32_16x16x32_bf16 v[244:247], a[176:179], a[140:143], v[244:247]
    v_mfma_f32_16x16x32_bf16 v[248:251], a[172:175], a[128:131], v[248:251]
    ds_read_b64_tr_b16 a[170:171], v6 offset:4608
    v_mfma_f32_16x16x32_bf16 v[248:251], a[176:179], a[144:147], v[248:251]
    s_waitcnt lgkmcnt(8)
    v_mfma_f32_16x16x32_bf16 v[16:19], a[148:151], a[84:87], v[16:19]
    ds_read_b64_tr_b16 a[172:173], v7 offset:0
    s_waitcnt vmcnt(16)
    v_mfma_f32_16x16x32_bf16 v[16:19], a[152:155], a[100:103], v[16:19]
    ds_read_b128 a[116:119], v252 offset:40960
    v_add_u32 v1, s81, v4
    v_mfma_f32_16x16x32_bf16 v[20:23], a[148:151], a[88:91], v[20:23]
    ds_read_b64_tr_b16 a[174:175], v7 offset:512
    v_add_u32 v2, s81, v5
    v_mfma_f32_16x16x32_bf16 v[20:23], a[152:155], a[104:107], v[20:23]
    v_add_u32 v3, s81, v6
    v_add_u32 v14, s81, v7
    v_mfma_f32_16x16x32_bf16 v[24:27], a[148:151], a[92:95], v[24:27]
    ds_read_b64_tr_b16 a[176:177], v7 offset:4096
    ds_read_b128 a[132:135], v253 offset:40960
    v_mfma_f32_16x16x32_bf16 v[24:27], a[152:155], a[108:111], v[24:27]
    s_bitcmp1_b32 s50, 0
    s_cselect_b64 vcc, -1, 0
    v_mfma_f32_16x16x32_bf16 a[0:3], a[148:151], a[96:99], a[0:3]
    ds_read_b64_tr_b16 a[178:179], v7 offset:4608
    v_cndmask_b32 v15, v8, v9, vcc
    v_mfma_f32_16x16x32_bf16 a[0:3], a[152:155], a[112:115], a[0:3]
    s_lshr_b32 s16, s50, 1
    s_waitcnt lgkmcnt(10)
    v_mfma_f32_16x16x32_bf16 v[28:31], a[156:159], a[84:87], v[28:31]
    ds_read_b64_tr_b16 a[148:149], v4 offset:8192
    s_lshl_b32 s16, s16, 10
    v_mfma_f32_16x16x32_bf16 v[28:31], a[160:163], a[100:103], v[28:31]
    v_add_u32 v15, s16, v15
    s_waitcnt vmcnt(14)
    v_mfma_f32_16x16x32_bf16 v[32:35], a[156:159], a[88:91], v[32:35]
    ds_read_b64_tr_b16 a[150:151], v4 offset:8704
    ds_read_b128 a[120:123], v252 offset:43008
    v_mfma_f32_16x16x32_bf16 v[32:35], a[160:163], a[104:107], v[32:35]
    v_mfma_f32_16x16x32_bf16 v[36:39], a[156:159], a[92:95], v[36:39]
    ds_read_b64_tr_b16 a[152:153], v4 offset:12288
    ds_read_b128 a[136:139], v253 offset:43008
    v_mfma_f32_16x16x32_bf16 v[36:39], a[160:163], a[108:111], v[36:39]
    v_mfma_f32_16x16x32_bf16 a[4:7], a[156:159], a[96:99], a[4:7]
    ds_read_b64_tr_b16 a[154:155], v4 offset:12800
    v_mfma_f32_16x16x32_bf16 a[4:7], a[160:163], a[112:115], a[4:7]
    s_waitcnt lgkmcnt(12)
    v_mfma_f32_16x16x32_bf16 v[40:43], a[164:167], a[84:87], v[40:43]
    ds_read_b64_tr_b16 a[156:157], v5 offset:8192
    s_waitcnt vmcnt(12)
    v_mfma_f32_16x16x32_bf16 v[40:43], a[168:171], a[100:103], v[40:43]
    ds_read_b128 a[124:127], v252 offset:45056
    ds_read_b64_tr_b16 a[180:181], v1 offset:0
    v_mfma_f32_16x16x32_bf16 v[44:47], a[164:167], a[88:91], v[44:47]
    ds_read_b64_tr_b16 a[158:159], v5 offset:8704
    ds_read_b64_tr_b16 a[182:183], v1 offset:512
    v_mfma_f32_16x16x32_bf16 v[44:47], a[168:171], a[104:107], v[44:47]
    v_mfma_f32_16x16x32_bf16 v[48:51], a[164:167], a[92:95], v[48:51]
    ds_read_b64_tr_b16 a[160:161], v5 offset:12288
    ds_read_b128 a[140:143], v253 offset:45056
    v_mfma_f32_16x16x32_bf16 v[48:51], a[168:171], a[108:111], v[48:51]
    ds_read_b64_tr_b16 a[184:185], v2 offset:0
    ds_read_b64_tr_b16 a[186:187], v2 offset:512
    v_mfma_f32_16x16x32_bf16 a[8:11], a[164:167], a[96:99], a[8:11]
    ds_read_b64_tr_b16 a[162:163], v5 offset:12800
    v_mfma_f32_16x16x32_bf16 a[8:11], a[168:171], a[112:115], a[8:11]
    s_waitcnt lgkmcnt(15)
    v_mfma_f32_16x16x32_bf16 v[52:55], a[172:175], a[84:87], v[52:55]
    ds_read_b64_tr_b16 a[164:165], v6 offset:8192
    s_waitcnt vmcnt(10)
    v_mfma_f32_16x16x32_bf16 v[52:55], a[176:179], a[100:103], v[52:55]
    ds_read_b128 a[128:131], v252 offset:47104
    ds_read_b64_tr_b16 a[188:189], v3 offset:0
    v_mfma_f32_16x16x32_bf16 v[56:59], a[172:175], a[88:91], v[56:59]
    ds_read_b64_tr_b16 a[166:167], v6 offset:8704
    ds_read_b64_tr_b16 a[190:191], v3 offset:512
    v_mfma_f32_16x16x32_bf16 v[56:59], a[176:179], a[104:107], v[56:59]
    v_mfma_f32_16x16x32_bf16 v[60:63], a[172:175], a[92:95], v[60:63]
    ds_read_b64_tr_b16 a[168:169], v6 offset:12288
    ds_read_b128 a[144:147], v253 offset:47104
    v_mfma_f32_16x16x32_bf16 v[60:63], a[176:179], a[108:111], v[60:63]
    ds_read_b64_tr_b16 a[192:193], v14 offset:0
    ds_read_b64_tr_b16 a[194:195], v14 offset:512
    v_mfma_f32_16x16x32_bf16 a[12:15], a[172:175], a[96:99], a[12:15]
    ds_read_b64_tr_b16 a[170:171], v6 offset:12800
    v_mfma_f32_16x16x32_bf16 a[12:15], a[176:179], a[112:115], a[12:15]
    s_waitcnt lgkmcnt(15)
    v_mfma_f32_16x16x32_bf16 v[64:67], a[148:151], a[84:87], v[64:67]
    ds_read_b64_tr_b16 a[172:173], v7 offset:8192
    s_add_u32 m0, s58, 122880
    v_mfma_f32_16x16x32_bf16 v[64:67], a[152:155], a[100:103], v[64:67]
    ds_read_b64_tr_b16 a[196:197], v15 offset:0
    ds_read_b64_tr_b16 a[198:199], v15 offset:256
    v_mfma_f32_16x16x32_bf16 v[68:71], a[148:151], a[88:91], v[68:71]
    ds_read_b64_tr_b16 a[174:175], v7 offset:8704
    v_mfma_f32_16x16x32_bf16 v[68:71], a[152:155], a[104:107], v[68:71]
    v_mfma_f32_16x16x32_bf16 v[72:75], a[148:151], a[92:95], v[72:75]
    ds_read_b64_tr_b16 a[176:177], v7 offset:12288
    buffer_load_dwordx4 v13, s[20:23], s40 offen offset:0 lds
    v_mfma_f32_16x16x32_bf16 v[72:75], a[152:155], a[108:111], v[72:75]
    v_mfma_f32_16x16x32_bf16 a[16:19], a[148:151], a[96:99], a[16:19]
    ds_read_b64_tr_b16 a[178:179], v7 offset:12800
    v_mfma_f32_16x16x32_bf16 a[16:19], a[152:155], a[112:115], a[16:19]
    s_waitcnt lgkmcnt(15)
    v_mfma_f32_16x16x32_bf16 v[76:79], a[156:159], a[84:87], v[76:79]
    ds_read_b64_tr_b16 a[148:149], v4 offset:16384
    buffer_load_dwordx4 v13, s[20:23], s41 offen offset:1024 lds
    v_mfma_f32_16x16x32_bf16 v[76:79], a[160:163], a[100:103], v[76:79]
    v_mfma_f32_16x16x32_bf16 a[200:203], a[220:223], a[180:183], 0
    v_mfma_f32_16x16x32_bf16 v[80:83], a[156:159], a[88:91], v[80:83]
    ds_read_b64_tr_b16 a[150:151], v4 offset:16896
    v_mfma_f32_16x16x32_bf16 v[80:83], a[160:163], a[104:107], v[80:83]
    v_mfma_f32_16x16x32_bf16 a[64:67], a[156:159], a[92:95], a[64:67]
    ds_read_b64_tr_b16 a[152:153], v4 offset:20480
    buffer_load_dwordx4 v13, s[20:23], s42 offen offset:2048 lds
    v_mfma_f32_16x16x32_bf16 a[64:67], a[160:163], a[108:111], a[64:67]
    v_mfma_f32_16x16x32_bf16 a[204:207], a[220:223], a[184:187], 0
    v_mfma_f32_16x16x32_bf16 a[20:23], a[156:159], a[96:99], a[20:23]
    ds_read_b64_tr_b16 a[154:155], v4 offset:20992
    v_mfma_f32_16x16x32_bf16 a[20:23], a[160:163], a[112:115], a[20:23]
    s_waitcnt lgkmcnt(10)
    v_mfma_f32_16x16x32_bf16 v[84:87], a[164:167], a[84:87], v[84:87]
    ds_read_b64_tr_b16 a[156:157], v5 offset:16384
    buffer_load_dwordx4 v13, s[20:23], s43 offen offset:3072 lds
    v_mfma_f32_16x16x32_bf16 v[84:87], a[168:171], a[100:103], v[84:87]
    s_add_u32 m0, s58, 126976
    v_mfma_f32_16x16x32_bf16 a[208:211], a[220:223], a[188:191], 0
    v_mfma_f32_16x16x32_bf16 v[88:91], a[164:167], a[88:91], v[88:91]
    ds_read_b64_tr_b16 a[158:159], v5 offset:16896
    v_mfma_f32_16x16x32_bf16 v[88:91], a[168:171], a[104:107], v[88:91]
    v_mfma_f32_16x16x32_bf16 v[92:95], a[164:167], a[92:95], v[92:95]
    ds_read_b64_tr_b16 a[160:161], v5 offset:20480
    buffer_load_dwordx4 v13, s[20:23], s84 offen offset:0 lds
    v_mfma_f32_16x16x32_bf16 v[92:95], a[168:171], a[108:111], v[92:95]
    v_mfma_f32_16x16x32_bf16 a[212:215], a[220:223], a[192:195], 0
    v_mfma_f32_16x16x32_bf16 a[24:27], a[164:167], a[96:99], a[24:27]
    ds_read_b64_tr_b16 a[162:163], v5 offset:20992
    v_mfma_f32_16x16x32_bf16 a[24:27], a[168:171], a[112:115], a[24:27]
    s_waitcnt lgkmcnt(8)
    v_mfma_f32_16x16x32_bf16 v[96:99], a[172:175], a[84:87], v[96:99]
    ds_read_b64_tr_b16 a[164:165], v6 offset:16384
    buffer_load_dwordx4 v13, s[20:23], s85 offen offset:1024 lds
    v_mfma_f32_16x16x32_bf16 v[96:99], a[176:179], a[100:103], v[96:99]
    v_mfma_f32_16x16x32_bf16 a[216:219], a[220:223], a[196:199], 0
    v_mfma_f32_16x16x32_bf16 v[100:103], a[172:175], a[88:91], v[100:103]
    ds_read_b64_tr_b16 a[166:167], v6 offset:16896
    v_mfma_f32_16x16x32_bf16 v[100:103], a[176:179], a[104:107], v[100:103]
    v_mfma_f32_16x16x32_bf16 a[68:71], a[172:175], a[92:95], a[68:71]
    ds_read_b64_tr_b16 a[168:169], v6 offset:20480
    buffer_load_dwordx4 v13, s[20:23], s86 offen offset:2048 lds
    v_mfma_f32_16x16x32_bf16 a[68:71], a[176:179], a[108:111], a[68:71]
    ds_read_b64_tr_b16 a[180:181], v1 offset:4096
    ds_read_b64_tr_b16 a[182:183], v1 offset:4608
    v_mfma_f32_16x16x32_bf16 a[28:31], a[172:175], a[96:99], a[28:31]
    ds_read_b64_tr_b16 a[170:171], v6 offset:20992
    v_mfma_f32_16x16x32_bf16 a[28:31], a[176:179], a[112:115], a[28:31]
    s_waitcnt lgkmcnt(10)
    v_mfma_f32_16x16x32_bf16 v[104:107], a[148:151], a[84:87], v[104:107]
    ds_read_b64_tr_b16 a[172:173], v7 offset:16384
    buffer_load_dwordx4 v13, s[20:23], s87 offen offset:3072 lds
    v_mfma_f32_16x16x32_bf16 v[104:107], a[152:155], a[100:103], v[104:107]
    s_cmp_eq_u32 s51, 5
    s_movk_i32 s82, 128
    v_mfma_f32_16x16x32_bf16 v[108:111], a[148:151], a[88:91], v[108:111]
    ds_read_b64_tr_b16 a[174:175], v7 offset:16896
    s_cselect_b32 s82, 384, s82
    v_mfma_f32_16x16x32_bf16 v[108:111], a[152:155], a[104:107], v[108:111]
    v_add_u32 v13, s82, v13
    ds_read_b64_tr_b16 a[184:185], v2 offset:4096
    v_mfma_f32_16x16x32_bf16 v[112:115], a[148:151], a[92:95], v[112:115]
    ds_read_b64_tr_b16 a[176:177], v7 offset:20480
    ds_read_b64_tr_b16 a[186:187], v2 offset:4608
    v_mfma_f32_16x16x32_bf16 v[112:115], a[152:155], a[108:111], v[112:115]
    s_add_u32 m0, s58, 0
    ds_read_b64_tr_b16 a[188:189], v3 offset:4096
    v_mfma_f32_16x16x32_bf16 a[32:35], a[148:151], a[96:99], a[32:35]
    ds_read_b64_tr_b16 a[178:179], v7 offset:20992
    ds_read_b64_tr_b16 a[190:191], v3 offset:4608
    v_mfma_f32_16x16x32_bf16 a[32:35], a[152:155], a[112:115], a[32:35]
    s_waitcnt lgkmcnt(14)
    v_mfma_f32_16x16x32_bf16 v[116:119], a[156:159], a[84:87], v[116:119]
    ds_read_b64_tr_b16 a[148:149], v4 offset:24576
    buffer_load_dwordx4 v10, s[24:27], s62 offen offset:0 lds
    v_mfma_f32_16x16x32_bf16 v[116:119], a[160:163], a[100:103], v[116:119]
    ds_read_b64_tr_b16 a[192:193], v14 offset:4096
    ds_read_b64_tr_b16 a[194:195], v14 offset:4608
    v_mfma_f32_16x16x32_bf16 v[120:123], a[156:159], a[88:91], v[120:123]
    ds_read_b64_tr_b16 a[150:151], v4 offset:25088
    v_mfma_f32_16x16x32_bf16 v[120:123], a[160:163], a[104:107], v[120:123]
    v_mfma_f32_16x16x32_bf16 v[124:127], a[156:159], a[92:95], v[124:127]
    ds_read_b64_tr_b16 a[152:153], v4 offset:28672
    ds_read_b64_tr_b16 a[196:197], v15 offset:4096
    v_mfma_f32_16x16x32_bf16 v[124:127], a[160:163], a[108:111], v[124:127]
    ds_read_b64_tr_b16 a[198:199], v15 offset:4352
    v_mfma_f32_16x16x32_bf16 a[36:39], a[156:159], a[96:99], a[36:39]
    ds_read_b64_tr_b16 a[154:155], v4 offset:29184
    v_mfma_f32_16x16x32_bf16 a[36:39], a[160:163], a[112:115], a[36:39]
    s_waitcnt lgkmcnt(15)
    v_mfma_f32_16x16x32_bf16 v[128:131], a[164:167], a[84:87], v[128:131]
    ds_read_b64_tr_b16 a[156:157], v5 offset:24576
    buffer_load_dwordx4 v11, s[24:27], s63 offen offset:1024 lds
    v_mfma_f32_16x16x32_bf16 v[128:131], a[168:171], a[100:103], v[128:131]
    v_add_u32 v4, 40960, v4
    v_mfma_f32_16x16x32_bf16 v[132:135], a[164:167], a[88:91], v[132:135]
    ds_read_b64_tr_b16 a[158:159], v5 offset:25088
    v_mfma_f32_16x16x32_bf16 v[132:135], a[168:171], a[104:107], v[132:135]
    v_mfma_f32_16x16x32_bf16 v[136:139], a[164:167], a[92:95], v[136:139]
    ds_read_b64_tr_b16 a[160:161], v5 offset:28672
    v_mfma_f32_16x16x32_bf16 a[200:203], a[220:223], a[180:183], a[200:203]
    v_mfma_f32_16x16x32_bf16 v[136:139], a[168:171], a[108:111], v[136:139]
    v_mfma_f32_16x16x32_bf16 a[40:43], a[164:167], a[96:99], a[40:43]
    ds_read_b64_tr_b16 a[162:163], v5 offset:29184
    v_mfma_f32_16x16x32_bf16 a[40:43], a[168:171], a[112:115], a[40:43]
    s_waitcnt lgkmcnt(13)
    v_mfma_f32_16x16x32_bf16 v[140:143], a[172:175], a[84:87], v[140:143]
    ds_read_b64_tr_b16 a[164:165], v6 offset:24576
    buffer_load_dwordx4 v10, s[24:27], s64 offen offset:2048 lds
    v_mfma_f32_16x16x32_bf16 v[140:143], a[176:179], a[100:103], v[140:143]
    v_add_u32 v5, 40960, v5
    v_mfma_f32_16x16x32_bf16 a[204:207], a[220:223], a[184:187], a[204:207]
    v_mfma_f32_16x16x32_bf16 v[144:147], a[172:175], a[88:91], v[144:147]
    ds_read_b64_tr_b16 a[166:167], v6 offset:25088
    v_mfma_f32_16x16x32_bf16 v[144:147], a[176:179], a[104:107], v[144:147]
    v_mfma_f32_16x16x32_bf16 a[80:83], a[172:175], a[92:95], a[80:83]
    ds_read_b64_tr_b16 a[168:169], v6 offset:28672
    s_waitcnt lgkmcnt(15)
    v_mfma_f32_16x16x32_bf16 a[208:211], a[220:223], a[188:191], a[208:211]
    v_mfma_f32_16x16x32_bf16 a[80:83], a[176:179], a[108:111], a[80:83]
    v_mfma_f32_16x16x32_bf16 a[44:47], a[172:175], a[96:99], a[44:47]
    ds_read_b64_tr_b16 a[170:171], v6 offset:29184
    v_mfma_f32_16x16x32_bf16 a[44:47], a[176:179], a[112:115], a[44:47]
    s_waitcnt lgkmcnt(8)
    v_mfma_f32_16x16x32_bf16 v[148:151], a[148:151], a[84:87], v[148:151]
    ds_read_b64_tr_b16 a[172:173], v7 offset:24576
    buffer_load_dwordx4 v11, s[24:27], s65 offen offset:3072 lds
    v_mfma_f32_16x16x32_bf16 v[148:151], a[152:155], a[100:103], v[148:151]
    v_add_u32 v6, 40960, v6
    v_mfma_f32_16x16x32_bf16 a[212:215], a[220:223], a[192:195], a[212:215]
    v_mfma_f32_16x16x32_bf16 v[152:155], a[148:151], a[88:91], v[152:155]
    ds_read_b64_tr_b16 a[174:175], v7 offset:25088
    v_mfma_f32_16x16x32_bf16 v[152:155], a[152:155], a[104:107], v[152:155]
    v_mfma_f32_16x16x32_bf16 v[156:159], a[148:151], a[92:95], v[156:159]
    ds_read_b64_tr_b16 a[176:177], v7 offset:28672
    s_add_u32 m0, s58, 4096
    v_mfma_f32_16x16x32_bf16 v[156:159], a[152:155], a[108:111], v[156:159]
    v_mfma_f32_16x16x32_bf16 a[216:219], a[220:223], a[196:199], a[216:219]
    v_mfma_f32_16x16x32_bf16 a[48:51], a[148:151], a[96:99], a[48:51]
    ds_read_b64_tr_b16 a[178:179], v7 offset:29184
    v_mfma_f32_16x16x32_bf16 a[48:51], a[152:155], a[112:115], a[48:51]
    s_waitcnt lgkmcnt(8)
    v_mfma_f32_16x16x32_bf16 v[160:163], a[156:159], a[84:87], v[160:163]
    ds_read_b64_tr_b16 a[148:149], v8 offset:0
    buffer_load_dwordx4 v10, s[24:27], s66 offen offset:0 lds
    v_mfma_f32_16x16x32_bf16 v[160:163], a[160:163], a[100:103], v[160:163]
    v_add_u32 v7, 40960, v7
    v_mfma_f32_16x16x32_bf16 v[164:167], a[156:159], a[88:91], v[164:167]
    ds_read_b64_tr_b16 a[150:151], v8 offset:256
    v_mfma_f32_16x16x32_bf16 v[164:167], a[160:163], a[104:107], v[164:167]
    v_mfma_f32_16x16x32_bf16 a[72:75], a[156:159], a[92:95], a[72:75]
    ds_read_b64_tr_b16 a[152:153], v8 offset:4096
    v_mfma_f32_16x16x32_bf16 a[72:75], a[160:163], a[108:111], a[72:75]
    v_mfma_f32_16x16x32_bf16 a[52:55], a[156:159], a[96:99], a[52:55]
    ds_read_b64_tr_b16 a[154:155], v8 offset:4352
    v_mfma_f32_16x16x32_bf16 a[52:55], a[160:163], a[112:115], a[52:55]
    s_waitcnt lgkmcnt(8)
    v_mfma_f32_16x16x32_bf16 v[168:171], a[164:167], a[84:87], v[168:171]
    ds_read_b64_tr_b16 a[156:157], v9 offset:0
    buffer_load_dwordx4 v11, s[24:27], s67 offen offset:1024 lds
    v_mfma_f32_16x16x32_bf16 v[168:171], a[168:171], a[100:103], v[168:171]
    v_mfma_f32_16x16x32_bf16 v[172:175], a[164:167], a[88:91], v[172:175]
    ds_read_b64_tr_b16 a[158:159], v9 offset:256
    v_mfma_f32_16x16x32_bf16 v[172:175], a[168:171], a[104:107], v[172:175]
    v_mfma_f32_16x16x32_bf16 v[176:179], a[164:167], a[92:95], v[176:179]
    ds_read_b64_tr_b16 a[160:161], v9 offset:4096
    v_mfma_f32_16x16x32_bf16 v[176:179], a[168:171], a[108:111], v[176:179]
    v_mfma_f32_16x16x32_bf16 a[56:59], a[164:167], a[96:99], a[56:59]
    ds_read_b64_tr_b16 a[162:163], v9 offset:4352
    v_mfma_f32_16x16x32_bf16 a[56:59], a[168:171], a[112:115], a[56:59]
    s_waitcnt lgkmcnt(8)
    v_mfma_f32_16x16x32_bf16 v[180:183], a[172:175], a[84:87], v[180:183]
    ds_read_b64_tr_b16 a[164:165], v8 offset:1024
    buffer_load_dwordx4 v10, s[24:27], s68 offen offset:2048 lds
    v_mfma_f32_16x16x32_bf16 v[180:183], a[176:179], a[100:103], v[180:183]
    v_mfma_f32_16x16x32_bf16 v[184:187], a[172:175], a[88:91], v[184:187]
    ds_read_b64_tr_b16 a[166:167], v8 offset:1280
    v_mfma_f32_16x16x32_bf16 v[184:187], a[176:179], a[104:107], v[184:187]
    v_mfma_f32_16x16x32_bf16 a[76:79], a[172:175], a[92:95], a[76:79]
    ds_read_b64_tr_b16 a[168:169], v8 offset:5120
    v_mfma_f32_16x16x32_bf16 a[76:79], a[176:179], a[108:111], a[76:79]
    v_mfma_f32_16x16x32_bf16 a[60:63], a[172:175], a[96:99], a[60:63]
    ds_read_b64_tr_b16 a[170:171], v8 offset:5376
    v_mfma_f32_16x16x32_bf16 a[60:63], a[176:179], a[112:115], a[60:63]
    s_waitcnt lgkmcnt(8)
    v_mfma_f32_16x16x32_bf16 v[188:191], a[148:151], a[84:87], v[188:191]
    ds_read_b64_tr_b16 a[172:173], v9 offset:1024
    buffer_load_dwordx4 v11, s[24:27], s69 offen offset:3072 lds
    v_mfma_f32_16x16x32_bf16 v[188:191], a[152:155], a[100:103], v[188:191]
    v_add_u32 v8, 40960, v8
    v_mfma_f32_16x16x32_bf16 v[192:195], a[148:151], a[88:91], v[192:195]
    ds_read_b64_tr_b16 a[174:175], v9 offset:1280
    v_mfma_f32_16x16x32_bf16 v[192:195], a[152:155], a[104:107], v[192:195]
    v_mfma_f32_16x16x32_bf16 v[196:199], a[148:151], a[92:95], v[196:199]
    ds_read_b64_tr_b16 a[176:177], v9 offset:5120
    s_add_u32 m0, s59, 0
    v_mfma_f32_16x16x32_bf16 v[196:199], a[152:155], a[108:111], v[196:199]
    v_mfma_f32_16x16x32_bf16 v[200:203], a[148:151], a[96:99], v[200:203]
    ds_read_b64_tr_b16 a[178:179], v9 offset:5376
    v_mfma_f32_16x16x32_bf16 v[200:203], a[152:155], a[112:115], v[200:203]
    s_waitcnt lgkmcnt(8)
    v_mfma_f32_16x16x32_bf16 v[204:207], a[156:159], a[84:87], v[204:207]
    buffer_load_dwordx4 v12, s[28:31], s52 offen lds
    v_mfma_f32_16x16x32_bf16 v[204:207], a[160:163], a[100:103], v[204:207]
    v_add_u32 v9, 40960, v9
    v_mfma_f32_16x16x32_bf16 v[208:211], a[156:159], a[88:91], v[208:211]
    v_mfma_f32_16x16x32_bf16 v[208:211], a[160:163], a[104:107], v[208:211]
    v_mfma_f32_16x16x32_bf16 v[212:215], a[156:159], a[92:95], v[212:215]
    s_add_u32 m0, s59, 1024
    v_mfma_f32_16x16x32_bf16 v[212:215], a[160:163], a[108:111], v[212:215]
    v_mfma_f32_16x16x32_bf16 v[216:219], a[156:159], a[96:99], v[216:219]
    v_mfma_f32_16x16x32_bf16 v[216:219], a[160:163], a[112:115], v[216:219]
    s_waitcnt vmcnt(17) lgkmcnt(0)
    s_barrier
    v_mfma_f32_16x16x32_bf16 v[220:223], a[164:167], a[84:87], v[220:223]
    ds_read_b64_tr_b16 a[148:149], v4 offset:0
    buffer_load_dwordx4 v12, s[32:35], s53 offen lds
    v_mfma_f32_16x16x32_bf16 v[220:223], a[168:171], a[100:103], v[220:223]
    ds_read_b64_tr_b16 a[150:151], v4 offset:512
    s_cmp_eq_u32 s51, 5
    v_mfma_f32_16x16x32_bf16 v[224:227], a[164:167], a[88:91], v[224:227]
    ds_read_b64_tr_b16 a[152:153], v4 offset:4096
    s_cselect_b32 s82, s73, s56
    v_mfma_f32_16x16x32_bf16 v[224:227], a[168:171], a[104:107], v[224:227]
    ds_read_b64_tr_b16 a[154:155], v4 offset:4608
    s_cselect_b32 s83, s74, s57
    v_mfma_f32_16x16x32_bf16 v[228:231], a[164:167], a[92:95], v[228:231]
    ds_read_b64_tr_b16 a[156:157], v5 offset:0
    v_add_u32 v10, s82, v10
    v_mfma_f32_16x16x32_bf16 v[228:231], a[168:171], a[108:111], v[228:231]
    ds_read_b64_tr_b16 a[158:159], v5 offset:512
    v_add_u32 v11, s82, v11
    v_mfma_f32_16x16x32_bf16 v[232:235], a[164:167], a[96:99], v[232:235]
    ds_read_b64_tr_b16 a[160:161], v5 offset:4096
    v_add_u32 v12, s83, v12
    v_mfma_f32_16x16x32_bf16 v[232:235], a[168:171], a[112:115], v[232:235]
    ds_read_b64_tr_b16 a[162:163], v5 offset:4608
    v_mfma_f32_16x16x32_bf16 v[236:239], a[172:175], a[84:87], v[236:239]
    ds_read_b64_tr_b16 a[164:165], v6 offset:0
    v_mfma_f32_16x16x32_bf16 v[236:239], a[176:179], a[100:103], v[236:239]
    v_mfma_f32_16x16x32_bf16 v[240:243], a[172:175], a[88:91], v[240:243]
    ds_read_b64_tr_b16 a[166:167], v6 offset:512
    v_mfma_f32_16x16x32_bf16 v[240:243], a[176:179], a[104:107], v[240:243]
    v_mfma_f32_16x16x32_bf16 v[244:247], a[172:175], a[92:95], v[244:247]
    ds_read_b64_tr_b16 a[168:169], v6 offset:4096
    v_mfma_f32_16x16x32_bf16 v[244:247], a[176:179], a[108:111], v[244:247]
    v_mfma_f32_16x16x32_bf16 v[248:251], a[172:175], a[96:99], v[248:251]
    ds_read_b64_tr_b16 a[170:171], v6 offset:4608
    v_mfma_f32_16x16x32_bf16 v[248:251], a[176:179], a[112:115], v[248:251]
    s_waitcnt lgkmcnt(8)
    v_mfma_f32_16x16x32_bf16 v[16:19], a[148:151], a[116:119], v[16:19]
    ds_read_b64_tr_b16 a[172:173], v7 offset:0
    s_waitcnt vmcnt(16)
    v_mfma_f32_16x16x32_bf16 v[16:19], a[152:155], a[132:135], v[16:19]
    ds_read_b128 a[84:87], v252 offset:40960
    v_add_u32 v1, s81, v4
    v_mfma_f32_16x16x32_bf16 v[20:23], a[148:151], a[120:123], v[20:23]
    ds_read_b64_tr_b16 a[174:175], v7 offset:512
    v_add_u32 v2, s81, v5
    v_mfma_f32_16x16x32_bf16 v[20:23], a[152:155], a[136:139], v[20:23]
    v_add_u32 v3, s81, v6
    v_add_u32 v14, s81, v7
    v_mfma_f32_16x16x32_bf16 v[24:27], a[148:151], a[124:127], v[24:27]
    ds_read_b64_tr_b16 a[176:177], v7 offset:4096
    ds_read_b128 a[100:103], v253 offset:40960
    v_mfma_f32_16x16x32_bf16 v[24:27], a[152:155], a[140:143], v[24:27]
    s_bitcmp1_b32 s50, 0
    s_cselect_b64 vcc, -1, 0
    v_mfma_f32_16x16x32_bf16 a[0:3], a[148:151], a[128:131], a[0:3]
    ds_read_b64_tr_b16 a[178:179], v7 offset:4608
    v_cndmask_b32 v15, v8, v9, vcc
    v_mfma_f32_16x16x32_bf16 a[0:3], a[152:155], a[144:147], a[0:3]
    s_lshr_b32 s16, s50, 1
    s_waitcnt lgkmcnt(10)
    v_mfma_f32_16x16x32_bf16 v[28:31], a[156:159], a[116:119], v[28:31]
    ds_read_b64_tr_b16 a[148:149], v4 offset:8192
    s_lshl_b32 s16, s16, 10
    v_mfma_f32_16x16x32_bf16 v[28:31], a[160:163], a[132:135], v[28:31]
    v_add_u32 v15, s16, v15
    s_waitcnt vmcnt(14)
    v_mfma_f32_16x16x32_bf16 v[32:35], a[156:159], a[120:123], v[32:35]
    ds_read_b64_tr_b16 a[150:151], v4 offset:8704
    ds_read_b128 a[88:91], v252 offset:43008
    v_mfma_f32_16x16x32_bf16 v[32:35], a[160:163], a[136:139], v[32:35]
    v_mfma_f32_16x16x32_bf16 v[36:39], a[156:159], a[124:127], v[36:39]
    ds_read_b64_tr_b16 a[152:153], v4 offset:12288
    ds_read_b128 a[104:107], v253 offset:43008
    v_mfma_f32_16x16x32_bf16 v[36:39], a[160:163], a[140:143], v[36:39]
    v_mfma_f32_16x16x32_bf16 a[4:7], a[156:159], a[128:131], a[4:7]
    ds_read_b64_tr_b16 a[154:155], v4 offset:12800
    v_mfma_f32_16x16x32_bf16 a[4:7], a[160:163], a[144:147], a[4:7]
    s_waitcnt lgkmcnt(12)
    v_mfma_f32_16x16x32_bf16 v[40:43], a[164:167], a[116:119], v[40:43]
    ds_read_b64_tr_b16 a[156:157], v5 offset:8192
    s_waitcnt vmcnt(12)
    v_mfma_f32_16x16x32_bf16 v[40:43], a[168:171], a[132:135], v[40:43]
    ds_read_b128 a[92:95], v252 offset:45056
    ds_read_b64_tr_b16 a[180:181], v1 offset:0
    v_mfma_f32_16x16x32_bf16 v[44:47], a[164:167], a[120:123], v[44:47]
    ds_read_b64_tr_b16 a[158:159], v5 offset:8704
    ds_read_b64_tr_b16 a[182:183], v1 offset:512
    v_mfma_f32_16x16x32_bf16 v[44:47], a[168:171], a[136:139], v[44:47]
    v_mfma_f32_16x16x32_bf16 v[48:51], a[164:167], a[124:127], v[48:51]
    ds_read_b64_tr_b16 a[160:161], v5 offset:12288
    ds_read_b128 a[108:111], v253 offset:45056
    v_mfma_f32_16x16x32_bf16 v[48:51], a[168:171], a[140:143], v[48:51]
    ds_read_b64_tr_b16 a[184:185], v2 offset:0
    ds_read_b64_tr_b16 a[186:187], v2 offset:512
    v_mfma_f32_16x16x32_bf16 a[8:11], a[164:167], a[128:131], a[8:11]
    ds_read_b64_tr_b16 a[162:163], v5 offset:12800
    v_mfma_f32_16x16x32_bf16 a[8:11], a[168:171], a[144:147], a[8:11]
    s_waitcnt lgkmcnt(15)
    v_mfma_f32_16x16x32_bf16 v[52:55], a[172:175], a[116:119], v[52:55]
    ds_read_b64_tr_b16 a[164:165], v6 offset:8192
    s_waitcnt vmcnt(10)
    v_mfma_f32_16x16x32_bf16 v[52:55], a[176:179], a[132:135], v[52:55]
    ds_read_b128 a[96:99], v252 offset:47104
    ds_read_b64_tr_b16 a[188:189], v3 offset:0
    v_mfma_f32_16x16x32_bf16 v[56:59], a[172:175], a[120:123], v[56:59]
    ds_read_b64_tr_b16 a[166:167], v6 offset:8704
    ds_read_b64_tr_b16 a[190:191], v3 offset:512
    v_mfma_f32_16x16x32_bf16 v[56:59], a[176:179], a[136:139], v[56:59]
    v_mfma_f32_16x16x32_bf16 v[60:63], a[172:175], a[124:127], v[60:63]
    ds_read_b64_tr_b16 a[168:169], v6 offset:12288
    ds_read_b128 a[112:115], v253 offset:47104
    v_mfma_f32_16x16x32_bf16 v[60:63], a[176:179], a[140:143], v[60:63]
    ds_read_b64_tr_b16 a[192:193], v14 offset:0
    ds_read_b64_tr_b16 a[194:195], v14 offset:512
    v_mfma_f32_16x16x32_bf16 a[12:15], a[172:175], a[128:131], a[12:15]
    ds_read_b64_tr_b16 a[170:171], v6 offset:12800
    v_mfma_f32_16x16x32_bf16 a[12:15], a[176:179], a[144:147], a[12:15]
    s_waitcnt lgkmcnt(15)
    v_mfma_f32_16x16x32_bf16 v[64:67], a[148:151], a[116:119], v[64:67]
    ds_read_b64_tr_b16 a[172:173], v7 offset:8192
    s_add_u32 m0, s58, 122880
    v_mfma_f32_16x16x32_bf16 v[64:67], a[152:155], a[132:135], v[64:67]
    ds_read_b64_tr_b16 a[196:197], v15 offset:0
    ds_read_b64_tr_b16 a[198:199], v15 offset:256
    v_mfma_f32_16x16x32_bf16 v[68:71], a[148:151], a[120:123], v[68:71]
    ds_read_b64_tr_b16 a[174:175], v7 offset:8704
    v_mfma_f32_16x16x32_bf16 v[68:71], a[152:155], a[136:139], v[68:71]
    v_mfma_f32_16x16x32_bf16 v[72:75], a[148:151], a[124:127], v[72:75]
    ds_read_b64_tr_b16 a[176:177], v7 offset:12288
    buffer_load_dwordx4 v13, s[20:23], s40 offen offset:0 lds
    v_mfma_f32_16x16x32_bf16 v[72:75], a[152:155], a[140:143], v[72:75]
    v_mfma_f32_16x16x32_bf16 a[16:19], a[148:151], a[128:131], a[16:19]
    ds_read_b64_tr_b16 a[178:179], v7 offset:12800
    v_mfma_f32_16x16x32_bf16 a[16:19], a[152:155], a[144:147], a[16:19]
    s_waitcnt lgkmcnt(15)
    v_mfma_f32_16x16x32_bf16 v[76:79], a[156:159], a[116:119], v[76:79]
    ds_read_b64_tr_b16 a[148:149], v4 offset:16384
    buffer_load_dwordx4 v13, s[20:23], s41 offen offset:1024 lds
    v_mfma_f32_16x16x32_bf16 v[76:79], a[160:163], a[132:135], v[76:79]
    v_mfma_f32_16x16x32_bf16 a[200:203], a[220:223], a[180:183], a[200:203]
    v_mfma_f32_16x16x32_bf16 v[80:83], a[156:159], a[120:123], v[80:83]
    ds_read_b64_tr_b16 a[150:151], v4 offset:16896
    v_mfma_f32_16x16x32_bf16 v[80:83], a[160:163], a[136:139], v[80:83]
    v_mfma_f32_16x16x32_bf16 a[64:67], a[156:159], a[124:127], a[64:67]
    ds_read_b64_tr_b16 a[152:153], v4 offset:20480
    buffer_load_dwordx4 v13, s[20:23], s42 offen offset:2048 lds
    v_mfma_f32_16x16x32_bf16 a[64:67], a[160:163], a[140:143], a[64:67]
    v_mfma_f32_16x16x32_bf16 a[204:207], a[220:223], a[184:187], a[204:207]
    v_mfma_f32_16x16x32_bf16 a[20:23], a[156:159], a[128:131], a[20:23]
    ds_read_b64_tr_b16 a[154:155], v4 offset:20992
    v_mfma_f32_16x16x32_bf16 a[20:23], a[160:163], a[144:147], a[20:23]
    s_waitcnt lgkmcnt(10)
    v_mfma_f32_16x16x32_bf16 v[84:87], a[164:167], a[116:119], v[84:87]
    ds_read_b64_tr_b16 a[156:157], v5 offset:16384
    buffer_load_dwordx4 v13, s[20:23], s43 offen offset:3072 lds
    v_mfma_f32_16x16x32_bf16 v[84:87], a[168:171], a[132:135], v[84:87]
    s_add_u32 m0, s58, 126976
    v_mfma_f32_16x16x32_bf16 a[208:211], a[220:223], a[188:191], a[208:211]
    v_mfma_f32_16x16x32_bf16 v[88:91], a[164:167], a[120:123], v[88:91]
    ds_read_b64_tr_b16 a[158:159], v5 offset:16896
    v_mfma_f32_16x16x32_bf16 v[88:91], a[168:171], a[136:139], v[88:91]
    v_mfma_f32_16x16x32_bf16 v[92:95], a[164:167], a[124:127], v[92:95]
    ds_read_b64_tr_b16 a[160:161], v5 offset:20480
    buffer_load_dwordx4 v13, s[20:23], s84 offen offset:0 lds
    v_mfma_f32_16x16x32_bf16 v[92:95], a[168:171], a[140:143], v[92:95]
    v_mfma_f32_16x16x32_bf16 a[212:215], a[220:223], a[192:195], a[212:215]
    v_mfma_f32_16x16x32_bf16 a[24:27], a[164:167], a[128:131], a[24:27]
    ds_read_b64_tr_b16 a[162:163], v5 offset:20992
    v_mfma_f32_16x16x32_bf16 a[24:27], a[168:171], a[144:147], a[24:27]
    s_waitcnt lgkmcnt(8)
    v_mfma_f32_16x16x32_bf16 v[96:99], a[172:175], a[116:119], v[96:99]
    ds_read_b64_tr_b16 a[164:165], v6 offset:16384
    buffer_load_dwordx4 v13, s[20:23], s85 offen offset:1024 lds
    v_mfma_f32_16x16x32_bf16 v[96:99], a[176:179], a[132:135], v[96:99]
    v_mfma_f32_16x16x32_bf16 a[216:219], a[220:223], a[196:199], a[216:219]
    v_mfma_f32_16x16x32_bf16 v[100:103], a[172:175], a[120:123], v[100:103]
    ds_read_b64_tr_b16 a[166:167], v6 offset:16896
    v_mfma_f32_16x16x32_bf16 v[100:103], a[176:179], a[136:139], v[100:103]
    v_mfma_f32_16x16x32_bf16 a[68:71], a[172:175], a[124:127], a[68:71]
    ds_read_b64_tr_b16 a[168:169], v6 offset:20480
    buffer_load_dwordx4 v13, s[20:23], s86 offen offset:2048 lds
    v_mfma_f32_16x16x32_bf16 a[68:71], a[176:179], a[140:143], a[68:71]
    ds_read_b64_tr_b16 a[180:181], v1 offset:4096
    ds_read_b64_tr_b16 a[182:183], v1 offset:4608
    v_mfma_f32_16x16x32_bf16 a[28:31], a[172:175], a[128:131], a[28:31]
    ds_read_b64_tr_b16 a[170:171], v6 offset:20992
    v_mfma_f32_16x16x32_bf16 a[28:31], a[176:179], a[144:147], a[28:31]
    s_waitcnt lgkmcnt(10)
    v_mfma_f32_16x16x32_bf16 v[104:107], a[148:151], a[116:119], v[104:107]
    ds_read_b64_tr_b16 a[172:173], v7 offset:16384
    buffer_load_dwordx4 v13, s[20:23], s87 offen offset:3072 lds
    v_mfma_f32_16x16x32_bf16 v[104:107], a[152:155], a[132:135], v[104:107]
    s_cmp_eq_u32 s51, 6
    s_movk_i32 s82, 128
    v_mfma_f32_16x16x32_bf16 v[108:111], a[148:151], a[120:123], v[108:111]
    ds_read_b64_tr_b16 a[174:175], v7 offset:16896
    s_cselect_b32 s82, 384, s82
    v_mfma_f32_16x16x32_bf16 v[108:111], a[152:155], a[136:139], v[108:111]
    v_add_u32 v13, s82, v13
    ds_read_b64_tr_b16 a[184:185], v2 offset:4096
    v_mfma_f32_16x16x32_bf16 v[112:115], a[148:151], a[124:127], v[112:115]
    ds_read_b64_tr_b16 a[176:177], v7 offset:20480
    ds_read_b64_tr_b16 a[186:187], v2 offset:4608
    v_mfma_f32_16x16x32_bf16 v[112:115], a[152:155], a[140:143], v[112:115]
    s_add_u32 m0, s58, 40960
    ds_read_b64_tr_b16 a[188:189], v3 offset:4096
    v_mfma_f32_16x16x32_bf16 a[32:35], a[148:151], a[128:131], a[32:35]
    ds_read_b64_tr_b16 a[178:179], v7 offset:20992
    ds_read_b64_tr_b16 a[190:191], v3 offset:4608
    v_mfma_f32_16x16x32_bf16 a[32:35], a[152:155], a[144:147], a[32:35]
    s_waitcnt lgkmcnt(14)
    v_mfma_f32_16x16x32_bf16 v[116:119], a[156:159], a[116:119], v[116:119]
    ds_read_b64_tr_b16 a[148:149], v4 offset:24576
    buffer_load_dwordx4 v10, s[24:27], s62 offen offset:0 lds
    v_mfma_f32_16x16x32_bf16 v[116:119], a[160:163], a[132:135], v[116:119]
    ds_read_b64_tr_b16 a[192:193], v14 offset:4096
    ds_read_b64_tr_b16 a[194:195], v14 offset:4608
    v_mfma_f32_16x16x32_bf16 v[120:123], a[156:159], a[120:123], v[120:123]
    ds_read_b64_tr_b16 a[150:151], v4 offset:25088
    v_mfma_f32_16x16x32_bf16 v[120:123], a[160:163], a[136:139], v[120:123]
    v_mfma_f32_16x16x32_bf16 v[124:127], a[156:159], a[124:127], v[124:127]
    ds_read_b64_tr_b16 a[152:153], v4 offset:28672
    ds_read_b64_tr_b16 a[196:197], v15 offset:4096
    v_mfma_f32_16x16x32_bf16 v[124:127], a[160:163], a[140:143], v[124:127]
    ds_read_b64_tr_b16 a[198:199], v15 offset:4352
    v_mfma_f32_16x16x32_bf16 a[36:39], a[156:159], a[128:131], a[36:39]
    ds_read_b64_tr_b16 a[154:155], v4 offset:29184
    v_mfma_f32_16x16x32_bf16 a[36:39], a[160:163], a[144:147], a[36:39]
    s_waitcnt lgkmcnt(15)
    v_mfma_f32_16x16x32_bf16 v[128:131], a[164:167], a[116:119], v[128:131]
    ds_read_b64_tr_b16 a[156:157], v5 offset:24576
    buffer_load_dwordx4 v11, s[24:27], s63 offen offset:1024 lds
    v_mfma_f32_16x16x32_bf16 v[128:131], a[168:171], a[132:135], v[128:131]
    v_subrev_u32 v4, 81920, v4
    v_mfma_f32_16x16x32_bf16 v[132:135], a[164:167], a[120:123], v[132:135]
    ds_read_b64_tr_b16 a[158:159], v5 offset:25088
    v_mfma_f32_16x16x32_bf16 v[132:135], a[168:171], a[136:139], v[132:135]
    v_mfma_f32_16x16x32_bf16 v[136:139], a[164:167], a[124:127], v[136:139]
    ds_read_b64_tr_b16 a[160:161], v5 offset:28672
    v_mfma_f32_16x16x32_bf16 a[200:203], a[220:223], a[180:183], a[200:203]
    v_mfma_f32_16x16x32_bf16 v[136:139], a[168:171], a[140:143], v[136:139]
    v_mfma_f32_16x16x32_bf16 a[40:43], a[164:167], a[128:131], a[40:43]
    ds_read_b64_tr_b16 a[162:163], v5 offset:29184
    v_mfma_f32_16x16x32_bf16 a[40:43], a[168:171], a[144:147], a[40:43]
    s_waitcnt lgkmcnt(13)
    v_mfma_f32_16x16x32_bf16 v[140:143], a[172:175], a[116:119], v[140:143]
    ds_read_b64_tr_b16 a[164:165], v6 offset:24576
    buffer_load_dwordx4 v10, s[24:27], s64 offen offset:2048 lds
    v_mfma_f32_16x16x32_bf16 v[140:143], a[176:179], a[132:135], v[140:143]
    v_subrev_u32 v5, 81920, v5
    v_mfma_f32_16x16x32_bf16 a[204:207], a[220:223], a[184:187], a[204:207]
    v_mfma_f32_16x16x32_bf16 v[144:147], a[172:175], a[120:123], v[144:147]
    ds_read_b64_tr_b16 a[166:167], v6 offset:25088
    v_mfma_f32_16x16x32_bf16 v[144:147], a[176:179], a[136:139], v[144:147]
    v_mfma_f32_16x16x32_bf16 a[80:83], a[172:175], a[124:127], a[80:83]
    ds_read_b64_tr_b16 a[168:169], v6 offset:28672
    s_waitcnt lgkmcnt(15)
    v_mfma_f32_16x16x32_bf16 a[208:211], a[220:223], a[188:191], a[208:211]
    v_mfma_f32_16x16x32_bf16 a[80:83], a[176:179], a[140:143], a[80:83]
    v_mfma_f32_16x16x32_bf16 a[44:47], a[172:175], a[128:131], a[44:47]
    ds_read_b64_tr_b16 a[170:171], v6 offset:29184
    v_mfma_f32_16x16x32_bf16 a[44:47], a[176:179], a[144:147], a[44:47]
    s_waitcnt lgkmcnt(8)
    v_mfma_f32_16x16x32_bf16 v[148:151], a[148:151], a[116:119], v[148:151]
    ds_read_b64_tr_b16 a[172:173], v7 offset:24576
    buffer_load_dwordx4 v11, s[24:27], s65 offen offset:3072 lds
    v_mfma_f32_16x16x32_bf16 v[148:151], a[152:155], a[132:135], v[148:151]
    v_subrev_u32 v6, 81920, v6
    v_mfma_f32_16x16x32_bf16 a[212:215], a[220:223], a[192:195], a[212:215]
    v_mfma_f32_16x16x32_bf16 v[152:155], a[148:151], a[120:123], v[152:155]
    ds_read_b64_tr_b16 a[174:175], v7 offset:25088
    v_mfma_f32_16x16x32_bf16 v[152:155], a[152:155], a[136:139], v[152:155]
    v_mfma_f32_16x16x32_bf16 v[156:159], a[148:151], a[124:127], v[156:159]
    ds_read_b64_tr_b16 a[176:177], v7 offset:28672
    s_add_u32 m0, s58, 45056
    v_mfma_f32_16x16x32_bf16 v[156:159], a[152:155], a[140:143], v[156:159]
    v_mfma_f32_16x16x32_bf16 a[216:219], a[220:223], a[196:199], a[216:219]
    v_mfma_f32_16x16x32_bf16 a[48:51], a[148:151], a[128:131], a[48:51]
    ds_read_b64_tr_b16 a[178:179], v7 offset:29184
    v_mfma_f32_16x16x32_bf16 a[48:51], a[152:155], a[144:147], a[48:51]
    s_waitcnt lgkmcnt(8)
    v_mfma_f32_16x16x32_bf16 v[160:163], a[156:159], a[116:119], v[160:163]
    ds_read_b64_tr_b16 a[148:149], v8 offset:0
    buffer_load_dwordx4 v10, s[24:27], s66 offen offset:0 lds
    v_mfma_f32_16x16x32_bf16 v[160:163], a[160:163], a[132:135], v[160:163]
    v_subrev_u32 v7, 81920, v7
    v_mfma_f32_16x16x32_bf16 v[164:167], a[156:159], a[120:123], v[164:167]
    ds_read_b64_tr_b16 a[150:151], v8 offset:256
    v_mfma_f32_16x16x32_bf16 v[164:167], a[160:163], a[136:139], v[164:167]
    v_mfma_f32_16x16x32_bf16 a[72:75], a[156:159], a[124:127], a[72:75]
    ds_read_b64_tr_b16 a[152:153], v8 offset:4096
    v_mfma_f32_16x16x32_bf16 a[72:75], a[160:163], a[140:143], a[72:75]
    v_mfma_f32_16x16x32_bf16 a[52:55], a[156:159], a[128:131], a[52:55]
    ds_read_b64_tr_b16 a[154:155], v8 offset:4352
    v_mfma_f32_16x16x32_bf16 a[52:55], a[160:163], a[144:147], a[52:55]
    s_waitcnt lgkmcnt(8)
    v_mfma_f32_16x16x32_bf16 v[168:171], a[164:167], a[116:119], v[168:171]
    ds_read_b64_tr_b16 a[156:157], v9 offset:0
    buffer_load_dwordx4 v11, s[24:27], s67 offen offset:1024 lds
    v_mfma_f32_16x16x32_bf16 v[168:171], a[168:171], a[132:135], v[168:171]
    v_and_b32 v1, 15, v0
    v_lshlrev_b32 v1, 4, v1
    v_mfma_f32_16x16x32_bf16 v[172:175], a[164:167], a[120:123], v[172:175]
    ds_read_b64_tr_b16 a[158:159], v9 offset:256
    s_mul_i32 s16, s70, 20480
    v_mfma_f32_16x16x32_bf16 v[172:175], a[168:171], a[136:139], v[172:175]
    s_lshr_b32 s17, s71, 1
    s_lshl_b32 s17, s17, 8
    v_mfma_f32_16x16x32_bf16 v[176:179], a[164:167], a[124:127], v[176:179]
    ds_read_b64_tr_b16 a[160:161], v9 offset:4096
    s_add_u32 s16, s16, s17
    v_mfma_f32_16x16x32_bf16 v[176:179], a[168:171], a[140:143], v[176:179]
    s_and_b32 s17, s71, 1
    s_lshl_b32 s17, s17, 3
    v_mfma_f32_16x16x32_bf16 a[56:59], a[164:167], a[128:131], a[56:59]
    ds_read_b64_tr_b16 a[162:163], v9 offset:4352
    s_add_u32 s16, s16, s17
    v_mfma_f32_16x16x32_bf16 a[56:59], a[168:171], a[144:147], a[56:59]
    v_add_u32 v1, s16, v1
    s_waitcnt lgkmcnt(8)
    v_mfma_f32_16x16x32_bf16 v[180:183], a[172:175], a[116:119], v[180:183]
    ds_read_b64_tr_b16 a[164:165], v8 offset:1024
    v_mov_b32 v2, 0x7ff00000
    v_mfma_f32_16x16x32_bf16 v[180:183], a[176:179], a[132:135], v[180:183]
    v_cmp_gt_u32 vcc, 16, v0
    v_cndmask_b32 v1, v2, v1, vcc
    v_mfma_f32_16x16x32_bf16 v[184:187], a[172:175], a[120:123], v[184:187]
    ds_read_b64_tr_b16 a[166:167], v8 offset:1280
    buffer_load_dwordx4 v10, s[24:27], s68 offen offset:2048 lds
    v_mfma_f32_16x16x32_bf16 v[184:187], a[176:179], a[136:139], v[184:187]
    v_mfma_f32_16x16x32_bf16 a[76:79], a[172:175], a[124:127], a[76:79]
    ds_read_b64_tr_b16 a[168:169], v8 offset:5120
    s_lshl_b32 s16, s71, 2
    v_mfma_f32_16x16x32_bf16 a[76:79], a[176:179], a[140:143], a[76:79]
    s_lshl_b32 s17, s70, 2
    s_add_u32 s17, s17, 32
    v_mfma_f32_16x16x32_bf16 a[60:63], a[172:175], a[128:131], a[60:63]
    ds_read_b64_tr_b16 a[170:171], v8 offset:5376
    v_mov_b32 v255, s17
    v_mfma_f32_16x16x32_bf16 a[60:63], a[176:179], a[144:147], a[60:63]
    v_mov_b32 v3, s16
    s_waitcnt lgkmcnt(8)
    v_mfma_f32_16x16x32_bf16 v[188:191], a[148:151], a[116:119], v[188:191]
    ds_read_b64_tr_b16 a[172:173], v9 offset:1024
    v_and_b32 v14, 1, v0
    v_mfma_f32_16x16x32_bf16 v[188:191], a[152:155], a[132:135], v[188:191]
    v_subrev_u32 v8, 81920, v8
    v_cmp_eq_u32 vcc, 0, v14
    v_mfma_f32_16x16x32_bf16 v[192:195], a[148:151], a[120:123], v[192:195]
    ds_read_b64_tr_b16 a[174:175], v9 offset:1280
    v_cndmask_b32 v255, v255, v3, vcc
    v_mfma_f32_16x16x32_bf16 v[192:195], a[152:155], a[136:139], v[192:195]
    s_cmp_eq_u32 s50, 0
    s_cselect_b32 s16, 2, 0
    v_mfma_f32_16x16x32_bf16 v[196:199], a[148:151], a[124:127], v[196:199]
    ds_read_b64_tr_b16 a[176:177], v9 offset:5120
    v_cmp_gt_u32 vcc, s16, v0
    v_mfma_f32_16x16x32_bf16 v[196:199], a[152:155], a[140:143], v[196:199]
    v_cndmask_b32 v254, v2, v255, vcc
    buffer_load_dwordx4 v11, s[24:27], s69 offen offset:3072 lds
    v_mfma_f32_16x16x32_bf16 v[200:203], a[148:151], a[128:131], v[200:203]
    ds_read_b64_tr_b16 a[178:179], v9 offset:5376
    s_add_u32 m0, s59, 40960
    v_mfma_f32_16x16x32_bf16 v[200:203], a[152:155], a[144:147], v[200:203]
    s_waitcnt lgkmcnt(8)
    v_mfma_f32_16x16x32_bf16 v[204:207], a[156:159], a[116:119], v[204:207]
    buffer_load_dwordx4 v12, s[28:31], s52 offen lds
    s_mov_b32 s8, 3
    v_mfma_f32_16x16x32_bf16 v[204:207], a[160:163], a[132:135], v[204:207]
    v_subrev_u32 v9, 81920, v9
    s_mov_b32 s9, 0
    v_mfma_f32_16x16x32_bf16 v[208:211], a[156:159], a[120:123], v[208:211]
    s_mov_b32 s75, 40960
    s_add_u32 s11, s58, 81920
    v_mfma_f32_16x16x32_bf16 v[208:211], a[160:163], a[136:139], v[208:211]
    s_add_u32 s12, s59, 81920
    s_mov_b32 s13, 6
    v_mfma_f32_16x16x32_bf16 v[212:215], a[156:159], a[124:127], v[212:215]
    s_mov_b32 s72, 6
    s_add_u32 m0, s59, 41984
    v_mfma_f32_16x16x32_bf16 v[212:215], a[160:163], a[140:143], v[212:215]
    v_mfma_f32_16x16x32_bf16 v[216:219], a[156:159], a[128:131], v[216:219]
    v_mfma_f32_16x16x32_bf16 v[216:219], a[160:163], a[144:147], v[216:219]
    s_waitcnt vmcnt(17) lgkmcnt(0)
    s_barrier
    v_mfma_f32_16x16x32_bf16 v[220:223], a[164:167], a[116:119], v[220:223]
    ds_read_b64_tr_b16 a[148:149], v4 offset:0
    buffer_load_dwordx4 v12, s[32:35], s53 offen lds
    v_mfma_f32_16x16x32_bf16 v[220:223], a[168:171], a[132:135], v[220:223]
    ds_read_b64_tr_b16 a[150:151], v4 offset:512
    s_cmp_eq_u32 s51, 6
    v_mfma_f32_16x16x32_bf16 v[224:227], a[164:167], a[120:123], v[224:227]
    ds_read_b64_tr_b16 a[152:153], v4 offset:4096
    s_cselect_b32 s82, s73, s56
    v_mfma_f32_16x16x32_bf16 v[224:227], a[168:171], a[136:139], v[224:227]
    ds_read_b64_tr_b16 a[154:155], v4 offset:4608
    s_cselect_b32 s83, s74, s57
    v_mfma_f32_16x16x32_bf16 v[228:231], a[164:167], a[124:127], v[228:231]
    ds_read_b64_tr_b16 a[156:157], v5 offset:0
    v_add_u32 v10, s82, v10
    v_mfma_f32_16x16x32_bf16 v[228:231], a[168:171], a[140:143], v[228:231]
    ds_read_b64_tr_b16 a[158:159], v5 offset:512
    v_add_u32 v11, s82, v11
    v_mfma_f32_16x16x32_bf16 v[232:235], a[164:167], a[128:131], v[232:235]
    ds_read_b64_tr_b16 a[160:161], v5 offset:4096
    v_add_u32 v12, s83, v12
    v_mfma_f32_16x16x32_bf16 v[232:235], a[168:171], a[144:147], v[232:235]
    ds_read_b64_tr_b16 a[162:163], v5 offset:4608
    v_mfma_f32_16x16x32_bf16 v[236:239], a[172:175], a[116:119], v[236:239]
    ds_read_b64_tr_b16 a[164:165], v6 offset:0
    v_mfma_f32_16x16x32_bf16 v[236:239], a[176:179], a[132:135], v[236:239]
    v_mfma_f32_16x16x32_bf16 v[240:243], a[172:175], a[120:123], v[240:243]
    ds_read_b64_tr_b16 a[166:167], v6 offset:512
    v_mfma_f32_16x16x32_bf16 v[240:243], a[176:179], a[136:139], v[240:243]
    v_mfma_f32_16x16x32_bf16 v[244:247], a[172:175], a[124:127], v[244:247]
    ds_read_b64_tr_b16 a[168:169], v6 offset:4096
    v_mfma_f32_16x16x32_bf16 v[244:247], a[176:179], a[140:143], v[244:247]
    v_mfma_f32_16x16x32_bf16 v[248:251], a[172:175], a[128:131], v[248:251]
    ds_read_b64_tr_b16 a[170:171], v6 offset:4608
    v_mfma_f32_16x16x32_bf16 v[248:251], a[176:179], a[144:147], v[248:251]
gemm1_kernel_loop:
    s_waitcnt lgkmcnt(8)
    v_mfma_f32_16x16x32_bf16 v[16:19], a[148:151], a[84:87], v[16:19]
    ds_read_b64_tr_b16 a[172:173], v7 offset:0
    s_waitcnt vmcnt(16)
    v_mfma_f32_16x16x32_bf16 v[16:19], a[152:155], a[100:103], v[16:19]
    ds_read_b128 a[116:119], v252 offset:40960
    v_mfma_f32_16x16x32_bf16 v[20:23], a[148:151], a[88:91], v[20:23]
    ds_read_b64_tr_b16 a[174:175], v7 offset:512
    v_mfma_f32_16x16x32_bf16 v[20:23], a[152:155], a[104:107], v[20:23]
    v_mfma_f32_16x16x32_bf16 v[24:27], a[148:151], a[92:95], v[24:27]
    ds_read_b64_tr_b16 a[176:177], v7 offset:4096
    ds_read_b128 a[132:135], v253 offset:40960
    v_mfma_f32_16x16x32_bf16 v[24:27], a[152:155], a[108:111], v[24:27]
    v_accvgpr_read_b32 v3, a200
    v_cvt_pk_bf16_f32 v2, v3, v3
    v_mfma_f32_16x16x32_bf16 a[0:3], a[148:151], a[96:99], a[0:3]
    ds_read_b64_tr_b16 a[178:179], v7 offset:4608
    v_and_b32 v14, 0xffff0000, v2
    v_mfma_f32_16x16x32_bf16 a[0:3], a[152:155], a[112:115], a[0:3]
    v_sub_f32 v3, v3, v14
    s_waitcnt lgkmcnt(10)
    v_mfma_f32_16x16x32_bf16 v[28:31], a[156:159], a[84:87], v[28:31]
    ds_read_b64_tr_b16 a[148:149], v4 offset:8192
    v_cvt_pk_bf16_f32 v3, v3, v3
    v_mfma_f32_16x16x32_bf16 v[28:31], a[160:163], a[100:103], v[28:31]
    buffer_store_dwordx2 v[2:3], v1, s[36:39], s60 offen offset:0 sc1
    s_waitcnt vmcnt(15)
    v_mfma_f32_16x16x32_bf16 v[32:35], a[156:159], a[88:91], v[32:35]
    ds_read_b64_tr_b16 a[150:151], v4 offset:8704
    ds_read_b128 a[120:123], v252 offset:43008
    v_mfma_f32_16x16x32_bf16 v[32:35], a[160:163], a[104:107], v[32:35]
    v_mfma_f32_16x16x32_bf16 v[36:39], a[156:159], a[92:95], v[36:39]
    ds_read_b64_tr_b16 a[152:153], v4 offset:12288
    ds_read_b128 a[136:139], v253 offset:43008
    v_mfma_f32_16x16x32_bf16 v[36:39], a[160:163], a[108:111], v[36:39]
    v_accvgpr_read_b32 v15, a204
    v_cvt_pk_bf16_f32 v14, v15, v15
    v_mfma_f32_16x16x32_bf16 a[4:7], a[156:159], a[96:99], a[4:7]
    ds_read_b64_tr_b16 a[154:155], v4 offset:12800
    v_and_b32 v2, 0xffff0000, v14
    v_mfma_f32_16x16x32_bf16 a[4:7], a[160:163], a[112:115], a[4:7]
    v_sub_f32 v15, v15, v2
    s_waitcnt lgkmcnt(12)
    v_mfma_f32_16x16x32_bf16 v[40:43], a[164:167], a[84:87], v[40:43]
    ds_read_b64_tr_b16 a[156:157], v5 offset:8192
    v_cvt_pk_bf16_f32 v15, v15, v15
    v_mfma_f32_16x16x32_bf16 v[40:43], a[168:171], a[100:103], v[40:43]
    buffer_store_dwordx2 v[14:15], v1, s[36:39], s60 offen offset:1024 sc1
    s_waitcnt vmcnt(14)
    v_mfma_f32_16x16x32_bf16 v[44:47], a[164:167], a[88:91], v[44:47]
    ds_read_b64_tr_b16 a[158:159], v5 offset:8704
    ds_read_b128 a[124:127], v252 offset:45056
    v_mfma_f32_16x16x32_bf16 v[44:47], a[168:171], a[104:107], v[44:47]
    v_mfma_f32_16x16x32_bf16 v[48:51], a[164:167], a[92:95], v[48:51]
    ds_read_b64_tr_b16 a[160:161], v5 offset:12288
    ds_read_b128 a[140:143], v253 offset:45056
    v_mfma_f32_16x16x32_bf16 v[48:51], a[168:171], a[108:111], v[48:51]
    v_accvgpr_read_b32 v3, a208
    v_cvt_pk_bf16_f32 v2, v3, v3
    v_mfma_f32_16x16x32_bf16 a[8:11], a[164:167], a[96:99], a[8:11]
    ds_read_b64_tr_b16 a[162:163], v5 offset:12800
    v_and_b32 v14, 0xffff0000, v2
    v_mfma_f32_16x16x32_bf16 a[8:11], a[168:171], a[112:115], a[8:11]
    v_sub_f32 v3, v3, v14
    s_waitcnt lgkmcnt(12)
    v_mfma_f32_16x16x32_bf16 v[52:55], a[172:175], a[84:87], v[52:55]
    ds_read_b64_tr_b16 a[164:165], v6 offset:8192
    v_cvt_pk_bf16_f32 v3, v3, v3
    v_mfma_f32_16x16x32_bf16 v[52:55], a[176:179], a[100:103], v[52:55]
    buffer_store_dwordx2 v[2:3], v1, s[36:39], s60 offen offset:2048 sc1
    s_waitcnt vmcnt(13)
    v_mfma_f32_16x16x32_bf16 v[56:59], a[172:175], a[88:91], v[56:59]
    ds_read_b64_tr_b16 a[166:167], v6 offset:8704
    ds_read_b128 a[128:131], v252 offset:47104
    v_mfma_f32_16x16x32_bf16 v[56:59], a[176:179], a[104:107], v[56:59]
    v_mfma_f32_16x16x32_bf16 v[60:63], a[172:175], a[92:95], v[60:63]
    ds_read_b64_tr_b16 a[168:169], v6 offset:12288
    ds_read_b128 a[144:147], v253 offset:47104
    v_mfma_f32_16x16x32_bf16 v[60:63], a[176:179], a[108:111], v[60:63]
    v_accvgpr_read_b32 v15, a212
    v_cvt_pk_bf16_f32 v14, v15, v15
    v_mfma_f32_16x16x32_bf16 a[12:15], a[172:175], a[96:99], a[12:15]
    ds_read_b64_tr_b16 a[170:171], v6 offset:12800
    v_and_b32 v2, 0xffff0000, v14
    v_mfma_f32_16x16x32_bf16 a[12:15], a[176:179], a[112:115], a[12:15]
    v_sub_f32 v15, v15, v2
    s_waitcnt lgkmcnt(12)
    v_mfma_f32_16x16x32_bf16 v[64:67], a[148:151], a[84:87], v[64:67]
    ds_read_b64_tr_b16 a[172:173], v7 offset:8192
    v_cvt_pk_bf16_f32 v15, v15, v15
    v_mfma_f32_16x16x32_bf16 v[64:67], a[152:155], a[100:103], v[64:67]
    buffer_store_dwordx2 v[14:15], v1, s[36:39], s60 offen offset:3072 sc1
    s_add_u32 m0, s58, 122880
    v_mfma_f32_16x16x32_bf16 v[68:71], a[148:151], a[88:91], v[68:71]
    ds_read_b64_tr_b16 a[174:175], v7 offset:8704
    s_cmp_eq_u32 s9, 2
    v_mfma_f32_16x16x32_bf16 v[68:71], a[152:155], a[104:107], v[68:71]
    s_cselect_b32 s10, -81920, s75
    v_mfma_f32_16x16x32_bf16 v[72:75], a[148:151], a[92:95], v[72:75]
    ds_read_b64_tr_b16 a[176:177], v7 offset:12288
    buffer_load_dwordx4 v13, s[20:23], s40 offen offset:0 lds
    v_mfma_f32_16x16x32_bf16 v[72:75], a[152:155], a[108:111], v[72:75]
    v_accvgpr_read_b32 v3, a216
    v_cvt_pk_bf16_f32 v2, v3, v3
    v_mfma_f32_16x16x32_bf16 a[16:19], a[148:151], a[96:99], a[16:19]
    ds_read_b64_tr_b16 a[178:179], v7 offset:12800
    v_and_b32 v14, 0xffff0000, v2
    v_mfma_f32_16x16x32_bf16 a[16:19], a[152:155], a[112:115], a[16:19]
    v_sub_f32 v3, v3, v14
    s_waitcnt lgkmcnt(10)
    v_mfma_f32_16x16x32_bf16 v[76:79], a[156:159], a[84:87], v[76:79]
    ds_read_b64_tr_b16 a[148:149], v4 offset:16384
    v_cvt_pk_bf16_f32 v3, v3, v3
    v_mfma_f32_16x16x32_bf16 v[76:79], a[160:163], a[100:103], v[76:79]
    buffer_store_dwordx2 v[2:3], v1, s[36:39], s61 offen offset:0 sc1
    buffer_load_dwordx4 v13, s[20:23], s41 offen offset:1024 lds
    v_mfma_f32_16x16x32_bf16 v[80:83], a[156:159], a[88:91], v[80:83]
    ds_read_b64_tr_b16 a[150:151], v4 offset:16896
    v_mfma_f32_16x16x32_bf16 v[80:83], a[160:163], a[104:107], v[80:83]
    v_mfma_f32_16x16x32_bf16 a[64:67], a[156:159], a[92:95], a[64:67]
    ds_read_b64_tr_b16 a[152:153], v4 offset:20480
    buffer_load_dwordx4 v13, s[20:23], s42 offen offset:2048 lds
    v_mfma_f32_16x16x32_bf16 a[64:67], a[160:163], a[108:111], a[64:67]
    v_mfma_f32_16x16x32_bf16 a[20:23], a[156:159], a[96:99], a[20:23]
    ds_read_b64_tr_b16 a[154:155], v4 offset:20992
    v_mfma_f32_16x16x32_bf16 a[20:23], a[160:163], a[112:115], a[20:23]
    s_waitcnt lgkmcnt(8)
    v_mfma_f32_16x16x32_bf16 v[84:87], a[164:167], a[84:87], v[84:87]
    ds_read_b64_tr_b16 a[156:157], v5 offset:16384
    buffer_load_dwordx4 v13, s[20:23], s43 offen offset:3072 lds
    v_mfma_f32_16x16x32_bf16 v[84:87], a[168:171], a[100:103], v[84:87]
    s_add_u32 m0, s58, 126976
    v_mov_b32 v1, 0x7ff00000
    v_mfma_f32_16x16x32_bf16 v[88:91], a[164:167], a[88:91], v[88:91]
    ds_read_b64_tr_b16 a[158:159], v5 offset:16896
    v_mfma_f32_16x16x32_bf16 v[88:91], a[168:171], a[104:107], v[88:91]
    v_mfma_f32_16x16x32_bf16 v[92:95], a[164:167], a[92:95], v[92:95]
    ds_read_b64_tr_b16 a[160:161], v5 offset:20480
    buffer_load_dwordx4 v13, s[20:23], s84 offen offset:0 lds
    v_mfma_f32_16x16x32_bf16 v[92:95], a[168:171], a[108:111], v[92:95]
    v_mfma_f32_16x16x32_bf16 a[24:27], a[164:167], a[96:99], a[24:27]
    ds_read_b64_tr_b16 a[162:163], v5 offset:20992
    v_mfma_f32_16x16x32_bf16 a[24:27], a[168:171], a[112:115], a[24:27]
    s_waitcnt lgkmcnt(8)
    v_mfma_f32_16x16x32_bf16 v[96:99], a[172:175], a[84:87], v[96:99]
    ds_read_b64_tr_b16 a[164:165], v6 offset:16384
    buffer_load_dwordx4 v13, s[20:23], s85 offen offset:1024 lds
    v_mfma_f32_16x16x32_bf16 v[96:99], a[176:179], a[100:103], v[96:99]
    v_mfma_f32_16x16x32_bf16 v[100:103], a[172:175], a[88:91], v[100:103]
    ds_read_b64_tr_b16 a[166:167], v6 offset:16896
    v_mfma_f32_16x16x32_bf16 v[100:103], a[176:179], a[104:107], v[100:103]
    v_mfma_f32_16x16x32_bf16 a[68:71], a[172:175], a[92:95], a[68:71]
    ds_read_b64_tr_b16 a[168:169], v6 offset:20480
    buffer_load_dwordx4 v13, s[20:23], s86 offen offset:2048 lds
    v_mfma_f32_16x16x32_bf16 a[68:71], a[176:179], a[108:111], a[68:71]
    v_mfma_f32_16x16x32_bf16 a[28:31], a[172:175], a[96:99], a[28:31]
    ds_read_b64_tr_b16 a[170:171], v6 offset:20992
    v_mfma_f32_16x16x32_bf16 a[28:31], a[176:179], a[112:115], a[28:31]
    s_waitcnt lgkmcnt(8)
    v_mfma_f32_16x16x32_bf16 v[104:107], a[148:151], a[84:87], v[104:107]
    ds_read_b64_tr_b16 a[172:173], v7 offset:16384
    buffer_load_dwordx4 v13, s[20:23], s87 offen offset:3072 lds
    v_mfma_f32_16x16x32_bf16 v[104:107], a[152:155], a[100:103], v[104:107]
    s_add_u32 s72, s72, 1
    s_cmp_eq_u32 s51, s72
    v_mfma_f32_16x16x32_bf16 v[108:111], a[148:151], a[88:91], v[108:111]
    ds_read_b64_tr_b16 a[174:175], v7 offset:16896
    s_movk_i32 s82, 128
    v_mfma_f32_16x16x32_bf16 v[108:111], a[152:155], a[104:107], v[108:111]
    s_cselect_b32 s82, 384, s82
    v_add_u32 v13, s82, v13
    v_mfma_f32_16x16x32_bf16 v[112:115], a[148:151], a[92:95], v[112:115]
    ds_read_b64_tr_b16 a[176:177], v7 offset:20480
    s_add_u32 m0, s11, 0
    v_mfma_f32_16x16x32_bf16 v[112:115], a[152:155], a[108:111], v[112:115]
    v_mfma_f32_16x16x32_bf16 a[32:35], a[148:151], a[96:99], a[32:35]
    ds_read_b64_tr_b16 a[178:179], v7 offset:20992
    v_mfma_f32_16x16x32_bf16 a[32:35], a[152:155], a[112:115], a[32:35]
    s_waitcnt lgkmcnt(8)
    v_mfma_f32_16x16x32_bf16 v[116:119], a[156:159], a[84:87], v[116:119]
    ds_read_b64_tr_b16 a[148:149], v4 offset:24576
    buffer_load_dwordx4 v10, s[24:27], s62 offen offset:0 lds
    v_mfma_f32_16x16x32_bf16 v[116:119], a[160:163], a[100:103], v[116:119]
    v_mfma_f32_16x16x32_bf16 v[120:123], a[156:159], a[88:91], v[120:123]
    ds_read_b64_tr_b16 a[150:151], v4 offset:25088
    v_mfma_f32_16x16x32_bf16 v[120:123], a[160:163], a[104:107], v[120:123]
    v_mfma_f32_16x16x32_bf16 v[124:127], a[156:159], a[92:95], v[124:127]
    ds_read_b64_tr_b16 a[152:153], v4 offset:28672
    v_mfma_f32_16x16x32_bf16 v[124:127], a[160:163], a[108:111], v[124:127]
    v_mfma_f32_16x16x32_bf16 a[36:39], a[156:159], a[96:99], a[36:39]
    ds_read_b64_tr_b16 a[154:155], v4 offset:29184
    v_mfma_f32_16x16x32_bf16 a[36:39], a[160:163], a[112:115], a[36:39]
    s_waitcnt lgkmcnt(8)
    v_mfma_f32_16x16x32_bf16 v[128:131], a[164:167], a[84:87], v[128:131]
    ds_read_b64_tr_b16 a[156:157], v5 offset:24576
    buffer_load_dwordx4 v11, s[24:27], s63 offen offset:1024 lds
    v_mfma_f32_16x16x32_bf16 v[128:131], a[168:171], a[100:103], v[128:131]
    v_add_u32 v4, s10, v4
    v_mfma_f32_16x16x32_bf16 v[132:135], a[164:167], a[88:91], v[132:135]
    ds_read_b64_tr_b16 a[158:159], v5 offset:25088
    v_mfma_f32_16x16x32_bf16 v[132:135], a[168:171], a[104:107], v[132:135]
    v_mfma_f32_16x16x32_bf16 v[136:139], a[164:167], a[92:95], v[136:139]
    ds_read_b64_tr_b16 a[160:161], v5 offset:28672
    v_mfma_f32_16x16x32_bf16 v[136:139], a[168:171], a[108:111], v[136:139]
    v_mfma_f32_16x16x32_bf16 a[40:43], a[164:167], a[96:99], a[40:43]
    ds_read_b64_tr_b16 a[162:163], v5 offset:29184
    v_mfma_f32_16x16x32_bf16 a[40:43], a[168:171], a[112:115], a[40:43]
    s_waitcnt lgkmcnt(8)
    v_mfma_f32_16x16x32_bf16 v[140:143], a[172:175], a[84:87], v[140:143]
    ds_read_b64_tr_b16 a[164:165], v6 offset:24576
    buffer_load_dwordx4 v10, s[24:27], s64 offen offset:2048 lds
    v_mfma_f32_16x16x32_bf16 v[140:143], a[176:179], a[100:103], v[140:143]
    v_add_u32 v5, s10, v5
    v_mfma_f32_16x16x32_bf16 v[144:147], a[172:175], a[88:91], v[144:147]
    ds_read_b64_tr_b16 a[166:167], v6 offset:25088
    v_mfma_f32_16x16x32_bf16 v[144:147], a[176:179], a[104:107], v[144:147]
    v_mfma_f32_16x16x32_bf16 a[80:83], a[172:175], a[92:95], a[80:83]
    ds_read_b64_tr_b16 a[168:169], v6 offset:28672
    v_mfma_f32_16x16x32_bf16 a[80:83], a[176:179], a[108:111], a[80:83]
    v_mfma_f32_16x16x32_bf16 a[44:47], a[172:175], a[96:99], a[44:47]
    ds_read_b64_tr_b16 a[170:171], v6 offset:29184
    v_mfma_f32_16x16x32_bf16 a[44:47], a[176:179], a[112:115], a[44:47]
    s_waitcnt lgkmcnt(8)
    v_mfma_f32_16x16x32_bf16 v[148:151], a[148:151], a[84:87], v[148:151]
    ds_read_b64_tr_b16 a[172:173], v7 offset:24576
    buffer_load_dwordx4 v11, s[24:27], s65 offen offset:3072 lds
    v_mfma_f32_16x16x32_bf16 v[148:151], a[152:155], a[100:103], v[148:151]
    v_add_u32 v6, s10, v6
    v_mfma_f32_16x16x32_bf16 v[152:155], a[148:151], a[88:91], v[152:155]
    ds_read_b64_tr_b16 a[174:175], v7 offset:25088
    v_mfma_f32_16x16x32_bf16 v[152:155], a[152:155], a[104:107], v[152:155]
    v_mfma_f32_16x16x32_bf16 v[156:159], a[148:151], a[92:95], v[156:159]
    ds_read_b64_tr_b16 a[176:177], v7 offset:28672
    s_add_u32 m0, s11, 4096
    v_mfma_f32_16x16x32_bf16 v[156:159], a[152:155], a[108:111], v[156:159]
    v_mfma_f32_16x16x32_bf16 a[48:51], a[148:151], a[96:99], a[48:51]
    ds_read_b64_tr_b16 a[178:179], v7 offset:29184
    v_mfma_f32_16x16x32_bf16 a[48:51], a[152:155], a[112:115], a[48:51]
    s_waitcnt lgkmcnt(8)
    v_mfma_f32_16x16x32_bf16 v[160:163], a[156:159], a[84:87], v[160:163]
    ds_read_b64_tr_b16 a[148:149], v8 offset:0
    buffer_load_dwordx4 v10, s[24:27], s66 offen offset:0 lds
    v_mfma_f32_16x16x32_bf16 v[160:163], a[160:163], a[100:103], v[160:163]
    v_add_u32 v7, s10, v7
    v_mfma_f32_16x16x32_bf16 v[164:167], a[156:159], a[88:91], v[164:167]
    ds_read_b64_tr_b16 a[150:151], v8 offset:256
    v_mfma_f32_16x16x32_bf16 v[164:167], a[160:163], a[104:107], v[164:167]
    v_mfma_f32_16x16x32_bf16 a[72:75], a[156:159], a[92:95], a[72:75]
    ds_read_b64_tr_b16 a[152:153], v8 offset:4096
    v_mfma_f32_16x16x32_bf16 a[72:75], a[160:163], a[108:111], a[72:75]
    v_mfma_f32_16x16x32_bf16 a[52:55], a[156:159], a[96:99], a[52:55]
    ds_read_b64_tr_b16 a[154:155], v8 offset:4352
    v_mfma_f32_16x16x32_bf16 a[52:55], a[160:163], a[112:115], a[52:55]
    s_waitcnt lgkmcnt(8)
    v_mfma_f32_16x16x32_bf16 v[168:171], a[164:167], a[84:87], v[168:171]
    ds_read_b64_tr_b16 a[156:157], v9 offset:0
    buffer_load_dwordx4 v11, s[24:27], s67 offen offset:1024 lds
    v_mfma_f32_16x16x32_bf16 v[168:171], a[168:171], a[100:103], v[168:171]
    v_mfma_f32_16x16x32_bf16 v[172:175], a[164:167], a[88:91], v[172:175]
    ds_read_b64_tr_b16 a[158:159], v9 offset:256
    v_mfma_f32_16x16x32_bf16 v[172:175], a[168:171], a[104:107], v[172:175]
    v_mfma_f32_16x16x32_bf16 v[176:179], a[164:167], a[92:95], v[176:179]
    ds_read_b64_tr_b16 a[160:161], v9 offset:4096
    v_mfma_f32_16x16x32_bf16 v[176:179], a[168:171], a[108:111], v[176:179]
    v_mfma_f32_16x16x32_bf16 a[56:59], a[164:167], a[96:99], a[56:59]
    ds_read_b64_tr_b16 a[162:163], v9 offset:4352
    v_mfma_f32_16x16x32_bf16 a[56:59], a[168:171], a[112:115], a[56:59]
    s_waitcnt lgkmcnt(8)
    v_mfma_f32_16x16x32_bf16 v[180:183], a[172:175], a[84:87], v[180:183]
    ds_read_b64_tr_b16 a[164:165], v8 offset:1024
    buffer_load_dwordx4 v10, s[24:27], s68 offen offset:2048 lds
    v_mfma_f32_16x16x32_bf16 v[180:183], a[176:179], a[100:103], v[180:183]
    v_mfma_f32_16x16x32_bf16 v[184:187], a[172:175], a[88:91], v[184:187]
    ds_read_b64_tr_b16 a[166:167], v8 offset:1280
    v_mfma_f32_16x16x32_bf16 v[184:187], a[176:179], a[104:107], v[184:187]
    v_mfma_f32_16x16x32_bf16 a[76:79], a[172:175], a[92:95], a[76:79]
    ds_read_b64_tr_b16 a[168:169], v8 offset:5120
    v_mfma_f32_16x16x32_bf16 a[76:79], a[176:179], a[108:111], a[76:79]
    v_mfma_f32_16x16x32_bf16 a[60:63], a[172:175], a[96:99], a[60:63]
    ds_read_b64_tr_b16 a[170:171], v8 offset:5376
    v_mfma_f32_16x16x32_bf16 a[60:63], a[176:179], a[112:115], a[60:63]
    s_waitcnt lgkmcnt(8)
    v_mfma_f32_16x16x32_bf16 v[188:191], a[148:151], a[84:87], v[188:191]
    ds_read_b64_tr_b16 a[172:173], v9 offset:1024
    buffer_load_dwordx4 v11, s[24:27], s69 offen offset:3072 lds
    v_mfma_f32_16x16x32_bf16 v[188:191], a[152:155], a[100:103], v[188:191]
    v_add_u32 v8, s10, v8
    v_mfma_f32_16x16x32_bf16 v[192:195], a[148:151], a[88:91], v[192:195]
    ds_read_b64_tr_b16 a[174:175], v9 offset:1280
    v_mfma_f32_16x16x32_bf16 v[192:195], a[152:155], a[104:107], v[192:195]
    v_mfma_f32_16x16x32_bf16 v[196:199], a[148:151], a[92:95], v[196:199]
    ds_read_b64_tr_b16 a[176:177], v9 offset:5120
    s_add_u32 m0, s12, 0
    v_mfma_f32_16x16x32_bf16 v[196:199], a[152:155], a[108:111], v[196:199]
    v_mfma_f32_16x16x32_bf16 v[200:203], a[148:151], a[96:99], v[200:203]
    ds_read_b64_tr_b16 a[178:179], v9 offset:5376
    v_mfma_f32_16x16x32_bf16 v[200:203], a[152:155], a[112:115], v[200:203]
    s_waitcnt lgkmcnt(8)
    v_mfma_f32_16x16x32_bf16 v[204:207], a[156:159], a[84:87], v[204:207]
    buffer_load_dwordx4 v12, s[28:31], s52 offen lds
    v_mfma_f32_16x16x32_bf16 v[204:207], a[160:163], a[100:103], v[204:207]
    v_add_u32 v9, s10, v9
    v_mfma_f32_16x16x32_bf16 v[208:211], a[156:159], a[88:91], v[208:211]
    v_mfma_f32_16x16x32_bf16 v[208:211], a[160:163], a[104:107], v[208:211]
    v_mfma_f32_16x16x32_bf16 v[212:215], a[156:159], a[92:95], v[212:215]
    s_add_u32 m0, s12, 1024
    v_mfma_f32_16x16x32_bf16 v[212:215], a[160:163], a[108:111], v[212:215]
    v_mfma_f32_16x16x32_bf16 v[216:219], a[156:159], a[96:99], v[216:219]
    v_mfma_f32_16x16x32_bf16 v[216:219], a[160:163], a[112:115], v[216:219]
    s_waitcnt vmcnt(22) lgkmcnt(0)
    s_barrier
    v_mfma_f32_16x16x32_bf16 v[220:223], a[164:167], a[84:87], v[220:223]
    ds_read_b64_tr_b16 a[148:149], v4 offset:0
    buffer_load_dwordx4 v12, s[32:35], s53 offen lds
    v_mfma_f32_16x16x32_bf16 v[220:223], a[168:171], a[100:103], v[220:223]
    ds_read_b64_tr_b16 a[150:151], v4 offset:512
    s_add_u32 s13, s13, 1
    v_mfma_f32_16x16x32_bf16 v[224:227], a[164:167], a[88:91], v[224:227]
    ds_read_b64_tr_b16 a[152:153], v4 offset:4096
    s_cmp_eq_u32 s51, s13
    v_mfma_f32_16x16x32_bf16 v[224:227], a[168:171], a[104:107], v[224:227]
    ds_read_b64_tr_b16 a[154:155], v4 offset:4608
    s_cselect_b32 s82, s73, s56
    v_mfma_f32_16x16x32_bf16 v[228:231], a[164:167], a[92:95], v[228:231]
    ds_read_b64_tr_b16 a[156:157], v5 offset:0
    s_cselect_b32 s83, s74, s57
    v_mfma_f32_16x16x32_bf16 v[228:231], a[168:171], a[108:111], v[228:231]
    ds_read_b64_tr_b16 a[158:159], v5 offset:512
    v_add_u32 v10, s82, v10
    v_mfma_f32_16x16x32_bf16 v[232:235], a[164:167], a[96:99], v[232:235]
    ds_read_b64_tr_b16 a[160:161], v5 offset:4096
    v_add_u32 v11, s82, v11
    v_mfma_f32_16x16x32_bf16 v[232:235], a[168:171], a[112:115], v[232:235]
    ds_read_b64_tr_b16 a[162:163], v5 offset:4608
    v_mfma_f32_16x16x32_bf16 v[236:239], a[172:175], a[84:87], v[236:239]
    ds_read_b64_tr_b16 a[164:165], v6 offset:0
    v_add_u32 v12, s83, v12
    v_mfma_f32_16x16x32_bf16 v[236:239], a[176:179], a[100:103], v[236:239]
    s_cmp_eq_u32 s9, 0
    s_cselect_b32 s82, -81920, s75
    v_mfma_f32_16x16x32_bf16 v[240:243], a[172:175], a[88:91], v[240:243]
    ds_read_b64_tr_b16 a[166:167], v6 offset:512
    s_add_u32 s11, s11, s82
    v_mfma_f32_16x16x32_bf16 v[240:243], a[176:179], a[104:107], v[240:243]
    s_add_u32 s12, s12, s82
    s_add_u32 s9, s9, 1
    v_mfma_f32_16x16x32_bf16 v[244:247], a[172:175], a[92:95], v[244:247]
    ds_read_b64_tr_b16 a[168:169], v6 offset:4096
    s_cmp_eq_u32 s9, 3
    v_mfma_f32_16x16x32_bf16 v[244:247], a[176:179], a[108:111], v[244:247]
    s_cselect_b32 s9, 0, s9
    v_mfma_f32_16x16x32_bf16 v[248:251], a[172:175], a[96:99], v[248:251]
    ds_read_b64_tr_b16 a[170:171], v6 offset:4608
    v_mfma_f32_16x16x32_bf16 v[248:251], a[176:179], a[112:115], v[248:251]
    s_waitcnt lgkmcnt(8)
    v_mfma_f32_16x16x32_bf16 v[16:19], a[148:151], a[116:119], v[16:19]
    ds_read_b64_tr_b16 a[172:173], v7 offset:0
    s_waitcnt vmcnt(16)
    v_mfma_f32_16x16x32_bf16 v[16:19], a[152:155], a[132:135], v[16:19]
    ds_read_b128 a[84:87], v252 offset:40960
    v_mfma_f32_16x16x32_bf16 v[20:23], a[148:151], a[120:123], v[20:23]
    ds_read_b64_tr_b16 a[174:175], v7 offset:512
    v_mfma_f32_16x16x32_bf16 v[20:23], a[152:155], a[136:139], v[20:23]
    v_mfma_f32_16x16x32_bf16 v[24:27], a[148:151], a[124:127], v[24:27]
    ds_read_b64_tr_b16 a[176:177], v7 offset:4096
    ds_read_b128 a[100:103], v253 offset:40960
    v_mfma_f32_16x16x32_bf16 v[24:27], a[152:155], a[140:143], v[24:27]
    v_mfma_f32_16x16x32_bf16 a[0:3], a[148:151], a[128:131], a[0:3]
    ds_read_b64_tr_b16 a[178:179], v7 offset:4608
    v_mfma_f32_16x16x32_bf16 a[0:3], a[152:155], a[144:147], a[0:3]
    s_waitcnt lgkmcnt(10)
    v_mfma_f32_16x16x32_bf16 v[28:31], a[156:159], a[116:119], v[28:31]
    ds_read_b64_tr_b16 a[148:149], v4 offset:8192
    s_waitcnt vmcnt(14)
    v_mfma_f32_16x16x32_bf16 v[28:31], a[160:163], a[132:135], v[28:31]
    ds_read_b128 a[88:91], v252 offset:43008
    v_mfma_f32_16x16x32_bf16 v[32:35], a[156:159], a[120:123], v[32:35]
    ds_read_b64_tr_b16 a[150:151], v4 offset:8704
    v_mfma_f32_16x16x32_bf16 v[32:35], a[160:163], a[136:139], v[32:35]
    v_mfma_f32_16x16x32_bf16 v[36:39], a[156:159], a[124:127], v[36:39]
    ds_read_b64_tr_b16 a[152:153], v4 offset:12288
    ds_read_b128 a[104:107], v253 offset:43008
    v_mfma_f32_16x16x32_bf16 v[36:39], a[160:163], a[140:143], v[36:39]
    v_mfma_f32_16x16x32_bf16 a[4:7], a[156:159], a[128:131], a[4:7]
    ds_read_b64_tr_b16 a[154:155], v4 offset:12800
    v_mfma_f32_16x16x32_bf16 a[4:7], a[160:163], a[144:147], a[4:7]
    s_waitcnt lgkmcnt(12)
    v_mfma_f32_16x16x32_bf16 v[40:43], a[164:167], a[116:119], v[40:43]
    ds_read_b64_tr_b16 a[156:157], v5 offset:8192
    s_waitcnt vmcnt(12)
    v_mfma_f32_16x16x32_bf16 v[40:43], a[168:171], a[132:135], v[40:43]
    ds_read_b128 a[92:95], v252 offset:45056
    v_mfma_f32_16x16x32_bf16 v[44:47], a[164:167], a[120:123], v[44:47]
    ds_read_b64_tr_b16 a[158:159], v5 offset:8704
    v_mfma_f32_16x16x32_bf16 v[44:47], a[168:171], a[136:139], v[44:47]
    v_mfma_f32_16x16x32_bf16 v[48:51], a[164:167], a[124:127], v[48:51]
    ds_read_b64_tr_b16 a[160:161], v5 offset:12288
    ds_read_b128 a[108:111], v253 offset:45056
    v_mfma_f32_16x16x32_bf16 v[48:51], a[168:171], a[140:143], v[48:51]
    v_mfma_f32_16x16x32_bf16 a[8:11], a[164:167], a[128:131], a[8:11]
    ds_read_b64_tr_b16 a[162:163], v5 offset:12800
    v_mfma_f32_16x16x32_bf16 a[8:11], a[168:171], a[144:147], a[8:11]
    s_waitcnt lgkmcnt(12)
    v_mfma_f32_16x16x32_bf16 v[52:55], a[172:175], a[116:119], v[52:55]
    ds_read_b64_tr_b16 a[164:165], v6 offset:8192
    s_waitcnt vmcnt(10)
    v_mfma_f32_16x16x32_bf16 v[52:55], a[176:179], a[132:135], v[52:55]
    ds_read_b128 a[96:99], v252 offset:47104
    v_mfma_f32_16x16x32_bf16 v[56:59], a[172:175], a[120:123], v[56:59]
    ds_read_b64_tr_b16 a[166:167], v6 offset:8704
    v_mfma_f32_16x16x32_bf16 v[56:59], a[176:179], a[136:139], v[56:59]
    v_mfma_f32_16x16x32_bf16 v[60:63], a[172:175], a[124:127], v[60:63]
    ds_read_b64_tr_b16 a[168:169], v6 offset:12288
    ds_read_b128 a[112:115], v253 offset:47104
    v_mfma_f32_16x16x32_bf16 v[60:63], a[176:179], a[140:143], v[60:63]
    v_mfma_f32_16x16x32_bf16 a[12:15], a[172:175], a[128:131], a[12:15]
    ds_read_b64_tr_b16 a[170:171], v6 offset:12800
    v_mfma_f32_16x16x32_bf16 a[12:15], a[176:179], a[144:147], a[12:15]
    s_waitcnt lgkmcnt(12)
    v_mfma_f32_16x16x32_bf16 v[64:67], a[148:151], a[116:119], v[64:67]
    ds_read_b64_tr_b16 a[172:173], v7 offset:8192
    s_add_u32 m0, s58, 122880
    v_mfma_f32_16x16x32_bf16 v[64:67], a[152:155], a[132:135], v[64:67]
    s_cmp_eq_u32 s9, 2
    s_cselect_b32 s10, -81920, s75
    v_mfma_f32_16x16x32_bf16 v[68:71], a[148:151], a[120:123], v[68:71]
    ds_read_b64_tr_b16 a[174:175], v7 offset:8704
    v_mfma_f32_16x16x32_bf16 v[68:71], a[152:155], a[136:139], v[68:71]
    v_mfma_f32_16x16x32_bf16 v[72:75], a[148:151], a[124:127], v[72:75]
    ds_read_b64_tr_b16 a[176:177], v7 offset:12288
    buffer_load_dwordx4 v13, s[20:23], s40 offen offset:0 lds
    v_mfma_f32_16x16x32_bf16 v[72:75], a[152:155], a[140:143], v[72:75]
    v_mfma_f32_16x16x32_bf16 a[16:19], a[148:151], a[128:131], a[16:19]
    ds_read_b64_tr_b16 a[178:179], v7 offset:12800
    v_mfma_f32_16x16x32_bf16 a[16:19], a[152:155], a[144:147], a[16:19]
    s_waitcnt lgkmcnt(10)
    v_mfma_f32_16x16x32_bf16 v[76:79], a[156:159], a[116:119], v[76:79]
    ds_read_b64_tr_b16 a[148:149], v4 offset:16384
    buffer_load_dwordx4 v13, s[20:23], s41 offen offset:1024 lds
    v_mfma_f32_16x16x32_bf16 v[76:79], a[160:163], a[132:135], v[76:79]
    v_mfma_f32_16x16x32_bf16 v[80:83], a[156:159], a[120:123], v[80:83]
    ds_read_b64_tr_b16 a[150:151], v4 offset:16896
    v_mfma_f32_16x16x32_bf16 v[80:83], a[160:163], a[136:139], v[80:83]
    v_mfma_f32_16x16x32_bf16 a[64:67], a[156:159], a[124:127], a[64:67]
    ds_read_b64_tr_b16 a[152:153], v4 offset:20480
    buffer_load_dwordx4 v13, s[20:23], s42 offen offset:2048 lds
    v_mfma_f32_16x16x32_bf16 a[64:67], a[160:163], a[140:143], a[64:67]
    v_mfma_f32_16x16x32_bf16 a[20:23], a[156:159], a[128:131], a[20:23]
    ds_read_b64_tr_b16 a[154:155], v4 offset:20992
    v_mfma_f32_16x16x32_bf16 a[20:23], a[160:163], a[144:147], a[20:23]
    s_waitcnt lgkmcnt(8)
    v_mfma_f32_16x16x32_bf16 v[84:87], a[164:167], a[116:119], v[84:87]
    ds_read_b64_tr_b16 a[156:157], v5 offset:16384
    buffer_load_dwordx4 v13, s[20:23], s43 offen offset:3072 lds
    v_mfma_f32_16x16x32_bf16 v[84:87], a[168:171], a[132:135], v[84:87]
    s_add_u32 m0, s58, 126976
    v_mfma_f32_16x16x32_bf16 v[88:91], a[164:167], a[120:123], v[88:91]
    ds_read_b64_tr_b16 a[158:159], v5 offset:16896
    v_mfma_f32_16x16x32_bf16 v[88:91], a[168:171], a[136:139], v[88:91]
    v_mfma_f32_16x16x32_bf16 v[92:95], a[164:167], a[124:127], v[92:95]
    ds_read_b64_tr_b16 a[160:161], v5 offset:20480
    buffer_load_dwordx4 v13, s[20:23], s84 offen offset:0 lds
    v_mfma_f32_16x16x32_bf16 v[92:95], a[168:171], a[140:143], v[92:95]
    v_mfma_f32_16x16x32_bf16 a[24:27], a[164:167], a[128:131], a[24:27]
    ds_read_b64_tr_b16 a[162:163], v5 offset:20992
    v_mfma_f32_16x16x32_bf16 a[24:27], a[168:171], a[144:147], a[24:27]
    s_waitcnt lgkmcnt(8)
    v_mfma_f32_16x16x32_bf16 v[96:99], a[172:175], a[116:119], v[96:99]
    ds_read_b64_tr_b16 a[164:165], v6 offset:16384
    buffer_load_dwordx4 v13, s[20:23], s85 offen offset:1024 lds
    v_mfma_f32_16x16x32_bf16 v[96:99], a[176:179], a[132:135], v[96:99]
    v_mfma_f32_16x16x32_bf16 v[100:103], a[172:175], a[120:123], v[100:103]
    ds_read_b64_tr_b16 a[166:167], v6 offset:16896
    v_mfma_f32_16x16x32_bf16 v[100:103], a[176:179], a[136:139], v[100:103]
    v_mfma_f32_16x16x32_bf16 a[68:71], a[172:175], a[124:127], a[68:71]
    ds_read_b64_tr_b16 a[168:169], v6 offset:20480
    buffer_load_dwordx4 v13, s[20:23], s86 offen offset:2048 lds
    v_mfma_f32_16x16x32_bf16 a[68:71], a[176:179], a[140:143], a[68:71]
    v_mfma_f32_16x16x32_bf16 a[28:31], a[172:175], a[128:131], a[28:31]
    ds_read_b64_tr_b16 a[170:171], v6 offset:20992
    v_mfma_f32_16x16x32_bf16 a[28:31], a[176:179], a[144:147], a[28:31]
    s_waitcnt lgkmcnt(8)
    v_mfma_f32_16x16x32_bf16 v[104:107], a[148:151], a[116:119], v[104:107]
    ds_read_b64_tr_b16 a[172:173], v7 offset:16384
    buffer_load_dwordx4 v13, s[20:23], s87 offen offset:3072 lds
    v_mfma_f32_16x16x32_bf16 v[104:107], a[152:155], a[132:135], v[104:107]
    s_add_u32 s72, s72, 1
    s_cmp_eq_u32 s51, s72
    v_mfma_f32_16x16x32_bf16 v[108:111], a[148:151], a[120:123], v[108:111]
    ds_read_b64_tr_b16 a[174:175], v7 offset:16896
    s_movk_i32 s82, 128
    v_mfma_f32_16x16x32_bf16 v[108:111], a[152:155], a[136:139], v[108:111]
    s_cselect_b32 s82, 384, s82
    v_add_u32 v13, s82, v13
    v_mfma_f32_16x16x32_bf16 v[112:115], a[148:151], a[124:127], v[112:115]
    ds_read_b64_tr_b16 a[176:177], v7 offset:20480
    s_add_u32 m0, s11, 0
    v_mfma_f32_16x16x32_bf16 v[112:115], a[152:155], a[140:143], v[112:115]
    v_lshl_add_u32 v3, v0, 6, s100
    buffer_load_dword a236, v3, s[96:99], 0 offen
    v_mfma_f32_16x16x32_bf16 a[32:35], a[148:151], a[128:131], a[32:35]
    ds_read_b64_tr_b16 a[178:179], v7 offset:20992
    s_add_u32 s100, s100, s89
    v_mfma_f32_16x16x32_bf16 a[32:35], a[152:155], a[144:147], a[32:35]
    s_mov_b32 s89, 0x70000000
    s_waitcnt lgkmcnt(8)
    v_mfma_f32_16x16x32_bf16 v[116:119], a[156:159], a[116:119], v[116:119]
    ds_read_b64_tr_b16 a[148:149], v4 offset:24576
    buffer_load_dwordx4 v10, s[24:27], s62 offen offset:0 lds
    v_mfma_f32_16x16x32_bf16 v[116:119], a[160:163], a[132:135], v[116:119]
    v_mfma_f32_16x16x32_bf16 v[120:123], a[156:159], a[120:123], v[120:123]
    ds_read_b64_tr_b16 a[150:151], v4 offset:25088
    v_mfma_f32_16x16x32_bf16 v[120:123], a[160:163], a[136:139], v[120:123]
    v_mfma_f32_16x16x32_bf16 v[124:127], a[156:159], a[124:127], v[124:127]
    ds_read_b64_tr_b16 a[152:153], v4 offset:28672
    v_lshl_add_u32 v14, v0, 6, s101
    v_mfma_f32_16x16x32_bf16 v[124:127], a[160:163], a[140:143], v[124:127]
    buffer_load_dword a237, v14, s[92:95], 0 offen
    s_mov_b32 s101, 0x70000000
    v_mfma_f32_16x16x32_bf16 a[36:39], a[156:159], a[128:131], a[36:39]
    ds_read_b64_tr_b16 a[154:155], v4 offset:29184
    v_mfma_f32_16x16x32_bf16 a[36:39], a[160:163], a[144:147], a[36:39]
    s_waitcnt lgkmcnt(8)
    v_mfma_f32_16x16x32_bf16 v[128:131], a[164:167], a[116:119], v[128:131]
    ds_read_b64_tr_b16 a[156:157], v5 offset:24576
    buffer_load_dwordx4 v11, s[24:27], s63 offen offset:1024 lds
    v_mfma_f32_16x16x32_bf16 v[128:131], a[168:171], a[132:135], v[128:131]
    v_add_u32 v4, s10, v4
    v_mfma_f32_16x16x32_bf16 v[132:135], a[164:167], a[120:123], v[132:135]
    ds_read_b64_tr_b16 a[158:159], v5 offset:25088
    v_mfma_f32_16x16x32_bf16 v[132:135], a[168:171], a[136:139], v[132:135]
    v_mfma_f32_16x16x32_bf16 v[136:139], a[164:167], a[124:127], v[136:139]
    ds_read_b64_tr_b16 a[160:161], v5 offset:28672
    v_mfma_f32_16x16x32_bf16 v[136:139], a[168:171], a[140:143], v[136:139]
    v_mfma_f32_16x16x32_bf16 a[40:43], a[164:167], a[128:131], a[40:43]
    ds_read_b64_tr_b16 a[162:163], v5 offset:29184
    v_mfma_f32_16x16x32_bf16 a[40:43], a[168:171], a[144:147], a[40:43]
    s_waitcnt lgkmcnt(8)
    v_mfma_f32_16x16x32_bf16 v[140:143], a[172:175], a[116:119], v[140:143]
    ds_read_b64_tr_b16 a[164:165], v6 offset:24576
    buffer_load_dwordx4 v10, s[24:27], s64 offen offset:2048 lds
    v_mfma_f32_16x16x32_bf16 v[140:143], a[176:179], a[132:135], v[140:143]
    v_add_u32 v5, s10, v5
    v_mfma_f32_16x16x32_bf16 v[144:147], a[172:175], a[120:123], v[144:147]
    ds_read_b64_tr_b16 a[166:167], v6 offset:25088
    v_mfma_f32_16x16x32_bf16 v[144:147], a[176:179], a[136:139], v[144:147]
    v_mfma_f32_16x16x32_bf16 a[80:83], a[172:175], a[124:127], a[80:83]
    ds_read_b64_tr_b16 a[168:169], v6 offset:28672
    v_mfma_f32_16x16x32_bf16 a[80:83], a[176:179], a[140:143], a[80:83]
    v_mfma_f32_16x16x32_bf16 a[44:47], a[172:175], a[128:131], a[44:47]
    ds_read_b64_tr_b16 a[170:171], v6 offset:29184
    v_mfma_f32_16x16x32_bf16 a[44:47], a[176:179], a[144:147], a[44:47]
    s_waitcnt lgkmcnt(8)
    v_mfma_f32_16x16x32_bf16 v[148:151], a[148:151], a[116:119], v[148:151]
    ds_read_b64_tr_b16 a[172:173], v7 offset:24576
    buffer_load_dwordx4 v11, s[24:27], s65 offen offset:3072 lds
    v_mfma_f32_16x16x32_bf16 v[148:151], a[152:155], a[132:135], v[148:151]
    v_add_u32 v6, s10, v6
    v_mfma_f32_16x16x32_bf16 v[152:155], a[148:151], a[120:123], v[152:155]
    ds_read_b64_tr_b16 a[174:175], v7 offset:25088
    v_mfma_f32_16x16x32_bf16 v[152:155], a[152:155], a[136:139], v[152:155]
    v_mfma_f32_16x16x32_bf16 v[156:159], a[148:151], a[124:127], v[156:159]
    ds_read_b64_tr_b16 a[176:177], v7 offset:28672
    s_add_u32 m0, s11, 4096
    v_mfma_f32_16x16x32_bf16 v[156:159], a[152:155], a[140:143], v[156:159]
    v_mfma_f32_16x16x32_bf16 a[48:51], a[148:151], a[128:131], a[48:51]
    ds_read_b64_tr_b16 a[178:179], v7 offset:29184
    v_mfma_f32_16x16x32_bf16 a[48:51], a[152:155], a[144:147], a[48:51]
    s_waitcnt lgkmcnt(8)
    v_mfma_f32_16x16x32_bf16 v[160:163], a[156:159], a[116:119], v[160:163]
    ds_read_b64_tr_b16 a[148:149], v8 offset:0
    buffer_load_dwordx4 v10, s[24:27], s66 offen offset:0 lds
    v_mfma_f32_16x16x32_bf16 v[160:163], a[160:163], a[132:135], v[160:163]
    v_add_u32 v7, s10, v7
    v_mfma_f32_16x16x32_bf16 v[164:167], a[156:159], a[120:123], v[164:167]
    ds_read_b64_tr_b16 a[150:151], v8 offset:256
    v_mfma_f32_16x16x32_bf16 v[164:167], a[160:163], a[136:139], v[164:167]
    v_mfma_f32_16x16x32_bf16 a[72:75], a[156:159], a[124:127], a[72:75]
    ds_read_b64_tr_b16 a[152:153], v8 offset:4096
    v_mfma_f32_16x16x32_bf16 a[72:75], a[160:163], a[140:143], a[72:75]
    v_mfma_f32_16x16x32_bf16 a[52:55], a[156:159], a[128:131], a[52:55]
    ds_read_b64_tr_b16 a[154:155], v8 offset:4352
    v_mfma_f32_16x16x32_bf16 a[52:55], a[160:163], a[144:147], a[52:55]
    s_waitcnt lgkmcnt(8)
    v_mfma_f32_16x16x32_bf16 v[168:171], a[164:167], a[116:119], v[168:171]
    ds_read_b64_tr_b16 a[156:157], v9 offset:0
    buffer_load_dwordx4 v11, s[24:27], s67 offen offset:1024 lds
    v_mfma_f32_16x16x32_bf16 v[168:171], a[168:171], a[132:135], v[168:171]
    v_mfma_f32_16x16x32_bf16 v[172:175], a[164:167], a[120:123], v[172:175]
    ds_read_b64_tr_b16 a[158:159], v9 offset:256
    v_mfma_f32_16x16x32_bf16 v[172:175], a[168:171], a[136:139], v[172:175]
    v_mfma_f32_16x16x32_bf16 v[176:179], a[164:167], a[124:127], v[176:179]
    ds_read_b64_tr_b16 a[160:161], v9 offset:4096
    v_mfma_f32_16x16x32_bf16 v[176:179], a[168:171], a[140:143], v[176:179]
    v_mfma_f32_16x16x32_bf16 a[56:59], a[164:167], a[128:131], a[56:59]
    ds_read_b64_tr_b16 a[162:163], v9 offset:4352
    v_mfma_f32_16x16x32_bf16 a[56:59], a[168:171], a[144:147], a[56:59]
    s_waitcnt lgkmcnt(8)
    v_mfma_f32_16x16x32_bf16 v[180:183], a[172:175], a[116:119], v[180:183]
    ds_read_b64_tr_b16 a[164:165], v8 offset:1024
    buffer_load_dwordx4 v10, s[24:27], s68 offen offset:2048 lds
    v_mfma_f32_16x16x32_bf16 v[180:183], a[176:179], a[132:135], v[180:183]
    v_mov_b32 v2, 1
    v_mfma_f32_16x16x32_bf16 v[184:187], a[172:175], a[120:123], v[184:187]
    ds_read_b64_tr_b16 a[166:167], v8 offset:1280
    v_mfma_f32_16x16x32_bf16 v[184:187], a[176:179], a[136:139], v[184:187]
    v_mfma_f32_16x16x32_bf16 a[76:79], a[172:175], a[124:127], a[76:79]
    ds_read_b64_tr_b16 a[168:169], v8 offset:5120
    v_mfma_f32_16x16x32_bf16 a[76:79], a[176:179], a[140:143], a[76:79]
    v_mfma_f32_16x16x32_bf16 a[60:63], a[172:175], a[128:131], a[60:63]
    ds_read_b64_tr_b16 a[170:171], v8 offset:5376
    v_mfma_f32_16x16x32_bf16 a[60:63], a[176:179], a[144:147], a[60:63]
    s_waitcnt lgkmcnt(8)
    v_mfma_f32_16x16x32_bf16 v[188:191], a[148:151], a[116:119], v[188:191]
    ds_read_b64_tr_b16 a[172:173], v9 offset:1024
    buffer_load_dwordx4 v11, s[24:27], s69 offen offset:3072 lds
    v_mfma_f32_16x16x32_bf16 v[188:191], a[152:155], a[132:135], v[188:191]
    v_add_u32 v8, s10, v8
    v_mfma_f32_16x16x32_bf16 v[192:195], a[148:151], a[120:123], v[192:195]
    ds_read_b64_tr_b16 a[174:175], v9 offset:1280
    v_mfma_f32_16x16x32_bf16 v[192:195], a[152:155], a[136:139], v[192:195]
    v_mfma_f32_16x16x32_bf16 v[196:199], a[148:151], a[124:127], v[196:199]
    ds_read_b64_tr_b16 a[176:177], v9 offset:5120
    s_add_u32 m0, s12, 0
    v_mfma_f32_16x16x32_bf16 v[196:199], a[152:155], a[140:143], v[196:199]
    v_mfma_f32_16x16x32_bf16 v[200:203], a[148:151], a[128:131], v[200:203]
    ds_read_b64_tr_b16 a[178:179], v9 offset:5376
    v_mfma_f32_16x16x32_bf16 v[200:203], a[152:155], a[144:147], v[200:203]
    s_waitcnt lgkmcnt(8)
    v_mfma_f32_16x16x32_bf16 v[204:207], a[156:159], a[116:119], v[204:207]
    buffer_load_dwordx4 v12, s[28:31], s52 offen lds
    v_mfma_f32_16x16x32_bf16 v[204:207], a[160:163], a[132:135], v[204:207]
    v_add_u32 v9, s10, v9
    v_mfma_f32_16x16x32_bf16 v[208:211], a[156:159], a[120:123], v[208:211]
    v_mfma_f32_16x16x32_bf16 v[208:211], a[160:163], a[136:139], v[208:211]
    v_mfma_f32_16x16x32_bf16 v[212:215], a[156:159], a[124:127], v[212:215]
    s_add_u32 m0, s12, 1024
    v_mfma_f32_16x16x32_bf16 v[212:215], a[160:163], a[140:143], v[212:215]
    v_mfma_f32_16x16x32_bf16 v[216:219], a[156:159], a[128:131], v[216:219]
    v_mfma_f32_16x16x32_bf16 v[216:219], a[160:163], a[144:147], v[216:219]
    s_waitcnt vmcnt(19) lgkmcnt(0)
    s_barrier
    buffer_atomic_add v2, v254, s[44:47], 0 offen
    v_mfma_f32_16x16x32_bf16 v[220:223], a[164:167], a[116:119], v[220:223]
    ds_read_b64_tr_b16 a[148:149], v4 offset:0
    buffer_load_dwordx4 v12, s[32:35], s53 offen lds
    v_mfma_f32_16x16x32_bf16 v[220:223], a[168:171], a[132:135], v[220:223]
    ds_read_b64_tr_b16 a[150:151], v4 offset:512
    s_add_u32 s13, s13, 1
    v_mfma_f32_16x16x32_bf16 v[224:227], a[164:167], a[120:123], v[224:227]
    ds_read_b64_tr_b16 a[152:153], v4 offset:4096
    s_cmp_eq_u32 s51, s13
    v_mfma_f32_16x16x32_bf16 v[224:227], a[168:171], a[136:139], v[224:227]
    ds_read_b64_tr_b16 a[154:155], v4 offset:4608
    s_cselect_b32 s82, s73, s56
    v_mfma_f32_16x16x32_bf16 v[228:231], a[164:167], a[124:127], v[228:231]
    ds_read_b64_tr_b16 a[156:157], v5 offset:0
    s_cselect_b32 s83, s74, s57
    v_mfma_f32_16x16x32_bf16 v[228:231], a[168:171], a[140:143], v[228:231]
    ds_read_b64_tr_b16 a[158:159], v5 offset:512
    v_add_u32 v10, s82, v10
    v_mfma_f32_16x16x32_bf16 v[232:235], a[164:167], a[128:131], v[232:235]
    ds_read_b64_tr_b16 a[160:161], v5 offset:4096
    v_add_u32 v11, s82, v11
    v_mfma_f32_16x16x32_bf16 v[232:235], a[168:171], a[144:147], v[232:235]
    ds_read_b64_tr_b16 a[162:163], v5 offset:4608
    v_mfma_f32_16x16x32_bf16 v[236:239], a[172:175], a[116:119], v[236:239]
    ds_read_b64_tr_b16 a[164:165], v6 offset:0
    v_add_u32 v12, s83, v12
    v_mfma_f32_16x16x32_bf16 v[236:239], a[176:179], a[132:135], v[236:239]
    s_cmp_eq_u32 s9, 0
    s_cselect_b32 s82, -81920, s75
    v_mfma_f32_16x16x32_bf16 v[240:243], a[172:175], a[120:123], v[240:243]
    ds_read_b64_tr_b16 a[166:167], v6 offset:512
    s_add_u32 s11, s11, s82
    v_mfma_f32_16x16x32_bf16 v[240:243], a[176:179], a[136:139], v[240:243]
    s_add_u32 s12, s12, s82
    v_mov_b32 v254, 0x7ff00000
    v_mfma_f32_16x16x32_bf16 v[244:247], a[172:175], a[124:127], v[244:247]
    ds_read_b64_tr_b16 a[168:169], v6 offset:4096
    s_add_u32 s9, s9, 1
    v_mfma_f32_16x16x32_bf16 v[244:247], a[176:179], a[140:143], v[244:247]
    s_cmp_eq_u32 s9, 3
    s_cselect_b32 s9, 0, s9
    v_mfma_f32_16x16x32_bf16 v[248:251], a[172:175], a[128:131], v[248:251]
    ds_read_b64_tr_b16 a[170:171], v6 offset:4608
    v_mfma_f32_16x16x32_bf16 v[248:251], a[176:179], a[144:147], v[248:251]
    s_sub_u32 s8, s8, 1
    s_cmp_lg_u32 s8, 0
    s_cbranch_scc1 gemm1_kernel_loop
    s_waitcnt lgkmcnt(8)
    v_mfma_f32_16x16x32_bf16 v[16:19], a[148:151], a[84:87], v[16:19]
    ds_read_b64_tr_b16 a[172:173], v7 offset:0
    s_waitcnt vmcnt(19)
    v_mfma_f32_16x16x32_bf16 v[16:19], a[152:155], a[100:103], v[16:19]
    ds_read_b128 a[116:119], v252 offset:40960
    buffer_load_dword v15, v255, s[44:47], 0 offen sc1
    v_mfma_f32_16x16x32_bf16 v[20:23], a[148:151], a[88:91], v[20:23]
    ds_read_b64_tr_b16 a[174:175], v7 offset:512
    v_and_b32 v3, 1, v0
    v_mfma_f32_16x16x32_bf16 v[20:23], a[152:155], a[104:107], v[20:23]
    v_cmp_eq_u32 vcc, 0, v3
    v_mov_b32 v2, 32
    v_mfma_f32_16x16x32_bf16 v[24:27], a[148:151], a[92:95], v[24:27]
    ds_read_b64_tr_b16 a[176:177], v7 offset:4096
    v_cndmask_b32 v14, 8, v2, vcc
    v_mfma_f32_16x16x32_bf16 v[24:27], a[152:155], a[108:111], v[24:27]
    ds_read_b128 a[132:135], v253 offset:40960
    v_mfma_f32_16x16x32_bf16 a[0:3], a[148:151], a[96:99], a[0:3]
    ds_read_b64_tr_b16 a[178:179], v7 offset:4608
    v_mfma_f32_16x16x32_bf16 a[0:3], a[152:155], a[112:115], a[0:3]
    s_waitcnt lgkmcnt(10)
    v_mfma_f32_16x16x32_bf16 v[28:31], a[156:159], a[84:87], v[28:31]
    ds_read_b64_tr_b16 a[148:149], v4 offset:8192
    s_waitcnt vmcnt(18)
    v_mfma_f32_16x16x32_bf16 v[28:31], a[160:163], a[100:103], v[28:31]
    ds_read_b128 a[120:123], v252 offset:43008
    v_mfma_f32_16x16x32_bf16 v[32:35], a[156:159], a[88:91], v[32:35]
    ds_read_b64_tr_b16 a[150:151], v4 offset:8704
    v_mfma_f32_16x16x32_bf16 v[32:35], a[160:163], a[104:107], v[32:35]
    v_mfma_f32_16x16x32_bf16 v[36:39], a[156:159], a[92:95], v[36:39]
    ds_read_b64_tr_b16 a[152:153], v4 offset:12288
    ds_read_b128 a[136:139], v253 offset:43008
    v_mfma_f32_16x16x32_bf16 v[36:39], a[160:163], a[108:111], v[36:39]
    v_and_b32 v1, 15, v0
    s_lshl_b32 s16, s71, 8
    v_mfma_f32_16x16x32_bf16 a[4:7], a[156:159], a[96:99], a[4:7]
    ds_read_b64_tr_b16 a[154:155], v4 offset:12800
    s_lshl_b32 s17, s50, 6
    v_mfma_f32_16x16x32_bf16 a[4:7], a[160:163], a[112:115], a[4:7]
    s_add_u32 s16, s16, s17
    s_waitcnt lgkmcnt(12)
    v_mfma_f32_16x16x32_bf16 v[40:43], a[164:167], a[84:87], v[40:43]
    ds_read_b64_tr_b16 a[156:157], v5 offset:8192
    v_add_u32 v1, s16, v1
    v_mfma_f32_16x16x32_bf16 v[40:43], a[168:171], a[100:103], v[40:43]
    v_lshlrev_b32 v1, 4, v1
    v_add_u32 v1, 1048576, v1
    v_mfma_f32_16x16x32_bf16 v[44:47], a[164:167], a[88:91], v[44:47]
    ds_read_b64_tr_b16 a[158:159], v5 offset:8704
    s_mul_i32 s16, s70, 20480
    v_mfma_f32_16x16x32_bf16 v[44:47], a[168:171], a[104:107], v[44:47]
    s_mul_i32 s17, s50, 5120
    s_add_u32 s16, s16, s17
    v_mfma_f32_16x16x32_bf16 v[48:51], a[164:167], a[92:95], v[48:51]
    ds_read_b64_tr_b16 a[160:161], v5 offset:12288
    v_lshlrev_b32 v2, 4, v0
    v_mfma_f32_16x16x32_bf16 v[48:51], a[168:171], a[108:111], v[48:51]
    v_add_u32 v2, s16, v2
    s_movk_i32 s18, 4096
    v_mfma_f32_16x16x32_bf16 a[8:11], a[164:167], a[96:99], a[8:11]
    ds_read_b64_tr_b16 a[162:163], v5 offset:12800
    s_waitcnt vmcnt(16)
    v_mfma_f32_16x16x32_bf16 a[8:11], a[168:171], a[112:115], a[8:11]
    ds_read_b128 a[124:127], v252 offset:45056
    s_waitcnt lgkmcnt(11)
    v_mfma_f32_16x16x32_bf16 v[52:55], a[172:175], a[84:87], v[52:55]
    ds_read_b64_tr_b16 a[164:165], v6 offset:8192
    ds_read_b128 a[140:143], v253 offset:45056
    v_mfma_f32_16x16x32_bf16 v[52:55], a[176:179], a[100:103], v[52:55]
    s_waitcnt vmcnt(14)
    ds_read_b128 a[128:131], v252 offset:47104
    v_mfma_f32_16x16x32_bf16 v[56:59], a[172:175], a[88:91], v[56:59]
    ds_read_b64_tr_b16 a[166:167], v6 offset:8704
    v_mfma_f32_16x16x32_bf16 v[56:59], a[176:179], a[104:107], v[56:59]
    v_mfma_f32_16x16x32_bf16 v[60:63], a[172:175], a[92:95], v[60:63]
    ds_read_b64_tr_b16 a[168:169], v6 offset:12288
    ds_read_b128 a[144:147], v253 offset:47104
    v_mfma_f32_16x16x32_bf16 v[60:63], a[176:179], a[108:111], v[60:63]
    v_mfma_f32_16x16x32_bf16 a[12:15], a[172:175], a[96:99], a[12:15]
    ds_read_b64_tr_b16 a[170:171], v6 offset:12800
    v_mfma_f32_16x16x32_bf16 a[12:15], a[176:179], a[112:115], a[12:15]
    s_waitcnt lgkmcnt(12)
    v_mfma_f32_16x16x32_bf16 v[64:67], a[148:151], a[84:87], v[64:67]
    ds_read_b64_tr_b16 a[172:173], v7 offset:8192
    s_add_u32 m0, s58, 122880
    v_mfma_f32_16x16x32_bf16 v[64:67], a[152:155], a[100:103], v[64:67]
    v_mfma_f32_16x16x32_bf16 v[68:71], a[148:151], a[88:91], v[68:71]
    ds_read_b64_tr_b16 a[174:175], v7 offset:8704
    v_mfma_f32_16x16x32_bf16 v[68:71], a[152:155], a[104:107], v[68:71]
    v_mfma_f32_16x16x32_bf16 v[72:75], a[148:151], a[92:95], v[72:75]
    ds_read_b64_tr_b16 a[176:177], v7 offset:12288
    buffer_load_dwordx4 v13, s[20:23], s40 offen offset:0 lds
    v_mfma_f32_16x16x32_bf16 v[72:75], a[152:155], a[108:111], v[72:75]
    v_mfma_f32_16x16x32_bf16 a[16:19], a[148:151], a[96:99], a[16:19]
    ds_read_b64_tr_b16 a[178:179], v7 offset:12800
    v_mfma_f32_16x16x32_bf16 a[16:19], a[152:155], a[112:115], a[16:19]
    s_waitcnt lgkmcnt(12)
    v_mfma_f32_16x16x32_bf16 v[76:79], a[156:159], a[84:87], v[76:79]
    ds_read_b64_tr_b16 a[148:149], v4 offset:16384
    buffer_load_dwordx4 v13, s[20:23], s41 offen offset:1024 lds
    v_mfma_f32_16x16x32_bf16 v[76:79], a[160:163], a[100:103], v[76:79]
    v_mfma_f32_16x16x32_bf16 v[80:83], a[156:159], a[88:91], v[80:83]
    ds_read_b64_tr_b16 a[150:151], v4 offset:16896
    v_mfma_f32_16x16x32_bf16 v[80:83], a[160:163], a[104:107], v[80:83]
    v_mfma_f32_16x16x32_bf16 a[64:67], a[156:159], a[92:95], a[64:67]
    ds_read_b64_tr_b16 a[152:153], v4 offset:20480
    buffer_load_dwordx4 v13, s[20:23], s42 offen offset:2048 lds
    v_mfma_f32_16x16x32_bf16 a[64:67], a[160:163], a[108:111], a[64:67]
    v_mfma_f32_16x16x32_bf16 a[20:23], a[156:159], a[96:99], a[20:23]
    ds_read_b64_tr_b16 a[154:155], v4 offset:20992
    v_mfma_f32_16x16x32_bf16 a[20:23], a[160:163], a[112:115], a[20:23]
    s_waitcnt lgkmcnt(8)
    v_mfma_f32_16x16x32_bf16 v[84:87], a[164:167], a[84:87], v[84:87]
    ds_read_b64_tr_b16 a[156:157], v5 offset:16384
    buffer_load_dwordx4 v13, s[20:23], s43 offen offset:3072 lds
    v_mfma_f32_16x16x32_bf16 v[84:87], a[168:171], a[100:103], v[84:87]
    s_add_u32 m0, s58, 126976
    v_mfma_f32_16x16x32_bf16 v[88:91], a[164:167], a[88:91], v[88:91]
    ds_read_b64_tr_b16 a[158:159], v5 offset:16896
    v_mfma_f32_16x16x32_bf16 v[88:91], a[168:171], a[104:107], v[88:91]
    v_mfma_f32_16x16x32_bf16 v[92:95], a[164:167], a[92:95], v[92:95]
    ds_read_b64_tr_b16 a[160:161], v5 offset:20480
    buffer_load_dwordx4 v13, s[20:23], s84 offen offset:0 lds
    v_mfma_f32_16x16x32_bf16 v[92:95], a[168:171], a[108:111], v[92:95]
    v_mfma_f32_16x16x32_bf16 a[24:27], a[164:167], a[96:99], a[24:27]
    ds_read_b64_tr_b16 a[162:163], v5 offset:20992
    v_mfma_f32_16x16x32_bf16 a[24:27], a[168:171], a[112:115], a[24:27]
    s_waitcnt lgkmcnt(8)
    v_mfma_f32_16x16x32_bf16 v[96:99], a[172:175], a[84:87], v[96:99]
    ds_read_b64_tr_b16 a[164:165], v6 offset:16384
    buffer_load_dwordx4 v13, s[20:23], s85 offen offset:1024 lds
    v_mfma_f32_16x16x32_bf16 v[96:99], a[176:179], a[100:103], v[96:99]
    v_mfma_f32_16x16x32_bf16 v[100:103], a[172:175], a[88:91], v[100:103]
    ds_read_b64_tr_b16 a[166:167], v6 offset:16896
    v_mfma_f32_16x16x32_bf16 v[100:103], a[176:179], a[104:107], v[100:103]
    v_mfma_f32_16x16x32_bf16 a[68:71], a[172:175], a[92:95], a[68:71]
    ds_read_b64_tr_b16 a[168:169], v6 offset:20480
    buffer_load_dwordx4 v13, s[20:23], s86 offen offset:2048 lds
    v_mfma_f32_16x16x32_bf16 a[68:71], a[176:179], a[108:111], a[68:71]
    v_mfma_f32_16x16x32_bf16 a[28:31], a[172:175], a[96:99], a[28:31]
    ds_read_b64_tr_b16 a[170:171], v6 offset:20992
    v_mfma_f32_16x16x32_bf16 a[28:31], a[176:179], a[112:115], a[28:31]
    s_waitcnt lgkmcnt(8)
    v_mfma_f32_16x16x32_bf16 v[104:107], a[148:151], a[84:87], v[104:107]
    ds_read_b64_tr_b16 a[172:173], v7 offset:16384
    buffer_load_dwordx4 v13, s[20:23], s87 offen offset:3072 lds
    v_mfma_f32_16x16x32_bf16 v[104:107], a[152:155], a[100:103], v[104:107]
    s_cmp_eq_u32 s51, 13
    s_movk_i32 s82, 128
    v_mfma_f32_16x16x32_bf16 v[108:111], a[148:151], a[88:91], v[108:111]
    ds_read_b64_tr_b16 a[174:175], v7 offset:16896
    s_cselect_b32 s82, 384, s82
    v_mfma_f32_16x16x32_bf16 v[108:111], a[152:155], a[104:107], v[108:111]
    v_add_u32 v13, s82, v13
    s_waitcnt vmcnt(8)
    v_cmp_gt_u32 vcc, v14, v15
    s_cbranch_vccnz gemm1_kernel_spin
gemm1_kernel_ready:
    v_mfma_f32_16x16x32_bf16 v[112:115], a[148:151], a[92:95], v[112:115]
    ds_read_b64_tr_b16 a[176:177], v7 offset:20480
    s_add_u32 m0, s58, 81920
    v_mfma_f32_16x16x32_bf16 v[112:115], a[152:155], a[108:111], v[112:115]
    v_mfma_f32_16x16x32_bf16 a[32:35], a[148:151], a[96:99], a[32:35]
    ds_read_b64_tr_b16 a[178:179], v7 offset:20992
    v_mfma_f32_16x16x32_bf16 a[32:35], a[152:155], a[112:115], a[32:35]
    s_waitcnt lgkmcnt(8)
    v_mfma_f32_16x16x32_bf16 v[116:119], a[156:159], a[84:87], v[116:119]
    ds_read_b64_tr_b16 a[148:149], v4 offset:24576
    buffer_load_dwordx4 v10, s[24:27], s62 offen offset:0 lds
    v_mfma_f32_16x16x32_bf16 v[116:119], a[160:163], a[100:103], v[116:119]
    v_mfma_f32_16x16x32_bf16 v[120:123], a[156:159], a[88:91], v[120:123]
    ds_read_b64_tr_b16 a[150:151], v4 offset:25088
    v_mfma_f32_16x16x32_bf16 v[120:123], a[160:163], a[104:107], v[120:123]
    v_mfma_f32_16x16x32_bf16 v[124:127], a[156:159], a[92:95], v[124:127]
    ds_read_b64_tr_b16 a[152:153], v4 offset:28672
    buffer_load_dwordx4 a[240:243], v1, s[36:39], 0 offen offset:0 sc1
    v_mfma_f32_16x16x32_bf16 v[124:127], a[160:163], a[108:111], v[124:127]
    v_mfma_f32_16x16x32_bf16 a[36:39], a[156:159], a[96:99], a[36:39]
    ds_read_b64_tr_b16 a[154:155], v4 offset:29184
    v_mfma_f32_16x16x32_bf16 a[36:39], a[160:163], a[112:115], a[36:39]
    s_waitcnt lgkmcnt(8)
    v_mfma_f32_16x16x32_bf16 v[128:131], a[164:167], a[84:87], v[128:131]
    ds_read_b64_tr_b16 a[156:157], v5 offset:24576
    buffer_load_dwordx4 v11, s[24:27], s63 offen offset:1024 lds
    v_mfma_f32_16x16x32_bf16 v[128:131], a[168:171], a[100:103], v[128:131]
    v_add_u32 v4, 40960, v4
    v_mfma_f32_16x16x32_bf16 v[132:135], a[164:167], a[88:91], v[132:135]
    ds_read_b64_tr_b16 a[158:159], v5 offset:25088
    v_mfma_f32_16x16x32_bf16 v[132:135], a[168:171], a[104:107], v[132:135]
    v_mfma_f32_16x16x32_bf16 v[136:139], a[164:167], a[92:95], v[136:139]
    ds_read_b64_tr_b16 a[160:161], v5 offset:28672
    buffer_load_dwordx4 a[244:247], v1, s[36:39], 0 offen offset:256 sc1
    v_mfma_f32_16x16x32_bf16 v[136:139], a[168:171], a[108:111], v[136:139]
    v_mfma_f32_16x16x32_bf16 a[40:43], a[164:167], a[96:99], a[40:43]
    ds_read_b64_tr_b16 a[162:163], v5 offset:29184
    v_mfma_f32_16x16x32_bf16 a[40:43], a[168:171], a[112:115], a[40:43]
    s_waitcnt lgkmcnt(8)
    v_mfma_f32_16x16x32_bf16 v[140:143], a[172:175], a[84:87], v[140:143]
    ds_read_b64_tr_b16 a[164:165], v6 offset:24576
    buffer_load_dwordx4 v10, s[24:27], s64 offen offset:2048 lds
    v_mfma_f32_16x16x32_bf16 v[140:143], a[176:179], a[100:103], v[140:143]
    v_add_u32 v5, 40960, v5
    v_mfma_f32_16x16x32_bf16 v[144:147], a[172:175], a[88:91], v[144:147]
    ds_read_b64_tr_b16 a[166:167], v6 offset:25088
    v_mfma_f32_16x16x32_bf16 v[144:147], a[176:179], a[104:107], v[144:147]
    v_mfma_f32_16x16x32_bf16 a[80:83], a[172:175], a[92:95], a[80:83]
    ds_read_b64_tr_b16 a[168:169], v6 offset:28672
    buffer_load_dwordx4 a[248:251], v1, s[36:39], 0 offen offset:512 sc1
    v_mfma_f32_16x16x32_bf16 a[80:83], a[176:179], a[108:111], a[80:83]
    v_mfma_f32_16x16x32_bf16 a[44:47], a[172:175], a[96:99], a[44:47]
    ds_read_b64_tr_b16 a[170:171], v6 offset:29184
    v_mfma_f32_16x16x32_bf16 a[44:47], a[176:179], a[112:115], a[44:47]
    s_waitcnt lgkmcnt(8)
    v_mfma_f32_16x16x32_bf16 v[148:151], a[148:151], a[84:87], v[148:151]
    ds_read_b64_tr_b16 a[172:173], v7 offset:24576
    buffer_load_dwordx4 v11, s[24:27], s65 offen offset:3072 lds
    v_mfma_f32_16x16x32_bf16 v[148:151], a[152:155], a[100:103], v[148:151]
    v_add_u32 v6, 40960, v6
    v_mfma_f32_16x16x32_bf16 v[152:155], a[148:151], a[88:91], v[152:155]
    ds_read_b64_tr_b16 a[174:175], v7 offset:25088
    v_mfma_f32_16x16x32_bf16 v[152:155], a[152:155], a[104:107], v[152:155]
    v_mfma_f32_16x16x32_bf16 v[156:159], a[148:151], a[92:95], v[156:159]
    ds_read_b64_tr_b16 a[176:177], v7 offset:28672
    s_add_u32 m0, s58, 86016
    v_mfma_f32_16x16x32_bf16 v[156:159], a[152:155], a[108:111], v[156:159]
    buffer_load_dwordx4 a[252:255], v1, s[36:39], 0 offen offset:768 sc1
    v_mfma_f32_16x16x32_bf16 a[48:51], a[148:151], a[96:99], a[48:51]
    ds_read_b64_tr_b16 a[178:179], v7 offset:29184
    v_mfma_f32_16x16x32_bf16 a[48:51], a[152:155], a[112:115], a[48:51]
    s_waitcnt lgkmcnt(8)
    v_mfma_f32_16x16x32_bf16 v[160:163], a[156:159], a[84:87], v[160:163]
    ds_read_b64_tr_b16 a[148:149], v8 offset:0
    buffer_load_dwordx4 v10, s[24:27], s66 offen offset:0 lds
    v_mfma_f32_16x16x32_bf16 v[160:163], a[160:163], a[100:103], v[160:163]
    v_add_u32 v7, 40960, v7
    v_mfma_f32_16x16x32_bf16 v[164:167], a[156:159], a[88:91], v[164:167]
    ds_read_b64_tr_b16 a[150:151], v8 offset:256
    v_mfma_f32_16x16x32_bf16 v[164:167], a[160:163], a[104:107], v[164:167]
    v_mfma_f32_16x16x32_bf16 a[72:75], a[156:159], a[92:95], a[72:75]
    ds_read_b64_tr_b16 a[152:153], v8 offset:4096
    buffer_load_dwordx4 a[180:183], v2, s[36:39], 0 offen offset:0 sc1
    v_mfma_f32_16x16x32_bf16 a[72:75], a[160:163], a[108:111], a[72:75]
    v_mfma_f32_16x16x32_bf16 a[52:55], a[156:159], a[96:99], a[52:55]
    ds_read_b64_tr_b16 a[154:155], v8 offset:4352
    v_mfma_f32_16x16x32_bf16 a[52:55], a[160:163], a[112:115], a[52:55]
    s_waitcnt lgkmcnt(8)
    v_mfma_f32_16x16x32_bf16 v[168:171], a[164:167], a[84:87], v[168:171]
    ds_read_b64_tr_b16 a[156:157], v9 offset:0
    buffer_load_dwordx4 v11, s[24:27], s67 offen offset:1024 lds
    v_mfma_f32_16x16x32_bf16 v[168:171], a[168:171], a[100:103], v[168:171]
    v_mfma_f32_16x16x32_bf16 v[172:175], a[164:167], a[88:91], v[172:175]
    ds_read_b64_tr_b16 a[158:159], v9 offset:256
    v_mfma_f32_16x16x32_bf16 v[172:175], a[168:171], a[104:107], v[172:175]
    v_mfma_f32_16x16x32_bf16 v[176:179], a[164:167], a[92:95], v[176:179]
    ds_read_b64_tr_b16 a[160:161], v9 offset:4096
    buffer_load_dwordx4 a[184:187], v2, s[36:39], 0 offen offset:1024 sc1
    v_mfma_f32_16x16x32_bf16 v[176:179], a[168:171], a[108:111], v[176:179]
    v_mfma_f32_16x16x32_bf16 a[56:59], a[164:167], a[96:99], a[56:59]
    ds_read_b64_tr_b16 a[162:163], v9 offset:4352
    v_mfma_f32_16x16x32_bf16 a[56:59], a[168:171], a[112:115], a[56:59]
    s_waitcnt lgkmcnt(8)
    v_mfma_f32_16x16x32_bf16 v[180:183], a[172:175], a[84:87], v[180:183]
    ds_read_b64_tr_b16 a[164:165], v8 offset:1024
    buffer_load_dwordx4 v10, s[24:27], s68 offen offset:2048 lds
    v_mfma_f32_16x16x32_bf16 v[180:183], a[176:179], a[100:103], v[180:183]
    v_mfma_f32_16x16x32_bf16 v[184:187], a[172:175], a[88:91], v[184:187]
    ds_read_b64_tr_b16 a[166:167], v8 offset:1280
    v_mfma_f32_16x16x32_bf16 v[184:187], a[176:179], a[104:107], v[184:187]
    v_mfma_f32_16x16x32_bf16 a[76:79], a[172:175], a[92:95], a[76:79]
    ds_read_b64_tr_b16 a[168:169], v8 offset:5120
    buffer_load_dwordx4 a[188:191], v2, s[36:39], 0 offen offset:2048 sc1
    v_mfma_f32_16x16x32_bf16 a[76:79], a[176:179], a[108:111], a[76:79]
    v_mfma_f32_16x16x32_bf16 a[60:63], a[172:175], a[96:99], a[60:63]
    ds_read_b64_tr_b16 a[170:171], v8 offset:5376
    v_mfma_f32_16x16x32_bf16 a[60:63], a[176:179], a[112:115], a[60:63]
    s_waitcnt lgkmcnt(8)
    v_mfma_f32_16x16x32_bf16 v[188:191], a[148:151], a[84:87], v[188:191]
    ds_read_b64_tr_b16 a[172:173], v9 offset:1024
    buffer_load_dwordx4 v11, s[24:27], s69 offen offset:3072 lds
    v_mfma_f32_16x16x32_bf16 v[188:191], a[152:155], a[100:103], v[188:191]
    v_add_u32 v8, 40960, v8
    v_mfma_f32_16x16x32_bf16 v[192:195], a[148:151], a[88:91], v[192:195]
    ds_read_b64_tr_b16 a[174:175], v9 offset:1280
    v_mfma_f32_16x16x32_bf16 v[192:195], a[152:155], a[104:107], v[192:195]
    v_mfma_f32_16x16x32_bf16 v[196:199], a[148:151], a[92:95], v[196:199]
    ds_read_b64_tr_b16 a[176:177], v9 offset:5120
    s_add_u32 m0, s59, 81920
    v_mfma_f32_16x16x32_bf16 v[196:199], a[152:155], a[108:111], v[196:199]
    buffer_load_dwordx4 a[192:195], v2, s[36:39], 0 offen offset:3072 sc1
    v_mfma_f32_16x16x32_bf16 v[200:203], a[148:151], a[96:99], v[200:203]
    ds_read_b64_tr_b16 a[178:179], v9 offset:5376
    v_mfma_f32_16x16x32_bf16 v[200:203], a[152:155], a[112:115], v[200:203]
    s_waitcnt lgkmcnt(8)
    v_mfma_f32_16x16x32_bf16 v[204:207], a[156:159], a[84:87], v[204:207]
    buffer_load_dwordx4 v12, s[28:31], s52 offen lds
    v_mfma_f32_16x16x32_bf16 v[204:207], a[160:163], a[100:103], v[204:207]
    v_add_u32 v9, 40960, v9
    v_mfma_f32_16x16x32_bf16 v[208:211], a[156:159], a[88:91], v[208:211]
    v_mfma_f32_16x16x32_bf16 v[208:211], a[160:163], a[104:107], v[208:211]
    v_mfma_f32_16x16x32_bf16 v[212:215], a[156:159], a[92:95], v[212:215]
    s_add_u32 m0, s59, 82944
    buffer_load_dwordx4 a[196:199], v2, s[36:39], s18 offen offset:0 sc1
    v_mfma_f32_16x16x32_bf16 v[212:215], a[160:163], a[108:111], v[212:215]
    v_mfma_f32_16x16x32_bf16 v[216:219], a[156:159], a[96:99], v[216:219]
    v_mfma_f32_16x16x32_bf16 v[216:219], a[160:163], a[112:115], v[216:219]
    s_waitcnt lgkmcnt(0)
    s_barrier
    v_mfma_f32_16x16x32_bf16 v[220:223], a[164:167], a[84:87], v[220:223]
    ds_read_b64_tr_b16 a[148:149], v4 offset:0
    buffer_load_dwordx4 v12, s[32:35], s53 offen lds
    v_mfma_f32_16x16x32_bf16 v[220:223], a[168:171], a[100:103], v[220:223]
    ds_read_b64_tr_b16 a[150:151], v4 offset:512
    s_cmp_eq_u32 s51, 13
    v_mfma_f32_16x16x32_bf16 v[224:227], a[164:167], a[88:91], v[224:227]
    ds_read_b64_tr_b16 a[152:153], v5 offset:0
    s_cselect_b32 s82, s73, s56
    v_mfma_f32_16x16x32_bf16 v[224:227], a[168:171], a[104:107], v[224:227]
    ds_read_b64_tr_b16 a[154:155], v5 offset:512
    s_cselect_b32 s83, s74, s57
    v_mfma_f32_16x16x32_bf16 v[228:231], a[164:167], a[92:95], v[228:231]
    ds_read_b64_tr_b16 a[156:157], v6 offset:0
    v_add_u32 v10, s82, v10
    v_mfma_f32_16x16x32_bf16 v[228:231], a[168:171], a[108:111], v[228:231]
    ds_read_b64_tr_b16 a[158:159], v6 offset:512
    v_add_u32 v11, s82, v11
    v_mfma_f32_16x16x32_bf16 v[232:235], a[164:167], a[96:99], v[232:235]
    ds_read_b64_tr_b16 a[160:161], v7 offset:0
    v_add_u32 v12, s83, v12
    v_mfma_f32_16x16x32_bf16 v[232:235], a[168:171], a[112:115], v[232:235]
    ds_read_b64_tr_b16 a[162:163], v7 offset:512
    v_mfma_f32_16x16x32_bf16 v[236:239], a[172:175], a[84:87], v[236:239]
    ds_read_b64_tr_b16 a[164:165], v4 offset:8192
    s_add_u32 m0, s58, 0
    v_mfma_f32_16x16x32_bf16 v[236:239], a[176:179], a[100:103], v[236:239]
    buffer_load_dwordx4 v10, s[24:27], s62 offen offset:0 lds
    buffer_load_dwordx4 v11, s[24:27], s63 offen offset:1024 lds
    v_mfma_f32_16x16x32_bf16 v[240:243], a[172:175], a[88:91], v[240:243]
    ds_read_b64_tr_b16 a[166:167], v4 offset:8704
    v_mfma_f32_16x16x32_bf16 v[240:243], a[176:179], a[104:107], v[240:243]
    v_mfma_f32_16x16x32_bf16 v[244:247], a[172:175], a[92:95], v[244:247]
    ds_read_b64_tr_b16 a[168:169], v5 offset:8192
    buffer_load_dwordx4 v10, s[24:27], s64 offen offset:2048 lds
    v_mfma_f32_16x16x32_bf16 v[244:247], a[176:179], a[108:111], v[244:247]
    v_mfma_f32_16x16x32_bf16 v[248:251], a[172:175], a[96:99], v[248:251]
    ds_read_b64_tr_b16 a[170:171], v5 offset:8704
    v_mfma_f32_16x16x32_bf16 v[248:251], a[176:179], a[112:115], v[248:251]
    s_waitcnt lgkmcnt(8)
    v_mfma_f32_16x16x32_bf16 v[16:19], a[148:151], a[116:119], v[16:19]
    ds_read_b64_tr_b16 a[172:173], v6 offset:8192
    buffer_load_dwordx4 v11, s[24:27], s65 offen offset:3072 lds
    v_mfma_f32_16x16x32_bf16 v[20:23], a[148:151], a[120:123], v[20:23]
    s_add_u32 m0, s58, 4096
    s_waitcnt vmcnt(29)
    v_mfma_f32_16x16x32_bf16 v[24:27], a[148:151], a[124:127], v[24:27]
    ds_read_b64_tr_b16 a[174:175], v6 offset:8704
    ds_read_b128 a[84:87], v252 offset:40960
    v_mfma_f32_16x16x32_bf16 a[0:3], a[148:151], a[128:131], a[0:3]
    v_mfma_f32_16x16x32_bf16 v[28:31], a[152:155], a[116:119], v[28:31]
    ds_read_b64_tr_b16 a[176:177], v7 offset:8192
    buffer_load_dwordx4 v10, s[24:27], s66 offen offset:0 lds
    v_mfma_f32_16x16x32_bf16 v[32:35], a[152:155], a[120:123], v[32:35]
    ds_read_b128 a[100:103], v253 offset:40960
    v_mfma_f32_16x16x32_bf16 v[36:39], a[152:155], a[124:127], v[36:39]
    ds_read_b64_tr_b16 a[178:179], v7 offset:8704
    v_mfma_f32_16x16x32_bf16 a[4:7], a[152:155], a[128:131], a[4:7]
    s_waitcnt lgkmcnt(10)
    v_mfma_f32_16x16x32_bf16 v[40:43], a[156:159], a[116:119], v[40:43]
    ds_read_b64_tr_b16 a[148:149], v4 offset:16384
    buffer_load_dwordx4 v11, s[24:27], s67 offen offset:1024 lds
    v_mfma_f32_16x16x32_bf16 v[44:47], a[156:159], a[120:123], v[44:47]
    s_waitcnt vmcnt(29)
    ds_read_b128 a[88:91], v252 offset:43008
    v_mfma_f32_16x16x32_bf16 v[48:51], a[156:159], a[124:127], v[48:51]
    ds_read_b64_tr_b16 a[150:151], v4 offset:16896
    v_mfma_f32_16x16x32_bf16 a[8:11], a[156:159], a[128:131], a[8:11]
    v_mfma_f32_16x16x32_bf16 v[52:55], a[160:163], a[116:119], v[52:55]
    ds_read_b64_tr_b16 a[152:153], v5 offset:16384
    buffer_load_dwordx4 v10, s[24:27], s68 offen offset:2048 lds
    v_mfma_f32_16x16x32_bf16 v[56:59], a[160:163], a[120:123], v[56:59]
    ds_read_b128 a[104:107], v253 offset:43008
    v_mfma_f32_16x16x32_bf16 v[60:63], a[160:163], a[124:127], v[60:63]
    ds_read_b64_tr_b16 a[154:155], v5 offset:16896
    v_mfma_f32_16x16x32_bf16 a[12:15], a[160:163], a[128:131], a[12:15]
    s_waitcnt lgkmcnt(12)
    v_mfma_f32_16x16x32_bf16 v[64:67], a[164:167], a[116:119], v[64:67]
    ds_read_b64_tr_b16 a[156:157], v6 offset:16384
    buffer_load_dwordx4 v11, s[24:27], s69 offen offset:3072 lds
    v_mfma_f32_16x16x32_bf16 v[68:71], a[164:167], a[120:123], v[68:71]
    s_add_u32 m0, s59, 0
    s_waitcnt vmcnt(29)
    v_mfma_f32_16x16x32_bf16 v[72:75], a[164:167], a[124:127], v[72:75]
    ds_read_b64_tr_b16 a[158:159], v6 offset:16896
    ds_read_b128 a[92:95], v252 offset:45056
    v_mfma_f32_16x16x32_bf16 a[16:19], a[164:167], a[128:131], a[16:19]
    v_mfma_f32_16x16x32_bf16 v[76:79], a[168:171], a[116:119], v[76:79]
    ds_read_b64_tr_b16 a[160:161], v7 offset:16384
    buffer_load_dwordx4 v12, s[28:31], s52 offen lds
    v_mfma_f32_16x16x32_bf16 v[80:83], a[168:171], a[120:123], v[80:83]
    s_add_u32 m0, s59, 1024
    ds_read_b128 a[108:111], v253 offset:45056
    v_mfma_f32_16x16x32_bf16 a[64:67], a[168:171], a[124:127], a[64:67]
    ds_read_b64_tr_b16 a[162:163], v7 offset:16896
    v_mfma_f32_16x16x32_bf16 a[20:23], a[168:171], a[128:131], a[20:23]
    s_waitcnt lgkmcnt(12)
    v_mfma_f32_16x16x32_bf16 v[84:87], a[172:175], a[116:119], v[84:87]
    ds_read_b64_tr_b16 a[164:165], v4 offset:24576
    buffer_load_dwordx4 v12, s[32:35], s53 offen lds
    v_mfma_f32_16x16x32_bf16 v[88:91], a[172:175], a[120:123], v[88:91]
    s_waitcnt vmcnt(29)
    ds_read_b128 a[96:99], v252 offset:47104
    v_mfma_f32_16x16x32_bf16 v[92:95], a[172:175], a[124:127], v[92:95]
    ds_read_b64_tr_b16 a[166:167], v4 offset:25088
    v_mfma_f32_16x16x32_bf16 a[24:27], a[172:175], a[128:131], a[24:27]
    v_mfma_f32_16x16x32_bf16 v[96:99], a[176:179], a[116:119], v[96:99]
    ds_read_b64_tr_b16 a[168:169], v5 offset:24576
    ds_read_b128 a[112:115], v253 offset:47104
    v_mfma_f32_16x16x32_bf16 v[100:103], a[176:179], a[120:123], v[100:103]
    v_mfma_f32_16x16x32_bf16 a[68:71], a[176:179], a[124:127], a[68:71]
    ds_read_b64_tr_b16 a[170:171], v5 offset:25088
    v_mfma_f32_16x16x32_bf16 a[28:31], a[176:179], a[128:131], a[28:31]
    s_waitcnt lgkmcnt(12)
    v_mfma_f32_16x16x32_bf16 v[104:107], a[148:151], a[116:119], v[104:107]
    ds_read_b64_tr_b16 a[172:173], v6 offset:24576
    s_add_u32 m0, s58, 122880
    v_mfma_f32_16x16x32_bf16 v[108:111], a[148:151], a[120:123], v[108:111]
    v_mfma_f32_16x16x32_bf16 v[112:115], a[148:151], a[124:127], v[112:115]
    ds_read_b64_tr_b16 a[174:175], v6 offset:25088
    v_mfma_f32_16x16x32_bf16 a[32:35], a[148:151], a[128:131], a[32:35]
    v_mfma_f32_16x16x32_bf16 v[116:119], a[152:155], a[116:119], v[116:119]
    ds_read_b64_tr_b16 a[176:177], v7 offset:24576
    buffer_load_dwordx4 v13, s[20:23], s40 offen offset:0 lds
    v_mfma_f32_16x16x32_bf16 v[120:123], a[152:155], a[120:123], v[120:123]
    v_mfma_f32_16x16x32_bf16 v[124:127], a[152:155], a[124:127], v[124:127]
    ds_read_b64_tr_b16 a[178:179], v7 offset:25088
    v_mfma_f32_16x16x32_bf16 a[36:39], a[152:155], a[128:131], a[36:39]
    s_waitcnt lgkmcnt(10)
    v_mfma_f32_16x16x32_bf16 v[128:131], a[156:159], a[116:119], v[128:131]
    ds_read_b64_tr_b16 a[148:149], v8 offset:0
    buffer_load_dwordx4 v13, s[20:23], s41 offen offset:1024 lds
    v_mfma_f32_16x16x32_bf16 v[132:135], a[156:159], a[120:123], v[132:135]
    v_mfma_f32_16x16x32_bf16 v[136:139], a[156:159], a[124:127], v[136:139]
    ds_read_b64_tr_b16 a[150:151], v8 offset:256
    v_mfma_f32_16x16x32_bf16 a[40:43], a[156:159], a[128:131], a[40:43]
    v_mfma_f32_16x16x32_bf16 v[140:143], a[160:163], a[116:119], v[140:143]
    ds_read_b64_tr_b16 a[152:153], v9 offset:0
    buffer_load_dwordx4 v13, s[20:23], s42 offen offset:2048 lds
    v_mfma_f32_16x16x32_bf16 v[144:147], a[160:163], a[120:123], v[144:147]
    v_mfma_f32_16x16x32_bf16 a[80:83], a[160:163], a[124:127], a[80:83]
    ds_read_b64_tr_b16 a[154:155], v9 offset:256
    v_mfma_f32_16x16x32_bf16 a[44:47], a[160:163], a[128:131], a[44:47]
    s_waitcnt lgkmcnt(8)
    v_mfma_f32_16x16x32_bf16 v[148:151], a[164:167], a[116:119], v[148:151]
    ds_read_b64_tr_b16 a[156:157], v8 offset:1024
    buffer_load_dwordx4 v13, s[20:23], s43 offen offset:3072 lds
    v_mfma_f32_16x16x32_bf16 v[152:155], a[164:167], a[120:123], v[152:155]
    s_add_u32 m0, s58, 126976
    v_mfma_f32_16x16x32_bf16 v[156:159], a[164:167], a[124:127], v[156:159]
    ds_read_b64_tr_b16 a[158:159], v8 offset:1280
    v_mfma_f32_16x16x32_bf16 a[48:51], a[164:167], a[128:131], a[48:51]
    v_mfma_f32_16x16x32_bf16 v[160:163], a[168:171], a[116:119], v[160:163]
    ds_read_b64_tr_b16 a[160:161], v9 offset:1024
    buffer_load_dwordx4 v13, s[20:23], s84 offen offset:0 lds
    v_mfma_f32_16x16x32_bf16 v[164:167], a[168:171], a[120:123], v[164:167]
    v_mfma_f32_16x16x32_bf16 a[72:75], a[168:171], a[124:127], a[72:75]
    ds_read_b64_tr_b16 a[162:163], v9 offset:1280
    v_mfma_f32_16x16x32_bf16 a[52:55], a[168:171], a[128:131], a[52:55]
    s_waitcnt lgkmcnt(8)
    v_mfma_f32_16x16x32_bf16 v[168:171], a[172:175], a[116:119], v[168:171]
    ds_read_b64_tr_b16 a[164:165], v4 offset:4096
    buffer_load_dwordx4 v13, s[20:23], s85 offen offset:1024 lds
    v_mfma_f32_16x16x32_bf16 v[172:175], a[172:175], a[120:123], v[172:175]
    v_mfma_f32_16x16x32_bf16 v[176:179], a[172:175], a[124:127], v[176:179]
    ds_read_b64_tr_b16 a[166:167], v4 offset:4608
    v_mfma_f32_16x16x32_bf16 a[56:59], a[172:175], a[128:131], a[56:59]
    v_mfma_f32_16x16x32_bf16 v[180:183], a[176:179], a[116:119], v[180:183]
    ds_read_b64_tr_b16 a[168:169], v5 offset:4096
    buffer_load_dwordx4 v13, s[20:23], s86 offen offset:2048 lds
    v_mfma_f32_16x16x32_bf16 v[184:187], a[176:179], a[120:123], v[184:187]
    v_mfma_f32_16x16x32_bf16 a[76:79], a[176:179], a[124:127], a[76:79]
    ds_read_b64_tr_b16 a[170:171], v5 offset:4608
    v_mfma_f32_16x16x32_bf16 a[60:63], a[176:179], a[128:131], a[60:63]
    s_waitcnt lgkmcnt(8)
    v_mfma_f32_16x16x32_bf16 v[188:191], a[148:151], a[116:119], v[188:191]
    ds_read_b64_tr_b16 a[172:173], v6 offset:4096
    buffer_load_dwordx4 v13, s[20:23], s87 offen offset:3072 lds
    v_mfma_f32_16x16x32_bf16 v[192:195], a[148:151], a[120:123], v[192:195]
    v_mfma_f32_16x16x32_bf16 v[196:199], a[148:151], a[124:127], v[196:199]
    ds_read_b64_tr_b16 a[174:175], v6 offset:4608
    v_mfma_f32_16x16x32_bf16 v[200:203], a[148:151], a[128:131], v[200:203]
    v_mfma_f32_16x16x32_bf16 v[204:207], a[152:155], a[116:119], v[204:207]
    ds_read_b64_tr_b16 a[176:177], v7 offset:4096
    v_mfma_f32_16x16x32_bf16 v[208:211], a[152:155], a[120:123], v[208:211]
    v_mfma_f32_16x16x32_bf16 v[212:215], a[152:155], a[124:127], v[212:215]
    ds_read_b64_tr_b16 a[178:179], v7 offset:4608
    v_mfma_f32_16x16x32_bf16 v[216:219], a[152:155], a[128:131], v[216:219]
    s_waitcnt lgkmcnt(8)
    v_mfma_f32_16x16x32_bf16 v[220:223], a[156:159], a[116:119], v[220:223]
    ds_read_b64_tr_b16 a[148:149], v4 offset:12288
    v_and_b32 v3, 15, v0
    v_mfma_f32_16x16x32_bf16 v[224:227], a[156:159], a[120:123], v[224:227]
    s_lshl_b32 s16, s71, 8
    s_lshl_b32 s17, s50, 6
    v_mfma_f32_16x16x32_bf16 v[228:231], a[156:159], a[124:127], v[228:231]
    ds_read_b64_tr_b16 a[150:151], v4 offset:12800
    s_add_u32 s16, s16, s17
    v_mfma_f32_16x16x32_bf16 v[232:235], a[156:159], a[128:131], v[232:235]
    v_add_u32 v3, s16, v3
    v_lshlrev_b32 v3, 2, v3
    v_mfma_f32_16x16x32_bf16 v[236:239], a[160:163], a[116:119], v[236:239]
    ds_read_b64_tr_b16 a[152:153], v5 offset:12288
    v_add_u32 v3, 1114112, v3
    v_mfma_f32_16x16x32_bf16 v[240:243], a[160:163], a[120:123], v[240:243]
    buffer_load_dword v10, v3, s[36:39], 0 offen offset:0 sc1
    buffer_load_dword v11, v3, s[36:39], 0 offen offset:64 sc1
    v_mfma_f32_16x16x32_bf16 v[244:247], a[160:163], a[124:127], v[244:247]
    ds_read_b64_tr_b16 a[154:155], v5 offset:12800
    buffer_load_dword v12, v3, s[36:39], 0 offen offset:128 sc1
    v_mfma_f32_16x16x32_bf16 v[248:251], a[160:163], a[128:131], v[248:251]
    buffer_load_dword v13, v3, s[36:39], 0 offen offset:192 sc1
    s_waitcnt lgkmcnt(8)
    v_mfma_f32_16x16x32_bf16 v[16:19], a[164:167], a[132:135], v[16:19]
    ds_read_b64_tr_b16 a[156:157], v6 offset:12288
    s_add_u32 s20, s14, 4194304
    v_mfma_f32_16x16x32_bf16 v[20:23], a[164:167], a[136:139], v[20:23]
    s_addc_u32 s21, s15, 0
    s_and_b32 s21, s21, 0xffff
    v_mfma_f32_16x16x32_bf16 v[24:27], a[164:167], a[140:143], v[24:27]
    ds_read_b64_tr_b16 a[158:159], v6 offset:12800
    s_mov_b32 s22, 12582912
    v_mfma_f32_16x16x32_bf16 a[0:3], a[164:167], a[144:147], a[0:3]
    s_mov_b32 s23, 0x20000
    s_add_u32 s24, s14, 16777216
    v_mfma_f32_16x16x32_bf16 v[28:31], a[168:171], a[132:135], v[28:31]
    ds_read_b64_tr_b16 a[160:161], v7 offset:12288
    s_addc_u32 s25, s15, 0
    v_mfma_f32_16x16x32_bf16 v[32:35], a[168:171], a[136:139], v[32:35]
    s_and_b32 s25, s25, 0xffff
    s_mov_b32 s26, 14680064
    v_mfma_f32_16x16x32_bf16 v[36:39], a[168:171], a[140:143], v[36:39]
    ds_read_b64_tr_b16 a[162:163], v7 offset:12800
    s_mov_b32 s27, 0x20000
    v_mfma_f32_16x16x32_bf16 a[4:7], a[168:171], a[144:147], a[4:7]
    s_lshl_b32 s81, s16, 6
    s_waitcnt lgkmcnt(8)
    v_mfma_f32_16x16x32_bf16 v[40:43], a[172:175], a[132:135], v[40:43]
    ds_read_b64_tr_b16 a[164:165], v4 offset:20480
    v_lshlrev_b32 v14, 4, v0
    v_mfma_f32_16x16x32_bf16 v[44:47], a[172:175], a[136:139], v[44:47]
    v_add_u32 v14, s81, v14
    v_bfe_u32 v1, v0, 2, 2
    v_mfma_f32_16x16x32_bf16 v[48:51], a[172:175], a[140:143], v[48:51]
    ds_read_b64_tr_b16 a[166:167], v4 offset:20992
    v_lshlrev_b32 v15, 8, v1
    v_mfma_f32_16x16x32_bf16 a[8:11], a[172:175], a[144:147], a[8:11]
    v_lshrrev_b32 v1, 4, v0
    v_lshl_add_u32 v15, v1, 6, v15
    v_mfma_f32_16x16x32_bf16 v[52:55], a[176:179], a[132:135], v[52:55]
    ds_read_b64_tr_b16 a[168:169], v5 offset:20480
    v_and_b32 v1, 3, v0
    v_mfma_f32_16x16x32_bf16 v[56:59], a[176:179], a[136:139], v[56:59]
    v_lshl_add_u32 v15, v1, 4, v15
    v_add_u32 v15, s81, v15
    v_mfma_f32_16x16x32_bf16 v[60:63], a[176:179], a[140:143], v[60:63]
    ds_read_b64_tr_b16 a[170:171], v5 offset:20992
    s_lshr_b32 s16, s16, 4
    v_mfma_f32_16x16x32_bf16 a[12:15], a[176:179], a[144:147], a[12:15]
    s_mul_i32 s16, s16, 114688
    s_waitcnt lgkmcnt(8)
    v_mfma_f32_16x16x32_bf16 v[64:67], a[148:151], a[132:135], v[64:67]
    ds_read_b64_tr_b16 a[172:173], v6 offset:20480
    v_lshlrev_b32 v2, 4, v0
    v_mfma_f32_16x16x32_bf16 v[68:71], a[148:151], a[136:139], v[68:71]
    v_add_u32 v2, s16, v2
    v_mfma_f32_16x16x32_bf16 v[72:75], a[148:151], a[140:143], v[72:75]
    ds_read_b64_tr_b16 a[174:175], v6 offset:20992
    v_mfma_f32_16x16x32_bf16 a[16:19], a[148:151], a[144:147], a[16:19]
    v_mfma_f32_16x16x32_bf16 v[76:79], a[152:155], a[132:135], v[76:79]
    ds_read_b64_tr_b16 a[176:177], v7 offset:20480
    v_mfma_f32_16x16x32_bf16 v[80:83], a[152:155], a[136:139], v[80:83]
    v_mfma_f32_16x16x32_bf16 a[64:67], a[152:155], a[140:143], a[64:67]
    ds_read_b64_tr_b16 a[178:179], v7 offset:20992
    v_mfma_f32_16x16x32_bf16 a[20:23], a[152:155], a[144:147], a[20:23]
    s_waitcnt lgkmcnt(8)
    v_mfma_f32_16x16x32_bf16 v[84:87], a[156:159], a[132:135], v[84:87]
    ds_read_b64_tr_b16 a[148:149], v4 offset:28672
    v_mfma_f32_16x16x32_bf16 v[88:91], a[156:159], a[136:139], v[88:91]
    v_mfma_f32_16x16x32_bf16 v[92:95], a[156:159], a[140:143], v[92:95]
    ds_read_b64_tr_b16 a[150:151], v4 offset:29184
    v_mfma_f32_16x16x32_bf16 a[24:27], a[156:159], a[144:147], a[24:27]
    v_mfma_f32_16x16x32_bf16 v[96:99], a[160:163], a[132:135], v[96:99]
    ds_read_b64_tr_b16 a[152:153], v5 offset:28672
    v_mfma_f32_16x16x32_bf16 v[100:103], a[160:163], a[136:139], v[100:103]
    v_add_u32 v4, 40960, v4
    v_mfma_f32_16x16x32_bf16 a[68:71], a[160:163], a[140:143], a[68:71]
    ds_read_b64_tr_b16 a[154:155], v5 offset:29184
    v_mfma_f32_16x16x32_bf16 a[28:31], a[160:163], a[144:147], a[28:31]
    s_waitcnt lgkmcnt(8)
    v_mfma_f32_16x16x32_bf16 v[104:107], a[164:167], a[132:135], v[104:107]
    ds_read_b64_tr_b16 a[156:157], v6 offset:28672
    v_mfma_f32_16x16x32_bf16 v[108:111], a[164:167], a[136:139], v[108:111]
    v_add_u32 v5, 40960, v5
    v_mfma_f32_16x16x32_bf16 v[112:115], a[164:167], a[140:143], v[112:115]
    ds_read_b64_tr_b16 a[158:159], v6 offset:29184
    v_mfma_f32_16x16x32_bf16 a[32:35], a[164:167], a[144:147], a[32:35]
    v_mfma_f32_16x16x32_bf16 v[116:119], a[168:171], a[132:135], v[116:119]
    ds_read_b64_tr_b16 a[160:161], v7 offset:28672
    v_mfma_f32_16x16x32_bf16 v[120:123], a[168:171], a[136:139], v[120:123]
    v_add_u32 v6, 40960, v6
    v_mfma_f32_16x16x32_bf16 v[124:127], a[168:171], a[140:143], v[124:127]
    ds_read_b64_tr_b16 a[162:163], v7 offset:29184
    v_mfma_f32_16x16x32_bf16 a[36:39], a[168:171], a[144:147], a[36:39]
    s_waitcnt lgkmcnt(8)
    v_mfma_f32_16x16x32_bf16 v[128:131], a[172:175], a[132:135], v[128:131]
    ds_read_b64_tr_b16 a[164:165], v8 offset:4096
    v_mfma_f32_16x16x32_bf16 v[132:135], a[172:175], a[136:139], v[132:135]
    v_add_u32 v7, 40960, v7
    v_mfma_f32_16x16x32_bf16 v[136:139], a[172:175], a[140:143], v[136:139]
    ds_read_b64_tr_b16 a[166:167], v8 offset:4352
    v_mfma_f32_16x16x32_bf16 a[40:43], a[172:175], a[144:147], a[40:43]
    v_mfma_f32_16x16x32_bf16 v[140:143], a[176:179], a[132:135], v[140:143]
    ds_read_b64_tr_b16 a[168:169], v9 offset:4096
    s_waitcnt vmcnt(10)
    v_mfma_f32_16x16x32_bf16 v[144:147], a[176:179], a[136:139], v[144:147]
    ds_read_b128 a[116:119], v252 offset:40960
    v_mfma_f32_16x16x32_bf16 a[80:83], a[176:179], a[140:143], a[80:83]
    ds_read_b64_tr_b16 a[170:171], v9 offset:4352
    v_mfma_f32_16x16x32_bf16 a[44:47], a[176:179], a[144:147], a[44:47]
    s_waitcnt lgkmcnt(9)
    v_mfma_f32_16x16x32_bf16 v[148:151], a[148:151], a[132:135], v[148:151]
    ds_read_b64_tr_b16 a[172:173], v8 offset:5120
    s_waitcnt vmcnt(8)
    v_mfma_f32_16x16x32_bf16 v[152:155], a[148:151], a[136:139], v[152:155]
    ds_read_b128 a[120:123], v252 offset:43008
    v_mfma_f32_16x16x32_bf16 v[156:159], a[148:151], a[140:143], v[156:159]
    ds_read_b64_tr_b16 a[174:175], v8 offset:5376
    v_mfma_f32_16x16x32_bf16 a[48:51], a[148:151], a[144:147], a[48:51]
    v_mfma_f32_16x16x32_bf16 v[160:163], a[152:155], a[132:135], v[160:163]
    ds_read_b64_tr_b16 a[176:177], v9 offset:5120
    s_waitcnt vmcnt(6)
    v_mfma_f32_16x16x32_bf16 v[164:167], a[152:155], a[136:139], v[164:167]
    v_add_u32 v8, 40960, v8
    ds_read_b128 a[124:127], v252 offset:45056
    v_mfma_f32_16x16x32_bf16 a[72:75], a[152:155], a[140:143], a[72:75]
    ds_read_b64_tr_b16 a[178:179], v9 offset:5376
    v_mfma_f32_16x16x32_bf16 a[52:55], a[152:155], a[144:147], a[52:55]
    s_waitcnt lgkmcnt(11)
    v_mfma_f32_16x16x32_bf16 v[168:171], a[156:159], a[132:135], v[168:171]
    s_waitcnt vmcnt(4)
    ds_read_b128 a[128:131], v252 offset:47104
    v_mfma_f32_16x16x32_bf16 v[172:175], a[156:159], a[136:139], v[172:175]
    v_add_u32 v9, 40960, v9
    v_mfma_f32_16x16x32_bf16 v[176:179], a[156:159], a[140:143], v[176:179]
    v_mfma_f32_16x16x32_bf16 a[56:59], a[156:159], a[144:147], a[56:59]
    v_mfma_f32_16x16x32_bf16 v[180:183], a[160:163], a[132:135], v[180:183]
    v_mfma_f32_16x16x32_bf16 v[184:187], a[160:163], a[136:139], v[184:187]
    v_mfma_f32_16x16x32_bf16 a[76:79], a[160:163], a[140:143], a[76:79]
    v_mfma_f32_16x16x32_bf16 a[60:63], a[160:163], a[144:147], a[60:63]
    s_waitcnt lgkmcnt(1)
    s_barrier
    v_mfma_f32_16x16x32_bf16 v[188:191], a[164:167], a[132:135], v[188:191]
    ds_read_b64_tr_b16 a[148:149], v4 offset:0
    v_mfma_f32_16x16x32_bf16 v[192:195], a[164:167], a[136:139], v[192:195]
    ds_read_b64_tr_b16 a[150:151], v4 offset:512
    v_mfma_f32_16x16x32_bf16 v[196:199], a[164:167], a[140:143], v[196:199]
    ds_read_b64_tr_b16 a[152:153], v4 offset:4096
    v_mfma_f32_16x16x32_bf16 v[200:203], a[164:167], a[144:147], v[200:203]
    ds_read_b64_tr_b16 a[154:155], v4 offset:4608
    v_mfma_f32_16x16x32_bf16 v[204:207], a[168:171], a[132:135], v[204:207]
    ds_read_b64_tr_b16 a[156:157], v5 offset:0
    v_lshlrev_b32 v252, 4, v0
    v_mfma_f32_16x16x32_bf16 v[208:211], a[168:171], a[136:139], v[208:211]
    ds_read_b64_tr_b16 a[158:159], v5 offset:512
    v_add_u32 v252, 40960, v252
    v_mfma_f32_16x16x32_bf16 v[212:215], a[168:171], a[140:143], v[212:215]
    ds_read_b64_tr_b16 a[160:161], v5 offset:4096
    s_mul_i32 s17, s50, 5120
    v_mfma_f32_16x16x32_bf16 v[216:219], a[168:171], a[144:147], v[216:219]
    ds_read_b64_tr_b16 a[162:163], v5 offset:4608
    v_mfma_f32_16x16x32_bf16 v[220:223], a[172:175], a[132:135], v[220:223]
    ds_read_b64_tr_b16 a[164:165], v4 offset:8192
    v_add_u32 v1, s17, v252
    v_mfma_f32_16x16x32_bf16 v[224:227], a[172:175], a[136:139], v[224:227]
    ds_write_b128 v1, a[180:183] offset:0
    v_mfma_f32_16x16x32_bf16 v[228:231], a[172:175], a[140:143], v[228:231]
    ds_read_b64_tr_b16 a[166:167], v4 offset:8704
    ds_write_b128 v1, a[184:187] offset:1024
    v_mfma_f32_16x16x32_bf16 v[232:235], a[172:175], a[144:147], v[232:235]
    ds_write_b128 v1, a[188:191] offset:2048
    ds_write_b128 v1, a[192:195] offset:3072
    v_mfma_f32_16x16x32_bf16 v[236:239], a[176:179], a[132:135], v[236:239]
    ds_read_b64_tr_b16 a[168:169], v4 offset:12288
    ds_write_b128 v1, a[196:199] offset:4096
    v_mfma_f32_16x16x32_bf16 v[240:243], a[176:179], a[136:139], v[240:243]
    v_mfma_f32_16x16x32_bf16 v[244:247], a[176:179], a[140:143], v[244:247]
    ds_read_b64_tr_b16 a[170:171], v4 offset:12800
    v_mfma_f32_16x16x32_bf16 v[248:251], a[176:179], a[144:147], v[248:251]
    s_waitcnt lgkmcnt(13)
    v_mfma_f32_16x16x32_bf16 v[16:19], a[148:151], a[84:87], v[16:19]
    ds_read_b64_tr_b16 a[172:173], v5 offset:8192
    ds_read_b128 a[132:135], v253 offset:40960
    v_mfma_f32_16x16x32_bf16 v[16:19], a[152:155], a[100:103], v[16:19]
    v_mfma_f32_16x16x32_bf16 v[20:23], a[148:151], a[88:91], v[20:23]
    ds_read_b64_tr_b16 a[174:175], v5 offset:8704
    v_mfma_f32_16x16x32_bf16 v[20:23], a[152:155], a[104:107], v[20:23]
    v_mfma_f32_16x16x32_bf16 v[24:27], a[148:151], a[92:95], v[24:27]
    ds_read_b64_tr_b16 a[176:177], v5 offset:12288
    ds_read_b128 a[136:139], v253 offset:43008
    v_mfma_f32_16x16x32_bf16 v[24:27], a[152:155], a[108:111], v[24:27]
    v_mfma_f32_16x16x32_bf16 a[0:3], a[148:151], a[96:99], a[0:3]
    ds_read_b64_tr_b16 a[178:179], v5 offset:12800
    v_mfma_f32_16x16x32_bf16 a[0:3], a[152:155], a[112:115], a[0:3]
    s_waitcnt lgkmcnt(7)
    s_barrier
    v_mfma_f32_16x16x32_bf16 v[28:31], a[156:159], a[84:87], v[28:31]
    v_subrev_u32 v254, 81920, v4
    ds_read_b128 a[140:143], v253 offset:45056
    v_mfma_f32_16x16x32_bf16 v[28:31], a[160:163], a[100:103], v[28:31]
    v_subrev_u32 v255, 81920, v5
    v_mfma_f32_16x16x32_bf16 v[32:35], a[156:159], a[88:91], v[32:35]
    ds_read_b64_tr_b16 a[148:149], v254 offset:0
    v_mfma_f32_16x16x32_bf16 v[32:35], a[160:163], a[104:107], v[32:35]
    ds_read_b64_tr_b16 a[150:151], v254 offset:512
    v_mfma_f32_16x16x32_bf16 v[36:39], a[156:159], a[92:95], v[36:39]
    ds_read_b64_tr_b16 a[152:153], v254 offset:4096
    ds_read_b128 a[144:147], v253 offset:47104
    v_mfma_f32_16x16x32_bf16 v[36:39], a[160:163], a[108:111], v[36:39]
    ds_read_b128 a[200:203], v252 offset:0
    v_mfma_f32_16x16x32_bf16 a[4:7], a[156:159], a[96:99], a[4:7]
    ds_read_b64_tr_b16 a[154:155], v254 offset:4608
    v_mfma_f32_16x16x32_bf16 a[4:7], a[160:163], a[112:115], a[4:7]
    s_waitcnt lgkmcnt(13)
    v_mfma_f32_16x16x32_bf16 v[64:67], a[164:167], a[84:87], v[64:67]
    ds_read_b64_tr_b16 a[156:157], v255 offset:0
    ds_read_b128 a[204:207], v252 offset:1024
    v_mfma_f32_16x16x32_bf16 v[64:67], a[168:171], a[100:103], v[64:67]
    v_mfma_f32_16x16x32_bf16 v[68:71], a[164:167], a[88:91], v[68:71]
    ds_read_b64_tr_b16 a[158:159], v255 offset:512
    v_mfma_f32_16x16x32_bf16 v[68:71], a[168:171], a[104:107], v[68:71]
    v_mfma_f32_16x16x32_bf16 v[72:75], a[164:167], a[92:95], v[72:75]
    ds_read_b64_tr_b16 a[160:161], v255 offset:4096
    ds_read_b128 a[208:211], v252 offset:4096
    v_mfma_f32_16x16x32_bf16 v[72:75], a[168:171], a[108:111], v[72:75]
    v_mfma_f32_16x16x32_bf16 a[16:19], a[164:167], a[96:99], a[16:19]
    ds_read_b64_tr_b16 a[162:163], v255 offset:4608
    v_mfma_f32_16x16x32_bf16 a[16:19], a[168:171], a[112:115], a[16:19]
    s_waitcnt lgkmcnt(13)
    v_mfma_f32_16x16x32_bf16 v[76:79], a[172:175], a[84:87], v[76:79]
    ds_read_b64_tr_b16 a[164:165], v254 offset:8192
    ds_read_b128 a[212:215], v252 offset:5120
    v_mfma_f32_16x16x32_bf16 v[76:79], a[176:179], a[100:103], v[76:79]
    v_mfma_f32_16x16x32_bf16 v[80:83], a[172:175], a[88:91], v[80:83]
    ds_read_b64_tr_b16 a[166:167], v254 offset:8704
    v_mfma_f32_16x16x32_bf16 v[80:83], a[176:179], a[104:107], v[80:83]
    v_mfma_f32_16x16x32_bf16 a[64:67], a[172:175], a[92:95], a[64:67]
    ds_read_b64_tr_b16 a[168:169], v254 offset:12288
    v_mfma_f32_16x16x32_bf16 a[64:67], a[176:179], a[108:111], a[64:67]
    v_mfma_f32_16x16x32_bf16 a[20:23], a[172:175], a[96:99], a[20:23]
    ds_read_b64_tr_b16 a[170:171], v254 offset:12800
    v_mfma_f32_16x16x32_bf16 a[20:23], a[176:179], a[112:115], a[20:23]
    s_waitcnt lgkmcnt(11)
    v_mfma_f32_16x16x32_bf16 v[16:19], a[148:151], a[116:119], v[16:19]
    ds_read_b64_tr_b16 a[172:173], v255 offset:8192
    ds_read_b128 a[216:219], v252 offset:2048
    s_waitcnt lgkmcnt(8)
    v_mfma_f32_16x16x32_bf16 v[64:67], a[208:211], a[240:243], v[64:67]
    v_mfma_f32_16x16x32_bf16 v[16:19], a[152:155], a[132:135], v[16:19]
    v_mfma_f32_16x16x32_bf16 v[68:71], a[208:211], a[244:247], v[68:71]
    v_mfma_f32_16x16x32_bf16 v[20:23], a[148:151], a[120:123], v[20:23]
    ds_read_b64_tr_b16 a[174:175], v255 offset:8704
    v_mfma_f32_16x16x32_bf16 v[72:75], a[208:211], a[248:251], v[72:75]
    v_mfma_f32_16x16x32_bf16 v[20:23], a[152:155], a[136:139], v[20:23]
    v_mfma_f32_16x16x32_bf16 a[16:19], a[208:211], a[252:255], a[16:19]
    v_mfma_f32_16x16x32_bf16 v[24:27], a[148:151], a[124:127], v[24:27]
    ds_read_b64_tr_b16 a[176:177], v255 offset:12288
    ds_read_b128 a[220:223], v252 offset:3072
    v_mfma_f32_16x16x32_bf16 v[24:27], a[152:155], a[140:143], v[24:27]
    v_mfma_f32_16x16x32_bf16 a[0:3], a[148:151], a[128:131], a[0:3]
    ds_read_b64_tr_b16 a[178:179], v255 offset:12800
    v_mfma_f32_16x16x32_bf16 a[0:3], a[152:155], a[144:147], a[0:3]
    s_waitcnt lgkmcnt(11)
    v_mfma_f32_16x16x32_bf16 v[28:31], a[156:159], a[116:119], v[28:31]
    ds_read_b64_tr_b16 a[148:149], v6 offset:0
    ds_read_b128 a[224:227], v252 offset:6144
    s_waitcnt lgkmcnt(11)
    v_mfma_f32_16x16x32_bf16 v[76:79], a[212:215], a[240:243], v[76:79]
    v_mfma_f32_16x16x32_bf16 v[28:31], a[160:163], a[132:135], v[28:31]
    v_mfma_f32_16x16x32_bf16 v[80:83], a[212:215], a[244:247], v[80:83]
    v_mfma_f32_16x16x32_bf16 v[32:35], a[156:159], a[120:123], v[32:35]
    ds_read_b64_tr_b16 a[150:151], v6 offset:512
    v_mfma_f32_16x16x32_bf16 a[64:67], a[212:215], a[248:251], a[64:67]
    v_mfma_f32_16x16x32_bf16 v[32:35], a[160:163], a[136:139], v[32:35]
    v_mfma_f32_16x16x32_bf16 a[20:23], a[212:215], a[252:255], a[20:23]
    v_mfma_f32_16x16x32_bf16 v[36:39], a[156:159], a[124:127], v[36:39]
    ds_read_b64_tr_b16 a[152:153], v6 offset:4096
    ds_read_b128 a[228:231], v252 offset:7168
    v_mfma_f32_16x16x32_bf16 v[36:39], a[160:163], a[140:143], v[36:39]
    v_mfma_f32_16x16x32_bf16 a[4:7], a[156:159], a[128:131], a[4:7]
    ds_read_b64_tr_b16 a[154:155], v6 offset:4608
    v_mfma_f32_16x16x32_bf16 a[4:7], a[160:163], a[144:147], a[4:7]
    s_waitcnt lgkmcnt(12)
    v_mfma_f32_16x16x32_bf16 v[64:67], a[164:167], a[116:119], v[64:67]
    ds_read_b64_tr_b16 a[156:157], v7 offset:0
    v_mfma_f32_16x16x32_bf16 v[16:19], a[200:203], a[240:243], v[16:19]
    v_mfma_f32_16x16x32_bf16 v[64:67], a[168:171], a[132:135], v[64:67]
    v_mfma_f32_16x16x32_bf16 v[20:23], a[200:203], a[244:247], v[20:23]
    v_mfma_f32_16x16x32_bf16 v[68:71], a[164:167], a[120:123], v[68:71]
    ds_read_b64_tr_b16 a[158:159], v7 offset:512
    v_mfma_f32_16x16x32_bf16 v[24:27], a[200:203], a[248:251], v[24:27]
    v_mfma_f32_16x16x32_bf16 v[68:71], a[168:171], a[136:139], v[68:71]
    v_mfma_f32_16x16x32_bf16 a[0:3], a[200:203], a[252:255], a[0:3]
    v_mfma_f32_16x16x32_bf16 v[72:75], a[164:167], a[124:127], v[72:75]
    ds_read_b64_tr_b16 a[160:161], v7 offset:4096
    v_mfma_f32_16x16x32_bf16 v[72:75], a[168:171], a[140:143], v[72:75]
    v_mfma_f32_16x16x32_bf16 a[16:19], a[164:167], a[128:131], a[16:19]
    ds_read_b64_tr_b16 a[162:163], v7 offset:4608
    v_mfma_f32_16x16x32_bf16 a[16:19], a[168:171], a[144:147], a[16:19]
    s_waitcnt lgkmcnt(10)
    v_mfma_f32_16x16x32_bf16 v[76:79], a[172:175], a[116:119], v[76:79]
    ds_read_b64_tr_b16 a[164:165], v6 offset:8192
    v_mfma_f32_16x16x32_bf16 v[28:31], a[204:207], a[240:243], v[28:31]
    v_mfma_f32_16x16x32_bf16 v[76:79], a[176:179], a[132:135], v[76:79]
    v_mfma_f32_16x16x32_bf16 v[32:35], a[204:207], a[244:247], v[32:35]
    v_mfma_f32_16x16x32_bf16 v[80:83], a[172:175], a[120:123], v[80:83]
    ds_read_b64_tr_b16 a[166:167], v6 offset:8704
    v_mfma_f32_16x16x32_bf16 v[36:39], a[204:207], a[248:251], v[36:39]
    v_mfma_f32_16x16x32_bf16 v[80:83], a[176:179], a[136:139], v[80:83]
    v_mfma_f32_16x16x32_bf16 a[4:7], a[204:207], a[252:255], a[4:7]
    v_mfma_f32_16x16x32_bf16 a[64:67], a[172:175], a[124:127], a[64:67]
    ds_read_b64_tr_b16 a[168:169], v6 offset:12288
    v_mfma_f32_16x16x32_bf16 a[64:67], a[176:179], a[140:143], a[64:67]
    v_mfma_f32_16x16x32_bf16 a[20:23], a[172:175], a[128:131], a[20:23]
    ds_read_b64_tr_b16 a[170:171], v6 offset:12800
    v_mfma_f32_16x16x32_bf16 a[20:23], a[176:179], a[144:147], a[20:23]
    s_waitcnt vmcnt(0)
    s_cmp_lt_u32 s70, 9
    s_cbranch_scc0 gemm1_kernel_tg
    s_waitcnt lgkmcnt(8)
    v_mfma_f32_16x16x32_bf16 v[40:43], a[148:151], a[84:87], v[40:43]
    ds_read_b64_tr_b16 a[172:173], v7 offset:8192
    s_add_u32 s55, s78, 0
    s_cmp_lt_u32 s55, 1024
    v_mfma_f32_16x16x32_bf16 v[84:87], a[224:227], a[240:243], v[84:87]
    s_cselect_b32 s76, 0x3e8293ee, 1.0
    s_lshl_b32 s77, s55, 12
    v_mfma_f32_16x16x32_bf16 v[40:43], a[152:155], a[100:103], v[40:43]
    s_cmp_ge_u32 s55, 2048
    s_cselect_b64 vcc, -1, 0
    v_mfma_f32_16x16x32_bf16 v[88:91], a[224:227], a[244:247], v[88:91]
    v_cndmask_b32 v1, v14, v15, vcc
    v_mul_f32 v3, s76, v10
    v_mfma_f32_16x16x32_bf16 v[44:47], a[148:151], a[88:91], v[44:47]
    ds_read_b64_tr_b16 a[174:175], v7 offset:8704
    v_mul_f32 v16, v3, v16
    v_mul_f32 v17, v3, v17
    v_mfma_f32_16x16x32_bf16 v[92:95], a[224:227], a[248:251], v[92:95]
    v_mul_f32 v18, v3, v18
    v_mul_f32 v19, v3, v19
    v_mfma_f32_16x16x32_bf16 v[44:47], a[152:155], a[104:107], v[44:47]
    v_cvt_pk_bf16_f32 v16, v16, v17
    v_mfma_f32_16x16x32_bf16 a[24:27], a[224:227], a[252:255], a[24:27]
    v_cvt_pk_bf16_f32 v17, v18, v19
    v_mul_f32 v28, v3, v28
    v_mfma_f32_16x16x32_bf16 v[48:51], a[148:151], a[92:95], v[48:51]
    ds_read_b64_tr_b16 a[176:177], v7 offset:12288
    v_mul_f32 v29, v3, v29
    v_mul_f32 v30, v3, v30
    v_mfma_f32_16x16x32_bf16 v[48:51], a[152:155], a[108:111], v[48:51]
    v_mul_f32 v31, v3, v31
    v_cvt_pk_bf16_f32 v18, v28, v29
    v_mfma_f32_16x16x32_bf16 a[8:11], a[148:151], a[96:99], a[8:11]
    ds_read_b64_tr_b16 a[178:179], v7 offset:12800
    v_cvt_pk_bf16_f32 v19, v30, v31
    buffer_store_dwordx4 v[16:19], v1, s[20:23], s77 offen offset:0 sc1
    v_mfma_f32_16x16x32_bf16 a[8:11], a[152:155], a[112:115], a[8:11]
    v_mul_f32 v3, s76, v11
    v_mul_f32 v20, v3, v20
    s_waitcnt lgkmcnt(8)
    v_mfma_f32_16x16x32_bf16 v[52:55], a[156:159], a[84:87], v[52:55]
    v_subrev_u32 v254, 81920, v6
    v_mul_f32 v21, v3, v21
    v_mul_f32 v22, v3, v22
    v_mfma_f32_16x16x32_bf16 v[96:99], a[228:231], a[240:243], v[96:99]
    v_mul_f32 v23, v3, v23
    v_mfma_f32_16x16x32_bf16 v[52:55], a[160:163], a[100:103], v[52:55]
    v_subrev_u32 v255, 81920, v7
    v_cvt_pk_bf16_f32 v20, v20, v21
    v_cvt_pk_bf16_f32 v21, v22, v23
    v_mfma_f32_16x16x32_bf16 v[100:103], a[228:231], a[244:247], v[100:103]
    v_mul_f32 v32, v3, v32
    v_mul_f32 v33, v3, v33
    v_mfma_f32_16x16x32_bf16 v[56:59], a[156:159], a[88:91], v[56:59]
    ds_read_b64_tr_b16 a[148:149], v254 offset:0
    v_mul_f32 v34, v3, v34
    v_mul_f32 v35, v3, v35
    v_mfma_f32_16x16x32_bf16 a[68:71], a[228:231], a[248:251], a[68:71]
    v_cvt_pk_bf16_f32 v22, v32, v33
    v_cvt_pk_bf16_f32 v23, v34, v35
    v_mfma_f32_16x16x32_bf16 v[56:59], a[160:163], a[104:107], v[56:59]
    ds_read_b64_tr_b16 a[150:151], v254 offset:512
    buffer_store_dwordx4 v[20:23], v1, s[20:23], s77 offen offset:1024 sc1
    v_mul_f32 v3, s76, v12
    v_mfma_f32_16x16x32_bf16 a[28:31], a[228:231], a[252:255], a[28:31]
    v_mul_f32 v24, v3, v24
    v_mfma_f32_16x16x32_bf16 v[60:63], a[156:159], a[92:95], v[60:63]
    ds_read_b64_tr_b16 a[152:153], v254 offset:4096
    v_mul_f32 v25, v3, v25
    v_mul_f32 v26, v3, v26
    v_mfma_f32_16x16x32_bf16 v[60:63], a[160:163], a[108:111], v[60:63]
    v_mul_f32 v27, v3, v27
    v_cvt_pk_bf16_f32 v24, v24, v25
    v_mfma_f32_16x16x32_bf16 a[12:15], a[156:159], a[96:99], a[12:15]
    ds_read_b64_tr_b16 a[154:155], v254 offset:4608
    v_cvt_pk_bf16_f32 v25, v26, v27
    v_mul_f32 v36, v3, v36
    v_mfma_f32_16x16x32_bf16 a[12:15], a[160:163], a[112:115], a[12:15]
    v_mul_f32 v37, v3, v37
    v_mul_f32 v38, v3, v38
    s_waitcnt lgkmcnt(8)
    v_mfma_f32_16x16x32_bf16 v[84:87], a[164:167], a[84:87], v[84:87]
    ds_read_b64_tr_b16 a[156:157], v255 offset:0
    v_mul_f32 v39, v3, v39
    v_cvt_pk_bf16_f32 v26, v36, v37
    v_mfma_f32_16x16x32_bf16 v[40:43], a[216:219], a[240:243], v[40:43]
    v_cvt_pk_bf16_f32 v27, v38, v39
    buffer_store_dwordx4 v[24:27], v1, s[20:23], s77 offen offset:2048 sc1
    v_mfma_f32_16x16x32_bf16 v[84:87], a[168:171], a[100:103], v[84:87]
    v_mul_f32 v3, s76, v13
    v_mfma_f32_16x16x32_bf16 v[44:47], a[216:219], a[244:247], v[44:47]
    v_accvgpr_read_b32 v28, a0
    v_accvgpr_read_b32 v29, a1
    v_mfma_f32_16x16x32_bf16 v[88:91], a[164:167], a[88:91], v[88:91]
    ds_read_b64_tr_b16 a[158:159], v255 offset:512
    v_accvgpr_read_b32 v30, a2
    v_accvgpr_read_b32 v31, a3
    v_mfma_f32_16x16x32_bf16 v[48:51], a[216:219], a[248:251], v[48:51]
    v_mul_f32 v28, v3, v28
    v_mul_f32 v29, v3, v29
    v_mfma_f32_16x16x32_bf16 v[88:91], a[168:171], a[104:107], v[88:91]
    v_mul_f32 v30, v3, v30
    v_mul_f32 v31, v3, v31
    v_mfma_f32_16x16x32_bf16 a[8:11], a[216:219], a[252:255], a[8:11]
    v_cvt_pk_bf16_f32 v28, v28, v29
    v_cvt_pk_bf16_f32 v29, v30, v31
    v_mfma_f32_16x16x32_bf16 v[92:95], a[164:167], a[92:95], v[92:95]
    ds_read_b64_tr_b16 a[160:161], v255 offset:4096
    v_accvgpr_read_b32 v16, a4
    v_mfma_f32_16x16x32_bf16 v[92:95], a[168:171], a[108:111], v[92:95]
    v_accvgpr_read_b32 v17, a5
    v_accvgpr_read_b32 v18, a6
    v_mfma_f32_16x16x32_bf16 a[24:27], a[164:167], a[96:99], a[24:27]
    ds_read_b64_tr_b16 a[162:163], v255 offset:4608
    v_accvgpr_read_b32 v19, a7
    v_mul_f32 v16, v3, v16
    v_mfma_f32_16x16x32_bf16 a[24:27], a[168:171], a[112:115], a[24:27]
    v_mul_f32 v17, v3, v17
    v_mul_f32 v18, v3, v18
    s_waitcnt lgkmcnt(8)
    v_mfma_f32_16x16x32_bf16 v[96:99], a[172:175], a[84:87], v[96:99]
    ds_read_b64_tr_b16 a[164:165], v254 offset:8192
    v_mul_f32 v19, v3, v19
    v_cvt_pk_bf16_f32 v30, v16, v17
    ds_read_b128 a[200:203], v252 offset:8192
    v_mfma_f32_16x16x32_bf16 v[52:55], a[220:223], a[240:243], v[52:55]
    v_cvt_pk_bf16_f32 v31, v18, v19
    buffer_store_dwordx4 v[28:31], v1, s[20:23], s77 offen offset:3072 sc1
    v_mfma_f32_16x16x32_bf16 v[96:99], a[176:179], a[100:103], v[96:99]
    s_add_u32 s55, s78, 64
    s_cmp_lt_u32 s55, 1024
    v_mfma_f32_16x16x32_bf16 v[56:59], a[220:223], a[244:247], v[56:59]
    s_cselect_b32 s76, 0x3e8293ee, 1.0
    v_mfma_f32_16x16x32_bf16 v[100:103], a[172:175], a[88:91], v[100:103]
    ds_read_b64_tr_b16 a[166:167], v254 offset:8704
    s_lshl_b32 s77, s55, 12
    s_cmp_ge_u32 s55, 2048
    v_mfma_f32_16x16x32_bf16 v[60:63], a[220:223], a[248:251], v[60:63]
    s_cselect_b64 vcc, -1, 0
    v_cndmask_b32 v1, v14, v15, vcc
    v_mfma_f32_16x16x32_bf16 v[100:103], a[176:179], a[104:107], v[100:103]
    v_mul_f32 v3, s76, v10
    v_mul_f32 v64, v3, v64
    v_mfma_f32_16x16x32_bf16 a[12:15], a[220:223], a[252:255], a[12:15]
    v_mul_f32 v65, v3, v65
    v_mul_f32 v66, v3, v66
    v_mfma_f32_16x16x32_bf16 a[68:71], a[172:175], a[92:95], a[68:71]
    ds_read_b64_tr_b16 a[168:169], v254 offset:12288
    v_mul_f32 v67, v3, v67
    v_cvt_pk_bf16_f32 v64, v64, v65
    ds_read_b128 a[204:207], v252 offset:9216
    v_mfma_f32_16x16x32_bf16 a[68:71], a[176:179], a[108:111], a[68:71]
    v_cvt_pk_bf16_f32 v65, v66, v67
    v_mul_f32 v76, v3, v76
    v_mfma_f32_16x16x32_bf16 a[28:31], a[172:175], a[96:99], a[28:31]
    ds_read_b64_tr_b16 a[170:171], v254 offset:12800
    v_mul_f32 v77, v3, v77
    v_mfma_f32_16x16x32_bf16 a[28:31], a[176:179], a[112:115], a[28:31]
    v_mul_f32 v78, v3, v78
    v_mul_f32 v79, v3, v79
    s_waitcnt lgkmcnt(10)
    v_mfma_f32_16x16x32_bf16 v[40:43], a[148:151], a[116:119], v[40:43]
    ds_read_b64_tr_b16 a[172:173], v255 offset:8192
    v_cvt_pk_bf16_f32 v66, v76, v77
    v_cvt_pk_bf16_f32 v67, v78, v79
    ds_read_b128 a[208:211], v252 offset:12288
    v_mfma_f32_16x16x32_bf16 v[40:43], a[152:155], a[132:135], v[40:43]
    buffer_store_dwordx4 v[64:67], v1, s[20:23], s77 offen offset:0 sc1
    v_mul_f32 v3, s76, v11
    v_mfma_f32_16x16x32_bf16 v[44:47], a[148:151], a[120:123], v[44:47]
    ds_read_b64_tr_b16 a[174:175], v255 offset:8704
    v_mul_f32 v68, v3, v68
    v_mul_f32 v69, v3, v69
    v_mfma_f32_16x16x32_bf16 v[44:47], a[152:155], a[136:139], v[44:47]
    v_mul_f32 v70, v3, v70
    v_mul_f32 v71, v3, v71
    v_mfma_f32_16x16x32_bf16 v[48:51], a[148:151], a[124:127], v[48:51]
    ds_read_b64_tr_b16 a[176:177], v255 offset:12288
    v_cvt_pk_bf16_f32 v68, v68, v69
    ds_read_b128 a[212:215], v252 offset:13312
    v_mfma_f32_16x16x32_bf16 v[48:51], a[152:155], a[140:143], v[48:51]
    v_cvt_pk_bf16_f32 v69, v70, v71
    v_mul_f32 v80, v3, v80
    v_mfma_f32_16x16x32_bf16 a[8:11], a[148:151], a[128:131], a[8:11]
    ds_read_b64_tr_b16 a[178:179], v255 offset:12800
    v_mul_f32 v81, v3, v81
    v_mul_f32 v82, v3, v82
    v_mfma_f32_16x16x32_bf16 a[8:11], a[152:155], a[144:147], a[8:11]
    v_mul_f32 v83, v3, v83
    v_cvt_pk_bf16_f32 v70, v80, v81
    s_waitcnt lgkmcnt(12)
    v_mfma_f32_16x16x32_bf16 v[52:55], a[156:159], a[116:119], v[52:55]
    ds_read_b64_tr_b16 a[148:149], v4 offset:16384
    v_cvt_pk_bf16_f32 v71, v82, v83
    buffer_store_dwordx4 v[68:71], v1, s[20:23], s77 offen offset:1024 sc1
    v_mfma_f32_16x16x32_bf16 v[52:55], a[160:163], a[132:135], v[52:55]
    v_mul_f32 v3, s76, v12
    v_mul_f32 v72, v3, v72
    v_mfma_f32_16x16x32_bf16 v[56:59], a[156:159], a[120:123], v[56:59]
    ds_read_b64_tr_b16 a[150:151], v4 offset:16896
    v_mul_f32 v73, v3, v73
    v_mul_f32 v74, v3, v74
    v_mfma_f32_16x16x32_bf16 v[56:59], a[160:163], a[136:139], v[56:59]
    v_mul_f32 v75, v3, v75
    v_mfma_f32_16x16x32_bf16 v[60:63], a[156:159], a[124:127], v[60:63]
    ds_read_b64_tr_b16 a[152:153], v4 offset:20480
    v_cvt_pk_bf16_f32 v72, v72, v73
    v_cvt_pk_bf16_f32 v73, v74, v75
    v_mfma_f32_16x16x32_bf16 v[60:63], a[160:163], a[140:143], v[60:63]
    v_accvgpr_read_b32 v32, a64
    v_accvgpr_read_b32 v33, a65
    v_mfma_f32_16x16x32_bf16 a[12:15], a[156:159], a[128:131], a[12:15]
    ds_read_b64_tr_b16 a[154:155], v4 offset:20992
    v_accvgpr_read_b32 v34, a66
    v_accvgpr_read_b32 v35, a67
    v_mfma_f32_16x16x32_bf16 a[12:15], a[160:163], a[144:147], a[12:15]
    v_mul_f32 v32, v3, v32
    v_mul_f32 v33, v3, v33
    s_waitcnt lgkmcnt(10)
    v_mfma_f32_16x16x32_bf16 v[84:87], a[164:167], a[116:119], v[84:87]
    ds_read_b64_tr_b16 a[156:157], v5 offset:16384
    v_mul_f32 v34, v3, v34
    v_mul_f32 v35, v3, v35
    v_mfma_f32_16x16x32_bf16 v[84:87], a[168:171], a[132:135], v[84:87]
    v_cvt_pk_bf16_f32 v74, v32, v33
    v_mfma_f32_16x16x32_bf16 v[88:91], a[164:167], a[120:123], v[88:91]
    ds_read_b64_tr_b16 a[158:159], v5 offset:16896
    v_cvt_pk_bf16_f32 v75, v34, v35
    buffer_store_dwordx4 v[72:75], v1, s[20:23], s77 offen offset:2048 sc1
    v_mfma_f32_16x16x32_bf16 v[88:91], a[168:171], a[136:139], v[88:91]
    v_mul_f32 v3, s76, v13
    v_accvgpr_read_b32 v20, a16
    v_mfma_f32_16x16x32_bf16 v[92:95], a[164:167], a[124:127], v[92:95]
    ds_read_b64_tr_b16 a[160:161], v5 offset:20480
    v_accvgpr_read_b32 v21, a17
    v_accvgpr_read_b32 v22, a18
    v_mfma_f32_16x16x32_bf16 v[92:95], a[168:171], a[140:143], v[92:95]
    v_accvgpr_read_b32 v23, a19
    v_mul_f32 v20, v3, v20
    v_mfma_f32_16x16x32_bf16 a[24:27], a[164:167], a[128:131], a[24:27]
    ds_read_b64_tr_b16 a[162:163], v5 offset:20992
    v_mul_f32 v21, v3, v21
    v_mul_f32 v22, v3, v22
    v_mfma_f32_16x16x32_bf16 a[24:27], a[168:171], a[144:147], a[24:27]
    v_mul_f32 v23, v3, v23
    v_cvt_pk_bf16_f32 v20, v20, v21
    s_waitcnt lgkmcnt(8)
    v_mfma_f32_16x16x32_bf16 v[96:99], a[172:175], a[116:119], v[96:99]
    ds_read_b64_tr_b16 a[164:165], v4 offset:24576
    v_cvt_pk_bf16_f32 v21, v22, v23
    v_mfma_f32_16x16x32_bf16 v[96:99], a[176:179], a[132:135], v[96:99]
    v_accvgpr_read_b32 v36, a20
    v_accvgpr_read_b32 v37, a21
    v_mfma_f32_16x16x32_bf16 v[100:103], a[172:175], a[120:123], v[100:103]
    ds_read_b64_tr_b16 a[166:167], v4 offset:25088
    v_accvgpr_read_b32 v38, a22
    v_accvgpr_read_b32 v39, a23
    v_mfma_f32_16x16x32_bf16 v[100:103], a[176:179], a[136:139], v[100:103]
    v_mul_f32 v36, v3, v36
    v_mul_f32 v37, v3, v37
    v_mfma_f32_16x16x32_bf16 a[68:71], a[172:175], a[124:127], a[68:71]
    ds_read_b64_tr_b16 a[168:169], v4 offset:28672
    v_mul_f32 v38, v3, v38
    v_mul_f32 v39, v3, v39
    v_mfma_f32_16x16x32_bf16 a[68:71], a[176:179], a[140:143], a[68:71]
    v_cvt_pk_bf16_f32 v22, v36, v37
    v_cvt_pk_bf16_f32 v23, v38, v39
    v_mfma_f32_16x16x32_bf16 a[28:31], a[172:175], a[128:131], a[28:31]
    ds_read_b64_tr_b16 a[170:171], v4 offset:29184
    buffer_store_dwordx4 v[20:23], v1, s[20:23], s77 offen offset:3072 sc1
    v_mfma_f32_16x16x32_bf16 a[28:31], a[176:179], a[144:147], a[28:31]
    s_waitcnt lgkmcnt(8)
    v_mfma_f32_16x16x32_bf16 v[104:107], a[148:151], a[84:87], v[104:107]
    ds_read_b64_tr_b16 a[172:173], v5 offset:24576
    s_add_u32 s55, s78, 32
    s_cmp_lt_u32 s55, 1024
    v_mfma_f32_16x16x32_bf16 v[148:151], a[208:211], a[240:243], v[148:151]
    s_cselect_b32 s76, 0x3e8293ee, 1.0
    s_lshl_b32 s77, s55, 12
    v_mfma_f32_16x16x32_bf16 v[104:107], a[152:155], a[100:103], v[104:107]
    s_cmp_ge_u32 s55, 2048
    s_cselect_b64 vcc, -1, 0
    v_mfma_f32_16x16x32_bf16 v[152:155], a[208:211], a[244:247], v[152:155]
    v_cndmask_b32 v1, v14, v15, vcc
    v_mul_f32 v3, s76, v10
    v_mfma_f32_16x16x32_bf16 v[108:111], a[148:151], a[88:91], v[108:111]
    ds_read_b64_tr_b16 a[174:175], v5 offset:25088
    v_mul_f32 v40, v3, v40
    v_mul_f32 v41, v3, v41
    v_mfma_f32_16x16x32_bf16 v[156:159], a[208:211], a[248:251], v[156:159]
    v_mul_f32 v42, v3, v42
    v_mul_f32 v43, v3, v43
    v_mfma_f32_16x16x32_bf16 v[108:111], a[152:155], a[104:107], v[108:111]
    v_cvt_pk_bf16_f32 v40, v40, v41
    v_mfma_f32_16x16x32_bf16 a[48:51], a[208:211], a[252:255], a[48:51]
    v_cvt_pk_bf16_f32 v41, v42, v43
    v_mul_f32 v52, v3, v52
    v_mfma_f32_16x16x32_bf16 v[112:115], a[148:151], a[92:95], v[112:115]
    ds_read_b64_tr_b16 a[176:177], v5 offset:28672
    v_mul_f32 v53, v3, v53
    v_mul_f32 v54, v3, v54
    v_mfma_f32_16x16x32_bf16 v[112:115], a[152:155], a[108:111], v[112:115]
    v_mul_f32 v55, v3, v55
    v_cvt_pk_bf16_f32 v42, v52, v53
    v_mfma_f32_16x16x32_bf16 a[32:35], a[148:151], a[96:99], a[32:35]
    ds_read_b64_tr_b16 a[178:179], v5 offset:29184
    v_cvt_pk_bf16_f32 v43, v54, v55
    buffer_store_dwordx4 v[40:43], v1, s[20:23], s77 offen offset:0 sc1
    v_mfma_f32_16x16x32_bf16 a[32:35], a[152:155], a[112:115], a[32:35]
    v_mul_f32 v3, s76, v11
    v_mul_f32 v44, v3, v44
    s_waitcnt lgkmcnt(8)
    v_mfma_f32_16x16x32_bf16 v[116:119], a[156:159], a[84:87], v[116:119]
    v_subrev_u32 v254, 81920, v4
    v_mul_f32 v45, v3, v45
    v_mul_f32 v46, v3, v46
    v_mfma_f32_16x16x32_bf16 v[160:163], a[212:215], a[240:243], v[160:163]
    v_mul_f32 v47, v3, v47
    v_mfma_f32_16x16x32_bf16 v[116:119], a[160:163], a[100:103], v[116:119]
    v_subrev_u32 v255, 81920, v5
    v_cvt_pk_bf16_f32 v44, v44, v45
    v_cvt_pk_bf16_f32 v45, v46, v47
    v_mfma_f32_16x16x32_bf16 v[164:167], a[212:215], a[244:247], v[164:167]
    v_mul_f32 v56, v3, v56
    v_mul_f32 v57, v3, v57
    v_mfma_f32_16x16x32_bf16 v[120:123], a[156:159], a[88:91], v[120:123]
    ds_read_b64_tr_b16 a[148:149], v254 offset:16384
    v_mul_f32 v58, v3, v58
    v_mul_f32 v59, v3, v59
    v_mfma_f32_16x16x32_bf16 a[72:75], a[212:215], a[248:251], a[72:75]
    v_cvt_pk_bf16_f32 v46, v56, v57
    v_cvt_pk_bf16_f32 v47, v58, v59
    v_mfma_f32_16x16x32_bf16 v[120:123], a[160:163], a[104:107], v[120:123]
    ds_read_b64_tr_b16 a[150:151], v254 offset:16896
    buffer_store_dwordx4 v[44:47], v1, s[20:23], s77 offen offset:1024 sc1
    v_mul_f32 v3, s76, v12
    v_mfma_f32_16x16x32_bf16 a[52:55], a[212:215], a[252:255], a[52:55]
    v_mul_f32 v48, v3, v48
    v_mfma_f32_16x16x32_bf16 v[124:127], a[156:159], a[92:95], v[124:127]
    ds_read_b64_tr_b16 a[152:153], v254 offset:20480
    v_mul_f32 v49, v3, v49
    v_mul_f32 v50, v3, v50
    v_mfma_f32_16x16x32_bf16 v[124:127], a[160:163], a[108:111], v[124:127]
    v_mul_f32 v51, v3, v51
    v_cvt_pk_bf16_f32 v48, v48, v49
    v_mfma_f32_16x16x32_bf16 a[36:39], a[156:159], a[96:99], a[36:39]
    ds_read_b64_tr_b16 a[154:155], v254 offset:20992
    v_cvt_pk_bf16_f32 v49, v50, v51
    v_mul_f32 v60, v3, v60
    v_mfma_f32_16x16x32_bf16 a[36:39], a[160:163], a[112:115], a[36:39]
    v_mul_f32 v61, v3, v61
    v_mul_f32 v62, v3, v62
    s_waitcnt lgkmcnt(8)
    v_mfma_f32_16x16x32_bf16 v[148:151], a[164:167], a[84:87], v[148:151]
    ds_read_b64_tr_b16 a[156:157], v255 offset:16384
    v_mul_f32 v63, v3, v63
    v_cvt_pk_bf16_f32 v50, v60, v61
    v_mfma_f32_16x16x32_bf16 v[104:107], a[200:203], a[240:243], v[104:107]
    v_cvt_pk_bf16_f32 v51, v62, v63
    buffer_store_dwordx4 v[48:51], v1, s[20:23], s77 offen offset:2048 sc1
    v_mfma_f32_16x16x32_bf16 v[148:151], a[168:171], a[100:103], v[148:151]
    v_mul_f32 v3, s76, v13
    v_mfma_f32_16x16x32_bf16 v[108:111], a[200:203], a[244:247], v[108:111]
    v_accvgpr_read_b32 v24, a8
    v_accvgpr_read_b32 v25, a9
    v_mfma_f32_16x16x32_bf16 v[152:155], a[164:167], a[88:91], v[152:155]
    ds_read_b64_tr_b16 a[158:159], v255 offset:16896
    v_accvgpr_read_b32 v26, a10
    v_accvgpr_read_b32 v27, a11
    v_mfma_f32_16x16x32_bf16 v[112:115], a[200:203], a[248:251], v[112:115]
    v_mul_f32 v24, v3, v24
    v_mul_f32 v25, v3, v25
    v_mfma_f32_16x16x32_bf16 v[152:155], a[168:171], a[104:107], v[152:155]
    v_mul_f32 v26, v3, v26
    v_mul_f32 v27, v3, v27
    v_mfma_f32_16x16x32_bf16 a[32:35], a[200:203], a[252:255], a[32:35]
    v_cvt_pk_bf16_f32 v24, v24, v25
    v_cvt_pk_bf16_f32 v25, v26, v27
    v_mfma_f32_16x16x32_bf16 v[156:159], a[164:167], a[92:95], v[156:159]
    ds_read_b64_tr_b16 a[160:161], v255 offset:20480
    v_accvgpr_read_b32 v16, a12
    v_mfma_f32_16x16x32_bf16 v[156:159], a[168:171], a[108:111], v[156:159]
    v_accvgpr_read_b32 v17, a13
    v_accvgpr_read_b32 v18, a14
    v_mfma_f32_16x16x32_bf16 a[48:51], a[164:167], a[96:99], a[48:51]
    ds_read_b64_tr_b16 a[162:163], v255 offset:20992
    v_accvgpr_read_b32 v19, a15
    v_mul_f32 v16, v3, v16
    v_mfma_f32_16x16x32_bf16 a[48:51], a[168:171], a[112:115], a[48:51]
    v_mul_f32 v17, v3, v17
    v_mul_f32 v18, v3, v18
    s_waitcnt lgkmcnt(8)
    v_mfma_f32_16x16x32_bf16 v[160:163], a[172:175], a[84:87], v[160:163]
    ds_read_b64_tr_b16 a[164:165], v254 offset:24576
    v_mul_f32 v19, v3, v19
    v_cvt_pk_bf16_f32 v26, v16, v17
    ds_read_b128 a[216:219], v252 offset:10240
    v_mfma_f32_16x16x32_bf16 v[116:119], a[204:207], a[240:243], v[116:119]
    v_cvt_pk_bf16_f32 v27, v18, v19
    buffer_store_dwordx4 v[24:27], v1, s[20:23], s77 offen offset:3072 sc1
    v_mfma_f32_16x16x32_bf16 v[160:163], a[176:179], a[100:103], v[160:163]
    s_add_u32 s55, s78, 96
    s_cmp_lt_u32 s55, 1024
    v_mfma_f32_16x16x32_bf16 v[120:123], a[204:207], a[244:247], v[120:123]
    s_cselect_b32 s76, 0x3e8293ee, 1.0
    v_mfma_f32_16x16x32_bf16 v[164:167], a[172:175], a[88:91], v[164:167]
    ds_read_b64_tr_b16 a[166:167], v254 offset:25088
    s_lshl_b32 s77, s55, 12
    s_cmp_ge_u32 s55, 2048
    v_mfma_f32_16x16x32_bf16 v[124:127], a[204:207], a[248:251], v[124:127]
    s_cselect_b64 vcc, -1, 0
    v_cndmask_b32 v1, v14, v15, vcc
    v_mfma_f32_16x16x32_bf16 v[164:167], a[176:179], a[104:107], v[164:167]
    v_mul_f32 v3, s76, v10
    v_mul_f32 v84, v3, v84
    v_mfma_f32_16x16x32_bf16 a[36:39], a[204:207], a[252:255], a[36:39]
    v_mul_f32 v85, v3, v85
    v_mul_f32 v86, v3, v86
    v_mfma_f32_16x16x32_bf16 a[72:75], a[172:175], a[92:95], a[72:75]
    ds_read_b64_tr_b16 a[168:169], v254 offset:28672
    v_mul_f32 v87, v3, v87
    v_cvt_pk_bf16_f32 v84, v84, v85
    ds_read_b128 a[220:223], v252 offset:11264
    v_mfma_f32_16x16x32_bf16 a[72:75], a[176:179], a[108:111], a[72:75]
    v_cvt_pk_bf16_f32 v85, v86, v87
    v_mul_f32 v96, v3, v96
    v_mfma_f32_16x16x32_bf16 a[52:55], a[172:175], a[96:99], a[52:55]
    ds_read_b64_tr_b16 a[170:171], v254 offset:29184
    v_mul_f32 v97, v3, v97
    v_mfma_f32_16x16x32_bf16 a[52:55], a[176:179], a[112:115], a[52:55]
    v_mul_f32 v98, v3, v98
    v_mul_f32 v99, v3, v99
    s_waitcnt lgkmcnt(10)
    v_mfma_f32_16x16x32_bf16 v[104:107], a[148:151], a[116:119], v[104:107]
    ds_read_b64_tr_b16 a[172:173], v255 offset:24576
    v_cvt_pk_bf16_f32 v86, v96, v97
    v_cvt_pk_bf16_f32 v87, v98, v99
    ds_read_b128 a[224:227], v252 offset:14336
    v_mfma_f32_16x16x32_bf16 v[104:107], a[152:155], a[132:135], v[104:107]
    buffer_store_dwordx4 v[84:87], v1, s[20:23], s77 offen offset:0 sc1
    v_mul_f32 v3, s76, v11
    v_mfma_f32_16x16x32_bf16 v[108:111], a[148:151], a[120:123], v[108:111]
    ds_read_b64_tr_b16 a[174:175], v255 offset:25088
    v_mul_f32 v88, v3, v88
    v_mul_f32 v89, v3, v89
    v_mfma_f32_16x16x32_bf16 v[108:111], a[152:155], a[136:139], v[108:111]
    v_mul_f32 v90, v3, v90
    v_mul_f32 v91, v3, v91
    v_mfma_f32_16x16x32_bf16 v[112:115], a[148:151], a[124:127], v[112:115]
    ds_read_b64_tr_b16 a[176:177], v255 offset:28672
    v_cvt_pk_bf16_f32 v88, v88, v89
    ds_read_b128 a[228:231], v252 offset:15360
    v_mfma_f32_16x16x32_bf16 v[112:115], a[152:155], a[140:143], v[112:115]
    v_cvt_pk_bf16_f32 v89, v90, v91
    v_mul_f32 v100, v3, v100
    v_mfma_f32_16x16x32_bf16 a[32:35], a[148:151], a[128:131], a[32:35]
    ds_read_b64_tr_b16 a[178:179], v255 offset:29184
    v_mul_f32 v101, v3, v101
    v_mul_f32 v102, v3, v102
    v_mfma_f32_16x16x32_bf16 a[32:35], a[152:155], a[144:147], a[32:35]
    v_mul_f32 v103, v3, v103
    v_cvt_pk_bf16_f32 v90, v100, v101
    s_waitcnt lgkmcnt(12)
    v_mfma_f32_16x16x32_bf16 v[116:119], a[156:159], a[116:119], v[116:119]
    ds_read_b64_tr_b16 a[148:149], v6 offset:16384
    v_cvt_pk_bf16_f32 v91, v102, v103
    buffer_store_dwordx4 v[88:91], v1, s[20:23], s77 offen offset:1024 sc1
    v_mfma_f32_16x16x32_bf16 v[116:119], a[160:163], a[132:135], v[116:119]
    v_mul_f32 v3, s76, v12
    v_mul_f32 v92, v3, v92
    v_mfma_f32_16x16x32_bf16 v[120:123], a[156:159], a[120:123], v[120:123]
    ds_read_b64_tr_b16 a[150:151], v6 offset:16896
    v_mul_f32 v93, v3, v93
    v_mul_f32 v94, v3, v94
    v_mfma_f32_16x16x32_bf16 v[120:123], a[160:163], a[136:139], v[120:123]
    v_mul_f32 v95, v3, v95
    v_mfma_f32_16x16x32_bf16 v[124:127], a[156:159], a[124:127], v[124:127]
    ds_read_b64_tr_b16 a[152:153], v6 offset:20480
    v_cvt_pk_bf16_f32 v92, v92, v93
    v_cvt_pk_bf16_f32 v93, v94, v95
    v_mfma_f32_16x16x32_bf16 v[124:127], a[160:163], a[140:143], v[124:127]
    v_accvgpr_read_b32 v28, a68
    v_accvgpr_read_b32 v29, a69
    v_mfma_f32_16x16x32_bf16 a[36:39], a[156:159], a[128:131], a[36:39]
    ds_read_b64_tr_b16 a[154:155], v6 offset:20992
    v_accvgpr_read_b32 v30, a70
    v_accvgpr_read_b32 v31, a71
    v_mfma_f32_16x16x32_bf16 a[36:39], a[160:163], a[144:147], a[36:39]
    v_mul_f32 v28, v3, v28
    v_mul_f32 v29, v3, v29
    s_waitcnt lgkmcnt(10)
    v_mfma_f32_16x16x32_bf16 v[148:151], a[164:167], a[116:119], v[148:151]
    ds_read_b64_tr_b16 a[156:157], v7 offset:16384
    v_mul_f32 v30, v3, v30
    v_mul_f32 v31, v3, v31
    v_mfma_f32_16x16x32_bf16 v[148:151], a[168:171], a[132:135], v[148:151]
    v_cvt_pk_bf16_f32 v94, v28, v29
    v_mfma_f32_16x16x32_bf16 v[152:155], a[164:167], a[120:123], v[152:155]
    ds_read_b64_tr_b16 a[158:159], v7 offset:16896
    v_cvt_pk_bf16_f32 v95, v30, v31
    buffer_store_dwordx4 v[92:95], v1, s[20:23], s77 offen offset:2048 sc1
    v_mfma_f32_16x16x32_bf16 v[152:155], a[168:171], a[136:139], v[152:155]
    v_mul_f32 v3, s76, v13
    v_accvgpr_read_b32 v76, a24
    v_mfma_f32_16x16x32_bf16 v[156:159], a[164:167], a[124:127], v[156:159]
    ds_read_b64_tr_b16 a[160:161], v7 offset:20480
    v_accvgpr_read_b32 v77, a25
    v_accvgpr_read_b32 v78, a26
    v_mfma_f32_16x16x32_bf16 v[156:159], a[168:171], a[140:143], v[156:159]
    v_accvgpr_read_b32 v79, a27
    v_mul_f32 v76, v3, v76
    v_mfma_f32_16x16x32_bf16 a[48:51], a[164:167], a[128:131], a[48:51]
    ds_read_b64_tr_b16 a[162:163], v7 offset:20992
    v_mul_f32 v77, v3, v77
    v_mul_f32 v78, v3, v78
    v_mfma_f32_16x16x32_bf16 a[48:51], a[168:171], a[144:147], a[48:51]
    v_mul_f32 v79, v3, v79
    v_cvt_pk_bf16_f32 v76, v76, v77
    s_waitcnt lgkmcnt(8)
    v_mfma_f32_16x16x32_bf16 v[160:163], a[172:175], a[116:119], v[160:163]
    ds_read_b64_tr_b16 a[164:165], v6 offset:24576
    v_cvt_pk_bf16_f32 v77, v78, v79
    v_mfma_f32_16x16x32_bf16 v[160:163], a[176:179], a[132:135], v[160:163]
    v_accvgpr_read_b32 v64, a28
    v_accvgpr_read_b32 v65, a29
    v_mfma_f32_16x16x32_bf16 v[164:167], a[172:175], a[120:123], v[164:167]
    ds_read_b64_tr_b16 a[166:167], v6 offset:25088
    v_accvgpr_read_b32 v66, a30
    v_accvgpr_read_b32 v67, a31
    v_mfma_f32_16x16x32_bf16 v[164:167], a[176:179], a[136:139], v[164:167]
    v_mul_f32 v64, v3, v64
    v_mul_f32 v65, v3, v65
    v_mfma_f32_16x16x32_bf16 a[72:75], a[172:175], a[124:127], a[72:75]
    ds_read_b64_tr_b16 a[168:169], v6 offset:28672
    v_mul_f32 v66, v3, v66
    v_mul_f32 v67, v3, v67
    v_mfma_f32_16x16x32_bf16 a[72:75], a[176:179], a[140:143], a[72:75]
    v_cvt_pk_bf16_f32 v78, v64, v65
    v_cvt_pk_bf16_f32 v79, v66, v67
    v_mfma_f32_16x16x32_bf16 a[52:55], a[172:175], a[128:131], a[52:55]
    ds_read_b64_tr_b16 a[170:171], v6 offset:29184
    buffer_store_dwordx4 v[76:79], v1, s[20:23], s77 offen offset:3072 sc1
    v_mfma_f32_16x16x32_bf16 a[52:55], a[176:179], a[144:147], a[52:55]
gemm1_kernel_q3:
    s_waitcnt lgkmcnt(8)
    v_mfma_f32_16x16x32_bf16 v[128:131], a[148:151], a[84:87], v[128:131]
    ds_read_b64_tr_b16 a[172:173], v7 offset:24576
    s_add_u32 s55, s78, 128
    s_cmp_lt_u32 s55, 1024
    v_mfma_f32_16x16x32_bf16 v[168:171], a[224:227], a[240:243], v[168:171]
    s_cselect_b32 s76, 0x3e8293ee, 1.0
    s_lshl_b32 s77, s55, 12
    v_mfma_f32_16x16x32_bf16 v[128:131], a[152:155], a[100:103], v[128:131]
    s_cmp_ge_u32 s55, 2048
    s_cselect_b64 vcc, -1, 0
    v_mfma_f32_16x16x32_bf16 v[172:175], a[224:227], a[244:247], v[172:175]
    v_cndmask_b32 v1, v14, v15, vcc
    v_mul_f32 v3, s76, v10
    v_mfma_f32_16x16x32_bf16 v[132:135], a[148:151], a[88:91], v[132:135]
    ds_read_b64_tr_b16 a[174:175], v7 offset:25088
    v_mul_f32 v104, v3, v104
    v_mul_f32 v105, v3, v105
    v_mfma_f32_16x16x32_bf16 v[176:179], a[224:227], a[248:251], v[176:179]
    v_mul_f32 v106, v3, v106
    v_mul_f32 v107, v3, v107
    v_mfma_f32_16x16x32_bf16 v[132:135], a[152:155], a[104:107], v[132:135]
    v_cvt_pk_bf16_f32 v104, v104, v105
    v_mfma_f32_16x16x32_bf16 a[56:59], a[224:227], a[252:255], a[56:59]
    v_cvt_pk_bf16_f32 v105, v106, v107
    v_mul_f32 v116, v3, v116
    v_mfma_f32_16x16x32_bf16 v[136:139], a[148:151], a[92:95], v[136:139]
    ds_read_b64_tr_b16 a[176:177], v7 offset:28672
    v_mul_f32 v117, v3, v117
    v_mul_f32 v118, v3, v118
    v_mfma_f32_16x16x32_bf16 v[136:139], a[152:155], a[108:111], v[136:139]
    v_mul_f32 v119, v3, v119
    v_cvt_pk_bf16_f32 v106, v116, v117
    v_mfma_f32_16x16x32_bf16 a[40:43], a[148:151], a[96:99], a[40:43]
    ds_read_b64_tr_b16 a[178:179], v7 offset:29184
    v_cvt_pk_bf16_f32 v107, v118, v119
    buffer_store_dwordx4 v[104:107], v1, s[20:23], s77 offen offset:0 sc1
    v_mfma_f32_16x16x32_bf16 a[40:43], a[152:155], a[112:115], a[40:43]
    v_mul_f32 v3, s76, v11
    v_mul_f32 v108, v3, v108
    s_waitcnt lgkmcnt(8)
    v_mfma_f32_16x16x32_bf16 v[140:143], a[156:159], a[84:87], v[140:143]
    v_subrev_u32 v254, 81920, v6
    v_mul_f32 v109, v3, v109
    v_mul_f32 v110, v3, v110
    v_mfma_f32_16x16x32_bf16 v[180:183], a[228:231], a[240:243], v[180:183]
    v_mul_f32 v111, v3, v111
    v_mfma_f32_16x16x32_bf16 v[140:143], a[160:163], a[100:103], v[140:143]
    v_subrev_u32 v255, 81920, v7
    v_cvt_pk_bf16_f32 v108, v108, v109
    v_cvt_pk_bf16_f32 v109, v110, v111
    v_mfma_f32_16x16x32_bf16 v[184:187], a[228:231], a[244:247], v[184:187]
    v_mul_f32 v120, v3, v120
    v_mul_f32 v121, v3, v121
    v_mfma_f32_16x16x32_bf16 v[144:147], a[156:159], a[88:91], v[144:147]
    ds_read_b64_tr_b16 a[148:149], v254 offset:16384
    v_mul_f32 v122, v3, v122
    v_mul_f32 v123, v3, v123
    v_mfma_f32_16x16x32_bf16 a[76:79], a[228:231], a[248:251], a[76:79]
    v_cvt_pk_bf16_f32 v110, v120, v121
    v_cvt_pk_bf16_f32 v111, v122, v123
    v_mfma_f32_16x16x32_bf16 v[144:147], a[160:163], a[104:107], v[144:147]
    ds_read_b64_tr_b16 a[150:151], v254 offset:16896
    buffer_store_dwordx4 v[108:111], v1, s[20:23], s77 offen offset:1024 sc1
    v_mul_f32 v3, s76, v12
    v_mfma_f32_16x16x32_bf16 a[60:63], a[228:231], a[252:255], a[60:63]
    v_mul_f32 v112, v3, v112
    v_mfma_f32_16x16x32_bf16 a[80:83], a[156:159], a[92:95], a[80:83]
    ds_read_b64_tr_b16 a[152:153], v254 offset:20480
    v_mul_f32 v113, v3, v113
    v_mul_f32 v114, v3, v114
    v_mfma_f32_16x16x32_bf16 a[80:83], a[160:163], a[108:111], a[80:83]
    v_mul_f32 v115, v3, v115
    v_cvt_pk_bf16_f32 v112, v112, v113
    v_mfma_f32_16x16x32_bf16 a[44:47], a[156:159], a[96:99], a[44:47]
    ds_read_b64_tr_b16 a[154:155], v254 offset:20992
    v_cvt_pk_bf16_f32 v113, v114, v115
    v_mul_f32 v124, v3, v124
    v_mfma_f32_16x16x32_bf16 a[44:47], a[160:163], a[112:115], a[44:47]
    v_mul_f32 v125, v3, v125
    v_mul_f32 v126, v3, v126
    s_waitcnt lgkmcnt(8)
    v_mfma_f32_16x16x32_bf16 v[168:171], a[164:167], a[84:87], v[168:171]
    ds_read_b64_tr_b16 a[156:157], v255 offset:16384
    v_mul_f32 v127, v3, v127
    v_cvt_pk_bf16_f32 v114, v124, v125
    v_mfma_f32_16x16x32_bf16 v[128:131], a[216:219], a[240:243], v[128:131]
    v_cvt_pk_bf16_f32 v115, v126, v127
    buffer_store_dwordx4 v[112:115], v1, s[20:23], s77 offen offset:2048 sc1
    v_mfma_f32_16x16x32_bf16 v[168:171], a[168:171], a[100:103], v[168:171]
    v_mul_f32 v3, s76, v13
    v_mfma_f32_16x16x32_bf16 v[132:135], a[216:219], a[244:247], v[132:135]
    v_accvgpr_read_b32 v16, a32
    v_accvgpr_read_b32 v17, a33
    v_mfma_f32_16x16x32_bf16 v[172:175], a[164:167], a[88:91], v[172:175]
    ds_read_b64_tr_b16 a[158:159], v255 offset:16896
    v_accvgpr_read_b32 v18, a34
    v_accvgpr_read_b32 v19, a35
    v_mfma_f32_16x16x32_bf16 v[136:139], a[216:219], a[248:251], v[136:139]
    v_mul_f32 v16, v3, v16
    v_mul_f32 v17, v3, v17
    v_mfma_f32_16x16x32_bf16 v[172:175], a[168:171], a[104:107], v[172:175]
    v_mul_f32 v18, v3, v18
    v_mul_f32 v19, v3, v19
    v_mfma_f32_16x16x32_bf16 a[40:43], a[216:219], a[252:255], a[40:43]
    v_cvt_pk_bf16_f32 v16, v16, v17
    v_cvt_pk_bf16_f32 v17, v18, v19
    v_mfma_f32_16x16x32_bf16 v[176:179], a[164:167], a[92:95], v[176:179]
    ds_read_b64_tr_b16 a[160:161], v255 offset:20480
    v_accvgpr_read_b32 v20, a36
    v_mfma_f32_16x16x32_bf16 v[176:179], a[168:171], a[108:111], v[176:179]
    v_accvgpr_read_b32 v21, a37
    v_accvgpr_read_b32 v22, a38
    v_mfma_f32_16x16x32_bf16 a[56:59], a[164:167], a[96:99], a[56:59]
    ds_read_b64_tr_b16 a[162:163], v255 offset:20992
    v_accvgpr_read_b32 v23, a39
    v_mul_f32 v20, v3, v20
    v_mfma_f32_16x16x32_bf16 a[56:59], a[168:171], a[112:115], a[56:59]
    v_mul_f32 v21, v3, v21
    v_mul_f32 v22, v3, v22
    s_waitcnt lgkmcnt(8)
    v_mfma_f32_16x16x32_bf16 v[180:183], a[172:175], a[84:87], v[180:183]
    ds_read_b64_tr_b16 a[164:165], v254 offset:24576
    v_mul_f32 v23, v3, v23
    v_cvt_pk_bf16_f32 v18, v20, v21
    ds_read_b128 a[200:203], v252 offset:16384
    v_mfma_f32_16x16x32_bf16 v[140:143], a[220:223], a[240:243], v[140:143]
    v_cvt_pk_bf16_f32 v19, v22, v23
    buffer_store_dwordx4 v[16:19], v1, s[20:23], s77 offen offset:3072 sc1
    v_mfma_f32_16x16x32_bf16 v[180:183], a[176:179], a[100:103], v[180:183]
    s_add_u32 s55, s78, 192
    s_cmp_lt_u32 s55, 1024
    v_mfma_f32_16x16x32_bf16 v[144:147], a[220:223], a[244:247], v[144:147]
    s_cselect_b32 s76, 0x3e8293ee, 1.0
    v_mfma_f32_16x16x32_bf16 v[184:187], a[172:175], a[88:91], v[184:187]
    ds_read_b64_tr_b16 a[166:167], v254 offset:25088
    s_lshl_b32 s77, s55, 12
    s_cmp_ge_u32 s55, 2048
    v_mfma_f32_16x16x32_bf16 a[80:83], a[220:223], a[248:251], a[80:83]
    s_cselect_b64 vcc, -1, 0
    v_cndmask_b32 v1, v14, v15, vcc
    v_mfma_f32_16x16x32_bf16 v[184:187], a[176:179], a[104:107], v[184:187]
    v_mul_f32 v3, s76, v10
    v_mul_f32 v148, v3, v148
    v_mfma_f32_16x16x32_bf16 a[44:47], a[220:223], a[252:255], a[44:47]
    v_mul_f32 v149, v3, v149
    v_mul_f32 v150, v3, v150
    v_mfma_f32_16x16x32_bf16 a[76:79], a[172:175], a[92:95], a[76:79]
    ds_read_b64_tr_b16 a[168:169], v254 offset:28672
    v_mul_f32 v151, v3, v151
    v_cvt_pk_bf16_f32 v148, v148, v149
    ds_read_b128 a[204:207], v252 offset:17408
    v_mfma_f32_16x16x32_bf16 a[76:79], a[176:179], a[108:111], a[76:79]
    v_cvt_pk_bf16_f32 v149, v150, v151
    v_mul_f32 v160, v3, v160
    v_mfma_f32_16x16x32_bf16 a[60:63], a[172:175], a[96:99], a[60:63]
    ds_read_b64_tr_b16 a[170:171], v254 offset:29184
    v_mul_f32 v161, v3, v161
    v_mfma_f32_16x16x32_bf16 a[60:63], a[176:179], a[112:115], a[60:63]
    v_mul_f32 v162, v3, v162
    v_mul_f32 v163, v3, v163
    s_waitcnt lgkmcnt(10)
    v_mfma_f32_16x16x32_bf16 v[128:131], a[148:151], a[116:119], v[128:131]
    ds_read_b64_tr_b16 a[172:173], v255 offset:24576
    v_cvt_pk_bf16_f32 v150, v160, v161
    v_cvt_pk_bf16_f32 v151, v162, v163
    ds_read_b128 a[208:211], v252 offset:18432
    v_mfma_f32_16x16x32_bf16 v[128:131], a[152:155], a[132:135], v[128:131]
    buffer_store_dwordx4 v[148:151], v1, s[20:23], s77 offen offset:0 sc1
    v_mul_f32 v3, s76, v11
    v_mfma_f32_16x16x32_bf16 v[132:135], a[148:151], a[120:123], v[132:135]
    ds_read_b64_tr_b16 a[174:175], v255 offset:25088
    v_mul_f32 v152, v3, v152
    v_mul_f32 v153, v3, v153
    v_mfma_f32_16x16x32_bf16 v[132:135], a[152:155], a[136:139], v[132:135]
    v_mul_f32 v154, v3, v154
    v_mul_f32 v155, v3, v155
    v_mfma_f32_16x16x32_bf16 v[136:139], a[148:151], a[124:127], v[136:139]
    ds_read_b64_tr_b16 a[176:177], v255 offset:28672
    v_cvt_pk_bf16_f32 v152, v152, v153
    ds_read_b128 a[212:215], v252 offset:19456
    v_mfma_f32_16x16x32_bf16 v[136:139], a[152:155], a[140:143], v[136:139]
    v_cvt_pk_bf16_f32 v153, v154, v155
    v_mul_f32 v164, v3, v164
    v_mfma_f32_16x16x32_bf16 a[40:43], a[148:151], a[128:131], a[40:43]
    ds_read_b64_tr_b16 a[178:179], v255 offset:29184
    v_mul_f32 v165, v3, v165
    v_mul_f32 v166, v3, v166
    v_mfma_f32_16x16x32_bf16 a[40:43], a[152:155], a[144:147], a[40:43]
    v_mul_f32 v167, v3, v167
    v_cvt_pk_bf16_f32 v154, v164, v165
    s_waitcnt lgkmcnt(12)
    v_mfma_f32_16x16x32_bf16 v[140:143], a[156:159], a[116:119], v[140:143]
    ds_read_b64_tr_b16 a[148:149], v8 offset:0
    v_cvt_pk_bf16_f32 v155, v166, v167
    buffer_store_dwordx4 v[152:155], v1, s[20:23], s77 offen offset:1024 sc1
    v_mfma_f32_16x16x32_bf16 v[140:143], a[160:163], a[132:135], v[140:143]
    v_mul_f32 v3, s76, v12
    v_mul_f32 v156, v3, v156
    v_mfma_f32_16x16x32_bf16 v[144:147], a[156:159], a[120:123], v[144:147]
    ds_read_b64_tr_b16 a[150:151], v8 offset:256
    v_mul_f32 v157, v3, v157
    v_mul_f32 v158, v3, v158
    v_mfma_f32_16x16x32_bf16 v[144:147], a[160:163], a[136:139], v[144:147]
    v_mul_f32 v159, v3, v159
    v_mfma_f32_16x16x32_bf16 a[80:83], a[156:159], a[124:127], a[80:83]
    ds_read_b64_tr_b16 a[152:153], v8 offset:4096
    v_cvt_pk_bf16_f32 v156, v156, v157
    v_cvt_pk_bf16_f32 v157, v158, v159
    v_mfma_f32_16x16x32_bf16 a[80:83], a[160:163], a[140:143], a[80:83]
    v_accvgpr_read_b32 v24, a72
    v_accvgpr_read_b32 v25, a73
    v_mfma_f32_16x16x32_bf16 a[44:47], a[156:159], a[128:131], a[44:47]
    ds_read_b64_tr_b16 a[154:155], v8 offset:4352
    v_accvgpr_read_b32 v26, a74
    v_accvgpr_read_b32 v27, a75
    v_mfma_f32_16x16x32_bf16 a[44:47], a[160:163], a[144:147], a[44:47]
    v_mul_f32 v24, v3, v24
    v_mul_f32 v25, v3, v25
    s_waitcnt lgkmcnt(10)
    v_mfma_f32_16x16x32_bf16 v[168:171], a[164:167], a[116:119], v[168:171]
    ds_read_b64_tr_b16 a[156:157], v9 offset:0
    v_mul_f32 v26, v3, v26
    v_mul_f32 v27, v3, v27
    v_mfma_f32_16x16x32_bf16 v[168:171], a[168:171], a[132:135], v[168:171]
    v_cvt_pk_bf16_f32 v158, v24, v25
    v_mfma_f32_16x16x32_bf16 v[172:175], a[164:167], a[120:123], v[172:175]
    ds_read_b64_tr_b16 a[158:159], v9 offset:256
    v_cvt_pk_bf16_f32 v159, v26, v27
    buffer_store_dwordx4 v[156:159], v1, s[20:23], s77 offen offset:2048 sc1
    v_mfma_f32_16x16x32_bf16 v[172:175], a[168:171], a[136:139], v[172:175]
    v_mul_f32 v3, s76, v13
    v_accvgpr_read_b32 v28, a48
    v_mfma_f32_16x16x32_bf16 v[176:179], a[164:167], a[124:127], v[176:179]
    ds_read_b64_tr_b16 a[160:161], v9 offset:4096
    v_accvgpr_read_b32 v29, a49
    v_accvgpr_read_b32 v30, a50
    v_mfma_f32_16x16x32_bf16 v[176:179], a[168:171], a[140:143], v[176:179]
    v_accvgpr_read_b32 v31, a51
    v_mul_f32 v28, v3, v28
    v_mfma_f32_16x16x32_bf16 a[56:59], a[164:167], a[128:131], a[56:59]
    ds_read_b64_tr_b16 a[162:163], v9 offset:4352
    v_mul_f32 v29, v3, v29
    v_mul_f32 v30, v3, v30
    v_mfma_f32_16x16x32_bf16 a[56:59], a[168:171], a[144:147], a[56:59]
    v_mul_f32 v31, v3, v31
    v_cvt_pk_bf16_f32 v28, v28, v29
    s_waitcnt lgkmcnt(8)
    v_mfma_f32_16x16x32_bf16 v[180:183], a[172:175], a[116:119], v[180:183]
    ds_read_b64_tr_b16 a[164:165], v8 offset:1024
    v_cvt_pk_bf16_f32 v29, v30, v31
    v_mfma_f32_16x16x32_bf16 v[180:183], a[176:179], a[132:135], v[180:183]
    v_accvgpr_read_b32 v32, a52
    v_accvgpr_read_b32 v33, a53
    v_mfma_f32_16x16x32_bf16 v[184:187], a[172:175], a[120:123], v[184:187]
    ds_read_b64_tr_b16 a[166:167], v8 offset:1280
    v_accvgpr_read_b32 v34, a54
    v_accvgpr_read_b32 v35, a55
    v_mfma_f32_16x16x32_bf16 v[184:187], a[176:179], a[136:139], v[184:187]
    v_mul_f32 v32, v3, v32
    v_mul_f32 v33, v3, v33
    v_mfma_f32_16x16x32_bf16 a[76:79], a[172:175], a[124:127], a[76:79]
    ds_read_b64_tr_b16 a[168:169], v8 offset:5120
    v_mul_f32 v34, v3, v34
    v_mul_f32 v35, v3, v35
    v_mfma_f32_16x16x32_bf16 a[76:79], a[176:179], a[140:143], a[76:79]
    v_cvt_pk_bf16_f32 v30, v32, v33
    v_cvt_pk_bf16_f32 v31, v34, v35
    v_mfma_f32_16x16x32_bf16 a[60:63], a[172:175], a[128:131], a[60:63]
    ds_read_b64_tr_b16 a[170:171], v8 offset:5376
    buffer_store_dwordx4 v[28:31], v1, s[20:23], s77 offen offset:3072 sc1
    v_mfma_f32_16x16x32_bf16 a[60:63], a[176:179], a[144:147], a[60:63]
    s_waitcnt lgkmcnt(8)
    v_mfma_f32_16x16x32_bf16 v[188:191], a[148:151], a[84:87], v[188:191]
    ds_read_b64_tr_b16 a[172:173], v9 offset:1024
    s_add_u32 s55, s78, 160
    s_cmp_lt_u32 s55, 1024
    v_mfma_f32_16x16x32_bf16 v[220:223], a[208:211], a[240:243], v[220:223]
    s_cselect_b32 s76, 0x3e8293ee, 1.0
    s_lshl_b32 s77, s55, 12
    v_mfma_f32_16x16x32_bf16 v[188:191], a[152:155], a[100:103], v[188:191]
    s_cmp_ge_u32 s55, 2048
    s_cselect_b64 vcc, -1, 0
    v_mfma_f32_16x16x32_bf16 v[224:227], a[208:211], a[244:247], v[224:227]
    v_cndmask_b32 v1, v14, v15, vcc
    v_mul_f32 v3, s76, v10
    v_mfma_f32_16x16x32_bf16 v[192:195], a[148:151], a[88:91], v[192:195]
    ds_read_b64_tr_b16 a[174:175], v9 offset:1280
    v_mul_f32 v128, v3, v128
    v_mul_f32 v129, v3, v129
    v_mfma_f32_16x16x32_bf16 v[228:231], a[208:211], a[248:251], v[228:231]
    v_mul_f32 v130, v3, v130
    v_mul_f32 v131, v3, v131
    v_mfma_f32_16x16x32_bf16 v[192:195], a[152:155], a[104:107], v[192:195]
    v_cvt_pk_bf16_f32 v128, v128, v129
    v_cvt_pk_bf16_f32 v129, v130, v131
    v_mfma_f32_16x16x32_bf16 v[232:235], a[208:211], a[252:255], v[232:235]
    v_mul_f32 v140, v3, v140
    v_mul_f32 v141, v3, v141
    v_mfma_f32_16x16x32_bf16 v[196:199], a[148:151], a[92:95], v[196:199]
    ds_read_b64_tr_b16 a[176:177], v9 offset:5120
    v_mul_f32 v142, v3, v142
    v_mul_f32 v143, v3, v143
    v_mfma_f32_16x16x32_bf16 v[196:199], a[152:155], a[108:111], v[196:199]
    v_cvt_pk_bf16_f32 v130, v140, v141
    v_mfma_f32_16x16x32_bf16 v[200:203], a[148:151], a[96:99], v[200:203]
    ds_read_b64_tr_b16 a[178:179], v9 offset:5376
    v_cvt_pk_bf16_f32 v131, v142, v143
    buffer_store_dwordx4 v[128:131], v1, s[20:23], s77 offen offset:0 sc1
    v_mfma_f32_16x16x32_bf16 v[200:203], a[152:155], a[112:115], v[200:203]
    v_mul_f32 v3, s76, v11
    v_mul_f32 v132, v3, v132
    s_waitcnt lgkmcnt(8)
    v_mfma_f32_16x16x32_bf16 v[204:207], a[156:159], a[84:87], v[204:207]
    v_subrev_u32 v254, 81920, v8
    v_mul_f32 v133, v3, v133
    v_mul_f32 v134, v3, v134
    v_mfma_f32_16x16x32_bf16 v[236:239], a[212:215], a[240:243], v[236:239]
    v_mul_f32 v135, v3, v135
    v_cvt_pk_bf16_f32 v132, v132, v133
    v_mfma_f32_16x16x32_bf16 v[204:207], a[160:163], a[100:103], v[204:207]
    v_subrev_u32 v255, 81920, v9
    v_cvt_pk_bf16_f32 v133, v134, v135
    v_mul_f32 v144, v3, v144
    v_mfma_f32_16x16x32_bf16 v[240:243], a[212:215], a[244:247], v[240:243]
    v_mul_f32 v145, v3, v145
    v_mul_f32 v146, v3, v146
    v_mfma_f32_16x16x32_bf16 v[208:211], a[156:159], a[88:91], v[208:211]
    ds_read_b64_tr_b16 a[148:149], v254 offset:0
    v_mul_f32 v147, v3, v147
    v_cvt_pk_bf16_f32 v134, v144, v145
    v_mfma_f32_16x16x32_bf16 v[244:247], a[212:215], a[248:251], v[244:247]
    v_cvt_pk_bf16_f32 v135, v146, v147
    buffer_store_dwordx4 v[132:135], v1, s[20:23], s77 offen offset:1024 sc1
    v_mfma_f32_16x16x32_bf16 v[208:211], a[160:163], a[104:107], v[208:211]
    ds_read_b64_tr_b16 a[150:151], v254 offset:256
    v_mul_f32 v3, s76, v12
    v_mul_f32 v136, v3, v136
    v_mfma_f32_16x16x32_bf16 v[248:251], a[212:215], a[252:255], v[248:251]
    v_mul_f32 v137, v3, v137
    v_mfma_f32_16x16x32_bf16 v[212:215], a[156:159], a[92:95], v[212:215]
    ds_read_b64_tr_b16 a[152:153], v254 offset:4096
    v_mul_f32 v138, v3, v138
    v_mul_f32 v139, v3, v139
    v_mfma_f32_16x16x32_bf16 v[212:215], a[160:163], a[108:111], v[212:215]
    v_cvt_pk_bf16_f32 v136, v136, v137
    v_cvt_pk_bf16_f32 v137, v138, v139
    v_mfma_f32_16x16x32_bf16 v[216:219], a[156:159], a[96:99], v[216:219]
    ds_read_b64_tr_b16 a[154:155], v254 offset:4352
    v_accvgpr_read_b32 v36, a80
    v_accvgpr_read_b32 v37, a81
    v_mfma_f32_16x16x32_bf16 v[216:219], a[160:163], a[112:115], v[216:219]
    v_accvgpr_read_b32 v38, a82
    v_accvgpr_read_b32 v39, a83
    s_waitcnt lgkmcnt(8)
    v_mfma_f32_16x16x32_bf16 v[220:223], a[164:167], a[84:87], v[220:223]
    ds_read_b64_tr_b16 a[156:157], v255 offset:0
    v_mul_f32 v36, v3, v36
    v_mul_f32 v37, v3, v37
    v_mfma_f32_16x16x32_bf16 v[188:191], a[200:203], a[240:243], v[188:191]
    v_mul_f32 v38, v3, v38
    v_mul_f32 v39, v3, v39
    v_mfma_f32_16x16x32_bf16 v[220:223], a[168:171], a[100:103], v[220:223]
    v_cvt_pk_bf16_f32 v138, v36, v37
    v_cvt_pk_bf16_f32 v139, v38, v39
    v_mfma_f32_16x16x32_bf16 v[192:195], a[200:203], a[244:247], v[192:195]
    buffer_store_dwordx4 v[136:139], v1, s[20:23], s77 offen offset:2048 sc1
    v_mul_f32 v3, s76, v13
    v_mfma_f32_16x16x32_bf16 v[224:227], a[164:167], a[88:91], v[224:227]
    ds_read_b64_tr_b16 a[158:159], v255 offset:256
    v_accvgpr_read_b32 v64, a40
    v_accvgpr_read_b32 v65, a41
    v_mfma_f32_16x16x32_bf16 v[196:199], a[200:203], a[248:251], v[196:199]
    v_accvgpr_read_b32 v66, a42
    v_mfma_f32_16x16x32_bf16 v[224:227], a[168:171], a[104:107], v[224:227]
    v_accvgpr_read_b32 v67, a43
    v_mul_f32 v64, v3, v64
    v_mfma_f32_16x16x32_bf16 v[200:203], a[200:203], a[252:255], v[200:203]
    v_mul_f32 v65, v3, v65
    v_mul_f32 v66, v3, v66
    v_mfma_f32_16x16x32_bf16 v[228:231], a[164:167], a[92:95], v[228:231]
    ds_read_b64_tr_b16 a[160:161], v255 offset:4096
    v_mul_f32 v67, v3, v67
    v_cvt_pk_bf16_f32 v64, v64, v65
    v_mfma_f32_16x16x32_bf16 v[228:231], a[168:171], a[108:111], v[228:231]
    v_cvt_pk_bf16_f32 v65, v66, v67
    v_accvgpr_read_b32 v68, a44
    v_mfma_f32_16x16x32_bf16 v[232:235], a[164:167], a[96:99], v[232:235]
    ds_read_b64_tr_b16 a[162:163], v255 offset:4352
    v_accvgpr_read_b32 v69, a45
    v_accvgpr_read_b32 v70, a46
    v_mfma_f32_16x16x32_bf16 v[232:235], a[168:171], a[112:115], v[232:235]
    v_accvgpr_read_b32 v71, a47
    v_mul_f32 v68, v3, v68
    s_waitcnt lgkmcnt(8)
    v_mfma_f32_16x16x32_bf16 v[236:239], a[172:175], a[84:87], v[236:239]
    ds_read_b64_tr_b16 a[164:165], v254 offset:1024
    v_mul_f32 v69, v3, v69
    v_mul_f32 v70, v3, v70
    v_mfma_f32_16x16x32_bf16 v[204:207], a[204:207], a[240:243], v[204:207]
    v_mul_f32 v71, v3, v71
    v_cvt_pk_bf16_f32 v66, v68, v69
    v_mfma_f32_16x16x32_bf16 v[236:239], a[176:179], a[100:103], v[236:239]
    v_cvt_pk_bf16_f32 v67, v70, v71
    buffer_store_dwordx4 v[64:67], v1, s[20:23], s77 offen offset:3072 sc1
    v_mfma_f32_16x16x32_bf16 v[208:211], a[204:207], a[244:247], v[208:211]
    s_add_u32 s55, s78, 224
    v_mfma_f32_16x16x32_bf16 v[240:243], a[172:175], a[88:91], v[240:243]
    ds_read_b64_tr_b16 a[166:167], v254 offset:1280
    s_cmp_lt_u32 s55, 1024
    s_cselect_b32 s76, 0x3e8293ee, 1.0
    v_mfma_f32_16x16x32_bf16 v[212:215], a[204:207], a[248:251], v[212:215]
    s_lshl_b32 s77, s55, 12
    s_cmp_ge_u32 s55, 2048
    v_mfma_f32_16x16x32_bf16 v[240:243], a[176:179], a[104:107], v[240:243]
    s_cselect_b64 vcc, -1, 0
    v_cndmask_b32 v1, v14, v15, vcc
    v_mfma_f32_16x16x32_bf16 v[216:219], a[204:207], a[252:255], v[216:219]
    v_mul_f32 v3, s76, v10
    v_mul_f32 v168, v3, v168
    v_mfma_f32_16x16x32_bf16 v[244:247], a[172:175], a[92:95], v[244:247]
    ds_read_b64_tr_b16 a[168:169], v254 offset:5120
    v_mul_f32 v169, v3, v169
    v_mul_f32 v170, v3, v170
    v_mfma_f32_16x16x32_bf16 v[244:247], a[176:179], a[108:111], v[244:247]
    v_mul_f32 v171, v3, v171
    v_cvt_pk_bf16_f32 v168, v168, v169
    v_mfma_f32_16x16x32_bf16 v[248:251], a[172:175], a[96:99], v[248:251]
    ds_read_b64_tr_b16 a[170:171], v254 offset:5376
    v_cvt_pk_bf16_f32 v169, v170, v171
    v_mul_f32 v180, v3, v180
    v_mfma_f32_16x16x32_bf16 v[248:251], a[176:179], a[112:115], v[248:251]
    v_mul_f32 v181, v3, v181
    v_mul_f32 v182, v3, v182
    s_waitcnt lgkmcnt(8)
    v_mfma_f32_16x16x32_bf16 v[188:191], a[148:151], a[116:119], v[188:191]
    ds_read_b64_tr_b16 a[172:173], v255 offset:1024
    v_mul_f32 v183, v3, v183
    v_cvt_pk_bf16_f32 v170, v180, v181
    v_mfma_f32_16x16x32_bf16 v[188:191], a[152:155], a[132:135], v[188:191]
    v_cvt_pk_bf16_f32 v171, v182, v183
    v_mfma_f32_16x16x32_bf16 v[192:195], a[148:151], a[120:123], v[192:195]
    ds_read_b64_tr_b16 a[174:175], v255 offset:1280
    buffer_store_dwordx4 v[168:171], v1, s[20:23], s77 offen offset:0 sc1
    v_mul_f32 v3, s76, v11
    v_mfma_f32_16x16x32_bf16 v[192:195], a[152:155], a[136:139], v[192:195]
    v_mul_f32 v172, v3, v172
    v_mul_f32 v173, v3, v173
    v_mfma_f32_16x16x32_bf16 v[196:199], a[148:151], a[124:127], v[196:199]
    ds_read_b64_tr_b16 a[176:177], v255 offset:5120
    v_mul_f32 v174, v3, v174
    v_mul_f32 v175, v3, v175
    v_mfma_f32_16x16x32_bf16 v[196:199], a[152:155], a[140:143], v[196:199]
    v_cvt_pk_bf16_f32 v172, v172, v173
    v_cvt_pk_bf16_f32 v173, v174, v175
    v_mfma_f32_16x16x32_bf16 v[200:203], a[148:151], a[128:131], v[200:203]
    ds_read_b64_tr_b16 a[178:179], v255 offset:5376
    v_mul_f32 v184, v3, v184
    v_mul_f32 v185, v3, v185
    v_mfma_f32_16x16x32_bf16 v[200:203], a[152:155], a[144:147], v[200:203]
    v_mul_f32 v186, v3, v186
    v_mul_f32 v187, v3, v187
    s_waitcnt lgkmcnt(8)
    v_mfma_f32_16x16x32_bf16 v[204:207], a[156:159], a[116:119], v[204:207]
    v_cvt_pk_bf16_f32 v174, v184, v185
    v_cvt_pk_bf16_f32 v175, v186, v187
    v_mfma_f32_16x16x32_bf16 v[204:207], a[160:163], a[132:135], v[204:207]
    buffer_store_dwordx4 v[172:175], v1, s[20:23], s77 offen offset:1024 sc1
    v_mul_f32 v3, s76, v12
    v_mfma_f32_16x16x32_bf16 v[208:211], a[156:159], a[120:123], v[208:211]
    v_mul_f32 v176, v3, v176
    v_mul_f32 v177, v3, v177
    v_mfma_f32_16x16x32_bf16 v[208:211], a[160:163], a[136:139], v[208:211]
    v_mul_f32 v178, v3, v178
    v_mfma_f32_16x16x32_bf16 v[212:215], a[156:159], a[124:127], v[212:215]
    v_mul_f32 v179, v3, v179
    v_cvt_pk_bf16_f32 v176, v176, v177
    v_mfma_f32_16x16x32_bf16 v[212:215], a[160:163], a[140:143], v[212:215]
    v_cvt_pk_bf16_f32 v177, v178, v179
    v_accvgpr_read_b32 v72, a76
    v_mfma_f32_16x16x32_bf16 v[216:219], a[156:159], a[128:131], v[216:219]
    v_accvgpr_read_b32 v73, a77
    v_accvgpr_read_b32 v74, a78
    v_mfma_f32_16x16x32_bf16 v[216:219], a[160:163], a[144:147], v[216:219]
    v_accvgpr_read_b32 v75, a79
    v_mul_f32 v72, v3, v72
    s_waitcnt lgkmcnt(4)
    v_mfma_f32_16x16x32_bf16 v[220:223], a[164:167], a[116:119], v[220:223]
    v_mul_f32 v73, v3, v73
    v_mul_f32 v74, v3, v74
    v_mfma_f32_16x16x32_bf16 v[220:223], a[168:171], a[132:135], v[220:223]
    v_mul_f32 v75, v3, v75
    v_cvt_pk_bf16_f32 v178, v72, v73
    v_mfma_f32_16x16x32_bf16 v[224:227], a[164:167], a[120:123], v[224:227]
    v_cvt_pk_bf16_f32 v179, v74, v75
    buffer_store_dwordx4 v[176:179], v1, s[20:23], s77 offen offset:2048 sc1
    v_mfma_f32_16x16x32_bf16 v[224:227], a[168:171], a[136:139], v[224:227]
    v_mul_f32 v3, s76, v13
    v_accvgpr_read_b32 v76, a56
    v_mfma_f32_16x16x32_bf16 v[228:231], a[164:167], a[124:127], v[228:231]
    v_accvgpr_read_b32 v77, a57
    v_accvgpr_read_b32 v78, a58
    v_mfma_f32_16x16x32_bf16 v[228:231], a[168:171], a[140:143], v[228:231]
    v_accvgpr_read_b32 v79, a59
    v_mfma_f32_16x16x32_bf16 v[232:235], a[164:167], a[128:131], v[232:235]
    v_mul_f32 v76, v3, v76
    v_mul_f32 v77, v3, v77
    v_mfma_f32_16x16x32_bf16 v[232:235], a[168:171], a[144:147], v[232:235]
    v_mul_f32 v78, v3, v78
    v_mul_f32 v79, v3, v79
    s_waitcnt lgkmcnt(0)
    v_mfma_f32_16x16x32_bf16 v[236:239], a[172:175], a[116:119], v[236:239]
    v_cvt_pk_bf16_f32 v76, v76, v77
    v_cvt_pk_bf16_f32 v77, v78, v79
    v_mfma_f32_16x16x32_bf16 v[236:239], a[176:179], a[132:135], v[236:239]
    v_accvgpr_read_b32 v80, a60
    v_accvgpr_read_b32 v81, a61
    v_mfma_f32_16x16x32_bf16 v[240:243], a[172:175], a[120:123], v[240:243]
    v_accvgpr_read_b32 v82, a62
    v_accvgpr_read_b32 v83, a63
    v_mfma_f32_16x16x32_bf16 v[240:243], a[176:179], a[136:139], v[240:243]
    v_mul_f32 v80, v3, v80
    v_mul_f32 v81, v3, v81
    v_mfma_f32_16x16x32_bf16 v[244:247], a[172:175], a[124:127], v[244:247]
    v_mul_f32 v82, v3, v82
    v_mul_f32 v83, v3, v83
    v_mfma_f32_16x16x32_bf16 v[244:247], a[176:179], a[140:143], v[244:247]
    v_cvt_pk_bf16_f32 v78, v80, v81
    v_cvt_pk_bf16_f32 v79, v82, v83
    v_mfma_f32_16x16x32_bf16 v[248:251], a[172:175], a[128:131], v[248:251]
    buffer_store_dwordx4 v[76:79], v1, s[20:23], s77 offen offset:3072 sc1
    v_mfma_f32_16x16x32_bf16 v[248:251], a[176:179], a[144:147], v[248:251]
    s_add_u32 s55, s78, 256
    s_cmp_lt_u32 s55, 1024
    s_cselect_b32 s76, 0x3e8293ee, 1.0
    s_lshl_b32 s77, s55, 12
    s_cmp_ge_u32 s55, 2048
    s_cselect_b64 vcc, -1, 0
    v_cndmask_b32 v1, v14, v15, vcc
    v_mul_f32 v3, s76, v10
    v_mul_f32 v188, v3, v188
    v_mul_f32 v189, v3, v189
    v_mul_f32 v190, v3, v190
    v_mul_f32 v191, v3, v191
    v_cvt_pk_bf16_f32 v188, v188, v189
    v_cvt_pk_bf16_f32 v189, v190, v191
    v_mul_f32 v204, v3, v204
    v_mul_f32 v205, v3, v205
    v_mul_f32 v206, v3, v206
    v_mul_f32 v207, v3, v207
    v_cvt_pk_bf16_f32 v190, v204, v205
    v_cvt_pk_bf16_f32 v191, v206, v207
    buffer_store_dwordx4 v[188:191], v1, s[20:23], s77 offen offset:0 sc1
    v_mul_f32 v3, s76, v11
    v_mul_f32 v192, v3, v192
    v_mul_f32 v193, v3, v193
    v_mul_f32 v194, v3, v194
    v_mul_f32 v195, v3, v195
    v_cvt_pk_bf16_f32 v192, v192, v193
    v_cvt_pk_bf16_f32 v193, v194, v195
    v_mul_f32 v208, v3, v208
    v_mul_f32 v209, v3, v209
    v_mul_f32 v210, v3, v210
    v_mul_f32 v211, v3, v211
    v_cvt_pk_bf16_f32 v194, v208, v209
    v_cvt_pk_bf16_f32 v195, v210, v211
    buffer_store_dwordx4 v[192:195], v1, s[20:23], s77 offen offset:1024 sc1
    v_mul_f32 v3, s76, v12
    v_mul_f32 v196, v3, v196
    v_mul_f32 v197, v3, v197
    v_mul_f32 v198, v3, v198
    v_mul_f32 v199, v3, v199
    v_cvt_pk_bf16_f32 v196, v196, v197
    v_cvt_pk_bf16_f32 v197, v198, v199
    v_mul_f32 v212, v3, v212
    v_mul_f32 v213, v3, v213
    v_mul_f32 v214, v3, v214
    v_mul_f32 v215, v3, v215
    v_cvt_pk_bf16_f32 v198, v212, v213
    v_cvt_pk_bf16_f32 v199, v214, v215
    buffer_store_dwordx4 v[196:199], v1, s[20:23], s77 offen offset:2048 sc1
    v_mul_f32 v3, s76, v13
    v_mul_f32 v200, v3, v200
    v_mul_f32 v201, v3, v201
    v_mul_f32 v202, v3, v202
    v_mul_f32 v203, v3, v203
    v_cvt_pk_bf16_f32 v200, v200, v201
    v_cvt_pk_bf16_f32 v201, v202, v203
    v_mul_f32 v216, v3, v216
    v_mul_f32 v217, v3, v217
    v_mul_f32 v218, v3, v218
    v_mul_f32 v219, v3, v219
    v_cvt_pk_bf16_f32 v202, v216, v217
    v_cvt_pk_bf16_f32 v203, v218, v219
    buffer_store_dwordx4 v[200:203], v1, s[20:23], s77 offen offset:3072 sc1
    s_add_u32 s55, s78, 288
    s_cmp_lt_u32 s55, 1024
    s_cselect_b32 s76, 0x3e8293ee, 1.0
    s_lshl_b32 s77, s55, 12
    s_cmp_ge_u32 s55, 2048
    s_cselect_b64 vcc, -1, 0
    v_cndmask_b32 v1, v14, v15, vcc
    v_mul_f32 v3, s76, v10
    v_mul_f32 v220, v3, v220
    v_mul_f32 v221, v3, v221
    v_mul_f32 v222, v3, v222
    v_mul_f32 v223, v3, v223
    v_cvt_pk_bf16_f32 v220, v220, v221
    v_cvt_pk_bf16_f32 v221, v222, v223
    v_mul_f32 v236, v3, v236
    v_mul_f32 v237, v3, v237
    v_mul_f32 v238, v3, v238
    v_mul_f32 v239, v3, v239
    v_cvt_pk_bf16_f32 v222, v236, v237
    v_cvt_pk_bf16_f32 v223, v238, v239
    buffer_store_dwordx4 v[220:223], v1, s[20:23], s77 offen offset:0 sc1
    v_mul_f32 v3, s76, v11
    v_mul_f32 v224, v3, v224
    v_mul_f32 v225, v3, v225
    v_mul_f32 v226, v3, v226
    v_mul_f32 v227, v3, v227
    v_cvt_pk_bf16_f32 v224, v224, v225
    v_cvt_pk_bf16_f32 v225, v226, v227
    v_mul_f32 v240, v3, v240
    v_mul_f32 v241, v3, v241
    v_mul_f32 v242, v3, v242
    v_mul_f32 v243, v3, v243
    v_cvt_pk_bf16_f32 v226, v240, v241
    v_cvt_pk_bf16_f32 v227, v242, v243
    buffer_store_dwordx4 v[224:227], v1, s[20:23], s77 offen offset:1024 sc1
    v_mul_f32 v3, s76, v12
    v_mul_f32 v228, v3, v228
    v_mul_f32 v229, v3, v229
    v_mul_f32 v230, v3, v230
    v_mul_f32 v231, v3, v231
    v_cvt_pk_bf16_f32 v228, v228, v229
    v_cvt_pk_bf16_f32 v229, v230, v231
    v_mul_f32 v244, v3, v244
    v_mul_f32 v245, v3, v245
    v_mul_f32 v246, v3, v246
    v_mul_f32 v247, v3, v247
    v_cvt_pk_bf16_f32 v230, v244, v245
    v_cvt_pk_bf16_f32 v231, v246, v247
    buffer_store_dwordx4 v[228:231], v1, s[20:23], s77 offen offset:2048 sc1
    v_mul_f32 v3, s76, v13
    v_mul_f32 v232, v3, v232
    v_mul_f32 v233, v3, v233
    v_mul_f32 v234, v3, v234
    v_mul_f32 v235, v3, v235
    v_cvt_pk_bf16_f32 v232, v232, v233
    v_cvt_pk_bf16_f32 v233, v234, v235
    v_mul_f32 v248, v3, v248
    v_mul_f32 v249, v3, v249
    v_mul_f32 v250, v3, v250
    v_mul_f32 v251, v3, v251
    v_cvt_pk_bf16_f32 v234, v248, v249
    v_cvt_pk_bf16_f32 v235, v250, v251
    buffer_store_dwordx4 v[232:235], v1, s[20:23], s77 offen offset:3072 sc1
gemm1_kernel_end:
    s_endpgm
gemm1_kernel_spin:
    s_mov_b32 s19, 0x4000
gemm1_kernel_spin1:
    s_sleep 8
    buffer_load_dword v15, v255, s[44:47], 0 offen sc1
    s_waitcnt vmcnt(0)
    v_cmp_gt_u32 vcc, v14, v15
    s_cbranch_vccz gemm1_kernel_ready
    s_sub_u32 s19, s19, 1
    s_cmp_lg_u32 s19, 0
    s_cbranch_scc1 gemm1_kernel_spin1
    s_branch gemm1_kernel_ready
gemm1_kernel_tg:
    s_waitcnt lgkmcnt(8)
    v_mfma_f32_16x16x32_bf16 v[40:43], a[148:151], a[84:87], v[40:43]
    ds_read_b64_tr_b16 a[172:173], v7 offset:8192
    s_add_u32 s77, s79, 0
    s_lshl_b32 s77, s77, 5
    v_mfma_f32_16x16x32_bf16 v[84:87], a[224:227], a[240:243], v[84:87]
    s_add_u32 s77, s77, 0
    v_mul_f32 v3, v10, v10
    v_mfma_f32_16x16x32_bf16 v[40:43], a[152:155], a[100:103], v[40:43]
    s_add_u32 s55, s77, 0
    v_max_f32 v16, 0, v16
    v_mfma_f32_16x16x32_bf16 v[88:91], a[224:227], a[244:247], v[88:91]
    v_max_f32 v17, 0, v17
    v_max_f32 v18, 0, v18
    v_mfma_f32_16x16x32_bf16 v[44:47], a[148:151], a[88:91], v[44:47]
    ds_read_b64_tr_b16 a[174:175], v7 offset:8704
    v_max_f32 v19, 0, v19
    v_mul_f32 v16, v3, v16
    v_mfma_f32_16x16x32_bf16 v[92:95], a[224:227], a[248:251], v[92:95]
    v_mul_f32 v17, v3, v17
    v_mul_f32 v18, v3, v18
    v_mfma_f32_16x16x32_bf16 v[44:47], a[152:155], a[104:107], v[44:47]
    v_mul_f32 v19, v3, v19
    v_mul_f32 v16, v64, v16
    v_mfma_f32_16x16x32_bf16 a[24:27], a[224:227], a[252:255], a[24:27]
    v_mul_f32 v17, v65, v17
    v_mfma_f32_16x16x32_bf16 v[48:51], a[148:151], a[92:95], v[48:51]
    ds_read_b64_tr_b16 a[176:177], v7 offset:12288
    v_mul_f32 v18, v66, v18
    v_mul_f32 v19, v67, v19
    v_mfma_f32_16x16x32_bf16 v[48:51], a[152:155], a[108:111], v[48:51]
    v_cvt_pk_bf16_f32 v16, v16, v17
    v_cvt_pk_bf16_f32 v17, v18, v19
    v_mfma_f32_16x16x32_bf16 a[8:11], a[148:151], a[96:99], a[8:11]
    ds_read_b64_tr_b16 a[178:179], v7 offset:12800
    v_max_f32 v28, 0, v28
    v_max_f32 v29, 0, v29
    v_mfma_f32_16x16x32_bf16 a[8:11], a[152:155], a[112:115], a[8:11]
    v_max_f32 v30, 0, v30
    v_max_f32 v31, 0, v31
    s_waitcnt lgkmcnt(8)
    v_mfma_f32_16x16x32_bf16 v[52:55], a[156:159], a[84:87], v[52:55]
    v_subrev_u32 v254, 81920, v6
    v_mul_f32 v28, v3, v28
    v_mul_f32 v29, v3, v29
    v_mfma_f32_16x16x32_bf16 v[96:99], a[228:231], a[240:243], v[96:99]
    v_mul_f32 v30, v3, v30
    v_mul_f32 v31, v3, v31
    v_mfma_f32_16x16x32_bf16 v[52:55], a[160:163], a[100:103], v[52:55]
    v_subrev_u32 v255, 81920, v7
    v_mul_f32 v28, v76, v28
    v_mfma_f32_16x16x32_bf16 v[100:103], a[228:231], a[244:247], v[100:103]
    v_mul_f32 v29, v77, v29
    v_mul_f32 v30, v78, v30
    v_mfma_f32_16x16x32_bf16 v[56:59], a[156:159], a[88:91], v[56:59]
    ds_read_b64_tr_b16 a[148:149], v254 offset:0
    v_mul_f32 v31, v79, v31
    v_cvt_pk_bf16_f32 v18, v28, v29
    v_mfma_f32_16x16x32_bf16 a[68:71], a[228:231], a[248:251], a[68:71]
    v_cvt_pk_bf16_f32 v19, v30, v31
    buffer_store_dwordx4 v[16:19], v2, s[24:27], s55 offen sc1
    v_mfma_f32_16x16x32_bf16 v[56:59], a[160:163], a[104:107], v[56:59]
    ds_read_b64_tr_b16 a[150:151], v254 offset:512
    v_mul_f32 v3, v11, v11
    s_add_u32 s55, s77, 114688
    v_mfma_f32_16x16x32_bf16 a[28:31], a[228:231], a[252:255], a[28:31]
    v_max_f32 v20, 0, v20
    v_max_f32 v21, 0, v21
    v_mfma_f32_16x16x32_bf16 v[60:63], a[156:159], a[92:95], v[60:63]
    ds_read_b64_tr_b16 a[152:153], v254 offset:4096
    v_max_f32 v22, 0, v22
    v_max_f32 v23, 0, v23
    v_mfma_f32_16x16x32_bf16 v[60:63], a[160:163], a[108:111], v[60:63]
    v_mul_f32 v20, v3, v20
    v_mfma_f32_16x16x32_bf16 a[12:15], a[156:159], a[96:99], a[12:15]
    ds_read_b64_tr_b16 a[154:155], v254 offset:4608
    v_mul_f32 v21, v3, v21
    v_mul_f32 v22, v3, v22
    v_mfma_f32_16x16x32_bf16 a[12:15], a[160:163], a[112:115], a[12:15]
    v_mul_f32 v23, v3, v23
    v_mul_f32 v20, v68, v20
    s_waitcnt lgkmcnt(8)
    v_mfma_f32_16x16x32_bf16 v[84:87], a[164:167], a[84:87], v[84:87]
    ds_read_b64_tr_b16 a[156:157], v255 offset:0
    v_mul_f32 v21, v69, v21
    v_mul_f32 v22, v70, v22
    v_mfma_f32_16x16x32_bf16 v[40:43], a[216:219], a[240:243], v[40:43]
    v_mul_f32 v23, v71, v23
    v_cvt_pk_bf16_f32 v20, v20, v21
    v_mfma_f32_16x16x32_bf16 v[84:87], a[168:171], a[100:103], v[84:87]
    v_cvt_pk_bf16_f32 v21, v22, v23
    v_max_f32 v32, 0, v32
    v_mfma_f32_16x16x32_bf16 v[44:47], a[216:219], a[244:247], v[44:47]
    v_max_f32 v33, 0, v33
    v_max_f32 v34, 0, v34
    v_mfma_f32_16x16x32_bf16 v[88:91], a[164:167], a[88:91], v[88:91]
    ds_read_b64_tr_b16 a[158:159], v255 offset:512
    v_max_f32 v35, 0, v35
    v_mfma_f32_16x16x32_bf16 v[48:51], a[216:219], a[248:251], v[48:51]
    v_mul_f32 v32, v3, v32
    v_mul_f32 v33, v3, v33
    v_mfma_f32_16x16x32_bf16 v[88:91], a[168:171], a[104:107], v[88:91]
    v_mul_f32 v34, v3, v34
    v_mul_f32 v35, v3, v35
    v_mfma_f32_16x16x32_bf16 a[8:11], a[216:219], a[252:255], a[8:11]
    v_mul_f32 v32, v80, v32
    v_mul_f32 v33, v81, v33
    v_mfma_f32_16x16x32_bf16 v[92:95], a[164:167], a[92:95], v[92:95]
    ds_read_b64_tr_b16 a[160:161], v255 offset:4096
    v_mul_f32 v34, v82, v34
    v_mul_f32 v35, v83, v35
    v_mfma_f32_16x16x32_bf16 v[92:95], a[168:171], a[108:111], v[92:95]
    v_cvt_pk_bf16_f32 v22, v32, v33
    v_cvt_pk_bf16_f32 v23, v34, v35
    v_mfma_f32_16x16x32_bf16 a[24:27], a[164:167], a[96:99], a[24:27]
    ds_read_b64_tr_b16 a[162:163], v255 offset:4608
    buffer_store_dwordx4 v[20:23], v2, s[24:27], s55 offen sc1
    v_mul_f32 v3, v12, v12
    v_mfma_f32_16x16x32_bf16 a[24:27], a[168:171], a[112:115], a[24:27]
    s_add_u32 s55, s77, 229376
    s_waitcnt lgkmcnt(8)
    v_mfma_f32_16x16x32_bf16 v[96:99], a[172:175], a[84:87], v[96:99]
    ds_read_b64_tr_b16 a[164:165], v254 offset:8192
    v_max_f32 v24, 0, v24
    v_max_f32 v25, 0, v25
    ds_read_b128 a[200:203], v252 offset:8192
    v_mfma_f32_16x16x32_bf16 v[52:55], a[220:223], a[240:243], v[52:55]
    v_max_f32 v26, 0, v26
    v_max_f32 v27, 0, v27
    v_mfma_f32_16x16x32_bf16 v[96:99], a[176:179], a[100:103], v[96:99]
    v_mul_f32 v24, v3, v24
    v_mul_f32 v25, v3, v25
    v_mfma_f32_16x16x32_bf16 v[56:59], a[220:223], a[244:247], v[56:59]
    v_mul_f32 v26, v3, v26
    v_mul_f32 v27, v3, v27
    v_mfma_f32_16x16x32_bf16 v[100:103], a[172:175], a[88:91], v[100:103]
    ds_read_b64_tr_b16 a[166:167], v254 offset:8704
    v_mul_f32 v24, v72, v24
    v_mul_f32 v25, v73, v25
    v_mfma_f32_16x16x32_bf16 v[60:63], a[220:223], a[248:251], v[60:63]
    v_mul_f32 v26, v74, v26
    v_mul_f32 v27, v75, v27
    v_mfma_f32_16x16x32_bf16 v[100:103], a[176:179], a[104:107], v[100:103]
    v_cvt_pk_bf16_f32 v24, v24, v25
    v_cvt_pk_bf16_f32 v25, v26, v27
    v_mfma_f32_16x16x32_bf16 a[12:15], a[220:223], a[252:255], a[12:15]
    v_max_f32 v36, 0, v36
    v_mfma_f32_16x16x32_bf16 a[68:71], a[172:175], a[92:95], a[68:71]
    ds_read_b64_tr_b16 a[168:169], v254 offset:12288
    v_max_f32 v37, 0, v37
    v_max_f32 v38, 0, v38
    ds_read_b128 a[204:207], v252 offset:9216
    v_mfma_f32_16x16x32_bf16 a[68:71], a[176:179], a[108:111], a[68:71]
    v_max_f32 v39, 0, v39
    v_mul_f32 v36, v3, v36
    v_mfma_f32_16x16x32_bf16 a[28:31], a[172:175], a[96:99], a[28:31]
    ds_read_b64_tr_b16 a[170:171], v254 offset:12800
    v_mul_f32 v37, v3, v37
    v_mul_f32 v38, v3, v38
    v_mfma_f32_16x16x32_bf16 a[28:31], a[176:179], a[112:115], a[28:31]
    v_mul_f32 v39, v3, v39
    v_accvgpr_read_b32 v64, a64
    s_waitcnt lgkmcnt(10)
    v_mfma_f32_16x16x32_bf16 v[40:43], a[148:151], a[116:119], v[40:43]
    ds_read_b64_tr_b16 a[172:173], v255 offset:8192
    v_accvgpr_read_b32 v65, a65
    v_accvgpr_read_b32 v66, a66
    ds_read_b128 a[208:211], v252 offset:12288
    v_mfma_f32_16x16x32_bf16 v[40:43], a[152:155], a[132:135], v[40:43]
    v_accvgpr_read_b32 v67, a67
    v_mul_f32 v36, v64, v36
    v_mfma_f32_16x16x32_bf16 v[44:47], a[148:151], a[120:123], v[44:47]
    ds_read_b64_tr_b16 a[174:175], v255 offset:8704
    v_mul_f32 v37, v65, v37
    v_mfma_f32_16x16x32_bf16 v[44:47], a[152:155], a[136:139], v[44:47]
    v_mul_f32 v38, v66, v38
    v_mul_f32 v39, v67, v39
    v_mfma_f32_16x16x32_bf16 v[48:51], a[148:151], a[124:127], v[48:51]
    ds_read_b64_tr_b16 a[176:177], v255 offset:12288
    v_cvt_pk_bf16_f32 v26, v36, v37
    v_cvt_pk_bf16_f32 v27, v38, v39
    ds_read_b128 a[212:215], v252 offset:13312
    v_mfma_f32_16x16x32_bf16 v[48:51], a[152:155], a[140:143], v[48:51]
    buffer_store_dwordx4 v[24:27], v2, s[24:27], s55 offen sc1
    v_mul_f32 v3, v13, v13
    v_mfma_f32_16x16x32_bf16 a[8:11], a[148:151], a[128:131], a[8:11]
    ds_read_b64_tr_b16 a[178:179], v255 offset:12800
    s_add_u32 s55, s77, 344064
    v_accvgpr_read_b32 v76, a0
    v_mfma_f32_16x16x32_bf16 a[8:11], a[152:155], a[144:147], a[8:11]
    v_accvgpr_read_b32 v77, a1
    v_accvgpr_read_b32 v78, a2
    s_waitcnt lgkmcnt(12)
    v_mfma_f32_16x16x32_bf16 v[52:55], a[156:159], a[116:119], v[52:55]
    ds_read_b64_tr_b16 a[148:149], v4 offset:16384
    v_accvgpr_read_b32 v79, a3
    v_max_f32 v76, 0, v76
    v_mfma_f32_16x16x32_bf16 v[52:55], a[160:163], a[132:135], v[52:55]
    v_max_f32 v77, 0, v77
    v_mfma_f32_16x16x32_bf16 v[56:59], a[156:159], a[120:123], v[56:59]
    ds_read_b64_tr_b16 a[150:151], v4 offset:16896
    v_max_f32 v78, 0, v78
    v_max_f32 v79, 0, v79
    v_mfma_f32_16x16x32_bf16 v[56:59], a[160:163], a[136:139], v[56:59]
    v_mul_f32 v76, v3, v76
    v_mul_f32 v77, v3, v77
    v_mfma_f32_16x16x32_bf16 v[60:63], a[156:159], a[124:127], v[60:63]
    ds_read_b64_tr_b16 a[152:153], v4 offset:20480
    v_mul_f32 v78, v3, v78
    v_mul_f32 v79, v3, v79
    v_mfma_f32_16x16x32_bf16 v[60:63], a[160:163], a[140:143], v[60:63]
    v_accvgpr_read_b32 v28, a16
    v_accvgpr_read_b32 v29, a17
    v_mfma_f32_16x16x32_bf16 a[12:15], a[156:159], a[128:131], a[12:15]
    ds_read_b64_tr_b16 a[154:155], v4 offset:20992
    v_accvgpr_read_b32 v30, a18
    v_accvgpr_read_b32 v31, a19
    v_mfma_f32_16x16x32_bf16 a[12:15], a[160:163], a[144:147], a[12:15]
    v_mul_f32 v76, v28, v76
    v_mul_f32 v77, v29, v77
    s_waitcnt lgkmcnt(10)
    v_mfma_f32_16x16x32_bf16 v[84:87], a[164:167], a[116:119], v[84:87]
    ds_read_b64_tr_b16 a[156:157], v5 offset:16384
    v_mul_f32 v78, v30, v78
    v_mfma_f32_16x16x32_bf16 v[84:87], a[168:171], a[132:135], v[84:87]
    v_mul_f32 v79, v31, v79
    v_cvt_pk_bf16_f32 v76, v76, v77
    v_mfma_f32_16x16x32_bf16 v[88:91], a[164:167], a[120:123], v[88:91]
    ds_read_b64_tr_b16 a[158:159], v5 offset:16896
    v_cvt_pk_bf16_f32 v77, v78, v79
    v_accvgpr_read_b32 v16, a4
    v_mfma_f32_16x16x32_bf16 v[88:91], a[168:171], a[136:139], v[88:91]
    v_accvgpr_read_b32 v17, a5
    v_accvgpr_read_b32 v18, a6
    v_mfma_f32_16x16x32_bf16 v[92:95], a[164:167], a[124:127], v[92:95]
    ds_read_b64_tr_b16 a[160:161], v5 offset:20480
    v_accvgpr_read_b32 v19, a7
    v_max_f32 v16, 0, v16
    v_mfma_f32_16x16x32_bf16 v[92:95], a[168:171], a[140:143], v[92:95]
    v_max_f32 v17, 0, v17
    v_max_f32 v18, 0, v18
    v_mfma_f32_16x16x32_bf16 a[24:27], a[164:167], a[128:131], a[24:27]
    ds_read_b64_tr_b16 a[162:163], v5 offset:20992
    v_max_f32 v19, 0, v19
    v_mul_f32 v16, v3, v16
    v_mfma_f32_16x16x32_bf16 a[24:27], a[168:171], a[144:147], a[24:27]
    v_mul_f32 v17, v3, v17
    s_waitcnt lgkmcnt(8)
    v_mfma_f32_16x16x32_bf16 v[96:99], a[172:175], a[116:119], v[96:99]
    ds_read_b64_tr_b16 a[164:165], v4 offset:24576
    v_mul_f32 v18, v3, v18
    v_mul_f32 v19, v3, v19
    v_mfma_f32_16x16x32_bf16 v[96:99], a[176:179], a[132:135], v[96:99]
    v_accvgpr_read_b32 v68, a20
    v_accvgpr_read_b32 v69, a21
    v_mfma_f32_16x16x32_bf16 v[100:103], a[172:175], a[120:123], v[100:103]
    ds_read_b64_tr_b16 a[166:167], v4 offset:25088
    v_accvgpr_read_b32 v70, a22
    v_accvgpr_read_b32 v71, a23
    v_mfma_f32_16x16x32_bf16 v[100:103], a[176:179], a[136:139], v[100:103]
    v_mul_f32 v16, v68, v16
    v_mul_f32 v17, v69, v17
    v_mfma_f32_16x16x32_bf16 a[68:71], a[172:175], a[124:127], a[68:71]
    ds_read_b64_tr_b16 a[168:169], v4 offset:28672
    v_mul_f32 v18, v70, v18
    v_mul_f32 v19, v71, v19
    v_mfma_f32_16x16x32_bf16 a[68:71], a[176:179], a[140:143], a[68:71]
    v_cvt_pk_bf16_f32 v78, v16, v17
    v_cvt_pk_bf16_f32 v79, v18, v19
    v_mfma_f32_16x16x32_bf16 a[28:31], a[172:175], a[128:131], a[28:31]
    ds_read_b64_tr_b16 a[170:171], v4 offset:29184
    buffer_store_dwordx4 v[76:79], v2, s[24:27], s55 offen sc1
    v_mfma_f32_16x16x32_bf16 a[28:31], a[176:179], a[144:147], a[28:31]
    s_waitcnt lgkmcnt(8)
    v_mfma_f32_16x16x32_bf16 v[104:107], a[148:151], a[84:87], v[104:107]
    ds_read_b64_tr_b16 a[172:173], v5 offset:24576
    s_add_u32 s77, s79, 0
    s_lshl_b32 s77, s77, 5
    v_mfma_f32_16x16x32_bf16 v[148:151], a[208:211], a[240:243], v[148:151]
    s_add_u32 s77, s77, 1024
    v_mul_f32 v3, v10, v10
    v_mfma_f32_16x16x32_bf16 v[104:107], a[152:155], a[100:103], v[104:107]
    s_add_u32 s55, s77, 0
    v_max_f32 v40, 0, v40
    v_mfma_f32_16x16x32_bf16 v[152:155], a[208:211], a[244:247], v[152:155]
    v_max_f32 v41, 0, v41
    v_max_f32 v42, 0, v42
    v_mfma_f32_16x16x32_bf16 v[108:111], a[148:151], a[88:91], v[108:111]
    ds_read_b64_tr_b16 a[174:175], v5 offset:25088
    v_max_f32 v43, 0, v43
    v_mul_f32 v40, v3, v40
    v_mfma_f32_16x16x32_bf16 v[156:159], a[208:211], a[248:251], v[156:159]
    v_mul_f32 v41, v3, v41
    v_mul_f32 v42, v3, v42
    v_mfma_f32_16x16x32_bf16 v[108:111], a[152:155], a[104:107], v[108:111]
    v_mul_f32 v43, v3, v43
    v_mul_f32 v40, v84, v40
    v_mfma_f32_16x16x32_bf16 a[48:51], a[208:211], a[252:255], a[48:51]
    v_mul_f32 v41, v85, v41
    v_mfma_f32_16x16x32_bf16 v[112:115], a[148:151], a[92:95], v[112:115]
    ds_read_b64_tr_b16 a[176:177], v5 offset:28672
    v_mul_f32 v42, v86, v42
    v_mul_f32 v43, v87, v43
    v_mfma_f32_16x16x32_bf16 v[112:115], a[152:155], a[108:111], v[112:115]
    v_cvt_pk_bf16_f32 v40, v40, v41
    v_cvt_pk_bf16_f32 v41, v42, v43
    v_mfma_f32_16x16x32_bf16 a[32:35], a[148:151], a[96:99], a[32:35]
    ds_read_b64_tr_b16 a[178:179], v5 offset:29184
    v_max_f32 v52, 0, v52
    v_max_f32 v53, 0, v53
    v_mfma_f32_16x16x32_bf16 a[32:35], a[152:155], a[112:115], a[32:35]
    v_max_f32 v54, 0, v54
    v_max_f32 v55, 0, v55
    s_waitcnt lgkmcnt(8)
    v_mfma_f32_16x16x32_bf16 v[116:119], a[156:159], a[84:87], v[116:119]
    v_subrev_u32 v254, 81920, v4
    v_mul_f32 v52, v3, v52
    v_mul_f32 v53, v3, v53
    v_mfma_f32_16x16x32_bf16 v[160:163], a[212:215], a[240:243], v[160:163]
    v_mul_f32 v54, v3, v54
    v_mul_f32 v55, v3, v55
    v_mfma_f32_16x16x32_bf16 v[116:119], a[160:163], a[100:103], v[116:119]
    v_subrev_u32 v255, 81920, v5
    v_mul_f32 v52, v96, v52
    v_mfma_f32_16x16x32_bf16 v[164:167], a[212:215], a[244:247], v[164:167]
    v_mul_f32 v53, v97, v53
    v_mul_f32 v54, v98, v54
    v_mfma_f32_16x16x32_bf16 v[120:123], a[156:159], a[88:91], v[120:123]
    ds_read_b64_tr_b16 a[148:149], v254 offset:16384
    v_mul_f32 v55, v99, v55
    v_cvt_pk_bf16_f32 v42, v52, v53
    v_mfma_f32_16x16x32_bf16 a[72:75], a[212:215], a[248:251], a[72:75]
    v_cvt_pk_bf16_f32 v43, v54, v55
    buffer_store_dwordx4 v[40:43], v2, s[24:27], s55 offen sc1
    v_mfma_f32_16x16x32_bf16 v[120:123], a[160:163], a[104:107], v[120:123]
    ds_read_b64_tr_b16 a[150:151], v254 offset:16896
    v_mul_f32 v3, v11, v11
    s_add_u32 s55, s77, 114688
    v_mfma_f32_16x16x32_bf16 a[52:55], a[212:215], a[252:255], a[52:55]
    v_max_f32 v44, 0, v44
    v_max_f32 v45, 0, v45
    v_mfma_f32_16x16x32_bf16 v[124:127], a[156:159], a[92:95], v[124:127]
    ds_read_b64_tr_b16 a[152:153], v254 offset:20480
    v_max_f32 v46, 0, v46
    v_max_f32 v47, 0, v47
    v_mfma_f32_16x16x32_bf16 v[124:127], a[160:163], a[108:111], v[124:127]
    v_mul_f32 v44, v3, v44
    v_mfma_f32_16x16x32_bf16 a[36:39], a[156:159], a[96:99], a[36:39]
    ds_read_b64_tr_b16 a[154:155], v254 offset:20992
    v_mul_f32 v45, v3, v45
    v_mul_f32 v46, v3, v46
    v_mfma_f32_16x16x32_bf16 a[36:39], a[160:163], a[112:115], a[36:39]
    v_mul_f32 v47, v3, v47
    v_mul_f32 v44, v88, v44
    s_waitcnt lgkmcnt(8)
    v_mfma_f32_16x16x32_bf16 v[148:151], a[164:167], a[84:87], v[148:151]
    ds_read_b64_tr_b16 a[156:157], v255 offset:16384
    v_mul_f32 v45, v89, v45
    v_mul_f32 v46, v90, v46
    v_mfma_f32_16x16x32_bf16 v[104:107], a[200:203], a[240:243], v[104:107]
    v_mul_f32 v47, v91, v47
    v_cvt_pk_bf16_f32 v44, v44, v45
    v_mfma_f32_16x16x32_bf16 v[148:151], a[168:171], a[100:103], v[148:151]
    v_cvt_pk_bf16_f32 v45, v46, v47
    v_max_f32 v56, 0, v56
    v_mfma_f32_16x16x32_bf16 v[108:111], a[200:203], a[244:247], v[108:111]
    v_max_f32 v57, 0, v57
    v_max_f32 v58, 0, v58
    v_mfma_f32_16x16x32_bf16 v[152:155], a[164:167], a[88:91], v[152:155]
    ds_read_b64_tr_b16 a[158:159], v255 offset:16896
    v_max_f32 v59, 0, v59
    v_mfma_f32_16x16x32_bf16 v[112:115], a[200:203], a[248:251], v[112:115]
    v_mul_f32 v56, v3, v56
    v_mul_f32 v57, v3, v57
    v_mfma_f32_16x16x32_bf16 v[152:155], a[168:171], a[104:107], v[152:155]
    v_mul_f32 v58, v3, v58
    v_mul_f32 v59, v3, v59
    v_mfma_f32_16x16x32_bf16 a[32:35], a[200:203], a[252:255], a[32:35]
    v_mul_f32 v56, v100, v56
    v_mul_f32 v57, v101, v57
    v_mfma_f32_16x16x32_bf16 v[156:159], a[164:167], a[92:95], v[156:159]
    ds_read_b64_tr_b16 a[160:161], v255 offset:20480
    v_mul_f32 v58, v102, v58
    v_mul_f32 v59, v103, v59
    v_mfma_f32_16x16x32_bf16 v[156:159], a[168:171], a[108:111], v[156:159]
    v_cvt_pk_bf16_f32 v46, v56, v57
    v_cvt_pk_bf16_f32 v47, v58, v59
    v_mfma_f32_16x16x32_bf16 a[48:51], a[164:167], a[96:99], a[48:51]
    ds_read_b64_tr_b16 a[162:163], v255 offset:20992
    buffer_store_dwordx4 v[44:47], v2, s[24:27], s55 offen sc1
    v_mul_f32 v3, v12, v12
    v_mfma_f32_16x16x32_bf16 a[48:51], a[168:171], a[112:115], a[48:51]
    s_add_u32 s55, s77, 229376
    s_waitcnt lgkmcnt(8)
    v_mfma_f32_16x16x32_bf16 v[160:163], a[172:175], a[84:87], v[160:163]
    ds_read_b64_tr_b16 a[164:165], v254 offset:24576
    v_max_f32 v48, 0, v48
    v_max_f32 v49, 0, v49
    ds_read_b128 a[216:219], v252 offset:10240
    v_mfma_f32_16x16x32_bf16 v[116:119], a[204:207], a[240:243], v[116:119]
    v_max_f32 v50, 0, v50
    v_max_f32 v51, 0, v51
    v_mfma_f32_16x16x32_bf16 v[160:163], a[176:179], a[100:103], v[160:163]
    v_mul_f32 v48, v3, v48
    v_mul_f32 v49, v3, v49
    v_mfma_f32_16x16x32_bf16 v[120:123], a[204:207], a[244:247], v[120:123]
    v_mul_f32 v50, v3, v50
    v_mul_f32 v51, v3, v51
    v_mfma_f32_16x16x32_bf16 v[164:167], a[172:175], a[88:91], v[164:167]
    ds_read_b64_tr_b16 a[166:167], v254 offset:25088
    v_mul_f32 v48, v92, v48
    v_mul_f32 v49, v93, v49
    v_mfma_f32_16x16x32_bf16 v[124:127], a[204:207], a[248:251], v[124:127]
    v_mul_f32 v50, v94, v50
    v_mul_f32 v51, v95, v51
    v_mfma_f32_16x16x32_bf16 v[164:167], a[176:179], a[104:107], v[164:167]
    v_cvt_pk_bf16_f32 v48, v48, v49
    v_cvt_pk_bf16_f32 v49, v50, v51
    v_mfma_f32_16x16x32_bf16 a[36:39], a[204:207], a[252:255], a[36:39]
    v_max_f32 v60, 0, v60
    v_mfma_f32_16x16x32_bf16 a[72:75], a[172:175], a[92:95], a[72:75]
    ds_read_b64_tr_b16 a[168:169], v254 offset:28672
    v_max_f32 v61, 0, v61
    v_max_f32 v62, 0, v62
    ds_read_b128 a[220:223], v252 offset:11264
    v_mfma_f32_16x16x32_bf16 a[72:75], a[176:179], a[108:111], a[72:75]
    v_max_f32 v63, 0, v63
    v_mul_f32 v60, v3, v60
    v_mfma_f32_16x16x32_bf16 a[52:55], a[172:175], a[96:99], a[52:55]
    ds_read_b64_tr_b16 a[170:171], v254 offset:29184
    v_mul_f32 v61, v3, v61
    v_mul_f32 v62, v3, v62
    v_mfma_f32_16x16x32_bf16 a[52:55], a[176:179], a[112:115], a[52:55]
    v_mul_f32 v63, v3, v63
    v_accvgpr_read_b32 v80, a68
    s_waitcnt lgkmcnt(10)
    v_mfma_f32_16x16x32_bf16 v[104:107], a[148:151], a[116:119], v[104:107]
    ds_read_b64_tr_b16 a[172:173], v255 offset:24576
    v_accvgpr_read_b32 v81, a69
    v_accvgpr_read_b32 v82, a70
    ds_read_b128 a[224:227], v252 offset:14336
    v_mfma_f32_16x16x32_bf16 v[104:107], a[152:155], a[132:135], v[104:107]
    v_accvgpr_read_b32 v83, a71
    v_mul_f32 v60, v80, v60
    v_mfma_f32_16x16x32_bf16 v[108:111], a[148:151], a[120:123], v[108:111]
    ds_read_b64_tr_b16 a[174:175], v255 offset:25088
    v_mul_f32 v61, v81, v61
    v_mfma_f32_16x16x32_bf16 v[108:111], a[152:155], a[136:139], v[108:111]
    v_mul_f32 v62, v82, v62
    v_mul_f32 v63, v83, v63
    v_mfma_f32_16x16x32_bf16 v[112:115], a[148:151], a[124:127], v[112:115]
    ds_read_b64_tr_b16 a[176:177], v255 offset:28672
    v_cvt_pk_bf16_f32 v50, v60, v61
    v_cvt_pk_bf16_f32 v51, v62, v63
    ds_read_b128 a[228:231], v252 offset:15360
    v_mfma_f32_16x16x32_bf16 v[112:115], a[152:155], a[140:143], v[112:115]
    buffer_store_dwordx4 v[48:51], v2, s[24:27], s55 offen sc1
    v_mul_f32 v3, v13, v13
    v_mfma_f32_16x16x32_bf16 a[32:35], a[148:151], a[128:131], a[32:35]
    ds_read_b64_tr_b16 a[178:179], v255 offset:29184
    s_add_u32 s55, s77, 344064
    v_accvgpr_read_b32 v32, a8
    v_mfma_f32_16x16x32_bf16 a[32:35], a[152:155], a[144:147], a[32:35]
    v_accvgpr_read_b32 v33, a9
    v_accvgpr_read_b32 v34, a10
    s_waitcnt lgkmcnt(12)
    v_mfma_f32_16x16x32_bf16 v[116:119], a[156:159], a[116:119], v[116:119]
    ds_read_b64_tr_b16 a[148:149], v6 offset:16384
    v_accvgpr_read_b32 v35, a11
    v_max_f32 v32, 0, v32
    v_mfma_f32_16x16x32_bf16 v[116:119], a[160:163], a[132:135], v[116:119]
    v_max_f32 v33, 0, v33
    v_mfma_f32_16x16x32_bf16 v[120:123], a[156:159], a[120:123], v[120:123]
    ds_read_b64_tr_b16 a[150:151], v6 offset:16896
    v_max_f32 v34, 0, v34
    v_max_f32 v35, 0, v35
    v_mfma_f32_16x16x32_bf16 v[120:123], a[160:163], a[136:139], v[120:123]
    v_mul_f32 v32, v3, v32
    v_mul_f32 v33, v3, v33
    v_mfma_f32_16x16x32_bf16 v[124:127], a[156:159], a[124:127], v[124:127]
    ds_read_b64_tr_b16 a[152:153], v6 offset:20480
    v_mul_f32 v34, v3, v34
    v_mul_f32 v35, v3, v35
    v_mfma_f32_16x16x32_bf16 v[124:127], a[160:163], a[140:143], v[124:127]
    v_accvgpr_read_b32 v20, a24
    v_accvgpr_read_b32 v21, a25
    v_mfma_f32_16x16x32_bf16 a[36:39], a[156:159], a[128:131], a[36:39]
    ds_read_b64_tr_b16 a[154:155], v6 offset:20992
    v_accvgpr_read_b32 v22, a26
    v_accvgpr_read_b32 v23, a27
    v_mfma_f32_16x16x32_bf16 a[36:39], a[160:163], a[144:147], a[36:39]
    v_mul_f32 v32, v20, v32
    v_mul_f32 v33, v21, v33
    s_waitcnt lgkmcnt(10)
    v_mfma_f32_16x16x32_bf16 v[148:151], a[164:167], a[116:119], v[148:151]
    ds_read_b64_tr_b16 a[156:157], v7 offset:16384
    v_mul_f32 v34, v22, v34
    v_mfma_f32_16x16x32_bf16 v[148:151], a[168:171], a[132:135], v[148:151]
    v_mul_f32 v35, v23, v35
    v_cvt_pk_bf16_f32 v32, v32, v33
    v_mfma_f32_16x16x32_bf16 v[152:155], a[164:167], a[120:123], v[152:155]
    ds_read_b64_tr_b16 a[158:159], v7 offset:16896
    v_cvt_pk_bf16_f32 v33, v34, v35
    v_accvgpr_read_b32 v72, a12
    v_mfma_f32_16x16x32_bf16 v[152:155], a[168:171], a[136:139], v[152:155]
    v_accvgpr_read_b32 v73, a13
    v_accvgpr_read_b32 v74, a14
    v_mfma_f32_16x16x32_bf16 v[156:159], a[164:167], a[124:127], v[156:159]
    ds_read_b64_tr_b16 a[160:161], v7 offset:20480
    v_accvgpr_read_b32 v75, a15
    v_max_f32 v72, 0, v72
    v_mfma_f32_16x16x32_bf16 v[156:159], a[168:171], a[140:143], v[156:159]
    v_max_f32 v73, 0, v73
    v_max_f32 v74, 0, v74
    v_mfma_f32_16x16x32_bf16 a[48:51], a[164:167], a[128:131], a[48:51]
    ds_read_b64_tr_b16 a[162:163], v7 offset:20992
    v_max_f32 v75, 0, v75
    v_mul_f32 v72, v3, v72
    v_mfma_f32_16x16x32_bf16 a[48:51], a[168:171], a[144:147], a[48:51]
    v_mul_f32 v73, v3, v73
    s_waitcnt lgkmcnt(8)
    v_mfma_f32_16x16x32_bf16 v[160:163], a[172:175], a[116:119], v[160:163]
    ds_read_b64_tr_b16 a[164:165], v6 offset:24576
    v_mul_f32 v74, v3, v74
    v_mul_f32 v75, v3, v75
    v_mfma_f32_16x16x32_bf16 v[160:163], a[176:179], a[132:135], v[160:163]
    v_accvgpr_read_b32 v64, a28
    v_accvgpr_read_b32 v65, a29
    v_mfma_f32_16x16x32_bf16 v[164:167], a[172:175], a[120:123], v[164:167]
    ds_read_b64_tr_b16 a[166:167], v6 offset:25088
    v_accvgpr_read_b32 v66, a30
    v_accvgpr_read_b32 v67, a31
    v_mfma_f32_16x16x32_bf16 v[164:167], a[176:179], a[136:139], v[164:167]
    v_mul_f32 v72, v64, v72
    v_mul_f32 v73, v65, v73
    v_mfma_f32_16x16x32_bf16 a[72:75], a[172:175], a[124:127], a[72:75]
    ds_read_b64_tr_b16 a[168:169], v6 offset:28672
    v_mul_f32 v74, v66, v74
    v_mul_f32 v75, v67, v75
    v_mfma_f32_16x16x32_bf16 a[72:75], a[176:179], a[140:143], a[72:75]
    v_cvt_pk_bf16_f32 v34, v72, v73
    v_cvt_pk_bf16_f32 v35, v74, v75
    v_mfma_f32_16x16x32_bf16 a[52:55], a[172:175], a[128:131], a[52:55]
    ds_read_b64_tr_b16 a[170:171], v6 offset:29184
    buffer_store_dwordx4 v[32:35], v2, s[24:27], s55 offen sc1
    v_mfma_f32_16x16x32_bf16 a[52:55], a[176:179], a[144:147], a[52:55]
    s_cmp_eq_u32 s70, 9
    s_cbranch_scc1 gemm1_kernel_q3
    s_waitcnt lgkmcnt(8)
    v_mfma_f32_16x16x32_bf16 v[128:131], a[148:151], a[84:87], v[128:131]
    ds_read_b64_tr_b16 a[172:173], v7 offset:24576
    s_add_u32 s77, s79, 64
    s_lshl_b32 s77, s77, 5
    v_mfma_f32_16x16x32_bf16 v[168:171], a[224:227], a[240:243], v[168:171]
    s_add_u32 s77, s77, 0
    v_mul_f32 v3, v10, v10
    v_mfma_f32_16x16x32_bf16 v[128:131], a[152:155], a[100:103], v[128:131]
    s_add_u32 s55, s77, 0
    v_max_f32 v104, 0, v104
    v_mfma_f32_16x16x32_bf16 v[172:175], a[224:227], a[244:247], v[172:175]
    v_max_f32 v105, 0, v105
    v_max_f32 v106, 0, v106
    v_mfma_f32_16x16x32_bf16 v[132:135], a[148:151], a[88:91], v[132:135]
    ds_read_b64_tr_b16 a[174:175], v7 offset:25088
    v_max_f32 v107, 0, v107
    v_mul_f32 v104, v3, v104
    v_mfma_f32_16x16x32_bf16 v[176:179], a[224:227], a[248:251], v[176:179]
    v_mul_f32 v105, v3, v105
    v_mul_f32 v106, v3, v106
    v_mfma_f32_16x16x32_bf16 v[132:135], a[152:155], a[104:107], v[132:135]
    v_mul_f32 v107, v3, v107
    v_mul_f32 v104, v148, v104
    v_mfma_f32_16x16x32_bf16 a[56:59], a[224:227], a[252:255], a[56:59]
    v_mul_f32 v105, v149, v105
    v_mfma_f32_16x16x32_bf16 v[136:139], a[148:151], a[92:95], v[136:139]
    ds_read_b64_tr_b16 a[176:177], v7 offset:28672
    v_mul_f32 v106, v150, v106
    v_mul_f32 v107, v151, v107
    v_mfma_f32_16x16x32_bf16 v[136:139], a[152:155], a[108:111], v[136:139]
    v_cvt_pk_bf16_f32 v104, v104, v105
    v_cvt_pk_bf16_f32 v105, v106, v107
    v_mfma_f32_16x16x32_bf16 a[40:43], a[148:151], a[96:99], a[40:43]
    ds_read_b64_tr_b16 a[178:179], v7 offset:29184
    v_max_f32 v116, 0, v116
    v_max_f32 v117, 0, v117
    v_mfma_f32_16x16x32_bf16 a[40:43], a[152:155], a[112:115], a[40:43]
    v_max_f32 v118, 0, v118
    v_max_f32 v119, 0, v119
    s_waitcnt lgkmcnt(8)
    v_mfma_f32_16x16x32_bf16 v[140:143], a[156:159], a[84:87], v[140:143]
    v_subrev_u32 v254, 81920, v6
    v_mul_f32 v116, v3, v116
    v_mul_f32 v117, v3, v117
    v_mfma_f32_16x16x32_bf16 v[180:183], a[228:231], a[240:243], v[180:183]
    v_mul_f32 v118, v3, v118
    v_mul_f32 v119, v3, v119
    v_mfma_f32_16x16x32_bf16 v[140:143], a[160:163], a[100:103], v[140:143]
    v_subrev_u32 v255, 81920, v7
    v_mul_f32 v116, v160, v116
    v_mfma_f32_16x16x32_bf16 v[184:187], a[228:231], a[244:247], v[184:187]
    v_mul_f32 v117, v161, v117
    v_mul_f32 v118, v162, v118
    v_mfma_f32_16x16x32_bf16 v[144:147], a[156:159], a[88:91], v[144:147]
    ds_read_b64_tr_b16 a[148:149], v254 offset:16384
    v_mul_f32 v119, v163, v119
    v_cvt_pk_bf16_f32 v106, v116, v117
    v_mfma_f32_16x16x32_bf16 a[76:79], a[228:231], a[248:251], a[76:79]
    v_cvt_pk_bf16_f32 v107, v118, v119
    buffer_store_dwordx4 v[104:107], v2, s[24:27], s55 offen sc1
    v_mfma_f32_16x16x32_bf16 v[144:147], a[160:163], a[104:107], v[144:147]
    ds_read_b64_tr_b16 a[150:151], v254 offset:16896
    v_mul_f32 v3, v11, v11
    s_add_u32 s55, s77, 114688
    v_mfma_f32_16x16x32_bf16 a[60:63], a[228:231], a[252:255], a[60:63]
    v_max_f32 v108, 0, v108
    v_max_f32 v109, 0, v109
    v_mfma_f32_16x16x32_bf16 a[80:83], a[156:159], a[92:95], a[80:83]
    ds_read_b64_tr_b16 a[152:153], v254 offset:20480
    v_max_f32 v110, 0, v110
    v_max_f32 v111, 0, v111
    v_mfma_f32_16x16x32_bf16 a[80:83], a[160:163], a[108:111], a[80:83]
    v_mul_f32 v108, v3, v108
    v_mfma_f32_16x16x32_bf16 a[44:47], a[156:159], a[96:99], a[44:47]
    ds_read_b64_tr_b16 a[154:155], v254 offset:20992
    v_mul_f32 v109, v3, v109
    v_mul_f32 v110, v3, v110
    v_mfma_f32_16x16x32_bf16 a[44:47], a[160:163], a[112:115], a[44:47]
    v_mul_f32 v111, v3, v111
    v_mul_f32 v108, v152, v108
    s_waitcnt lgkmcnt(8)
    v_mfma_f32_16x16x32_bf16 v[168:171], a[164:167], a[84:87], v[168:171]
    ds_read_b64_tr_b16 a[156:157], v255 offset:16384
    v_mul_f32 v109, v153, v109
    v_mul_f32 v110, v154, v110
    v_mfma_f32_16x16x32_bf16 v[128:131], a[216:219], a[240:243], v[128:131]
    v_mul_f32 v111, v155, v111
    v_cvt_pk_bf16_f32 v108, v108, v109
    v_mfma_f32_16x16x32_bf16 v[168:171], a[168:171], a[100:103], v[168:171]
    v_cvt_pk_bf16_f32 v109, v110, v111
    v_max_f32 v120, 0, v120
    v_mfma_f32_16x16x32_bf16 v[132:135], a[216:219], a[244:247], v[132:135]
    v_max_f32 v121, 0, v121
    v_max_f32 v122, 0, v122
    v_mfma_f32_16x16x32_bf16 v[172:175], a[164:167], a[88:91], v[172:175]
    ds_read_b64_tr_b16 a[158:159], v255 offset:16896
    v_max_f32 v123, 0, v123
    v_mfma_f32_16x16x32_bf16 v[136:139], a[216:219], a[248:251], v[136:139]
    v_mul_f32 v120, v3, v120
    v_mul_f32 v121, v3, v121
    v_mfma_f32_16x16x32_bf16 v[172:175], a[168:171], a[104:107], v[172:175]
    v_mul_f32 v122, v3, v122
    v_mul_f32 v123, v3, v123
    v_mfma_f32_16x16x32_bf16 a[40:43], a[216:219], a[252:255], a[40:43]
    v_mul_f32 v120, v164, v120
    v_mul_f32 v121, v165, v121
    v_mfma_f32_16x16x32_bf16 v[176:179], a[164:167], a[92:95], v[176:179]
    ds_read_b64_tr_b16 a[160:161], v255 offset:20480
    v_mul_f32 v122, v166, v122
    v_mul_f32 v123, v167, v123
    v_mfma_f32_16x16x32_bf16 v[176:179], a[168:171], a[108:111], v[176:179]
    v_cvt_pk_bf16_f32 v110, v120, v121
    v_cvt_pk_bf16_f32 v111, v122, v123
    v_mfma_f32_16x16x32_bf16 a[56:59], a[164:167], a[96:99], a[56:59]
    ds_read_b64_tr_b16 a[162:163], v255 offset:20992
    buffer_store_dwordx4 v[108:111], v2, s[24:27], s55 offen sc1
    v_mul_f32 v3, v12, v12
    v_mfma_f32_16x16x32_bf16 a[56:59], a[168:171], a[112:115], a[56:59]
    s_add_u32 s55, s77, 229376
    s_waitcnt lgkmcnt(8)
    v_mfma_f32_16x16x32_bf16 v[180:183], a[172:175], a[84:87], v[180:183]
    ds_read_b64_tr_b16 a[164:165], v254 offset:24576
    v_max_f32 v112, 0, v112
    v_max_f32 v113, 0, v113
    ds_read_b128 a[200:203], v252 offset:16384
    v_mfma_f32_16x16x32_bf16 v[140:143], a[220:223], a[240:243], v[140:143]
    v_max_f32 v114, 0, v114
    v_max_f32 v115, 0, v115
    v_mfma_f32_16x16x32_bf16 v[180:183], a[176:179], a[100:103], v[180:183]
    v_mul_f32 v112, v3, v112
    v_mul_f32 v113, v3, v113
    v_mfma_f32_16x16x32_bf16 v[144:147], a[220:223], a[244:247], v[144:147]
    v_mul_f32 v114, v3, v114
    v_mul_f32 v115, v3, v115
    v_mfma_f32_16x16x32_bf16 v[184:187], a[172:175], a[88:91], v[184:187]
    ds_read_b64_tr_b16 a[166:167], v254 offset:25088
    v_mul_f32 v112, v156, v112
    v_mul_f32 v113, v157, v113
    v_mfma_f32_16x16x32_bf16 a[80:83], a[220:223], a[248:251], a[80:83]
    v_mul_f32 v114, v158, v114
    v_mul_f32 v115, v159, v115
    v_mfma_f32_16x16x32_bf16 v[184:187], a[176:179], a[104:107], v[184:187]
    v_cvt_pk_bf16_f32 v112, v112, v113
    v_cvt_pk_bf16_f32 v113, v114, v115
    v_mfma_f32_16x16x32_bf16 a[44:47], a[220:223], a[252:255], a[44:47]
    v_max_f32 v124, 0, v124
    v_mfma_f32_16x16x32_bf16 a[76:79], a[172:175], a[92:95], a[76:79]
    ds_read_b64_tr_b16 a[168:169], v254 offset:28672
    v_max_f32 v125, 0, v125
    v_max_f32 v126, 0, v126
    ds_read_b128 a[204:207], v252 offset:17408
    v_mfma_f32_16x16x32_bf16 a[76:79], a[176:179], a[108:111], a[76:79]
    v_max_f32 v127, 0, v127
    v_mul_f32 v124, v3, v124
    v_mfma_f32_16x16x32_bf16 a[60:63], a[172:175], a[96:99], a[60:63]
    ds_read_b64_tr_b16 a[170:171], v254 offset:29184
    v_mul_f32 v125, v3, v125
    v_mul_f32 v126, v3, v126
    v_mfma_f32_16x16x32_bf16 a[60:63], a[176:179], a[112:115], a[60:63]
    v_mul_f32 v127, v3, v127
    v_accvgpr_read_b32 v16, a72
    s_waitcnt lgkmcnt(10)
    v_mfma_f32_16x16x32_bf16 v[128:131], a[148:151], a[116:119], v[128:131]
    ds_read_b64_tr_b16 a[172:173], v255 offset:24576
    v_accvgpr_read_b32 v17, a73
    v_accvgpr_read_b32 v18, a74
    ds_read_b128 a[208:211], v252 offset:18432
    v_mfma_f32_16x16x32_bf16 v[128:131], a[152:155], a[132:135], v[128:131]
    v_accvgpr_read_b32 v19, a75
    v_mul_f32 v124, v16, v124
    v_mfma_f32_16x16x32_bf16 v[132:135], a[148:151], a[120:123], v[132:135]
    ds_read_b64_tr_b16 a[174:175], v255 offset:25088
    v_mul_f32 v125, v17, v125
    v_mfma_f32_16x16x32_bf16 v[132:135], a[152:155], a[136:139], v[132:135]
    v_mul_f32 v126, v18, v126
    v_mul_f32 v127, v19, v127
    v_mfma_f32_16x16x32_bf16 v[136:139], a[148:151], a[124:127], v[136:139]
    ds_read_b64_tr_b16 a[176:177], v255 offset:28672
    v_cvt_pk_bf16_f32 v114, v124, v125
    v_cvt_pk_bf16_f32 v115, v126, v127
    ds_read_b128 a[212:215], v252 offset:19456
    v_mfma_f32_16x16x32_bf16 v[136:139], a[152:155], a[140:143], v[136:139]
    buffer_store_dwordx4 v[112:115], v2, s[24:27], s55 offen sc1
    v_mul_f32 v3, v13, v13
    v_mfma_f32_16x16x32_bf16 a[40:43], a[148:151], a[128:131], a[40:43]
    ds_read_b64_tr_b16 a[178:179], v255 offset:29184
    s_add_u32 s55, s77, 344064
    v_accvgpr_read_b32 v20, a32
    v_mfma_f32_16x16x32_bf16 a[40:43], a[152:155], a[144:147], a[40:43]
    v_accvgpr_read_b32 v21, a33
    v_accvgpr_read_b32 v22, a34
    s_waitcnt lgkmcnt(12)
    v_mfma_f32_16x16x32_bf16 v[140:143], a[156:159], a[116:119], v[140:143]
    ds_read_b64_tr_b16 a[148:149], v8 offset:0
    v_accvgpr_read_b32 v23, a35
    v_max_f32 v20, 0, v20
    v_mfma_f32_16x16x32_bf16 v[140:143], a[160:163], a[132:135], v[140:143]
    v_max_f32 v21, 0, v21
    v_mfma_f32_16x16x32_bf16 v[144:147], a[156:159], a[120:123], v[144:147]
    ds_read_b64_tr_b16 a[150:151], v8 offset:256
    v_max_f32 v22, 0, v22
    v_max_f32 v23, 0, v23
    v_mfma_f32_16x16x32_bf16 v[144:147], a[160:163], a[136:139], v[144:147]
    v_mul_f32 v20, v3, v20
    v_mul_f32 v21, v3, v21
    v_mfma_f32_16x16x32_bf16 a[80:83], a[156:159], a[124:127], a[80:83]
    ds_read_b64_tr_b16 a[152:153], v8 offset:4096
    v_mul_f32 v22, v3, v22
    v_mul_f32 v23, v3, v23
    v_mfma_f32_16x16x32_bf16 a[80:83], a[160:163], a[140:143], a[80:83]
    v_accvgpr_read_b32 v24, a48
    v_accvgpr_read_b32 v25, a49
    v_mfma_f32_16x16x32_bf16 a[44:47], a[156:159], a[128:131], a[44:47]
    ds_read_b64_tr_b16 a[154:155], v8 offset:4352
    v_accvgpr_read_b32 v26, a50
    v_accvgpr_read_b32 v27, a51
    v_mfma_f32_16x16x32_bf16 a[44:47], a[160:163], a[144:147], a[44:47]
    v_mul_f32 v20, v24, v20
    v_mul_f32 v21, v25, v21
    s_waitcnt lgkmcnt(10)
    v_mfma_f32_16x16x32_bf16 v[168:171], a[164:167], a[116:119], v[168:171]
    ds_read_b64_tr_b16 a[156:157], v9 offset:0
    v_mul_f32 v22, v26, v22
    v_mfma_f32_16x16x32_bf16 v[168:171], a[168:171], a[132:135], v[168:171]
    v_mul_f32 v23, v27, v23
    v_cvt_pk_bf16_f32 v20, v20, v21
    v_mfma_f32_16x16x32_bf16 v[172:175], a[164:167], a[120:123], v[172:175]
    ds_read_b64_tr_b16 a[158:159], v9 offset:256
    v_cvt_pk_bf16_f32 v21, v22, v23
    v_accvgpr_read_b32 v28, a36
    v_mfma_f32_16x16x32_bf16 v[172:175], a[168:171], a[136:139], v[172:175]
    v_accvgpr_read_b32 v29, a37
    v_accvgpr_read_b32 v30, a38
    v_mfma_f32_16x16x32_bf16 v[176:179], a[164:167], a[124:127], v[176:179]
    ds_read_b64_tr_b16 a[160:161], v9 offset:4096
    v_accvgpr_read_b32 v31, a39
    v_max_f32 v28, 0, v28
    v_mfma_f32_16x16x32_bf16 v[176:179], a[168:171], a[140:143], v[176:179]
    v_max_f32 v29, 0, v29
    v_max_f32 v30, 0, v30
    v_mfma_f32_16x16x32_bf16 a[56:59], a[164:167], a[128:131], a[56:59]
    ds_read_b64_tr_b16 a[162:163], v9 offset:4352
    v_max_f32 v31, 0, v31
    v_mul_f32 v28, v3, v28
    v_mfma_f32_16x16x32_bf16 a[56:59], a[168:171], a[144:147], a[56:59]
    v_mul_f32 v29, v3, v29
    s_waitcnt lgkmcnt(8)
    v_mfma_f32_16x16x32_bf16 v[180:183], a[172:175], a[116:119], v[180:183]
    ds_read_b64_tr_b16 a[164:165], v8 offset:1024
    v_mul_f32 v30, v3, v30
    v_mul_f32 v31, v3, v31
    v_mfma_f32_16x16x32_bf16 v[180:183], a[176:179], a[132:135], v[180:183]
    v_accvgpr_read_b32 v32, a52
    v_accvgpr_read_b32 v33, a53
    v_mfma_f32_16x16x32_bf16 v[184:187], a[172:175], a[120:123], v[184:187]
    ds_read_b64_tr_b16 a[166:167], v8 offset:1280
    v_accvgpr_read_b32 v34, a54
    v_accvgpr_read_b32 v35, a55
    v_mfma_f32_16x16x32_bf16 v[184:187], a[176:179], a[136:139], v[184:187]
    v_mul_f32 v28, v32, v28
    v_mul_f32 v29, v33, v29
    v_mfma_f32_16x16x32_bf16 a[76:79], a[172:175], a[124:127], a[76:79]
    ds_read_b64_tr_b16 a[168:169], v8 offset:5120
    v_mul_f32 v30, v34, v30
    v_mul_f32 v31, v35, v31
    v_mfma_f32_16x16x32_bf16 a[76:79], a[176:179], a[140:143], a[76:79]
    v_cvt_pk_bf16_f32 v22, v28, v29
    v_cvt_pk_bf16_f32 v23, v30, v31
    v_mfma_f32_16x16x32_bf16 a[60:63], a[172:175], a[128:131], a[60:63]
    ds_read_b64_tr_b16 a[170:171], v8 offset:5376
    buffer_store_dwordx4 v[20:23], v2, s[24:27], s55 offen sc1
    v_mfma_f32_16x16x32_bf16 a[60:63], a[176:179], a[144:147], a[60:63]
    s_waitcnt lgkmcnt(8)
    v_mfma_f32_16x16x32_bf16 v[188:191], a[148:151], a[84:87], v[188:191]
    ds_read_b64_tr_b16 a[172:173], v9 offset:1024
    s_add_u32 s77, s79, 64
    s_lshl_b32 s77, s77, 5
    v_mfma_f32_16x16x32_bf16 v[220:223], a[208:211], a[240:243], v[220:223]
    s_add_u32 s77, s77, 1024
    v_mul_f32 v3, v10, v10
    v_mfma_f32_16x16x32_bf16 v[188:191], a[152:155], a[100:103], v[188:191]
    s_add_u32 s55, s77, 0
    v_max_f32 v128, 0, v128
    v_mfma_f32_16x16x32_bf16 v[224:227], a[208:211], a[244:247], v[224:227]
    v_max_f32 v129, 0, v129
    v_max_f32 v130, 0, v130
    v_mfma_f32_16x16x32_bf16 v[192:195], a[148:151], a[88:91], v[192:195]
    ds_read_b64_tr_b16 a[174:175], v9 offset:1280
    v_max_f32 v131, 0, v131
    v_mul_f32 v128, v3, v128
    v_mfma_f32_16x16x32_bf16 v[228:231], a[208:211], a[248:251], v[228:231]
    v_mul_f32 v129, v3, v129
    v_mul_f32 v130, v3, v130
    v_mfma_f32_16x16x32_bf16 v[192:195], a[152:155], a[104:107], v[192:195]
    v_mul_f32 v131, v3, v131
    v_mul_f32 v128, v168, v128
    v_mfma_f32_16x16x32_bf16 v[232:235], a[208:211], a[252:255], v[232:235]
    v_mul_f32 v129, v169, v129
    v_mul_f32 v130, v170, v130
    v_mfma_f32_16x16x32_bf16 v[196:199], a[148:151], a[92:95], v[196:199]
    ds_read_b64_tr_b16 a[176:177], v9 offset:5120
    v_mul_f32 v131, v171, v131
    v_cvt_pk_bf16_f32 v128, v128, v129
    v_mfma_f32_16x16x32_bf16 v[196:199], a[152:155], a[108:111], v[196:199]
    v_cvt_pk_bf16_f32 v129, v130, v131
    v_max_f32 v140, 0, v140
    v_mfma_f32_16x16x32_bf16 v[200:203], a[148:151], a[96:99], v[200:203]
    ds_read_b64_tr_b16 a[178:179], v9 offset:5376
    v_max_f32 v141, 0, v141
    v_max_f32 v142, 0, v142
    v_mfma_f32_16x16x32_bf16 v[200:203], a[152:155], a[112:115], v[200:203]
    v_max_f32 v143, 0, v143
    s_waitcnt lgkmcnt(8)
    v_mfma_f32_16x16x32_bf16 v[204:207], a[156:159], a[84:87], v[204:207]
    v_subrev_u32 v254, 81920, v8
    v_mul_f32 v140, v3, v140
    v_mul_f32 v141, v3, v141
    v_mfma_f32_16x16x32_bf16 v[236:239], a[212:215], a[240:243], v[236:239]
    v_mul_f32 v142, v3, v142
    v_mul_f32 v143, v3, v143
    v_mfma_f32_16x16x32_bf16 v[204:207], a[160:163], a[100:103], v[204:207]
    v_subrev_u32 v255, 81920, v9
    v_mul_f32 v140, v180, v140
    v_mul_f32 v141, v181, v141
    v_mfma_f32_16x16x32_bf16 v[240:243], a[212:215], a[244:247], v[240:243]
    v_mul_f32 v142, v182, v142
    v_mul_f32 v143, v183, v143
    v_mfma_f32_16x16x32_bf16 v[208:211], a[156:159], a[88:91], v[208:211]
    ds_read_b64_tr_b16 a[148:149], v254 offset:0
    v_cvt_pk_bf16_f32 v130, v140, v141
    v_cvt_pk_bf16_f32 v131, v142, v143
    v_mfma_f32_16x16x32_bf16 v[244:247], a[212:215], a[248:251], v[244:247]
    buffer_store_dwordx4 v[128:131], v2, s[24:27], s55 offen sc1
    v_mul_f32 v3, v11, v11
    v_mfma_f32_16x16x32_bf16 v[208:211], a[160:163], a[104:107], v[208:211]
    ds_read_b64_tr_b16 a[150:151], v254 offset:256
    s_add_u32 s55, s77, 114688
    v_max_f32 v132, 0, v132
    v_mfma_f32_16x16x32_bf16 v[248:251], a[212:215], a[252:255], v[248:251]
    v_max_f32 v133, 0, v133
    v_max_f32 v134, 0, v134
    v_mfma_f32_16x16x32_bf16 v[212:215], a[156:159], a[92:95], v[212:215]
    ds_read_b64_tr_b16 a[152:153], v254 offset:4096
    v_max_f32 v135, 0, v135
    v_mul_f32 v132, v3, v132
    v_mfma_f32_16x16x32_bf16 v[212:215], a[160:163], a[108:111], v[212:215]
    v_mul_f32 v133, v3, v133
    v_mul_f32 v134, v3, v134
    v_mfma_f32_16x16x32_bf16 v[216:219], a[156:159], a[96:99], v[216:219]
    ds_read_b64_tr_b16 a[154:155], v254 offset:4352
    v_mul_f32 v135, v3, v135
    v_mfma_f32_16x16x32_bf16 v[216:219], a[160:163], a[112:115], v[216:219]
    v_mul_f32 v132, v172, v132
    v_mul_f32 v133, v173, v133
    s_waitcnt lgkmcnt(8)
    v_mfma_f32_16x16x32_bf16 v[220:223], a[164:167], a[84:87], v[220:223]
    ds_read_b64_tr_b16 a[156:157], v255 offset:0
    v_mul_f32 v134, v174, v134
    v_mul_f32 v135, v175, v135
    v_mfma_f32_16x16x32_bf16 v[188:191], a[200:203], a[240:243], v[188:191]
    v_cvt_pk_bf16_f32 v132, v132, v133
    v_cvt_pk_bf16_f32 v133, v134, v135
    v_mfma_f32_16x16x32_bf16 v[220:223], a[168:171], a[100:103], v[220:223]
    v_max_f32 v144, 0, v144
    v_max_f32 v145, 0, v145
    v_mfma_f32_16x16x32_bf16 v[192:195], a[200:203], a[244:247], v[192:195]
    v_max_f32 v146, 0, v146
    v_max_f32 v147, 0, v147
    v_mfma_f32_16x16x32_bf16 v[224:227], a[164:167], a[88:91], v[224:227]
    ds_read_b64_tr_b16 a[158:159], v255 offset:256
    v_mul_f32 v144, v3, v144
    v_mul_f32 v145, v3, v145
    v_mfma_f32_16x16x32_bf16 v[196:199], a[200:203], a[248:251], v[196:199]
    v_mul_f32 v146, v3, v146
    v_mul_f32 v147, v3, v147
    v_mfma_f32_16x16x32_bf16 v[224:227], a[168:171], a[104:107], v[224:227]
    v_mul_f32 v144, v184, v144
    v_mul_f32 v145, v185, v145
    v_mfma_f32_16x16x32_bf16 v[200:203], a[200:203], a[252:255], v[200:203]
    v_mul_f32 v146, v186, v146
    v_mul_f32 v147, v187, v147
    v_mfma_f32_16x16x32_bf16 v[228:231], a[164:167], a[92:95], v[228:231]
    ds_read_b64_tr_b16 a[160:161], v255 offset:4096
    v_cvt_pk_bf16_f32 v134, v144, v145
    v_cvt_pk_bf16_f32 v135, v146, v147
    v_mfma_f32_16x16x32_bf16 v[228:231], a[168:171], a[108:111], v[228:231]
    buffer_store_dwordx4 v[132:135], v2, s[24:27], s55 offen sc1
    v_mfma_f32_16x16x32_bf16 v[232:235], a[164:167], a[96:99], v[232:235]
    ds_read_b64_tr_b16 a[162:163], v255 offset:4352
    v_mul_f32 v3, v12, v12
    s_add_u32 s55, s77, 229376
    v_mfma_f32_16x16x32_bf16 v[232:235], a[168:171], a[112:115], v[232:235]
    v_max_f32 v136, 0, v136
    v_max_f32 v137, 0, v137
    s_waitcnt lgkmcnt(8)
    v_mfma_f32_16x16x32_bf16 v[236:239], a[172:175], a[84:87], v[236:239]
    ds_read_b64_tr_b16 a[164:165], v254 offset:1024
    v_max_f32 v138, 0, v138
    v_max_f32 v139, 0, v139
    v_mfma_f32_16x16x32_bf16 v[204:207], a[204:207], a[240:243], v[204:207]
    v_mul_f32 v136, v3, v136
    v_mul_f32 v137, v3, v137
    v_mfma_f32_16x16x32_bf16 v[236:239], a[176:179], a[100:103], v[236:239]
    v_mul_f32 v138, v3, v138
    v_mul_f32 v139, v3, v139
    v_mfma_f32_16x16x32_bf16 v[208:211], a[204:207], a[244:247], v[208:211]
    v_mul_f32 v136, v176, v136
    v_mul_f32 v137, v177, v137
    v_mfma_f32_16x16x32_bf16 v[240:243], a[172:175], a[88:91], v[240:243]
    ds_read_b64_tr_b16 a[166:167], v254 offset:1280
    v_mul_f32 v138, v178, v138
    v_mul_f32 v139, v179, v139
    v_mfma_f32_16x16x32_bf16 v[212:215], a[204:207], a[248:251], v[212:215]
    v_cvt_pk_bf16_f32 v136, v136, v137
    v_cvt_pk_bf16_f32 v137, v138, v139
    v_mfma_f32_16x16x32_bf16 v[240:243], a[176:179], a[104:107], v[240:243]
    v_accvgpr_read_b32 v36, a80
    v_accvgpr_read_b32 v37, a81
    v_mfma_f32_16x16x32_bf16 v[216:219], a[204:207], a[252:255], v[216:219]
    v_accvgpr_read_b32 v38, a82
    v_accvgpr_read_b32 v39, a83
    v_mfma_f32_16x16x32_bf16 v[244:247], a[172:175], a[92:95], v[244:247]
    ds_read_b64_tr_b16 a[168:169], v254 offset:5120
    v_max_f32 v36, 0, v36
    v_max_f32 v37, 0, v37
    v_mfma_f32_16x16x32_bf16 v[244:247], a[176:179], a[108:111], v[244:247]
    v_max_f32 v38, 0, v38
    v_mfma_f32_16x16x32_bf16 v[248:251], a[172:175], a[96:99], v[248:251]
    ds_read_b64_tr_b16 a[170:171], v254 offset:5376
    v_max_f32 v39, 0, v39
    v_mul_f32 v36, v3, v36
    v_mfma_f32_16x16x32_bf16 v[248:251], a[176:179], a[112:115], v[248:251]
    v_mul_f32 v37, v3, v37
    v_mul_f32 v38, v3, v38
    s_waitcnt lgkmcnt(8)
    v_mfma_f32_16x16x32_bf16 v[188:191], a[148:151], a[116:119], v[188:191]
    ds_read_b64_tr_b16 a[172:173], v255 offset:1024
    v_mul_f32 v39, v3, v39
    v_accvgpr_read_b32 v64, a76
    v_mfma_f32_16x16x32_bf16 v[188:191], a[152:155], a[132:135], v[188:191]
    v_accvgpr_read_b32 v65, a77
    v_accvgpr_read_b32 v66, a78
    v_mfma_f32_16x16x32_bf16 v[192:195], a[148:151], a[120:123], v[192:195]
    ds_read_b64_tr_b16 a[174:175], v255 offset:1280
    v_accvgpr_read_b32 v67, a79
    v_mul_f32 v36, v64, v36
    v_mfma_f32_16x16x32_bf16 v[192:195], a[152:155], a[136:139], v[192:195]
    v_mul_f32 v37, v65, v37
    v_mul_f32 v38, v66, v38
    v_mfma_f32_16x16x32_bf16 v[196:199], a[148:151], a[124:127], v[196:199]
    ds_read_b64_tr_b16 a[176:177], v255 offset:5120
    v_mul_f32 v39, v67, v39
    v_cvt_pk_bf16_f32 v138, v36, v37
    v_mfma_f32_16x16x32_bf16 v[196:199], a[152:155], a[140:143], v[196:199]
    v_cvt_pk_bf16_f32 v139, v38, v39
    buffer_store_dwordx4 v[136:139], v2, s[24:27], s55 offen sc1
    v_mfma_f32_16x16x32_bf16 v[200:203], a[148:151], a[128:131], v[200:203]
    ds_read_b64_tr_b16 a[178:179], v255 offset:5376
    v_mul_f32 v3, v13, v13
    s_add_u32 s55, s77, 344064
    v_mfma_f32_16x16x32_bf16 v[200:203], a[152:155], a[144:147], v[200:203]
    v_accvgpr_read_b32 v68, a40
    v_accvgpr_read_b32 v69, a41
    s_waitcnt lgkmcnt(8)
    v_mfma_f32_16x16x32_bf16 v[204:207], a[156:159], a[116:119], v[204:207]
    v_accvgpr_read_b32 v70, a42
    v_mfma_f32_16x16x32_bf16 v[204:207], a[160:163], a[132:135], v[204:207]
    v_accvgpr_read_b32 v71, a43
    v_max_f32 v68, 0, v68
    v_mfma_f32_16x16x32_bf16 v[208:211], a[156:159], a[120:123], v[208:211]
    v_max_f32 v69, 0, v69
    v_max_f32 v70, 0, v70
    v_mfma_f32_16x16x32_bf16 v[208:211], a[160:163], a[136:139], v[208:211]
    v_max_f32 v71, 0, v71
    v_mul_f32 v68, v3, v68
    v_mfma_f32_16x16x32_bf16 v[212:215], a[156:159], a[124:127], v[212:215]
    v_mul_f32 v69, v3, v69
    v_mul_f32 v70, v3, v70
    v_mfma_f32_16x16x32_bf16 v[212:215], a[160:163], a[140:143], v[212:215]
    v_mul_f32 v71, v3, v71
    v_accvgpr_read_b32 v72, a56
    v_mfma_f32_16x16x32_bf16 v[216:219], a[156:159], a[128:131], v[216:219]
    v_accvgpr_read_b32 v73, a57
    v_accvgpr_read_b32 v74, a58
    v_mfma_f32_16x16x32_bf16 v[216:219], a[160:163], a[144:147], v[216:219]
    v_accvgpr_read_b32 v75, a59
    v_mul_f32 v68, v72, v68
    s_waitcnt lgkmcnt(4)
    v_mfma_f32_16x16x32_bf16 v[220:223], a[164:167], a[116:119], v[220:223]
    v_mul_f32 v69, v73, v69
    v_mul_f32 v70, v74, v70
    v_mfma_f32_16x16x32_bf16 v[220:223], a[168:171], a[132:135], v[220:223]
    v_mul_f32 v71, v75, v71
    v_cvt_pk_bf16_f32 v68, v68, v69
    v_mfma_f32_16x16x32_bf16 v[224:227], a[164:167], a[120:123], v[224:227]
    v_cvt_pk_bf16_f32 v69, v70, v71
    v_accvgpr_read_b32 v76, a44
    v_mfma_f32_16x16x32_bf16 v[224:227], a[168:171], a[136:139], v[224:227]
    v_accvgpr_read_b32 v77, a45
    v_mfma_f32_16x16x32_bf16 v[228:231], a[164:167], a[124:127], v[228:231]
    v_accvgpr_read_b32 v78, a46
    v_accvgpr_read_b32 v79, a47
    v_mfma_f32_16x16x32_bf16 v[228:231], a[168:171], a[140:143], v[228:231]
    v_max_f32 v76, 0, v76
    v_max_f32 v77, 0, v77
    v_mfma_f32_16x16x32_bf16 v[232:235], a[164:167], a[128:131], v[232:235]
    v_max_f32 v78, 0, v78
    v_max_f32 v79, 0, v79
    v_mfma_f32_16x16x32_bf16 v[232:235], a[168:171], a[144:147], v[232:235]
    v_mul_f32 v76, v3, v76
    v_mul_f32 v77, v3, v77
    s_waitcnt lgkmcnt(0)
    v_mfma_f32_16x16x32_bf16 v[236:239], a[172:175], a[116:119], v[236:239]
    v_mul_f32 v78, v3, v78
    v_mul_f32 v79, v3, v79
    v_mfma_f32_16x16x32_bf16 v[236:239], a[176:179], a[132:135], v[236:239]
    v_accvgpr_read_b32 v80, a60
    v_accvgpr_read_b32 v81, a61
    v_mfma_f32_16x16x32_bf16 v[240:243], a[172:175], a[120:123], v[240:243]
    v_accvgpr_read_b32 v82, a62
    v_accvgpr_read_b32 v83, a63
    v_mfma_f32_16x16x32_bf16 v[240:243], a[176:179], a[136:139], v[240:243]
    v_mul_f32 v76, v80, v76
    v_mul_f32 v77, v81, v77
    v_mfma_f32_16x16x32_bf16 v[244:247], a[172:175], a[124:127], v[244:247]
    v_mul_f32 v78, v82, v78
    v_mul_f32 v79, v83, v79
    v_mfma_f32_16x16x32_bf16 v[244:247], a[176:179], a[140:143], v[244:247]
    v_cvt_pk_bf16_f32 v70, v76, v77
    v_cvt_pk_bf16_f32 v71, v78, v79
    v_mfma_f32_16x16x32_bf16 v[248:251], a[172:175], a[128:131], v[248:251]
    buffer_store_dwordx4 v[68:71], v2, s[24:27], s55 offen sc1
    v_mfma_f32_16x16x32_bf16 v[248:251], a[176:179], a[144:147], v[248:251]
    s_lshl_b32 s77, s80, 5
    v_mul_f32 v3, v10, v10
    s_add_u32 s55, s77, 0
    v_max_f32 v188, 0, v188
    v_max_f32 v189, 0, v189
    v_max_f32 v190, 0, v190
    v_max_f32 v191, 0, v191
    v_mul_f32 v188, v3, v188
    v_mul_f32 v189, v3, v189
    v_mul_f32 v190, v3, v190
    v_mul_f32 v191, v3, v191
    v_mul_f32 v188, v220, v188
    v_mul_f32 v189, v221, v189
    v_mul_f32 v190, v222, v190
    v_mul_f32 v191, v223, v191
    v_cvt_pk_bf16_f32 v188, v188, v189
    v_cvt_pk_bf16_f32 v189, v190, v191
    v_max_f32 v204, 0, v204
    v_max_f32 v205, 0, v205
    v_max_f32 v206, 0, v206
    v_max_f32 v207, 0, v207
    v_mul_f32 v204, v3, v204
    v_mul_f32 v205, v3, v205
    v_mul_f32 v206, v3, v206
    v_mul_f32 v207, v3, v207
    v_mul_f32 v204, v236, v204
    v_mul_f32 v205, v237, v205
    v_mul_f32 v206, v238, v206
    v_mul_f32 v207, v239, v207
    v_cvt_pk_bf16_f32 v190, v204, v205
    v_cvt_pk_bf16_f32 v191, v206, v207
    buffer_store_dwordx4 v[188:191], v2, s[24:27], s55 offen sc1
    v_mul_f32 v3, v11, v11
    s_add_u32 s55, s77, 114688
    v_max_f32 v192, 0, v192
    v_max_f32 v193, 0, v193
    v_max_f32 v194, 0, v194
    v_max_f32 v195, 0, v195
    v_mul_f32 v192, v3, v192
    v_mul_f32 v193, v3, v193
    v_mul_f32 v194, v3, v194
    v_mul_f32 v195, v3, v195
    v_mul_f32 v192, v224, v192
    v_mul_f32 v193, v225, v193
    v_mul_f32 v194, v226, v194
    v_mul_f32 v195, v227, v195
    v_cvt_pk_bf16_f32 v192, v192, v193
    v_cvt_pk_bf16_f32 v193, v194, v195
    v_max_f32 v208, 0, v208
    v_max_f32 v209, 0, v209
    v_max_f32 v210, 0, v210
    v_max_f32 v211, 0, v211
    v_mul_f32 v208, v3, v208
    v_mul_f32 v209, v3, v209
    v_mul_f32 v210, v3, v210
    v_mul_f32 v211, v3, v211
    v_mul_f32 v208, v240, v208
    v_mul_f32 v209, v241, v209
    v_mul_f32 v210, v242, v210
    v_mul_f32 v211, v243, v211
    v_cvt_pk_bf16_f32 v194, v208, v209
    v_cvt_pk_bf16_f32 v195, v210, v211
    buffer_store_dwordx4 v[192:195], v2, s[24:27], s55 offen sc1
    v_mul_f32 v3, v12, v12
    s_add_u32 s55, s77, 229376
    v_max_f32 v196, 0, v196
    v_max_f32 v197, 0, v197
    v_max_f32 v198, 0, v198
    v_max_f32 v199, 0, v199
    v_mul_f32 v196, v3, v196
    v_mul_f32 v197, v3, v197
    v_mul_f32 v198, v3, v198
    v_mul_f32 v199, v3, v199
    v_mul_f32 v196, v228, v196
    v_mul_f32 v197, v229, v197
    v_mul_f32 v198, v230, v198
    v_mul_f32 v199, v231, v199
    v_cvt_pk_bf16_f32 v196, v196, v197
    v_cvt_pk_bf16_f32 v197, v198, v199
    v_max_f32 v212, 0, v212
    v_max_f32 v213, 0, v213
    v_max_f32 v214, 0, v214
    v_max_f32 v215, 0, v215
    v_mul_f32 v212, v3, v212
    v_mul_f32 v213, v3, v213
    v_mul_f32 v214, v3, v214
    v_mul_f32 v215, v3, v215
    v_mul_f32 v212, v244, v212
    v_mul_f32 v213, v245, v213
    v_mul_f32 v214, v246, v214
    v_mul_f32 v215, v247, v215
    v_cvt_pk_bf16_f32 v198, v212, v213
    v_cvt_pk_bf16_f32 v199, v214, v215
    buffer_store_dwordx4 v[196:199], v2, s[24:27], s55 offen sc1
    v_mul_f32 v3, v13, v13
    s_add_u32 s55, s77, 344064
    v_max_f32 v200, 0, v200
    v_max_f32 v201, 0, v201
    v_max_f32 v202, 0, v202
    v_max_f32 v203, 0, v203
    v_mul_f32 v200, v3, v200
    v_mul_f32 v201, v3, v201
    v_mul_f32 v202, v3, v202
    v_mul_f32 v203, v3, v203
    v_mul_f32 v200, v232, v200
    v_mul_f32 v201, v233, v201
    v_mul_f32 v202, v234, v202
    v_mul_f32 v203, v235, v203
    v_cvt_pk_bf16_f32 v200, v200, v201
    v_cvt_pk_bf16_f32 v201, v202, v203
    v_max_f32 v216, 0, v216
    v_max_f32 v217, 0, v217
    v_max_f32 v218, 0, v218
    v_max_f32 v219, 0, v219
    v_mul_f32 v216, v3, v216
    v_mul_f32 v217, v3, v217
    v_mul_f32 v218, v3, v218
    v_mul_f32 v219, v3, v219
    v_mul_f32 v216, v248, v216
    v_mul_f32 v217, v249, v217
    v_mul_f32 v218, v250, v218
    v_mul_f32 v219, v251, v219
    v_cvt_pk_bf16_f32 v202, v216, v217
    v_cvt_pk_bf16_f32 v203, v218, v219
    buffer_store_dwordx4 v[200:203], v2, s[24:27], s55 offen sc1
    s_endpgm
.globl attn_out_kernel
.p2align 8
.type attn_out_kernel,@function
attn_out_kernel:
    s_cmp_ge_u32 s2, 256
    s_cbranch_scc1 attn_out_kernel_end
    s_load_dwordx2 s[4:5], s[0:1], 72
    s_load_dwordx4 s[68:71], s[0:1], 48
    s_load_dwordx2 s[72:73], s[0:1], 0
    s_load_dwordx2 s[44:45], s[0:1], 16
    v_lshrrev_b32 v1, 6, v0
    v_and_b32 v0, 63, v0
    s_nop 0
    v_readfirstlane_b32 s33, v1
    s_and_b32 s27, s2, 7
    s_lshl_b32 s25, s27, 2
    s_lshr_b32 s27, s2, 3
    s_and_b32 s28, s27, 3
    s_add_u32 s25, s25, s28
    s_lshr_b32 s26, s27, 2
    s_and_b32 s24, s33, 3
    s_waitcnt lgkmcnt(0)
    s_cmp_ge_u32 s33, 4
    s_cbranch_scc1 attn_out_kernel_down
    s_setprio 1
    s_lshl_b32 s27, s25, 17
    s_add_u32 s6, s4, 4194304
    s_addc_u32 s7, s5, 0
    s_add_u32 s6, s6, s27
    s_addc_u32 s7, s7, 0
    s_mov_b32 s8, s6
    s_and_b32 s9, s7, 0xffff
    s_mov_b32 s10, 131072
    s_mov_b32 s11, 0x20000
    s_add_u32 s6, s4, 33554432
    s_addc_u32 s7, s5, 0
    s_mov_b32 s20, s6
    s_and_b32 s21, s7, 0xffff
    s_mov_b32 s22, 4194304
    s_mov_b32 s23, 0x20000
    v_lshlrev_b32 v2, 4, v0
    s_lshl_b32 s27, s26, 14
    s_lshl_b32 s28, s24, 12
    s_add_u32 s27, s27, s28
    v_add_u32 v9, s27, v2
    buffer_load_dwordx4 v[128:131], v9, s[8:11], 0 offen offset:0
    buffer_load_dwordx4 v[132:135], v9, s[8:11], 0 offen offset:1024
    buffer_load_dwordx4 v[136:139], v9, s[8:11], 0 offen offset:2048
    buffer_load_dwordx4 v[140:143], v9, s[8:11], 0 offen offset:3072
    v_lshrrev_b32 v8, 4, v0
    v_lshlrev_b32 v4, 8, v8
    v_and_b32 v7, 1, v8
    v_lshl_add_u32 v4, v7, 7, v4
    v_bfe_u32 v7, v0, 1, 1
    v_lshl_add_u32 v4, v7, 6, v4
    v_bfe_u32 v7, v0, 2, 2
    v_lshl_add_u32 v4, v7, 4, v4
    v_and_b32 v7, 1, v0
    v_lshl_add_u32 v4, v7, 3, v4
    v_add_u32 v4, 8192, v4
    v_xor_b32 v3, 128, v4
    v_and_b32 v7, 7, v0
    v_mov_b32 v8, 0x3f803f80
    v_cmp_eq_u32 vcc, 0, v7
    v_cndmask_b32 v176, 0, v8, vcc
    v_mov_b32 v177, v176
    v_mov_b32 v178, v176
    v_mov_b32 v179, v176
    v_cmp_eq_u32 vcc, 4, v7
    v_cndmask_b32 v208, 0, v8, vcc
    v_mov_b32 v209, v208
    v_mov_b32 v210, v208
    v_mov_b32 v211, v208
    s_mov_b32 s29, 0x71800000
    s_mov_b32 s32, 0x42c40000
    v_mov_b32 v48, 0
    v_mov_b32 v49, 0
    v_mov_b32 v50, 0
    v_mov_b32 v51, 0
    v_mov_b32 v52, 0
    v_mov_b32 v53, 0
    v_mov_b32 v54, 0
    v_mov_b32 v55, 0
    v_mov_b32 v56, 0
    v_mov_b32 v57, 0
    v_mov_b32 v58, 0
    v_mov_b32 v59, 0
    v_mov_b32 v60, 0
    v_mov_b32 v61, 0
    v_mov_b32 v62, 0
    v_mov_b32 v63, 0
    v_mov_b32 v160, 0
    v_mov_b32 v161, 0
    v_mov_b32 v162, 0
    v_mov_b32 v163, 0
    v_mov_b32 v164, 0
    v_mov_b32 v165, 0
    v_mov_b32 v166, 0
    v_mov_b32 v167, 0
    v_mov_b32 v64, 0
    v_mov_b32 v65, 0
    v_mov_b32 v66, 0
    v_mov_b32 v67, 0
    v_mov_b32 v68, 0
    v_mov_b32 v69, 0
    v_mov_b32 v70, 0
    v_mov_b32 v71, 0
    v_mov_b32 v72, 0
    v_mov_b32 v73, 0
    v_mov_b32 v74, 0
    v_mov_b32 v75, 0
    v_mov_b32 v76, 0
    v_mov_b32 v77, 0
    v_mov_b32 v78, 0
    v_mov_b32 v79, 0
    v_mov_b32 v168, 0
    v_mov_b32 v169, 0
    v_mov_b32 v170, 0
    v_mov_b32 v171, 0
    v_mov_b32 v172, 0
    v_mov_b32 v173, 0
    v_mov_b32 v174, 0
    v_mov_b32 v175, 0
    v_mov_b32 v120, 0
    v_mov_b32 v152, 0
    v_mov_b32 v121, 0
    v_mov_b32 v153, 0
    v_mov_b32 v122, 0
    v_mov_b32 v154, 0
    v_mov_b32 v123, 0
    v_mov_b32 v155, 0
    v_mov_b32 v124, 0
    v_mov_b32 v156, 0
    v_mov_b32 v125, 0
    v_mov_b32 v157, 0
    v_mov_b32 v126, 0
    v_mov_b32 v158, 0
    v_mov_b32 v127, 0
    v_mov_b32 v159, 0
    s_waitcnt vmcnt(0)
    s_barrier
    ds_read_b128 v[144:147], v2 offset:0
    ds_read_b128 v[148:151], v2 offset:1024
    ds_read_b128 v[184:187], v2 offset:2048
    ds_read_b128 v[188:191], v2 offset:3072
    ds_read_b128 v[192:195], v2 offset:4096
    ds_read_b128 v[196:199], v2 offset:5120
    ds_read_b128 v[200:203], v2 offset:6144
    ds_read_b128 v[204:207], v2 offset:7168
    s_waitcnt lgkmcnt(6)
    v_mfma_f32_16x16x32_bf16 v[16:19], v[144:147], v[128:131], 0
    v_mfma_f32_16x16x32_bf16 v[24:27], v[144:147], v[132:135], 0
    v_mfma_f32_16x16x32_bf16 v[28:31], v[148:151], v[132:135], 0
    v_mfma_f32_16x16x32_bf16 v[20:23], v[148:151], v[128:131], 0
    v_mfma_f32_16x16x32_bf16 v[32:35], v[144:147], v[136:139], 0
    v_mfma_f32_16x16x32_bf16 v[40:43], v[144:147], v[140:143], 0
    v_mfma_f32_16x16x32_bf16 v[44:47], v[148:151], v[140:143], 0
    v_mfma_f32_16x16x32_bf16 v[36:39], v[148:151], v[136:139], 0
    s_waitcnt lgkmcnt(4)
    v_mfma_f32_16x16x32_bf16 v[80:83], v[184:187], v[128:131], 0
    v_mfma_f32_16x16x32_bf16 v[88:91], v[184:187], v[132:135], 0
    v_mfma_f32_16x16x32_bf16 v[92:95], v[188:191], v[132:135], 0
    v_mfma_f32_16x16x32_bf16 v[84:87], v[188:191], v[128:131], 0
    v_mfma_f32_16x16x32_bf16 v[96:99], v[184:187], v[136:139], 0
    v_mfma_f32_16x16x32_bf16 v[104:107], v[184:187], v[140:143], 0
    v_mfma_f32_16x16x32_bf16 v[108:111], v[188:191], v[140:143], 0
    v_mfma_f32_16x16x32_bf16 v[100:103], v[188:191], v[136:139], 0
    s_nop 4
    v_max3_f32 v180, v16, v17, v18
    v_max3_f32 v180, v180, v19, v20
    v_max3_f32 v180, v180, v21, v22
    v_max_f32 v180, v180, v23
    v_max3_f32 v182, v24, v25, v26
    v_max3_f32 v182, v182, v27, v28
    v_max3_f32 v182, v182, v29, v30
    v_max_f32 v182, v182, v31
    s_waitcnt lgkmcnt(2)
    v_mfma_f32_16x16x32_bf16 v[16:19], v[192:195], v[128:131], 0
    v_mfma_f32_16x16x32_bf16 v[24:27], v[192:195], v[132:135], 0
    v_mfma_f32_16x16x32_bf16 v[28:31], v[196:199], v[132:135], 0
    v_mfma_f32_16x16x32_bf16 v[20:23], v[196:199], v[128:131], 0
    v_max3_f32 v181, v32, v33, v34
    v_max3_f32 v181, v181, v35, v36
    v_max3_f32 v181, v181, v37, v38
    v_max_f32 v181, v181, v39
    v_max3_f32 v183, v40, v41, v42
    v_max3_f32 v183, v183, v43, v44
    v_max3_f32 v183, v183, v45, v46
    v_max_f32 v183, v183, v47
    v_mfma_f32_16x16x32_bf16 v[32:35], v[192:195], v[136:139], 0
    v_mfma_f32_16x16x32_bf16 v[40:43], v[192:195], v[140:143], 0
    v_mfma_f32_16x16x32_bf16 v[44:47], v[196:199], v[140:143], 0
    v_mfma_f32_16x16x32_bf16 v[36:39], v[196:199], v[136:139], 0
    v_max3_f32 v180, v180, v80, v81
    v_max3_f32 v180, v180, v82, v83
    v_max3_f32 v180, v180, v84, v85
    v_max3_f32 v180, v180, v86, v87
    v_max3_f32 v182, v182, v88, v89
    v_max3_f32 v182, v182, v90, v91
    v_max3_f32 v182, v182, v92, v93
    v_max3_f32 v182, v182, v94, v95
    s_waitcnt lgkmcnt(0)
    v_mfma_f32_16x16x32_bf16 v[80:83], v[200:203], v[128:131], 0
    v_mfma_f32_16x16x32_bf16 v[88:91], v[200:203], v[132:135], 0
    v_mfma_f32_16x16x32_bf16 v[92:95], v[204:207], v[132:135], 0
    v_mfma_f32_16x16x32_bf16 v[84:87], v[204:207], v[128:131], 0
    v_max3_f32 v181, v181, v96, v97
    v_max3_f32 v181, v181, v98, v99
    v_max3_f32 v181, v181, v100, v101
    v_max3_f32 v181, v181, v102, v103
    v_max3_f32 v183, v183, v104, v105
    v_max3_f32 v183, v183, v106, v107
    v_max3_f32 v183, v183, v108, v109
    v_max3_f32 v183, v183, v110, v111
    v_mfma_f32_16x16x32_bf16 v[96:99], v[200:203], v[136:139], 0
    v_mfma_f32_16x16x32_bf16 v[104:107], v[200:203], v[140:143], 0
    v_mfma_f32_16x16x32_bf16 v[108:111], v[204:207], v[140:143], 0
    v_mfma_f32_16x16x32_bf16 v[100:103], v[204:207], v[136:139], 0
    v_max3_f32 v180, v180, v16, v17
    v_max3_f32 v180, v180, v18, v19
    v_max3_f32 v180, v180, v20, v21
    v_max3_f32 v180, v180, v22, v23
    v_max3_f32 v182, v182, v24, v25
    v_max3_f32 v182, v182, v26, v27
    v_max3_f32 v182, v182, v28, v29
    v_max3_f32 v182, v182, v30, v31
    v_max3_f32 v180, v180, v80, v81
    v_max3_f32 v180, v180, v82, v83
    v_max3_f32 v180, v180, v84, v85
    v_max3_f32 v180, v180, v86, v87
    v_max3_f32 v182, v182, v88, v89
    v_max3_f32 v182, v182, v90, v91
    v_max3_f32 v182, v182, v92, v93
    v_max3_f32 v182, v182, v94, v95
    s_nop 1
    v_permlane16_swap_b32 v180, v182
    s_nop 1
    v_max_f32 v180, v180, v182
    v_mov_b32 v9, v180
    s_nop 1
    v_permlane32_swap_b32 v9, v180
    s_nop 1
    v_max_f32 v180, v180, v9
    v_add_f32 v180, s32, v180
    v_ceil_f32 v180, v180
    v_mov_b32 v7, v180
    v_mov_b32 v8, v7
    s_nop 1
    v_permlane16_swap_b32 v7, v8
    s_nop 1
    v_sub_f32 v80, 0, v7
    v_sub_f32 v84, 0, v8
    v_mov_b32 v81, v80
    v_mov_b32 v85, v84
    v_mov_b32 v82, v80
    v_mov_b32 v86, v84
    v_mov_b32 v83, v80
    v_mov_b32 v87, v84
    s_nop 1
    v_mfma_f32_16x16x32_bf16 v[16:19], v[144:147], v[128:131], v[80:83]
    v_mfma_f32_16x16x32_bf16 v[24:27], v[144:147], v[132:135], v[84:87]
    v_mfma_f32_16x16x32_bf16 v[28:31], v[148:151], v[132:135], v[84:87]
    v_mfma_f32_16x16x32_bf16 v[20:23], v[148:151], v[128:131], v[80:83]
    v_max3_f32 v181, v181, v32, v33
    v_max3_f32 v181, v181, v34, v35
    v_max3_f32 v181, v181, v36, v37
    v_max3_f32 v181, v181, v38, v39
    v_max3_f32 v183, v183, v40, v41
    v_max3_f32 v183, v183, v42, v43
    v_max3_f32 v183, v183, v44, v45
    v_max3_f32 v183, v183, v46, v47
    v_max3_f32 v181, v181, v96, v97
    v_max3_f32 v181, v181, v98, v99
    v_max3_f32 v181, v181, v100, v101
    v_max3_f32 v181, v181, v102, v103
    v_max3_f32 v183, v183, v104, v105
    v_max3_f32 v183, v183, v106, v107
    v_max3_f32 v183, v183, v108, v109
    v_max3_f32 v183, v183, v110, v111
    s_nop 1
    v_permlane16_swap_b32 v181, v183
    s_nop 1
    v_max_f32 v181, v181, v183
    v_mov_b32 v9, v181
    s_nop 1
    v_permlane32_swap_b32 v9, v181
    s_nop 1
    v_max_f32 v181, v181, v9
    v_add_f32 v181, s32, v181
    v_ceil_f32 v181, v181
    v_mov_b32 v7, v181
    v_mov_b32 v8, v7
    s_nop 1
    v_permlane16_swap_b32 v7, v8
    s_nop 1
    v_sub_f32 v96, 0, v7
    v_sub_f32 v100, 0, v8
    v_mov_b32 v97, v96
    v_mov_b32 v101, v100
    v_mov_b32 v98, v96
    v_mov_b32 v102, v100
    v_mov_b32 v99, v96
    v_mov_b32 v103, v100
    s_barrier
    s_mov_b32 s30, 16
attn_out_kernel_loop:
    v_mfma_f32_16x16x32_bf16 v[172:175], v[176:179], v[120:123], v[168:171]
    v_exp_f32 v16, v16
    v_mfma_f32_16x16x32_bf16 v[172:175], v[208:211], v[124:127], v[172:175]
    v_exp_f32 v17, v17
    v_exp_f32 v18, v18
    v_mfma_f32_16x16x32_bf16 v[32:35], v[144:147], v[136:139], v[96:99]
    v_exp_f32 v19, v19
    v_mfma_f32_16x16x32_bf16 v[40:43], v[144:147], v[140:143], v[100:103]
    v_exp_f32 v20, v20
    v_exp_f32 v21, v21
    v_cvt_pk_bf16_f32 v112, v16, v17
    v_cmp_ngt_f32 vcc, s29, v172
    v_mfma_f32_16x16x32_bf16 v[44:47], v[148:151], v[140:143], v[100:103]
    v_cvt_pk_bf16_f32 v113, v18, v19
    v_exp_f32 v22, v22
    v_mfma_f32_16x16x32_bf16 v[36:39], v[148:151], v[136:139], v[96:99]
    s_cbranch_vccnz attn_out_kernel_rare0
attn_out_kernel_back0:
    ds_read_b128 v[144:147], v2 offset:2048
    ds_read_b128 v[148:151], v2 offset:3072
    v_exp_f32 v23, v23
    v_exp_f32 v24, v24
    v_mfma_f32_16x16x32_bf16 v[64:67], v[152:155], v[120:123], v[64:67]
    v_exp_f32 v25, v25
    v_mfma_f32_16x16x32_bf16 v[72:75], v[152:155], v[124:127], v[72:75]
    ds_read_b64_tr_b16 v[152:153], v4 offset:0
    v_cvt_pk_bf16_f32 v114, v20, v21
    v_cvt_pk_bf16_f32 v115, v22, v23
    v_exp_f32 v26, v26
    v_exp_f32 v27, v27
    v_mfma_f32_16x16x32_bf16 v[76:79], v[156:159], v[124:127], v[76:79]
    v_exp_f32 v28, v28
    v_mfma_f32_16x16x32_bf16 v[68:71], v[156:159], v[120:123], v[68:71]
    v_exp_f32 v29, v29
    ds_read_b64_tr_b16 v[154:155], v4 offset:1024
    v_cvt_pk_bf16_f32 v116, v24, v25
    v_exp_f32 v30, v30
    v_exp_f32 v31, v31
    v_cvt_pk_bf16_f32 v117, v26, v27
    v_cvt_pk_bf16_f32 v118, v28, v29
    v_cvt_pk_bf16_f32 v119, v30, v31
    v_exp_f32 v32, v32
    v_mfma_f32_16x16x32_bf16 v[160:163], v[176:179], v[112:115], v[164:167]
    v_exp_f32 v33, v33
    v_mfma_f32_16x16x32_bf16 v[160:163], v[208:211], v[116:119], v[160:163]
    s_waitcnt lgkmcnt(2)
    ds_read_b64_tr_b16 v[156:157], v3 offset:0
    ds_read_b64_tr_b16 v[158:159], v3 offset:1024
    v_mfma_f32_16x16x32_bf16 v[16:19], v[144:147], v[128:131], v[80:83]
    v_exp_f32 v34, v34
    v_mfma_f32_16x16x32_bf16 v[24:27], v[144:147], v[132:135], v[84:87]
    v_exp_f32 v35, v35
    v_mfma_f32_16x16x32_bf16 v[28:31], v[148:151], v[132:135], v[84:87]
    s_setprio 2
    v_exp_f32 v36, v36
    v_exp_f32 v37, v37
    v_cmp_ngt_f32 vcc, s29, v160
    v_mfma_f32_16x16x32_bf16 v[20:23], v[148:151], v[128:131], v[80:83]
    v_cvt_pk_bf16_f32 v120, v32, v33
    v_cvt_pk_bf16_f32 v121, v34, v35
    s_waitcnt lgkmcnt(2)
    s_cbranch_vccnz attn_out_kernel_rare1
attn_out_kernel_back1:
    v_exp_f32 v38, v38
    v_exp_f32 v39, v39
    v_exp_f32 v40, v40
    v_mfma_f32_16x16x32_bf16 v[48:51], v[152:155], v[112:115], v[48:51]
    s_waitcnt lgkmcnt(0)
    v_cvt_pk_bf16_f32 v122, v36, v37
    v_cvt_pk_bf16_f32 v123, v38, v39
    v_mfma_f32_16x16x32_bf16 v[56:59], v[152:155], v[116:119], v[56:59]
    v_exp_f32 v41, v41
    v_mfma_f32_16x16x32_bf16 v[60:63], v[156:159], v[116:119], v[60:63]
    v_exp_f32 v42, v42
    v_exp_f32 v43, v43
    v_exp_f32 v44, v44
    v_exp_f32 v45, v45
    v_exp_f32 v46, v46
    v_mfma_f32_16x16x32_bf16 v[52:55], v[156:159], v[112:115], v[52:55]
    v_exp_f32 v47, v47
    v_cvt_pk_bf16_f32 v124, v40, v41
    v_cvt_pk_bf16_f32 v125, v42, v43
    v_cvt_pk_bf16_f32 v126, v44, v45
    v_cvt_pk_bf16_f32 v127, v46, v47
    v_mfma_f32_16x16x32_bf16 v[168:171], v[176:179], v[120:123], v[172:175]
    v_exp_f32 v16, v16
    v_mfma_f32_16x16x32_bf16 v[168:171], v[208:211], v[124:127], v[168:171]
    v_exp_f32 v17, v17
    v_exp_f32 v18, v18
    v_mfma_f32_16x16x32_bf16 v[32:35], v[144:147], v[136:139], v[96:99]
    v_exp_f32 v19, v19
    v_mfma_f32_16x16x32_bf16 v[40:43], v[144:147], v[140:143], v[100:103]
    v_exp_f32 v20, v20
    v_exp_f32 v21, v21
    v_cvt_pk_bf16_f32 v112, v16, v17
    v_cmp_ngt_f32 vcc, s29, v168
    v_mfma_f32_16x16x32_bf16 v[44:47], v[148:151], v[140:143], v[100:103]
    v_cvt_pk_bf16_f32 v113, v18, v19
    v_exp_f32 v22, v22
    v_mfma_f32_16x16x32_bf16 v[36:39], v[148:151], v[136:139], v[96:99]
    s_cbranch_vccnz attn_out_kernel_rare2
attn_out_kernel_back2:
    ds_read_b128 v[144:147], v2 offset:4096
    ds_read_b128 v[148:151], v2 offset:5120
    v_exp_f32 v23, v23
    v_exp_f32 v24, v24
    v_mfma_f32_16x16x32_bf16 v[64:67], v[152:155], v[120:123], v[64:67]
    v_exp_f32 v25, v25
    v_mfma_f32_16x16x32_bf16 v[72:75], v[152:155], v[124:127], v[72:75]
    ds_read_b64_tr_b16 v[152:153], v4 offset:2048
    v_cvt_pk_bf16_f32 v114, v20, v21
    v_cvt_pk_bf16_f32 v115, v22, v23
    v_exp_f32 v26, v26
    v_exp_f32 v27, v27
    v_mfma_f32_16x16x32_bf16 v[76:79], v[156:159], v[124:127], v[76:79]
    v_exp_f32 v28, v28
    v_mfma_f32_16x16x32_bf16 v[68:71], v[156:159], v[120:123], v[68:71]
    v_exp_f32 v29, v29
    ds_read_b64_tr_b16 v[154:155], v4 offset:3072
    v_cvt_pk_bf16_f32 v116, v24, v25
    v_exp_f32 v30, v30
    v_exp_f32 v31, v31
    v_cvt_pk_bf16_f32 v117, v26, v27
    v_cvt_pk_bf16_f32 v118, v28, v29
    v_cvt_pk_bf16_f32 v119, v30, v31
    v_exp_f32 v32, v32
    v_mfma_f32_16x16x32_bf16 v[164:167], v[176:179], v[112:115], v[160:163]
    v_exp_f32 v33, v33
    v_mfma_f32_16x16x32_bf16 v[164:167], v[208:211], v[116:119], v[164:167]
    s_waitcnt lgkmcnt(2)
    ds_read_b64_tr_b16 v[156:157], v3 offset:2048
    ds_read_b64_tr_b16 v[158:159], v3 offset:3072
    v_mfma_f32_16x16x32_bf16 v[16:19], v[144:147], v[128:131], v[80:83]
    v_exp_f32 v34, v34
    v_mfma_f32_16x16x32_bf16 v[24:27], v[144:147], v[132:135], v[84:87]
    v_exp_f32 v35, v35
    v_mfma_f32_16x16x32_bf16 v[28:31], v[148:151], v[132:135], v[84:87]
    s_setprio 2
    v_exp_f32 v36, v36
    v_exp_f32 v37, v37
    v_cmp_ngt_f32 vcc, s29, v164
    v_mfma_f32_16x16x32_bf16 v[20:23], v[148:151], v[128:131], v[80:83]
    v_cvt_pk_bf16_f32 v120, v32, v33
    v_cvt_pk_bf16_f32 v121, v34, v35
    s_waitcnt lgkmcnt(2)
    s_cbranch_vccnz attn_out_kernel_rare3
attn_out_kernel_back3:
    v_exp_f32 v38, v38
    v_exp_f32 v39, v39
    v_exp_f32 v40, v40
    v_mfma_f32_16x16x32_bf16 v[48:51], v[152:155], v[112:115], v[48:51]
    s_waitcnt lgkmcnt(0)
    v_cvt_pk_bf16_f32 v122, v36, v37
    v_cvt_pk_bf16_f32 v123, v38, v39
    v_mfma_f32_16x16x32_bf16 v[56:59], v[152:155], v[116:119], v[56:59]
    v_exp_f32 v41, v41
    v_mfma_f32_16x16x32_bf16 v[60:63], v[156:159], v[116:119], v[60:63]
    v_exp_f32 v42, v42
    v_exp_f32 v43, v43
    v_exp_f32 v44, v44
    v_exp_f32 v45, v45
    v_exp_f32 v46, v46
    v_mfma_f32_16x16x32_bf16 v[52:55], v[156:159], v[112:115], v[52:55]
    v_exp_f32 v47, v47
    v_cvt_pk_bf16_f32 v124, v40, v41
    v_cvt_pk_bf16_f32 v125, v42, v43
    v_cvt_pk_bf16_f32 v126, v44, v45
    v_cvt_pk_bf16_f32 v127, v46, v47
    v_mfma_f32_16x16x32_bf16 v[172:175], v[176:179], v[120:123], v[168:171]
    v_exp_f32 v16, v16
    v_mfma_f32_16x16x32_bf16 v[172:175], v[208:211], v[124:127], v[172:175]
    v_exp_f32 v17, v17
    v_exp_f32 v18, v18
    v_mfma_f32_16x16x32_bf16 v[32:35], v[144:147], v[136:139], v[96:99]
    v_exp_f32 v19, v19
    v_mfma_f32_16x16x32_bf16 v[40:43], v[144:147], v[140:143], v[100:103]
    v_exp_f32 v20, v20
    v_exp_f32 v21, v21
    v_cvt_pk_bf16_f32 v112, v16, v17
    v_cmp_ngt_f32 vcc, s29, v172
    v_mfma_f32_16x16x32_bf16 v[44:47], v[148:151], v[140:143], v[100:103]
    v_cvt_pk_bf16_f32 v113, v18, v19
    v_exp_f32 v22, v22
    v_mfma_f32_16x16x32_bf16 v[36:39], v[148:151], v[136:139], v[96:99]
    s_cbranch_vccnz attn_out_kernel_rare4
attn_out_kernel_back4:
    ds_read_b128 v[144:147], v2 offset:6144
    ds_read_b128 v[148:151], v2 offset:7168
    v_exp_f32 v23, v23
    v_exp_f32 v24, v24
    v_mfma_f32_16x16x32_bf16 v[64:67], v[152:155], v[120:123], v[64:67]
    v_exp_f32 v25, v25
    v_mfma_f32_16x16x32_bf16 v[72:75], v[152:155], v[124:127], v[72:75]
    ds_read_b64_tr_b16 v[152:153], v4 offset:4096
    v_cvt_pk_bf16_f32 v114, v20, v21
    v_cvt_pk_bf16_f32 v115, v22, v23
    v_exp_f32 v26, v26
    v_exp_f32 v27, v27
    v_mfma_f32_16x16x32_bf16 v[76:79], v[156:159], v[124:127], v[76:79]
    v_exp_f32 v28, v28
    v_mfma_f32_16x16x32_bf16 v[68:71], v[156:159], v[120:123], v[68:71]
    v_exp_f32 v29, v29
    ds_read_b64_tr_b16 v[154:155], v4 offset:5120
    v_cvt_pk_bf16_f32 v116, v24, v25
    v_exp_f32 v30, v30
    v_exp_f32 v31, v31
    v_cvt_pk_bf16_f32 v117, v26, v27
    v_cvt_pk_bf16_f32 v118, v28, v29
    v_cvt_pk_bf16_f32 v119, v30, v31
    v_exp_f32 v32, v32
    v_mfma_f32_16x16x32_bf16 v[160:163], v[176:179], v[112:115], v[164:167]
    v_exp_f32 v33, v33
    v_mfma_f32_16x16x32_bf16 v[160:163], v[208:211], v[116:119], v[160:163]
    s_waitcnt lgkmcnt(2)
    ds_read_b64_tr_b16 v[156:157], v3 offset:4096
    ds_read_b64_tr_b16 v[158:159], v3 offset:5120
    v_mfma_f32_16x16x32_bf16 v[16:19], v[144:147], v[128:131], v[80:83]
    v_exp_f32 v34, v34
    v_mfma_f32_16x16x32_bf16 v[24:27], v[144:147], v[132:135], v[84:87]
    v_exp_f32 v35, v35
    v_mfma_f32_16x16x32_bf16 v[28:31], v[148:151], v[132:135], v[84:87]
    s_setprio 2
    v_exp_f32 v36, v36
    v_exp_f32 v37, v37
    v_cmp_ngt_f32 vcc, s29, v160
    v_mfma_f32_16x16x32_bf16 v[20:23], v[148:151], v[128:131], v[80:83]
    v_cvt_pk_bf16_f32 v120, v32, v33
    v_cvt_pk_bf16_f32 v121, v34, v35
    s_waitcnt lgkmcnt(2)
    s_cbranch_vccnz attn_out_kernel_rare5
attn_out_kernel_back5:
    v_exp_f32 v38, v38
    v_exp_f32 v39, v39
    v_exp_f32 v40, v40
    v_mfma_f32_16x16x32_bf16 v[48:51], v[152:155], v[112:115], v[48:51]
    s_waitcnt lgkmcnt(0)
    v_cvt_pk_bf16_f32 v122, v36, v37
    v_cvt_pk_bf16_f32 v123, v38, v39
    v_mfma_f32_16x16x32_bf16 v[56:59], v[152:155], v[116:119], v[56:59]
    v_exp_f32 v41, v41
    v_mfma_f32_16x16x32_bf16 v[60:63], v[156:159], v[116:119], v[60:63]
    v_exp_f32 v42, v42
    v_exp_f32 v43, v43
    v_exp_f32 v44, v44
    v_exp_f32 v45, v45
    v_exp_f32 v46, v46
    v_mfma_f32_16x16x32_bf16 v[52:55], v[156:159], v[112:115], v[52:55]
    v_exp_f32 v47, v47
    v_cvt_pk_bf16_f32 v124, v40, v41
    v_cvt_pk_bf16_f32 v125, v42, v43
    v_cvt_pk_bf16_f32 v126, v44, v45
    v_cvt_pk_bf16_f32 v127, v46, v47
    v_mfma_f32_16x16x32_bf16 v[168:171], v[176:179], v[120:123], v[172:175]
    v_exp_f32 v16, v16
    v_mfma_f32_16x16x32_bf16 v[168:171], v[208:211], v[124:127], v[168:171]
    v_exp_f32 v17, v17
    v_exp_f32 v18, v18
    v_mfma_f32_16x16x32_bf16 v[32:35], v[144:147], v[136:139], v[96:99]
    v_exp_f32 v19, v19
    v_mfma_f32_16x16x32_bf16 v[40:43], v[144:147], v[140:143], v[100:103]
    v_exp_f32 v20, v20
    v_exp_f32 v21, v21
    v_cvt_pk_bf16_f32 v112, v16, v17
    v_cmp_ngt_f32 vcc, s29, v168
    v_mfma_f32_16x16x32_bf16 v[44:47], v[148:151], v[140:143], v[100:103]
    v_cvt_pk_bf16_f32 v113, v18, v19
    v_exp_f32 v22, v22
    v_mfma_f32_16x16x32_bf16 v[36:39], v[148:151], v[136:139], v[96:99]
    s_cbranch_vccnz attn_out_kernel_rare6
attn_out_kernel_back6:
    s_barrier
    ds_read_b128 v[144:147], v2 offset:16384
    ds_read_b128 v[148:151], v2 offset:17408
    v_exp_f32 v23, v23
    v_exp_f32 v24, v24
    v_mfma_f32_16x16x32_bf16 v[64:67], v[152:155], v[120:123], v[64:67]
    v_exp_f32 v25, v25
    v_mfma_f32_16x16x32_bf16 v[72:75], v[152:155], v[124:127], v[72:75]
    ds_read_b64_tr_b16 v[152:153], v4 offset:6144
    v_cvt_pk_bf16_f32 v114, v20, v21
    v_cvt_pk_bf16_f32 v115, v22, v23
    v_exp_f32 v26, v26
    v_exp_f32 v27, v27
    v_mfma_f32_16x16x32_bf16 v[76:79], v[156:159], v[124:127], v[76:79]
    v_exp_f32 v28, v28
    v_mfma_f32_16x16x32_bf16 v[68:71], v[156:159], v[120:123], v[68:71]
    v_exp_f32 v29, v29
    ds_read_b64_tr_b16 v[154:155], v4 offset:7168
    v_cvt_pk_bf16_f32 v116, v24, v25
    v_exp_f32 v30, v30
    v_exp_f32 v31, v31
    v_cvt_pk_bf16_f32 v117, v26, v27
    v_cvt_pk_bf16_f32 v118, v28, v29
    v_cvt_pk_bf16_f32 v119, v30, v31
    v_exp_f32 v32, v32
    v_mfma_f32_16x16x32_bf16 v[164:167], v[176:179], v[112:115], v[160:163]
    v_exp_f32 v33, v33
    v_mfma_f32_16x16x32_bf16 v[164:167], v[208:211], v[116:119], v[164:167]
    s_waitcnt lgkmcnt(2)
    ds_read_b64_tr_b16 v[156:157], v3 offset:6144
    ds_read_b64_tr_b16 v[158:159], v3 offset:7168
    v_mfma_f32_16x16x32_bf16 v[16:19], v[144:147], v[128:131], v[80:83]
    v_exp_f32 v34, v34
    v_mfma_f32_16x16x32_bf16 v[24:27], v[144:147], v[132:135], v[84:87]
    v_exp_f32 v35, v35
    v_mfma_f32_16x16x32_bf16 v[28:31], v[148:151], v[132:135], v[84:87]
    s_setprio 2
    v_exp_f32 v36, v36
    v_exp_f32 v37, v37
    v_cmp_ngt_f32 vcc, s29, v164
    v_mfma_f32_16x16x32_bf16 v[20:23], v[148:151], v[128:131], v[80:83]
    v_cvt_pk_bf16_f32 v120, v32, v33
    v_cvt_pk_bf16_f32 v121, v34, v35
    s_waitcnt lgkmcnt(2)
    s_cbranch_vccnz attn_out_kernel_rare7
attn_out_kernel_back7:
    v_exp_f32 v38, v38
    v_exp_f32 v39, v39
    v_exp_f32 v40, v40
    v_mfma_f32_16x16x32_bf16 v[48:51], v[152:155], v[112:115], v[48:51]
    s_waitcnt lgkmcnt(0)
    v_cvt_pk_bf16_f32 v122, v36, v37
    v_cvt_pk_bf16_f32 v123, v38, v39
    v_mfma_f32_16x16x32_bf16 v[56:59], v[152:155], v[116:119], v[56:59]
    v_exp_f32 v41, v41
    v_mfma_f32_16x16x32_bf16 v[60:63], v[156:159], v[116:119], v[60:63]
    v_exp_f32 v42, v42
    v_exp_f32 v43, v43
    v_exp_f32 v44, v44
    v_exp_f32 v45, v45
    v_exp_f32 v46, v46
    v_mfma_f32_16x16x32_bf16 v[52:55], v[156:159], v[112:115], v[52:55]
    v_exp_f32 v47, v47
    v_cvt_pk_bf16_f32 v124, v40, v41
    v_cvt_pk_bf16_f32 v125, v42, v43
    v_cvt_pk_bf16_f32 v126, v44, v45
    v_cvt_pk_bf16_f32 v127, v46, v47
    v_mfma_f32_16x16x32_bf16 v[172:175], v[176:179], v[120:123], v[168:171]
    v_exp_f32 v16, v16
    v_mfma_f32_16x16x32_bf16 v[172:175], v[208:211], v[124:127], v[172:175]
    v_exp_f32 v17, v17
    v_exp_f32 v18, v18
    v_mfma_f32_16x16x32_bf16 v[32:35], v[144:147], v[136:139], v[96:99]
    v_exp_f32 v19, v19
    v_mfma_f32_16x16x32_bf16 v[40:43], v[144:147], v[140:143], v[100:103]
    v_exp_f32 v20, v20
    v_exp_f32 v21, v21
    v_cvt_pk_bf16_f32 v112, v16, v17
    v_cmp_ngt_f32 vcc, s29, v172
    v_mfma_f32_16x16x32_bf16 v[44:47], v[148:151], v[140:143], v[100:103]
    v_cvt_pk_bf16_f32 v113, v18, v19
    v_exp_f32 v22, v22
    v_mfma_f32_16x16x32_bf16 v[36:39], v[148:151], v[136:139], v[96:99]
    s_cbranch_vccnz attn_out_kernel_rare8
attn_out_kernel_back8:
    ds_read_b128 v[144:147], v2 offset:18432
    ds_read_b128 v[148:151], v2 offset:19456
    v_exp_f32 v23, v23
    v_exp_f32 v24, v24
    v_mfma_f32_16x16x32_bf16 v[64:67], v[152:155], v[120:123], v[64:67]
    v_exp_f32 v25, v25
    v_mfma_f32_16x16x32_bf16 v[72:75], v[152:155], v[124:127], v[72:75]
    ds_read_b64_tr_b16 v[152:153], v4 offset:16384
    v_cvt_pk_bf16_f32 v114, v20, v21
    v_cvt_pk_bf16_f32 v115, v22, v23
    v_exp_f32 v26, v26
    v_exp_f32 v27, v27
    v_mfma_f32_16x16x32_bf16 v[76:79], v[156:159], v[124:127], v[76:79]
    v_exp_f32 v28, v28
    v_mfma_f32_16x16x32_bf16 v[68:71], v[156:159], v[120:123], v[68:71]
    v_exp_f32 v29, v29
    ds_read_b64_tr_b16 v[154:155], v4 offset:17408
    v_cvt_pk_bf16_f32 v116, v24, v25
    v_exp_f32 v30, v30
    v_exp_f32 v31, v31
    v_cvt_pk_bf16_f32 v117, v26, v27
    v_cvt_pk_bf16_f32 v118, v28, v29
    v_cvt_pk_bf16_f32 v119, v30, v31
    v_exp_f32 v32, v32
    v_mfma_f32_16x16x32_bf16 v[160:163], v[176:179], v[112:115], v[164:167]
    v_exp_f32 v33, v33
    v_mfma_f32_16x16x32_bf16 v[160:163], v[208:211], v[116:119], v[160:163]
    s_waitcnt lgkmcnt(2)
    ds_read_b64_tr_b16 v[156:157], v3 offset:16384
    ds_read_b64_tr_b16 v[158:159], v3 offset:17408
    v_mfma_f32_16x16x32_bf16 v[16:19], v[144:147], v[128:131], v[80:83]
    v_exp_f32 v34, v34
    v_mfma_f32_16x16x32_bf16 v[24:27], v[144:147], v[132:135], v[84:87]
    v_exp_f32 v35, v35
    v_mfma_f32_16x16x32_bf16 v[28:31], v[148:151], v[132:135], v[84:87]
    s_setprio 2
    v_exp_f32 v36, v36
    v_exp_f32 v37, v37
    v_cmp_ngt_f32 vcc, s29, v160
    v_mfma_f32_16x16x32_bf16 v[20:23], v[148:151], v[128:131], v[80:83]
    v_cvt_pk_bf16_f32 v120, v32, v33
    v_cvt_pk_bf16_f32 v121, v34, v35
    s_waitcnt lgkmcnt(2)
    s_cbranch_vccnz attn_out_kernel_rare9
attn_out_kernel_back9:
    v_exp_f32 v38, v38
    v_exp_f32 v39, v39
    v_exp_f32 v40, v40
    v_mfma_f32_16x16x32_bf16 v[48:51], v[152:155], v[112:115], v[48:51]
    s_waitcnt lgkmcnt(0)
    v_cvt_pk_bf16_f32 v122, v36, v37
    v_cvt_pk_bf16_f32 v123, v38, v39
    v_mfma_f32_16x16x32_bf16 v[56:59], v[152:155], v[116:119], v[56:59]
    v_exp_f32 v41, v41
    v_mfma_f32_16x16x32_bf16 v[60:63], v[156:159], v[116:119], v[60:63]
    v_exp_f32 v42, v42
    v_exp_f32 v43, v43
    v_exp_f32 v44, v44
    v_exp_f32 v45, v45
    v_exp_f32 v46, v46
    v_mfma_f32_16x16x32_bf16 v[52:55], v[156:159], v[112:115], v[52:55]
    v_exp_f32 v47, v47
    v_cvt_pk_bf16_f32 v124, v40, v41
    v_cvt_pk_bf16_f32 v125, v42, v43
    v_cvt_pk_bf16_f32 v126, v44, v45
    v_cvt_pk_bf16_f32 v127, v46, v47
    v_mfma_f32_16x16x32_bf16 v[168:171], v[176:179], v[120:123], v[172:175]
    v_exp_f32 v16, v16
    v_mfma_f32_16x16x32_bf16 v[168:171], v[208:211], v[124:127], v[168:171]
    v_exp_f32 v17, v17
    v_exp_f32 v18, v18
    v_mfma_f32_16x16x32_bf16 v[32:35], v[144:147], v[136:139], v[96:99]
    v_exp_f32 v19, v19
    v_mfma_f32_16x16x32_bf16 v[40:43], v[144:147], v[140:143], v[100:103]
    v_exp_f32 v20, v20
    v_exp_f32 v21, v21
    v_cvt_pk_bf16_f32 v112, v16, v17
    v_cmp_ngt_f32 vcc, s29, v168
    v_mfma_f32_16x16x32_bf16 v[44:47], v[148:151], v[140:143], v[100:103]
    v_cvt_pk_bf16_f32 v113, v18, v19
    v_exp_f32 v22, v22
    v_mfma_f32_16x16x32_bf16 v[36:39], v[148:151], v[136:139], v[96:99]
    s_cbranch_vccnz attn_out_kernel_rare10
attn_out_kernel_back10:
    ds_read_b128 v[144:147], v2 offset:20480
    ds_read_b128 v[148:151], v2 offset:21504
    v_exp_f32 v23, v23
    v_exp_f32 v24, v24
    v_mfma_f32_16x16x32_bf16 v[64:67], v[152:155], v[120:123], v[64:67]
    v_exp_f32 v25, v25
    v_mfma_f32_16x16x32_bf16 v[72:75], v[152:155], v[124:127], v[72:75]
    ds_read_b64_tr_b16 v[152:153], v4 offset:18432
    v_cvt_pk_bf16_f32 v114, v20, v21
    v_cvt_pk_bf16_f32 v115, v22, v23
    v_exp_f32 v26, v26
    v_exp_f32 v27, v27
    v_mfma_f32_16x16x32_bf16 v[76:79], v[156:159], v[124:127], v[76:79]
    v_exp_f32 v28, v28
    v_mfma_f32_16x16x32_bf16 v[68:71], v[156:159], v[120:123], v[68:71]
    v_exp_f32 v29, v29
    ds_read_b64_tr_b16 v[154:155], v4 offset:19456
    v_cvt_pk_bf16_f32 v116, v24, v25
    v_exp_f32 v30, v30
    v_exp_f32 v31, v31
    v_cvt_pk_bf16_f32 v117, v26, v27
    v_cvt_pk_bf16_f32 v118, v28, v29
    v_cvt_pk_bf16_f32 v119, v30, v31
    v_exp_f32 v32, v32
    v_mfma_f32_16x16x32_bf16 v[164:167], v[176:179], v[112:115], v[160:163]
    v_exp_f32 v33, v33
    v_mfma_f32_16x16x32_bf16 v[164:167], v[208:211], v[116:119], v[164:167]
    s_waitcnt lgkmcnt(2)
    ds_read_b64_tr_b16 v[156:157], v3 offset:18432
    ds_read_b64_tr_b16 v[158:159], v3 offset:19456
    v_mfma_f32_16x16x32_bf16 v[16:19], v[144:147], v[128:131], v[80:83]
    v_exp_f32 v34, v34
    v_mfma_f32_16x16x32_bf16 v[24:27], v[144:147], v[132:135], v[84:87]
    v_exp_f32 v35, v35
    v_mfma_f32_16x16x32_bf16 v[28:31], v[148:151], v[132:135], v[84:87]
    s_setprio 2
    v_exp_f32 v36, v36
    v_exp_f32 v37, v37
    v_cmp_ngt_f32 vcc, s29, v164
    v_mfma_f32_16x16x32_bf16 v[20:23], v[148:151], v[128:131], v[80:83]
    v_cvt_pk_bf16_f32 v120, v32, v33
    v_cvt_pk_bf16_f32 v121, v34, v35
    s_waitcnt lgkmcnt(2)
    s_cbranch_vccnz attn_out_kernel_rare11
attn_out_kernel_back11:
    v_exp_f32 v38, v38
    v_exp_f32 v39, v39
    v_exp_f32 v40, v40
    v_mfma_f32_16x16x32_bf16 v[48:51], v[152:155], v[112:115], v[48:51]
    s_waitcnt lgkmcnt(0)
    v_cvt_pk_bf16_f32 v122, v36, v37
    v_cvt_pk_bf16_f32 v123, v38, v39
    v_mfma_f32_16x16x32_bf16 v[56:59], v[152:155], v[116:119], v[56:59]
    v_exp_f32 v41, v41
    v_mfma_f32_16x16x32_bf16 v[60:63], v[156:159], v[116:119], v[60:63]
    v_exp_f32 v42, v42
    v_exp_f32 v43, v43
    v_exp_f32 v44, v44
    v_exp_f32 v45, v45
    v_exp_f32 v46, v46
    v_mfma_f32_16x16x32_bf16 v[52:55], v[156:159], v[112:115], v[52:55]
    v_exp_f32 v47, v47
    v_cvt_pk_bf16_f32 v124, v40, v41
    v_cvt_pk_bf16_f32 v125, v42, v43
    v_cvt_pk_bf16_f32 v126, v44, v45
    v_cvt_pk_bf16_f32 v127, v46, v47
    v_mfma_f32_16x16x32_bf16 v[172:175], v[176:179], v[120:123], v[168:171]
    v_exp_f32 v16, v16
    v_mfma_f32_16x16x32_bf16 v[172:175], v[208:211], v[124:127], v[172:175]
    v_exp_f32 v17, v17
    v_exp_f32 v18, v18
    v_mfma_f32_16x16x32_bf16 v[32:35], v[144:147], v[136:139], v[96:99]
    v_exp_f32 v19, v19
    v_mfma_f32_16x16x32_bf16 v[40:43], v[144:147], v[140:143], v[100:103]
    v_exp_f32 v20, v20
    v_exp_f32 v21, v21
    v_cvt_pk_bf16_f32 v112, v16, v17
    v_cmp_ngt_f32 vcc, s29, v172
    v_mfma_f32_16x16x32_bf16 v[44:47], v[148:151], v[140:143], v[100:103]
    v_cvt_pk_bf16_f32 v113, v18, v19
    v_exp_f32 v22, v22
    v_mfma_f32_16x16x32_bf16 v[36:39], v[148:151], v[136:139], v[96:99]
    s_cbranch_vccnz attn_out_kernel_rare12
attn_out_kernel_back12:
    ds_read_b128 v[144:147], v2 offset:22528
    ds_read_b128 v[148:151], v2 offset:23552
    v_exp_f32 v23, v23
    v_exp_f32 v24, v24
    v_mfma_f32_16x16x32_bf16 v[64:67], v[152:155], v[120:123], v[64:67]
    v_exp_f32 v25, v25
    v_mfma_f32_16x16x32_bf16 v[72:75], v[152:155], v[124:127], v[72:75]
    ds_read_b64_tr_b16 v[152:153], v4 offset:20480
    v_cvt_pk_bf16_f32 v114, v20, v21
    v_cvt_pk_bf16_f32 v115, v22, v23
    v_exp_f32 v26, v26
    v_exp_f32 v27, v27
    v_mfma_f32_16x16x32_bf16 v[76:79], v[156:159], v[124:127], v[76:79]
    v_exp_f32 v28, v28
    v_mfma_f32_16x16x32_bf16 v[68:71], v[156:159], v[120:123], v[68:71]
    v_exp_f32 v29, v29
    ds_read_b64_tr_b16 v[154:155], v4 offset:21504
    v_cvt_pk_bf16_f32 v116, v24, v25
    v_exp_f32 v30, v30
    v_exp_f32 v31, v31
    v_cvt_pk_bf16_f32 v117, v26, v27
    v_cvt_pk_bf16_f32 v118, v28, v29
    v_cvt_pk_bf16_f32 v119, v30, v31
    v_exp_f32 v32, v32
    v_mfma_f32_16x16x32_bf16 v[160:163], v[176:179], v[112:115], v[164:167]
    v_exp_f32 v33, v33
    v_mfma_f32_16x16x32_bf16 v[160:163], v[208:211], v[116:119], v[160:163]
    s_waitcnt lgkmcnt(2)
    ds_read_b64_tr_b16 v[156:157], v3 offset:20480
    ds_read_b64_tr_b16 v[158:159], v3 offset:21504
    v_mfma_f32_16x16x32_bf16 v[16:19], v[144:147], v[128:131], v[80:83]
    v_exp_f32 v34, v34
    v_mfma_f32_16x16x32_bf16 v[24:27], v[144:147], v[132:135], v[84:87]
    v_exp_f32 v35, v35
    v_mfma_f32_16x16x32_bf16 v[28:31], v[148:151], v[132:135], v[84:87]
    s_setprio 2
    v_exp_f32 v36, v36
    v_exp_f32 v37, v37
    v_cmp_ngt_f32 vcc, s29, v160
    v_mfma_f32_16x16x32_bf16 v[20:23], v[148:151], v[128:131], v[80:83]
    v_cvt_pk_bf16_f32 v120, v32, v33
    v_cvt_pk_bf16_f32 v121, v34, v35
    s_waitcnt lgkmcnt(2)
    s_cbranch_vccnz attn_out_kernel_rare13
attn_out_kernel_back13:
    v_exp_f32 v38, v38
    v_exp_f32 v39, v39
    v_exp_f32 v40, v40
    v_mfma_f32_16x16x32_bf16 v[48:51], v[152:155], v[112:115], v[48:51]
    s_waitcnt lgkmcnt(0)
    v_cvt_pk_bf16_f32 v122, v36, v37
    v_cvt_pk_bf16_f32 v123, v38, v39
    v_mfma_f32_16x16x32_bf16 v[56:59], v[152:155], v[116:119], v[56:59]
    v_exp_f32 v41, v41
    v_mfma_f32_16x16x32_bf16 v[60:63], v[156:159], v[116:119], v[60:63]
    v_exp_f32 v42, v42
    v_exp_f32 v43, v43
    v_exp_f32 v44, v44
    v_exp_f32 v45, v45
    v_exp_f32 v46, v46
    v_mfma_f32_16x16x32_bf16 v[52:55], v[156:159], v[112:115], v[52:55]
    v_exp_f32 v47, v47
    v_cvt_pk_bf16_f32 v124, v40, v41
    v_cvt_pk_bf16_f32 v125, v42, v43
    v_cvt_pk_bf16_f32 v126, v44, v45
    v_cvt_pk_bf16_f32 v127, v46, v47
    v_mfma_f32_16x16x32_bf16 v[168:171], v[176:179], v[120:123], v[172:175]
    v_exp_f32 v16, v16
    v_mfma_f32_16x16x32_bf16 v[168:171], v[208:211], v[124:127], v[168:171]
    v_exp_f32 v17, v17
    v_exp_f32 v18, v18
    v_mfma_f32_16x16x32_bf16 v[32:35], v[144:147], v[136:139], v[96:99]
    v_exp_f32 v19, v19
    v_mfma_f32_16x16x32_bf16 v[40:43], v[144:147], v[140:143], v[100:103]
    v_exp_f32 v20, v20
    v_exp_f32 v21, v21
    v_cvt_pk_bf16_f32 v112, v16, v17
    v_cmp_ngt_f32 vcc, s29, v168
    v_mfma_f32_16x16x32_bf16 v[44:47], v[148:151], v[140:143], v[100:103]
    v_cvt_pk_bf16_f32 v113, v18, v19
    v_exp_f32 v22, v22
    v_mfma_f32_16x16x32_bf16 v[36:39], v[148:151], v[136:139], v[96:99]
    s_cbranch_vccnz attn_out_kernel_rare14
attn_out_kernel_back14:
    s_barrier
    ds_read_b128 v[144:147], v2 offset:32768
    ds_read_b128 v[148:151], v2 offset:33792
    v_exp_f32 v23, v23
    v_exp_f32 v24, v24
    v_mfma_f32_16x16x32_bf16 v[64:67], v[152:155], v[120:123], v[64:67]
    v_exp_f32 v25, v25
    v_mfma_f32_16x16x32_bf16 v[72:75], v[152:155], v[124:127], v[72:75]
    ds_read_b64_tr_b16 v[152:153], v4 offset:22528
    v_cvt_pk_bf16_f32 v114, v20, v21
    v_cvt_pk_bf16_f32 v115, v22, v23
    v_exp_f32 v26, v26
    v_exp_f32 v27, v27
    v_mfma_f32_16x16x32_bf16 v[76:79], v[156:159], v[124:127], v[76:79]
    v_exp_f32 v28, v28
    v_mfma_f32_16x16x32_bf16 v[68:71], v[156:159], v[120:123], v[68:71]
    v_exp_f32 v29, v29
    ds_read_b64_tr_b16 v[154:155], v4 offset:23552
    v_cvt_pk_bf16_f32 v116, v24, v25
    v_exp_f32 v30, v30
    v_exp_f32 v31, v31
    v_cvt_pk_bf16_f32 v117, v26, v27
    v_cvt_pk_bf16_f32 v118, v28, v29
    v_cvt_pk_bf16_f32 v119, v30, v31
    v_exp_f32 v32, v32
    v_mfma_f32_16x16x32_bf16 v[164:167], v[176:179], v[112:115], v[160:163]
    v_exp_f32 v33, v33
    v_mfma_f32_16x16x32_bf16 v[164:167], v[208:211], v[116:119], v[164:167]
    s_waitcnt lgkmcnt(2)
    ds_read_b64_tr_b16 v[156:157], v3 offset:22528
    ds_read_b64_tr_b16 v[158:159], v3 offset:23552
    v_mfma_f32_16x16x32_bf16 v[16:19], v[144:147], v[128:131], v[80:83]
    v_exp_f32 v34, v34
    v_mfma_f32_16x16x32_bf16 v[24:27], v[144:147], v[132:135], v[84:87]
    v_exp_f32 v35, v35
    v_mfma_f32_16x16x32_bf16 v[28:31], v[148:151], v[132:135], v[84:87]
    s_setprio 2
    v_exp_f32 v36, v36
    v_exp_f32 v37, v37
    v_cmp_ngt_f32 vcc, s29, v164
    v_mfma_f32_16x16x32_bf16 v[20:23], v[148:151], v[128:131], v[80:83]
    v_cvt_pk_bf16_f32 v120, v32, v33
    v_cvt_pk_bf16_f32 v121, v34, v35
    s_waitcnt lgkmcnt(2)
    s_cbranch_vccnz attn_out_kernel_rare15
attn_out_kernel_back15:
    v_exp_f32 v38, v38
    v_exp_f32 v39, v39
    v_exp_f32 v40, v40
    v_mfma_f32_16x16x32_bf16 v[48:51], v[152:155], v[112:115], v[48:51]
    s_waitcnt lgkmcnt(0)
    v_cvt_pk_bf16_f32 v122, v36, v37
    v_cvt_pk_bf16_f32 v123, v38, v39
    v_mfma_f32_16x16x32_bf16 v[56:59], v[152:155], v[116:119], v[56:59]
    v_exp_f32 v41, v41
    v_mfma_f32_16x16x32_bf16 v[60:63], v[156:159], v[116:119], v[60:63]
    v_exp_f32 v42, v42
    v_exp_f32 v43, v43
    v_exp_f32 v44, v44
    v_exp_f32 v45, v45
    v_exp_f32 v46, v46
    v_mfma_f32_16x16x32_bf16 v[52:55], v[156:159], v[112:115], v[52:55]
    v_exp_f32 v47, v47
    v_cvt_pk_bf16_f32 v124, v40, v41
    v_cvt_pk_bf16_f32 v125, v42, v43
    v_cvt_pk_bf16_f32 v126, v44, v45
    v_cvt_pk_bf16_f32 v127, v46, v47
    v_mfma_f32_16x16x32_bf16 v[172:175], v[176:179], v[120:123], v[168:171]
    v_exp_f32 v16, v16
    v_mfma_f32_16x16x32_bf16 v[172:175], v[208:211], v[124:127], v[172:175]
    v_exp_f32 v17, v17
    v_exp_f32 v18, v18
    v_mfma_f32_16x16x32_bf16 v[32:35], v[144:147], v[136:139], v[96:99]
    v_exp_f32 v19, v19
    v_mfma_f32_16x16x32_bf16 v[40:43], v[144:147], v[140:143], v[100:103]
    v_exp_f32 v20, v20
    v_exp_f32 v21, v21
    v_cvt_pk_bf16_f32 v112, v16, v17
    v_cmp_ngt_f32 vcc, s29, v172
    v_mfma_f32_16x16x32_bf16 v[44:47], v[148:151], v[140:143], v[100:103]
    v_cvt_pk_bf16_f32 v113, v18, v19
    v_exp_f32 v22, v22
    v_mfma_f32_16x16x32_bf16 v[36:39], v[148:151], v[136:139], v[96:99]
    s_cbranch_vccnz attn_out_kernel_rare16
attn_out_kernel_back16:
    ds_read_b128 v[144:147], v2 offset:34816
    ds_read_b128 v[148:151], v2 offset:35840
    v_exp_f32 v23, v23
    v_exp_f32 v24, v24
    v_mfma_f32_16x16x32_bf16 v[64:67], v[152:155], v[120:123], v[64:67]
    v_exp_f32 v25, v25
    v_mfma_f32_16x16x32_bf16 v[72:75], v[152:155], v[124:127], v[72:75]
    ds_read_b64_tr_b16 v[152:153], v4 offset:32768
    v_cvt_pk_bf16_f32 v114, v20, v21
    v_cvt_pk_bf16_f32 v115, v22, v23
    v_exp_f32 v26, v26
    v_exp_f32 v27, v27
    v_mfma_f32_16x16x32_bf16 v[76:79], v[156:159], v[124:127], v[76:79]
    v_exp_f32 v28, v28
    v_mfma_f32_16x16x32_bf16 v[68:71], v[156:159], v[120:123], v[68:71]
    v_exp_f32 v29, v29
    ds_read_b64_tr_b16 v[154:155], v4 offset:33792
    v_cvt_pk_bf16_f32 v116, v24, v25
    v_exp_f32 v30, v30
    v_exp_f32 v31, v31
    v_cvt_pk_bf16_f32 v117, v26, v27
    v_cvt_pk_bf16_f32 v118, v28, v29
    v_cvt_pk_bf16_f32 v119, v30, v31
    v_exp_f32 v32, v32
    v_mfma_f32_16x16x32_bf16 v[160:163], v[176:179], v[112:115], v[164:167]
    v_exp_f32 v33, v33
    v_mfma_f32_16x16x32_bf16 v[160:163], v[208:211], v[116:119], v[160:163]
    s_waitcnt lgkmcnt(2)
    ds_read_b64_tr_b16 v[156:157], v3 offset:32768
    ds_read_b64_tr_b16 v[158:159], v3 offset:33792
    v_mfma_f32_16x16x32_bf16 v[16:19], v[144:147], v[128:131], v[80:83]
    v_exp_f32 v34, v34
    v_mfma_f32_16x16x32_bf16 v[24:27], v[144:147], v[132:135], v[84:87]
    v_exp_f32 v35, v35
    v_mfma_f32_16x16x32_bf16 v[28:31], v[148:151], v[132:135], v[84:87]
    s_setprio 2
    v_exp_f32 v36, v36
    v_exp_f32 v37, v37
    v_cmp_ngt_f32 vcc, s29, v160
    v_mfma_f32_16x16x32_bf16 v[20:23], v[148:151], v[128:131], v[80:83]
    v_cvt_pk_bf16_f32 v120, v32, v33
    v_cvt_pk_bf16_f32 v121, v34, v35
    s_waitcnt lgkmcnt(2)
    s_cbranch_vccnz attn_out_kernel_rare17
attn_out_kernel_back17:
    v_exp_f32 v38, v38
    v_exp_f32 v39, v39
    v_exp_f32 v40, v40
    v_mfma_f32_16x16x32_bf16 v[48:51], v[152:155], v[112:115], v[48:51]
    s_waitcnt lgkmcnt(0)
    v_cvt_pk_bf16_f32 v122, v36, v37
    v_cvt_pk_bf16_f32 v123, v38, v39
    v_mfma_f32_16x16x32_bf16 v[56:59], v[152:155], v[116:119], v[56:59]
    v_exp_f32 v41, v41
    v_mfma_f32_16x16x32_bf16 v[60:63], v[156:159], v[116:119], v[60:63]
    v_exp_f32 v42, v42
    v_exp_f32 v43, v43
    v_exp_f32 v44, v44
    v_exp_f32 v45, v45
    v_exp_f32 v46, v46
    v_mfma_f32_16x16x32_bf16 v[52:55], v[156:159], v[112:115], v[52:55]
    v_exp_f32 v47, v47
    v_cvt_pk_bf16_f32 v124, v40, v41
    v_cvt_pk_bf16_f32 v125, v42, v43
    v_cvt_pk_bf16_f32 v126, v44, v45
    v_cvt_pk_bf16_f32 v127, v46, v47
    v_mfma_f32_16x16x32_bf16 v[168:171], v[176:179], v[120:123], v[172:175]
    v_exp_f32 v16, v16
    v_mfma_f32_16x16x32_bf16 v[168:171], v[208:211], v[124:127], v[168:171]
    v_exp_f32 v17, v17
    v_exp_f32 v18, v18
    v_mfma_f32_16x16x32_bf16 v[32:35], v[144:147], v[136:139], v[96:99]
    v_exp_f32 v19, v19
    v_mfma_f32_16x16x32_bf16 v[40:43], v[144:147], v[140:143], v[100:103]
    v_exp_f32 v20, v20
    v_exp_f32 v21, v21
    v_cvt_pk_bf16_f32 v112, v16, v17
    v_cmp_ngt_f32 vcc, s29, v168
    v_mfma_f32_16x16x32_bf16 v[44:47], v[148:151], v[140:143], v[100:103]
    v_cvt_pk_bf16_f32 v113, v18, v19
    v_exp_f32 v22, v22
    v_mfma_f32_16x16x32_bf16 v[36:39], v[148:151], v[136:139], v[96:99]
    s_cbranch_vccnz attn_out_kernel_rare18
attn_out_kernel_back18:
    ds_read_b128 v[144:147], v2 offset:36864
    ds_read_b128 v[148:151], v2 offset:37888
    v_exp_f32 v23, v23
    v_exp_f32 v24, v24
    v_mfma_f32_16x16x32_bf16 v[64:67], v[152:155], v[120:123], v[64:67]
    v_exp_f32 v25, v25
    v_mfma_f32_16x16x32_bf16 v[72:75], v[152:155], v[124:127], v[72:75]
    ds_read_b64_tr_b16 v[152:153], v4 offset:34816
    v_cvt_pk_bf16_f32 v114, v20, v21
    v_cvt_pk_bf16_f32 v115, v22, v23
    v_exp_f32 v26, v26
    v_exp_f32 v27, v27
    v_mfma_f32_16x16x32_bf16 v[76:79], v[156:159], v[124:127], v[76:79]
    v_exp_f32 v28, v28
    v_mfma_f32_16x16x32_bf16 v[68:71], v[156:159], v[120:123], v[68:71]
    v_exp_f32 v29, v29
    ds_read_b64_tr_b16 v[154:155], v4 offset:35840
    v_cvt_pk_bf16_f32 v116, v24, v25
    v_exp_f32 v30, v30
    v_exp_f32 v31, v31
    v_cvt_pk_bf16_f32 v117, v26, v27
    v_cvt_pk_bf16_f32 v118, v28, v29
    v_cvt_pk_bf16_f32 v119, v30, v31
    v_exp_f32 v32, v32
    v_mfma_f32_16x16x32_bf16 v[164:167], v[176:179], v[112:115], v[160:163]
    v_exp_f32 v33, v33
    v_mfma_f32_16x16x32_bf16 v[164:167], v[208:211], v[116:119], v[164:167]
    s_waitcnt lgkmcnt(2)
    ds_read_b64_tr_b16 v[156:157], v3 offset:34816
    ds_read_b64_tr_b16 v[158:159], v3 offset:35840
    v_mfma_f32_16x16x32_bf16 v[16:19], v[144:147], v[128:131], v[80:83]
    v_exp_f32 v34, v34
    v_mfma_f32_16x16x32_bf16 v[24:27], v[144:147], v[132:135], v[84:87]
    v_exp_f32 v35, v35
    v_mfma_f32_16x16x32_bf16 v[28:31], v[148:151], v[132:135], v[84:87]
    s_setprio 2
    v_exp_f32 v36, v36
    v_exp_f32 v37, v37
    v_cmp_ngt_f32 vcc, s29, v164
    v_mfma_f32_16x16x32_bf16 v[20:23], v[148:151], v[128:131], v[80:83]
    v_cvt_pk_bf16_f32 v120, v32, v33
    v_cvt_pk_bf16_f32 v121, v34, v35
    s_waitcnt lgkmcnt(2)
    s_cbranch_vccnz attn_out_kernel_rare19
attn_out_kernel_back19:
    v_exp_f32 v38, v38
    v_exp_f32 v39, v39
    v_exp_f32 v40, v40
    v_mfma_f32_16x16x32_bf16 v[48:51], v[152:155], v[112:115], v[48:51]
    s_waitcnt lgkmcnt(0)
    v_cvt_pk_bf16_f32 v122, v36, v37
    v_cvt_pk_bf16_f32 v123, v38, v39
    v_mfma_f32_16x16x32_bf16 v[56:59], v[152:155], v[116:119], v[56:59]
    v_exp_f32 v41, v41
    v_mfma_f32_16x16x32_bf16 v[60:63], v[156:159], v[116:119], v[60:63]
    v_exp_f32 v42, v42
    v_exp_f32 v43, v43
    v_exp_f32 v44, v44
    v_exp_f32 v45, v45
    v_exp_f32 v46, v46
    v_mfma_f32_16x16x32_bf16 v[52:55], v[156:159], v[112:115], v[52:55]
    v_exp_f32 v47, v47
    v_cvt_pk_bf16_f32 v124, v40, v41
    v_cvt_pk_bf16_f32 v125, v42, v43
    v_cvt_pk_bf16_f32 v126, v44, v45
    v_cvt_pk_bf16_f32 v127, v46, v47
    v_mfma_f32_16x16x32_bf16 v[172:175], v[176:179], v[120:123], v[168:171]
    v_exp_f32 v16, v16
    v_mfma_f32_16x16x32_bf16 v[172:175], v[208:211], v[124:127], v[172:175]
    v_exp_f32 v17, v17
    v_exp_f32 v18, v18
    v_mfma_f32_16x16x32_bf16 v[32:35], v[144:147], v[136:139], v[96:99]
    v_exp_f32 v19, v19
    v_mfma_f32_16x16x32_bf16 v[40:43], v[144:147], v[140:143], v[100:103]
    v_exp_f32 v20, v20
    v_exp_f32 v21, v21
    v_cvt_pk_bf16_f32 v112, v16, v17
    v_cmp_ngt_f32 vcc, s29, v172
    v_mfma_f32_16x16x32_bf16 v[44:47], v[148:151], v[140:143], v[100:103]
    v_cvt_pk_bf16_f32 v113, v18, v19
    v_exp_f32 v22, v22
    v_mfma_f32_16x16x32_bf16 v[36:39], v[148:151], v[136:139], v[96:99]
    s_cbranch_vccnz attn_out_kernel_rare20
attn_out_kernel_back20:
    ds_read_b128 v[144:147], v2 offset:38912
    ds_read_b128 v[148:151], v2 offset:39936
    v_exp_f32 v23, v23
    v_exp_f32 v24, v24
    v_mfma_f32_16x16x32_bf16 v[64:67], v[152:155], v[120:123], v[64:67]
    v_exp_f32 v25, v25
    v_mfma_f32_16x16x32_bf16 v[72:75], v[152:155], v[124:127], v[72:75]
    ds_read_b64_tr_b16 v[152:153], v4 offset:36864
    v_cvt_pk_bf16_f32 v114, v20, v21
    v_cvt_pk_bf16_f32 v115, v22, v23
    v_exp_f32 v26, v26
    v_exp_f32 v27, v27
    v_mfma_f32_16x16x32_bf16 v[76:79], v[156:159], v[124:127], v[76:79]
    v_exp_f32 v28, v28
    v_mfma_f32_16x16x32_bf16 v[68:71], v[156:159], v[120:123], v[68:71]
    v_exp_f32 v29, v29
    ds_read_b64_tr_b16 v[154:155], v4 offset:37888
    v_cvt_pk_bf16_f32 v116, v24, v25
    v_exp_f32 v30, v30
    v_exp_f32 v31, v31
    v_cvt_pk_bf16_f32 v117, v26, v27
    v_cvt_pk_bf16_f32 v118, v28, v29
    v_cvt_pk_bf16_f32 v119, v30, v31
    v_exp_f32 v32, v32
    v_mfma_f32_16x16x32_bf16 v[160:163], v[176:179], v[112:115], v[164:167]
    v_exp_f32 v33, v33
    v_mfma_f32_16x16x32_bf16 v[160:163], v[208:211], v[116:119], v[160:163]
    s_waitcnt lgkmcnt(2)
    ds_read_b64_tr_b16 v[156:157], v3 offset:36864
    ds_read_b64_tr_b16 v[158:159], v3 offset:37888
    v_mfma_f32_16x16x32_bf16 v[16:19], v[144:147], v[128:131], v[80:83]
    v_exp_f32 v34, v34
    v_mfma_f32_16x16x32_bf16 v[24:27], v[144:147], v[132:135], v[84:87]
    v_exp_f32 v35, v35
    v_mfma_f32_16x16x32_bf16 v[28:31], v[148:151], v[132:135], v[84:87]
    s_setprio 2
    v_exp_f32 v36, v36
    v_exp_f32 v37, v37
    v_cmp_ngt_f32 vcc, s29, v160
    v_mfma_f32_16x16x32_bf16 v[20:23], v[148:151], v[128:131], v[80:83]
    v_cvt_pk_bf16_f32 v120, v32, v33
    v_cvt_pk_bf16_f32 v121, v34, v35
    s_waitcnt lgkmcnt(2)
    s_cbranch_vccnz attn_out_kernel_rare21
attn_out_kernel_back21:
    v_exp_f32 v38, v38
    v_exp_f32 v39, v39
    v_exp_f32 v40, v40
    v_mfma_f32_16x16x32_bf16 v[48:51], v[152:155], v[112:115], v[48:51]
    s_waitcnt lgkmcnt(0)
    v_cvt_pk_bf16_f32 v122, v36, v37
    v_cvt_pk_bf16_f32 v123, v38, v39
    v_mfma_f32_16x16x32_bf16 v[56:59], v[152:155], v[116:119], v[56:59]
    v_exp_f32 v41, v41
    v_mfma_f32_16x16x32_bf16 v[60:63], v[156:159], v[116:119], v[60:63]
    v_exp_f32 v42, v42
    v_exp_f32 v43, v43
    v_exp_f32 v44, v44
    v_exp_f32 v45, v45
    v_exp_f32 v46, v46
    v_mfma_f32_16x16x32_bf16 v[52:55], v[156:159], v[112:115], v[52:55]
    v_exp_f32 v47, v47
    v_cvt_pk_bf16_f32 v124, v40, v41
    v_cvt_pk_bf16_f32 v125, v42, v43
    v_cvt_pk_bf16_f32 v126, v44, v45
    v_cvt_pk_bf16_f32 v127, v46, v47
    v_mfma_f32_16x16x32_bf16 v[168:171], v[176:179], v[120:123], v[172:175]
    v_exp_f32 v16, v16
    v_mfma_f32_16x16x32_bf16 v[168:171], v[208:211], v[124:127], v[168:171]
    v_exp_f32 v17, v17
    v_exp_f32 v18, v18
    v_mfma_f32_16x16x32_bf16 v[32:35], v[144:147], v[136:139], v[96:99]
    v_exp_f32 v19, v19
    v_mfma_f32_16x16x32_bf16 v[40:43], v[144:147], v[140:143], v[100:103]
    v_exp_f32 v20, v20
    v_exp_f32 v21, v21
    v_cvt_pk_bf16_f32 v112, v16, v17
    v_cmp_ngt_f32 vcc, s29, v168
    v_mfma_f32_16x16x32_bf16 v[44:47], v[148:151], v[140:143], v[100:103]
    v_cvt_pk_bf16_f32 v113, v18, v19
    v_exp_f32 v22, v22
    v_mfma_f32_16x16x32_bf16 v[36:39], v[148:151], v[136:139], v[96:99]
    s_cbranch_vccnz attn_out_kernel_rare22
attn_out_kernel_back22:
    s_barrier
    ds_read_b128 v[144:147], v2 offset:49152
    ds_read_b128 v[148:151], v2 offset:50176
    v_exp_f32 v23, v23
    v_exp_f32 v24, v24
    v_mfma_f32_16x16x32_bf16 v[64:67], v[152:155], v[120:123], v[64:67]
    v_exp_f32 v25, v25
    v_mfma_f32_16x16x32_bf16 v[72:75], v[152:155], v[124:127], v[72:75]
    ds_read_b64_tr_b16 v[152:153], v4 offset:38912
    v_cvt_pk_bf16_f32 v114, v20, v21
    v_cvt_pk_bf16_f32 v115, v22, v23
    v_exp_f32 v26, v26
    v_exp_f32 v27, v27
    v_mfma_f32_16x16x32_bf16 v[76:79], v[156:159], v[124:127], v[76:79]
    v_exp_f32 v28, v28
    v_mfma_f32_16x16x32_bf16 v[68:71], v[156:159], v[120:123], v[68:71]
    v_exp_f32 v29, v29
    ds_read_b64_tr_b16 v[154:155], v4 offset:39936
    v_cvt_pk_bf16_f32 v116, v24, v25
    v_exp_f32 v30, v30
    v_exp_f32 v31, v31
    v_cvt_pk_bf16_f32 v117, v26, v27
    v_cvt_pk_bf16_f32 v118, v28, v29
    v_cvt_pk_bf16_f32 v119, v30, v31
    v_exp_f32 v32, v32
    v_mfma_f32_16x16x32_bf16 v[164:167], v[176:179], v[112:115], v[160:163]
    v_exp_f32 v33, v33
    v_mfma_f32_16x16x32_bf16 v[164:167], v[208:211], v[116:119], v[164:167]
    s_waitcnt lgkmcnt(2)
    ds_read_b64_tr_b16 v[156:157], v3 offset:38912
    ds_read_b64_tr_b16 v[158:159], v3 offset:39936
    v_mfma_f32_16x16x32_bf16 v[16:19], v[144:147], v[128:131], v[80:83]
    v_exp_f32 v34, v34
    v_mfma_f32_16x16x32_bf16 v[24:27], v[144:147], v[132:135], v[84:87]
    v_exp_f32 v35, v35
    v_mfma_f32_16x16x32_bf16 v[28:31], v[148:151], v[132:135], v[84:87]
    s_setprio 2
    v_exp_f32 v36, v36
    v_exp_f32 v37, v37
    v_cmp_ngt_f32 vcc, s29, v164
    v_mfma_f32_16x16x32_bf16 v[20:23], v[148:151], v[128:131], v[80:83]
    v_cvt_pk_bf16_f32 v120, v32, v33
    v_cvt_pk_bf16_f32 v121, v34, v35
    s_waitcnt lgkmcnt(2)
    s_cbranch_vccnz attn_out_kernel_rare23
attn_out_kernel_back23:
    v_exp_f32 v38, v38
    v_exp_f32 v39, v39
    v_exp_f32 v40, v40
    v_mfma_f32_16x16x32_bf16 v[48:51], v[152:155], v[112:115], v[48:51]
    s_waitcnt lgkmcnt(0)
    v_cvt_pk_bf16_f32 v122, v36, v37
    v_cvt_pk_bf16_f32 v123, v38, v39
    v_mfma_f32_16x16x32_bf16 v[56:59], v[152:155], v[116:119], v[56:59]
    v_exp_f32 v41, v41
    v_mfma_f32_16x16x32_bf16 v[60:63], v[156:159], v[116:119], v[60:63]
    v_exp_f32 v42, v42
    v_exp_f32 v43, v43
    v_exp_f32 v44, v44
    v_exp_f32 v45, v45
    v_exp_f32 v46, v46
    v_mfma_f32_16x16x32_bf16 v[52:55], v[156:159], v[112:115], v[52:55]
    v_exp_f32 v47, v47
    v_cvt_pk_bf16_f32 v124, v40, v41
    v_cvt_pk_bf16_f32 v125, v42, v43
    v_cvt_pk_bf16_f32 v126, v44, v45
    v_cvt_pk_bf16_f32 v127, v46, v47
    v_mfma_f32_16x16x32_bf16 v[172:175], v[176:179], v[120:123], v[168:171]
    v_exp_f32 v16, v16
    v_mfma_f32_16x16x32_bf16 v[172:175], v[208:211], v[124:127], v[172:175]
    v_exp_f32 v17, v17
    v_exp_f32 v18, v18
    v_mfma_f32_16x16x32_bf16 v[32:35], v[144:147], v[136:139], v[96:99]
    v_exp_f32 v19, v19
    v_mfma_f32_16x16x32_bf16 v[40:43], v[144:147], v[140:143], v[100:103]
    v_exp_f32 v20, v20
    v_exp_f32 v21, v21
    v_cvt_pk_bf16_f32 v112, v16, v17
    v_cmp_ngt_f32 vcc, s29, v172
    v_mfma_f32_16x16x32_bf16 v[44:47], v[148:151], v[140:143], v[100:103]
    v_cvt_pk_bf16_f32 v113, v18, v19
    v_exp_f32 v22, v22
    v_mfma_f32_16x16x32_bf16 v[36:39], v[148:151], v[136:139], v[96:99]
    s_cbranch_vccnz attn_out_kernel_rare24
attn_out_kernel_back24:
    ds_read_b128 v[144:147], v2 offset:51200
    ds_read_b128 v[148:151], v2 offset:52224
    v_exp_f32 v23, v23
    v_exp_f32 v24, v24
    v_mfma_f32_16x16x32_bf16 v[64:67], v[152:155], v[120:123], v[64:67]
    v_exp_f32 v25, v25
    v_mfma_f32_16x16x32_bf16 v[72:75], v[152:155], v[124:127], v[72:75]
    ds_read_b64_tr_b16 v[152:153], v4 offset:49152
    v_cvt_pk_bf16_f32 v114, v20, v21
    v_cvt_pk_bf16_f32 v115, v22, v23
    v_exp_f32 v26, v26
    v_exp_f32 v27, v27
    v_mfma_f32_16x16x32_bf16 v[76:79], v[156:159], v[124:127], v[76:79]
    v_exp_f32 v28, v28
    v_mfma_f32_16x16x32_bf16 v[68:71], v[156:159], v[120:123], v[68:71]
    v_exp_f32 v29, v29
    ds_read_b64_tr_b16 v[154:155], v4 offset:50176
    v_cvt_pk_bf16_f32 v116, v24, v25
    v_exp_f32 v30, v30
    v_exp_f32 v31, v31
    v_cvt_pk_bf16_f32 v117, v26, v27
    v_cvt_pk_bf16_f32 v118, v28, v29
    v_cvt_pk_bf16_f32 v119, v30, v31
    v_exp_f32 v32, v32
    v_mfma_f32_16x16x32_bf16 v[160:163], v[176:179], v[112:115], v[164:167]
    v_exp_f32 v33, v33
    v_mfma_f32_16x16x32_bf16 v[160:163], v[208:211], v[116:119], v[160:163]
    s_waitcnt lgkmcnt(2)
    ds_read_b64_tr_b16 v[156:157], v3 offset:49152
    ds_read_b64_tr_b16 v[158:159], v3 offset:50176
    v_mfma_f32_16x16x32_bf16 v[16:19], v[144:147], v[128:131], v[80:83]
    v_exp_f32 v34, v34
    v_mfma_f32_16x16x32_bf16 v[24:27], v[144:147], v[132:135], v[84:87]
    v_exp_f32 v35, v35
    v_mfma_f32_16x16x32_bf16 v[28:31], v[148:151], v[132:135], v[84:87]
    s_setprio 2
    v_exp_f32 v36, v36
    v_exp_f32 v37, v37
    v_cmp_ngt_f32 vcc, s29, v160
    v_mfma_f32_16x16x32_bf16 v[20:23], v[148:151], v[128:131], v[80:83]
    v_cvt_pk_bf16_f32 v120, v32, v33
    v_cvt_pk_bf16_f32 v121, v34, v35
    s_waitcnt lgkmcnt(2)
    s_cbranch_vccnz attn_out_kernel_rare25
attn_out_kernel_back25:
    v_exp_f32 v38, v38
    v_exp_f32 v39, v39
    v_exp_f32 v40, v40
    v_mfma_f32_16x16x32_bf16 v[48:51], v[152:155], v[112:115], v[48:51]
    s_waitcnt lgkmcnt(0)
    v_cvt_pk_bf16_f32 v122, v36, v37
    v_cvt_pk_bf16_f32 v123, v38, v39
    v_mfma_f32_16x16x32_bf16 v[56:59], v[152:155], v[116:119], v[56:59]
    v_exp_f32 v41, v41
    v_mfma_f32_16x16x32_bf16 v[60:63], v[156:159], v[116:119], v[60:63]
    v_exp_f32 v42, v42
    v_exp_f32 v43, v43
    v_exp_f32 v44, v44
    v_exp_f32 v45, v45
    v_exp_f32 v46, v46
    v_mfma_f32_16x16x32_bf16 v[52:55], v[156:159], v[112:115], v[52:55]
    v_exp_f32 v47, v47
    v_cvt_pk_bf16_f32 v124, v40, v41
    v_cvt_pk_bf16_f32 v125, v42, v43
    v_cvt_pk_bf16_f32 v126, v44, v45
    v_cvt_pk_bf16_f32 v127, v46, v47
    v_mfma_f32_16x16x32_bf16 v[168:171], v[176:179], v[120:123], v[172:175]
    v_exp_f32 v16, v16
    v_mfma_f32_16x16x32_bf16 v[168:171], v[208:211], v[124:127], v[168:171]
    v_exp_f32 v17, v17
    v_exp_f32 v18, v18
    v_mfma_f32_16x16x32_bf16 v[32:35], v[144:147], v[136:139], v[96:99]
    v_exp_f32 v19, v19
    v_mfma_f32_16x16x32_bf16 v[40:43], v[144:147], v[140:143], v[100:103]
    v_exp_f32 v20, v20
    v_exp_f32 v21, v21
    v_cvt_pk_bf16_f32 v112, v16, v17
    v_cmp_ngt_f32 vcc, s29, v168
    v_mfma_f32_16x16x32_bf16 v[44:47], v[148:151], v[140:143], v[100:103]
    v_cvt_pk_bf16_f32 v113, v18, v19
    v_exp_f32 v22, v22
    v_mfma_f32_16x16x32_bf16 v[36:39], v[148:151], v[136:139], v[96:99]
    s_cbranch_vccnz attn_out_kernel_rare26
attn_out_kernel_back26:
    ds_read_b128 v[144:147], v2 offset:53248
    ds_read_b128 v[148:151], v2 offset:54272
    v_exp_f32 v23, v23
    v_exp_f32 v24, v24
    v_mfma_f32_16x16x32_bf16 v[64:67], v[152:155], v[120:123], v[64:67]
    v_exp_f32 v25, v25
    v_mfma_f32_16x16x32_bf16 v[72:75], v[152:155], v[124:127], v[72:75]
    ds_read_b64_tr_b16 v[152:153], v4 offset:51200
    v_cvt_pk_bf16_f32 v114, v20, v21
    v_cvt_pk_bf16_f32 v115, v22, v23
    v_exp_f32 v26, v26
    v_exp_f32 v27, v27
    v_mfma_f32_16x16x32_bf16 v[76:79], v[156:159], v[124:127], v[76:79]
    v_exp_f32 v28, v28
    v_mfma_f32_16x16x32_bf16 v[68:71], v[156:159], v[120:123], v[68:71]
    v_exp_f32 v29, v29
    ds_read_b64_tr_b16 v[154:155], v4 offset:52224
    v_cvt_pk_bf16_f32 v116, v24, v25
    v_exp_f32 v30, v30
    v_exp_f32 v31, v31
    v_cvt_pk_bf16_f32 v117, v26, v27
    v_cvt_pk_bf16_f32 v118, v28, v29
    v_cvt_pk_bf16_f32 v119, v30, v31
    v_exp_f32 v32, v32
    v_mfma_f32_16x16x32_bf16 v[164:167], v[176:179], v[112:115], v[160:163]
    v_exp_f32 v33, v33
    v_mfma_f32_16x16x32_bf16 v[164:167], v[208:211], v[116:119], v[164:167]
    s_waitcnt lgkmcnt(2)
    ds_read_b64_tr_b16 v[156:157], v3 offset:51200
    ds_read_b64_tr_b16 v[158:159], v3 offset:52224
    v_mfma_f32_16x16x32_bf16 v[16:19], v[144:147], v[128:131], v[80:83]
    v_exp_f32 v34, v34
    v_mfma_f32_16x16x32_bf16 v[24:27], v[144:147], v[132:135], v[84:87]
    v_exp_f32 v35, v35
    v_mfma_f32_16x16x32_bf16 v[28:31], v[148:151], v[132:135], v[84:87]
    s_setprio 2
    v_exp_f32 v36, v36
    v_exp_f32 v37, v37
    v_cmp_ngt_f32 vcc, s29, v164
    v_mfma_f32_16x16x32_bf16 v[20:23], v[148:151], v[128:131], v[80:83]
    v_cvt_pk_bf16_f32 v120, v32, v33
    v_cvt_pk_bf16_f32 v121, v34, v35
    s_waitcnt lgkmcnt(2)
    s_cbranch_vccnz attn_out_kernel_rare27
attn_out_kernel_back27:
    v_exp_f32 v38, v38
    v_exp_f32 v39, v39
    v_exp_f32 v40, v40
    v_mfma_f32_16x16x32_bf16 v[48:51], v[152:155], v[112:115], v[48:51]
    s_waitcnt lgkmcnt(0)
    v_cvt_pk_bf16_f32 v122, v36, v37
    v_cvt_pk_bf16_f32 v123, v38, v39
    v_mfma_f32_16x16x32_bf16 v[56:59], v[152:155], v[116:119], v[56:59]
    v_exp_f32 v41, v41
    v_mfma_f32_16x16x32_bf16 v[60:63], v[156:159], v[116:119], v[60:63]
    v_exp_f32 v42, v42
    v_exp_f32 v43, v43
    v_exp_f32 v44, v44
    v_exp_f32 v45, v45
    v_exp_f32 v46, v46
    v_mfma_f32_16x16x32_bf16 v[52:55], v[156:159], v[112:115], v[52:55]
    v_exp_f32 v47, v47
    v_cvt_pk_bf16_f32 v124, v40, v41
    v_cvt_pk_bf16_f32 v125, v42, v43
    v_cvt_pk_bf16_f32 v126, v44, v45
    v_cvt_pk_bf16_f32 v127, v46, v47
    v_mfma_f32_16x16x32_bf16 v[172:175], v[176:179], v[120:123], v[168:171]
    v_exp_f32 v16, v16
    v_mfma_f32_16x16x32_bf16 v[172:175], v[208:211], v[124:127], v[172:175]
    v_exp_f32 v17, v17
    v_exp_f32 v18, v18
    v_mfma_f32_16x16x32_bf16 v[32:35], v[144:147], v[136:139], v[96:99]
    v_exp_f32 v19, v19
    v_mfma_f32_16x16x32_bf16 v[40:43], v[144:147], v[140:143], v[100:103]
    v_exp_f32 v20, v20
    v_exp_f32 v21, v21
    v_cvt_pk_bf16_f32 v112, v16, v17
    v_cmp_ngt_f32 vcc, s29, v172
    v_mfma_f32_16x16x32_bf16 v[44:47], v[148:151], v[140:143], v[100:103]
    v_cvt_pk_bf16_f32 v113, v18, v19
    v_exp_f32 v22, v22
    v_mfma_f32_16x16x32_bf16 v[36:39], v[148:151], v[136:139], v[96:99]
    s_cbranch_vccnz attn_out_kernel_rare28
attn_out_kernel_back28:
    ds_read_b128 v[144:147], v2 offset:55296
    ds_read_b128 v[148:151], v2 offset:56320
    v_exp_f32 v23, v23
    v_exp_f32 v24, v24
    v_mfma_f32_16x16x32_bf16 v[64:67], v[152:155], v[120:123], v[64:67]
    v_exp_f32 v25, v25
    v_mfma_f32_16x16x32_bf16 v[72:75], v[152:155], v[124:127], v[72:75]
    ds_read_b64_tr_b16 v[152:153], v4 offset:53248
    v_cvt_pk_bf16_f32 v114, v20, v21
    v_cvt_pk_bf16_f32 v115, v22, v23
    v_exp_f32 v26, v26
    v_exp_f32 v27, v27
    v_mfma_f32_16x16x32_bf16 v[76:79], v[156:159], v[124:127], v[76:79]
    v_exp_f32 v28, v28
    v_mfma_f32_16x16x32_bf16 v[68:71], v[156:159], v[120:123], v[68:71]
    v_exp_f32 v29, v29
    ds_read_b64_tr_b16 v[154:155], v4 offset:54272
    v_cvt_pk_bf16_f32 v116, v24, v25
    v_exp_f32 v30, v30
    v_exp_f32 v31, v31
    v_cvt_pk_bf16_f32 v117, v26, v27
    v_cvt_pk_bf16_f32 v118, v28, v29
    v_cvt_pk_bf16_f32 v119, v30, v31
    v_exp_f32 v32, v32
    v_mfma_f32_16x16x32_bf16 v[160:163], v[176:179], v[112:115], v[164:167]
    v_exp_f32 v33, v33
    v_mfma_f32_16x16x32_bf16 v[160:163], v[208:211], v[116:119], v[160:163]
    s_waitcnt lgkmcnt(2)
    ds_read_b64_tr_b16 v[156:157], v3 offset:53248
    ds_read_b64_tr_b16 v[158:159], v3 offset:54272
    v_mfma_f32_16x16x32_bf16 v[16:19], v[144:147], v[128:131], v[80:83]
    v_exp_f32 v34, v34
    v_mfma_f32_16x16x32_bf16 v[24:27], v[144:147], v[132:135], v[84:87]
    v_exp_f32 v35, v35
    v_mfma_f32_16x16x32_bf16 v[28:31], v[148:151], v[132:135], v[84:87]
    s_setprio 2
    v_exp_f32 v36, v36
    v_exp_f32 v37, v37
    v_cmp_ngt_f32 vcc, s29, v160
    v_mfma_f32_16x16x32_bf16 v[20:23], v[148:151], v[128:131], v[80:83]
    v_cvt_pk_bf16_f32 v120, v32, v33
    v_cvt_pk_bf16_f32 v121, v34, v35
    s_waitcnt lgkmcnt(2)
    s_cbranch_vccnz attn_out_kernel_rare29
attn_out_kernel_back29:
    v_exp_f32 v38, v38
    v_exp_f32 v39, v39
    v_exp_f32 v40, v40
    v_mfma_f32_16x16x32_bf16 v[48:51], v[152:155], v[112:115], v[48:51]
    s_waitcnt lgkmcnt(0)
    v_cvt_pk_bf16_f32 v122, v36, v37
    v_cvt_pk_bf16_f32 v123, v38, v39
    v_mfma_f32_16x16x32_bf16 v[56:59], v[152:155], v[116:119], v[56:59]
    v_exp_f32 v41, v41
    v_mfma_f32_16x16x32_bf16 v[60:63], v[156:159], v[116:119], v[60:63]
    v_exp_f32 v42, v42
    v_exp_f32 v43, v43
    v_exp_f32 v44, v44
    v_exp_f32 v45, v45
    v_exp_f32 v46, v46
    v_mfma_f32_16x16x32_bf16 v[52:55], v[156:159], v[112:115], v[52:55]
    v_exp_f32 v47, v47
    v_cvt_pk_bf16_f32 v124, v40, v41
    v_cvt_pk_bf16_f32 v125, v42, v43
    v_cvt_pk_bf16_f32 v126, v44, v45
    v_cvt_pk_bf16_f32 v127, v46, v47
    v_mfma_f32_16x16x32_bf16 v[168:171], v[176:179], v[120:123], v[172:175]
    v_exp_f32 v16, v16
    v_mfma_f32_16x16x32_bf16 v[168:171], v[208:211], v[124:127], v[168:171]
    v_exp_f32 v17, v17
    v_exp_f32 v18, v18
    v_mfma_f32_16x16x32_bf16 v[32:35], v[144:147], v[136:139], v[96:99]
    v_exp_f32 v19, v19
    v_mfma_f32_16x16x32_bf16 v[40:43], v[144:147], v[140:143], v[100:103]
    v_exp_f32 v20, v20
    v_exp_f32 v21, v21
    v_cvt_pk_bf16_f32 v112, v16, v17
    v_cmp_ngt_f32 vcc, s29, v168
    v_mfma_f32_16x16x32_bf16 v[44:47], v[148:151], v[140:143], v[100:103]
    v_cvt_pk_bf16_f32 v113, v18, v19
    v_exp_f32 v22, v22
    v_mfma_f32_16x16x32_bf16 v[36:39], v[148:151], v[136:139], v[96:99]
    s_cbranch_vccnz attn_out_kernel_rare30
attn_out_kernel_back30:
    s_barrier
    ds_read_b128 v[144:147], v2 offset:0
    ds_read_b128 v[148:151], v2 offset:1024
    v_exp_f32 v23, v23
    v_exp_f32 v24, v24
    v_mfma_f32_16x16x32_bf16 v[64:67], v[152:155], v[120:123], v[64:67]
    v_exp_f32 v25, v25
    v_mfma_f32_16x16x32_bf16 v[72:75], v[152:155], v[124:127], v[72:75]
    ds_read_b64_tr_b16 v[152:153], v4 offset:55296
    v_cvt_pk_bf16_f32 v114, v20, v21
    v_cvt_pk_bf16_f32 v115, v22, v23
    v_exp_f32 v26, v26
    v_exp_f32 v27, v27
    v_mfma_f32_16x16x32_bf16 v[76:79], v[156:159], v[124:127], v[76:79]
    v_exp_f32 v28, v28
    v_mfma_f32_16x16x32_bf16 v[68:71], v[156:159], v[120:123], v[68:71]
    v_exp_f32 v29, v29
    ds_read_b64_tr_b16 v[154:155], v4 offset:56320
    v_cvt_pk_bf16_f32 v116, v24, v25
    v_exp_f32 v30, v30
    v_exp_f32 v31, v31
    v_cvt_pk_bf16_f32 v117, v26, v27
    v_cvt_pk_bf16_f32 v118, v28, v29
    v_cvt_pk_bf16_f32 v119, v30, v31
    v_exp_f32 v32, v32
    v_mfma_f32_16x16x32_bf16 v[164:167], v[176:179], v[112:115], v[160:163]
    v_exp_f32 v33, v33
    v_mfma_f32_16x16x32_bf16 v[164:167], v[208:211], v[116:119], v[164:167]
    s_waitcnt lgkmcnt(2)
    ds_read_b64_tr_b16 v[156:157], v3 offset:55296
    ds_read_b64_tr_b16 v[158:159], v3 offset:56320
    v_mfma_f32_16x16x32_bf16 v[16:19], v[144:147], v[128:131], v[80:83]
    v_exp_f32 v34, v34
    v_mfma_f32_16x16x32_bf16 v[24:27], v[144:147], v[132:135], v[84:87]
    v_exp_f32 v35, v35
    v_mfma_f32_16x16x32_bf16 v[28:31], v[148:151], v[132:135], v[84:87]
    s_setprio 2
    v_exp_f32 v36, v36
    v_exp_f32 v37, v37
    v_cmp_ngt_f32 vcc, s29, v164
    v_mfma_f32_16x16x32_bf16 v[20:23], v[148:151], v[128:131], v[80:83]
    v_cvt_pk_bf16_f32 v120, v32, v33
    v_cvt_pk_bf16_f32 v121, v34, v35
    s_waitcnt lgkmcnt(2)
    s_cbranch_vccnz attn_out_kernel_rare31
attn_out_kernel_back31:
    v_exp_f32 v38, v38
    v_exp_f32 v39, v39
    v_exp_f32 v40, v40
    v_mfma_f32_16x16x32_bf16 v[48:51], v[152:155], v[112:115], v[48:51]
    s_waitcnt lgkmcnt(0)
    v_cvt_pk_bf16_f32 v122, v36, v37
    v_cvt_pk_bf16_f32 v123, v38, v39
    v_mfma_f32_16x16x32_bf16 v[56:59], v[152:155], v[116:119], v[56:59]
    v_exp_f32 v41, v41
    v_mfma_f32_16x16x32_bf16 v[60:63], v[156:159], v[116:119], v[60:63]
    v_exp_f32 v42, v42
    v_exp_f32 v43, v43
    v_exp_f32 v44, v44
    v_exp_f32 v45, v45
    v_exp_f32 v46, v46
    v_mfma_f32_16x16x32_bf16 v[52:55], v[156:159], v[112:115], v[52:55]
    v_exp_f32 v47, v47
    v_cvt_pk_bf16_f32 v124, v40, v41
    v_cvt_pk_bf16_f32 v125, v42, v43
    v_cvt_pk_bf16_f32 v126, v44, v45
    v_cvt_pk_bf16_f32 v127, v46, v47
    s_sub_u32 s30, s30, 4
    s_cmp_lg_u32 s30, 0
    s_cbranch_scc1 attn_out_kernel_loop
    v_bfe_u32 v13, v0, 4, 1
    v_lshlrev_b32 v13, 15, v13
    v_lshrrev_b32 v12, 5, v0
    v_lshl_add_u32 v13, v12, 9, v13
    v_and_b32 v12, 15, v0
    v_lshl_add_u32 v13, v12, 4, v13
    v_and_b32 v13, 15, v0
    v_lshlrev_b32 v13, 4, v13
    v_bfe_u32 v12, v0, 4, 1
    v_lshl_add_u32 v13, v12, 9, v13
    v_lshrrev_b32 v12, 5, v0
    v_lshl_add_u32 v13, v12, 8, v13
    v_add_u32 v14, 0x8000, v13
    s_lshl_b32 s27, s26, 4
    s_lshl_b32 s28, s24, 2
    s_add_u32 s27, s27, s28
    s_lshl_b32 s27, s27, 15
    s_lshl_b32 s28, s25, 10
    s_add_u32 s27, s27, s28
    s_add_u32 s28, s27, 65536
    v_mfma_f32_16x16x32_bf16 v[172:175], v[176:179], v[120:123], v[168:171]
    s_nop 1
    v_mfma_f32_16x16x32_bf16 v[172:175], v[208:211], v[124:127], v[172:175]
    s_nop 3
    v_rcp_f32 v12, v164
    s_nop 0
    v_mov_b32 v15, v12
    s_nop 1
    v_permlane16_swap_b32 v12, v15
    s_nop 1
    v_mul_f32 v48, v48, v12
    v_cmp_ngt_f32 vcc, s29, v172
    v_mul_f32 v49, v49, v12
    v_mul_f32 v50, v50, v12
    s_cbranch_vccnz attn_out_kernel_rare32
attn_out_kernel_back32:
    v_mfma_f32_16x16x32_bf16 v[64:67], v[152:155], v[120:123], v[64:67]
    v_mfma_f32_16x16x32_bf16 v[72:75], v[152:155], v[124:127], v[72:75]
    v_mul_f32 v51, v51, v12
    v_mul_f32 v52, v52, v12
    v_mul_f32 v53, v53, v12
    v_mul_f32 v54, v54, v12
    v_mfma_f32_16x16x32_bf16 v[76:79], v[156:159], v[124:127], v[76:79]
    v_mfma_f32_16x16x32_bf16 v[68:71], v[156:159], v[120:123], v[68:71]
    v_mul_f32 v55, v55, v12
    v_cvt_pk_bf16_f32 v16, v48, v49
    v_cvt_pk_bf16_f32 v17, v50, v51
    v_cvt_pk_bf16_f32 v18, v52, v53
    v_cvt_pk_bf16_f32 v19, v54, v55
    s_nop 1
    v_permlane16_swap_b32 v16, v18
    v_permlane16_swap_b32 v17, v19
    s_nop 1
    buffer_store_dwordx4 v[16:19], v13, s[20:23], s27 offen sc1
    v_mul_f32 v56, v56, v15
    v_mul_f32 v57, v57, v15
    v_mul_f32 v58, v58, v15
    v_mul_f32 v59, v59, v15
    v_mul_f32 v60, v60, v15
    v_mul_f32 v61, v61, v15
    v_mul_f32 v62, v62, v15
    v_mul_f32 v63, v63, v15
    v_cvt_pk_bf16_f32 v20, v56, v57
    v_cvt_pk_bf16_f32 v21, v58, v59
    v_cvt_pk_bf16_f32 v22, v60, v61
    v_cvt_pk_bf16_f32 v23, v62, v63
    s_nop 1
    v_permlane16_swap_b32 v20, v22
    v_permlane16_swap_b32 v21, v23
    s_nop 1
    buffer_store_dwordx4 v[20:23], v14, s[20:23], s27 offen sc1
    s_nop 7
    v_rcp_f32 v12, v172
    s_nop 0
    v_mov_b32 v15, v12
    s_nop 1
    v_permlane16_swap_b32 v12, v15
    s_nop 1
    v_mul_f32 v64, v64, v12
    v_mul_f32 v65, v65, v12
    v_mul_f32 v66, v66, v12
    v_mul_f32 v67, v67, v12
    v_mul_f32 v68, v68, v12
    v_mul_f32 v69, v69, v12
    v_mul_f32 v70, v70, v12
    v_mul_f32 v71, v71, v12
    v_cvt_pk_bf16_f32 v32, v64, v65
    v_cvt_pk_bf16_f32 v33, v66, v67
    v_cvt_pk_bf16_f32 v34, v68, v69
    v_cvt_pk_bf16_f32 v35, v70, v71
    s_nop 1
    v_permlane16_swap_b32 v32, v34
    v_permlane16_swap_b32 v33, v35
    s_nop 1
    buffer_store_dwordx4 v[32:35], v13, s[20:23], s28 offen sc1
    v_mul_f32 v72, v72, v15
    v_mul_f32 v73, v73, v15
    v_mul_f32 v74, v74, v15
    v_mul_f32 v75, v75, v15
    v_mul_f32 v76, v76, v15
    v_mul_f32 v77, v77, v15
    v_mul_f32 v78, v78, v15
    v_mul_f32 v79, v79, v15
    v_cvt_pk_bf16_f32 v36, v72, v73
    v_cvt_pk_bf16_f32 v37, v74, v75
    v_cvt_pk_bf16_f32 v38, v76, v77
    v_cvt_pk_bf16_f32 v39, v78, v79
    s_nop 1
    v_permlane16_swap_b32 v36, v38
    v_permlane16_swap_b32 v37, v39
    s_nop 1
    buffer_store_dwordx4 v[36:39], v14, s[20:23], s28 offen sc1
    s_and_b32 s27, s2, 7
    s_lshr_b32 s28, s2, 3
    s_lshr_b32 s48, s27, 1
    s_lshl_b32 s48, s48, 2
    s_and_b32 s3, s28, 3
    s_add_u32 s48, s48, s3
    s_and_b32 s49, s27, 1
    s_lshr_b32 s3, s28, 2
    s_lshl_b32 s3, s3, 1
    s_add_u32 s49, s49, s3
    s_lshl_b32 s50, s49, 7
    s_lshl_b32 s51, s48, 3
    s_lshl_b32 s3, s24, 1
    s_add_u32 s51, s51, s3
    s_add_u32 s6, s4, 43122688
    s_addc_u32 s7, s5, 0
    s_mov_b32 s76, s6
    s_and_b32 s77, s7, 0xffff
    s_mov_b32 s78, 32768
    s_mov_b32 s79, 0x20000
    s_mov_b32 s52, 98304
    s_cmp_ge_u32 s24, 2
    s_cselect_b32 s52, 147456, s52
    s_lshl_b32 s3, s24, 12
    s_add_u32 s52, s52, s3
    v_lshrrev_b32 v11, 4, v0
    v_bfe_u32 v12, v0, 2, 2
    v_lshl_add_u32 v4, v11, 2, v12
    v_lshlrev_b32 v4, 7, v4
    v_lshrrev_b32 v12, 1, v12
    v_and_b32 v11, 1, v11
    v_lshl_or_b32 v12, v11, 1, v12
    v_lshl_add_u32 v4, v12, 5, v4
    v_and_b32 v11, 1, v0
    v_lshl_add_u32 v4, v11, 4, v4
    v_bfe_u32 v11, v0, 1, 1
    v_lshl_add_u32 v4, v11, 3, v4
    v_add_u32 v4, 139264, v4
    v_mov_b32 v5, v4
    v_xor_b32 v4, 64, v5
    s_lshl_b32 s28, s51, 15
    v_lshlrev_b32 v9, 4, v0
    v_add_u32 v9, s28, v9
    v_add_u32 v9, 16384, v9
    s_mov_b32 s53, -106496
    s_mov_b32 s54, 32768
    s_mov_b32 s55, 16384
    s_lshl_b32 s28, s24, 12
    s_add_u32 s28, s28, 49152
    v_lshlrev_b32 v11, 4, v0
    v_add_u32 v2, s52, v11
    v_add_u32 v3, s28, v11
    v_and_b32 v11, 31, v0
    v_bfe_u32 v12, v0, 1, 2
    v_lshrrev_b32 v8, 4, v0
    v_and_b32 v8, 2, v8
    v_xor_b32 v12, v12, v8
    v_lshlrev_b32 v12, 4, v12
    v_lshl_add_u32 v6, v11, 6, v12
    v_add_u32 v6, s28, v6
    v_lshrrev_b32 v11, 2, v0
    v_bfe_u32 v12, v0, 3, 2
    v_and_b32 v8, 3, v0
    v_xor_b32 v12, v12, v8
    v_lshlrev_b32 v12, 4, v12
    v_lshl_add_u32 v8, v11, 6, v12
    v_add_u32 v8, s28, v8
    s_lshl_b32 s27, s51, 4
    v_add_u32 v11, s27, v11
    v_lshlrev_b32 v10, 11, v11
    v_and_b32 v11, 3, v0
    v_lshl_add_u32 v10, v11, 4, v10
    s_add_u32 s27, s50, 64
    v_add_u32 v10, s27, v10
    s_mov_b32 s36, s70
    s_and_b32 s37, s71, 0xffff
    s_mov_b32 s38, 4194304
    s_mov_b32 s39, 0x20000
    s_mov_b32 s67, 32768
    s_lshr_b32 s27, s24, 1
    s_lshl_b32 s28, s26, 1
    s_add_u32 s27, s27, s28
    s_lshl_b32 s27, s27, 3
    s_lshr_b32 s28, s25, 2
    s_add_u32 s27, s27, s28
    s_lshl_b32 s27, s27, 8
    s_and_b32 s28, s25, 3
    s_lshl_b32 s28, s28, 3
    s_add_u32 s27, s27, s28
    s_and_b32 s28, s24, 1
    s_lshl_b32 s28, s28, 2
    s_add_u32 s27, s27, s28
    v_mov_b32 v11, s27
    v_mov_b32 v12, 1
    s_waitcnt vmcnt(0)
    s_mov_b64 exec, 1
    buffer_store_dword v12, v11, s[76:79], 0 offen sc1
    s_mov_b64 exec, -1
    s_setprio 0
    v_lshlrev_b32 v11, 4, v0
    v_add_u32 v11, s52, v11
    s_barrier
    ds_read_b128 v[16:19], v11 offset:0
    ds_read_b128 v[20:23], v11 offset:1024
    ds_read_b128 v[24:27], v11 offset:2048
    ds_read_b128 v[28:31], v11 offset:3072
    s_branch attn_out_kernel_proj
attn_out_kernel_rare0:
    ds_read_b128 v[184:187], v2 offset:55296
    ds_read_b128 v[188:191], v2 offset:56320
    s_waitcnt lgkmcnt(0)
    v_mfma_f32_16x16x32_bf16 v[192:195], v[184:187], v[136:139], 0
    v_mfma_f32_16x16x32_bf16 v[200:203], v[184:187], v[140:143], 0
    v_mfma_f32_16x16x32_bf16 v[204:207], v[188:191], v[140:143], 0
    v_mfma_f32_16x16x32_bf16 v[196:199], v[188:191], v[136:139], 0
    v_log_f32 v7, v168
    v_subrev_f32 v8, s32, v181
    v_add_f32 v7, v7, v181
    v_max_f32 v7, v7, v8
    s_nop 7
    s_nop 7
    v_max3_f32 v8, v192, v193, v194
    v_max3_f32 v8, v8, v195, v196
    v_max3_f32 v8, v8, v197, v198
    v_max_f32 v8, v8, v199
    v_max3_f32 v9, v200, v201, v202
    v_max3_f32 v9, v9, v203, v204
    v_max3_f32 v9, v9, v205, v206
    v_max_f32 v9, v9, v207
    s_nop 1
    v_permlane16_swap_b32 v8, v9
    s_nop 1
    v_max_f32 v8, v8, v9
    v_mov_b32 v11, v8
    s_nop 1
    v_permlane32_swap_b32 v11, v8
    s_nop 1
    v_max_f32 v8, v8, v11
    v_max_f32 v7, v7, v8
    v_add_f32 v7, s32, v7
    v_ceil_f32 v7, v7
    v_sub_f32 v8, v181, v7
    v_cvt_i32_f32 v8, v8
    v_mov_b32 v181, v7
    v_ldexp_f32 v168, v168, v8
    v_mov_b32 v9, v8
    s_nop 1
    v_permlane16_swap_b32 v8, v9
    s_nop 1
    v_ldexp_f32 v64, v64, v8
    v_ldexp_f32 v65, v65, v8
    v_ldexp_f32 v66, v66, v8
    v_ldexp_f32 v67, v67, v8
    v_ldexp_f32 v68, v68, v8
    v_ldexp_f32 v69, v69, v8
    v_ldexp_f32 v70, v70, v8
    v_ldexp_f32 v71, v71, v8
    v_ldexp_f32 v72, v72, v9
    v_ldexp_f32 v73, v73, v9
    v_ldexp_f32 v74, v74, v9
    v_ldexp_f32 v75, v75, v9
    v_ldexp_f32 v76, v76, v9
    v_ldexp_f32 v77, v77, v9
    v_ldexp_f32 v78, v78, v9
    v_ldexp_f32 v79, v79, v9
    v_mov_b32 v11, v7
    s_nop 1
    v_permlane16_swap_b32 v7, v11
    s_nop 1
    v_sub_f32 v96, 0, v7
    v_sub_f32 v100, 0, v11
    v_mov_b32 v97, v96
    v_mov_b32 v101, v100
    v_mov_b32 v98, v96
    v_mov_b32 v102, v100
    v_mov_b32 v99, v96
    v_mov_b32 v103, v100
    v_add_f32 v192, v192, v96
    v_add_f32 v193, v193, v96
    v_add_f32 v194, v194, v96
    v_add_f32 v195, v195, v96
    v_add_f32 v196, v196, v96
    v_add_f32 v197, v197, v96
    v_add_f32 v198, v198, v96
    v_add_f32 v199, v199, v96
    v_add_f32 v200, v200, v100
    v_add_f32 v201, v201, v100
    v_add_f32 v202, v202, v100
    v_add_f32 v203, v203, v100
    v_add_f32 v204, v204, v100
    v_add_f32 v205, v205, v100
    v_add_f32 v206, v206, v100
    v_add_f32 v207, v207, v100
    v_exp_f32 v192, v192
    v_exp_f32 v193, v193
    v_exp_f32 v194, v194
    v_exp_f32 v195, v195
    v_exp_f32 v196, v196
    v_exp_f32 v197, v197
    v_exp_f32 v198, v198
    v_exp_f32 v199, v199
    v_exp_f32 v200, v200
    v_exp_f32 v201, v201
    v_exp_f32 v202, v202
    v_exp_f32 v203, v203
    v_exp_f32 v204, v204
    v_exp_f32 v205, v205
    v_exp_f32 v206, v206
    v_exp_f32 v207, v207
    s_nop 0
    v_cvt_pk_bf16_f32 v120, v192, v193
    v_cvt_pk_bf16_f32 v121, v194, v195
    v_cvt_pk_bf16_f32 v122, v196, v197
    v_cvt_pk_bf16_f32 v123, v198, v199
    v_cvt_pk_bf16_f32 v124, v200, v201
    v_cvt_pk_bf16_f32 v125, v202, v203
    v_cvt_pk_bf16_f32 v126, v204, v205
    v_cvt_pk_bf16_f32 v127, v206, v207
    s_nop 1
    v_mfma_f32_16x16x32_bf16 v[172:175], v[176:179], v[120:123], v[168:171]
    v_mfma_f32_16x16x32_bf16 v[172:175], v[208:211], v[124:127], v[172:175]
    v_mfma_f32_16x16x32_bf16 v[32:35], v[144:147], v[136:139], v[96:99]
    v_mfma_f32_16x16x32_bf16 v[40:43], v[144:147], v[140:143], v[100:103]
    v_mfma_f32_16x16x32_bf16 v[44:47], v[148:151], v[140:143], v[100:103]
    v_mfma_f32_16x16x32_bf16 v[36:39], v[148:151], v[136:139], v[96:99]
    s_branch attn_out_kernel_back0
attn_out_kernel_rare1:
    ds_read_b128 v[184:187], v2 offset:0
    ds_read_b128 v[188:191], v2 offset:1024
    s_waitcnt lgkmcnt(0)
    v_mfma_f32_16x16x32_bf16 v[192:195], v[184:187], v[128:131], 0
    v_mfma_f32_16x16x32_bf16 v[200:203], v[184:187], v[132:135], 0
    v_mfma_f32_16x16x32_bf16 v[204:207], v[188:191], v[132:135], 0
    v_mfma_f32_16x16x32_bf16 v[196:199], v[188:191], v[128:131], 0
    v_log_f32 v7, v164
    v_subrev_f32 v8, s32, v180
    v_add_f32 v7, v7, v180
    v_max_f32 v7, v7, v8
    s_nop 7
    s_nop 7
    v_max3_f32 v8, v192, v193, v194
    v_max3_f32 v8, v8, v195, v196
    v_max3_f32 v8, v8, v197, v198
    v_max_f32 v8, v8, v199
    v_max3_f32 v9, v200, v201, v202
    v_max3_f32 v9, v9, v203, v204
    v_max3_f32 v9, v9, v205, v206
    v_max_f32 v9, v9, v207
    s_nop 1
    v_permlane16_swap_b32 v8, v9
    s_nop 1
    v_max_f32 v8, v8, v9
    v_mov_b32 v11, v8
    s_nop 1
    v_permlane32_swap_b32 v11, v8
    s_nop 1
    v_max_f32 v8, v8, v11
    v_max_f32 v7, v7, v8
    v_add_f32 v7, s32, v7
    v_ceil_f32 v7, v7
    v_sub_f32 v8, v180, v7
    v_cvt_i32_f32 v8, v8
    v_mov_b32 v180, v7
    v_ldexp_f32 v164, v164, v8
    v_mov_b32 v9, v8
    s_nop 1
    v_permlane16_swap_b32 v8, v9
    s_nop 1
    v_ldexp_f32 v48, v48, v8
    v_ldexp_f32 v49, v49, v8
    v_ldexp_f32 v50, v50, v8
    v_ldexp_f32 v51, v51, v8
    v_ldexp_f32 v52, v52, v8
    v_ldexp_f32 v53, v53, v8
    v_ldexp_f32 v54, v54, v8
    v_ldexp_f32 v55, v55, v8
    v_ldexp_f32 v56, v56, v9
    v_ldexp_f32 v57, v57, v9
    v_ldexp_f32 v58, v58, v9
    v_ldexp_f32 v59, v59, v9
    v_ldexp_f32 v60, v60, v9
    v_ldexp_f32 v61, v61, v9
    v_ldexp_f32 v62, v62, v9
    v_ldexp_f32 v63, v63, v9
    v_mov_b32 v11, v7
    s_nop 1
    v_permlane16_swap_b32 v7, v11
    s_nop 1
    v_sub_f32 v80, 0, v7
    v_sub_f32 v84, 0, v11
    v_mov_b32 v81, v80
    v_mov_b32 v85, v84
    v_mov_b32 v82, v80
    v_mov_b32 v86, v84
    v_mov_b32 v83, v80
    v_mov_b32 v87, v84
    v_add_f32 v192, v192, v80
    v_add_f32 v193, v193, v80
    v_add_f32 v194, v194, v80
    v_add_f32 v195, v195, v80
    v_add_f32 v196, v196, v80
    v_add_f32 v197, v197, v80
    v_add_f32 v198, v198, v80
    v_add_f32 v199, v199, v80
    v_add_f32 v200, v200, v84
    v_add_f32 v201, v201, v84
    v_add_f32 v202, v202, v84
    v_add_f32 v203, v203, v84
    v_add_f32 v204, v204, v84
    v_add_f32 v205, v205, v84
    v_add_f32 v206, v206, v84
    v_add_f32 v207, v207, v84
    v_exp_f32 v192, v192
    v_exp_f32 v193, v193
    v_exp_f32 v194, v194
    v_exp_f32 v195, v195
    v_exp_f32 v196, v196
    v_exp_f32 v197, v197
    v_exp_f32 v198, v198
    v_exp_f32 v199, v199
    v_exp_f32 v200, v200
    v_exp_f32 v201, v201
    v_exp_f32 v202, v202
    v_exp_f32 v203, v203
    v_exp_f32 v204, v204
    v_exp_f32 v205, v205
    v_exp_f32 v206, v206
    v_exp_f32 v207, v207
    s_nop 0
    v_cvt_pk_bf16_f32 v112, v192, v193
    v_cvt_pk_bf16_f32 v113, v194, v195
    v_cvt_pk_bf16_f32 v114, v196, v197
    v_cvt_pk_bf16_f32 v115, v198, v199
    v_cvt_pk_bf16_f32 v116, v200, v201
    v_cvt_pk_bf16_f32 v117, v202, v203
    v_cvt_pk_bf16_f32 v118, v204, v205
    v_cvt_pk_bf16_f32 v119, v206, v207
    s_nop 1
    v_mfma_f32_16x16x32_bf16 v[160:163], v[176:179], v[112:115], v[164:167]
    v_mfma_f32_16x16x32_bf16 v[160:163], v[208:211], v[116:119], v[160:163]
    v_mfma_f32_16x16x32_bf16 v[16:19], v[144:147], v[128:131], v[80:83]
    v_mfma_f32_16x16x32_bf16 v[24:27], v[144:147], v[132:135], v[84:87]
    v_mfma_f32_16x16x32_bf16 v[28:31], v[148:151], v[132:135], v[84:87]
    v_mfma_f32_16x16x32_bf16 v[20:23], v[148:151], v[128:131], v[80:83]
    s_branch attn_out_kernel_back1
attn_out_kernel_rare2:
    ds_read_b128 v[184:187], v2 offset:0
    ds_read_b128 v[188:191], v2 offset:1024
    s_waitcnt lgkmcnt(0)
    v_mfma_f32_16x16x32_bf16 v[192:195], v[184:187], v[136:139], 0
    v_mfma_f32_16x16x32_bf16 v[200:203], v[184:187], v[140:143], 0
    v_mfma_f32_16x16x32_bf16 v[204:207], v[188:191], v[140:143], 0
    v_mfma_f32_16x16x32_bf16 v[196:199], v[188:191], v[136:139], 0
    v_log_f32 v7, v172
    v_subrev_f32 v8, s32, v181
    v_add_f32 v7, v7, v181
    v_max_f32 v7, v7, v8
    s_nop 7
    s_nop 7
    v_max3_f32 v8, v192, v193, v194
    v_max3_f32 v8, v8, v195, v196
    v_max3_f32 v8, v8, v197, v198
    v_max_f32 v8, v8, v199
    v_max3_f32 v9, v200, v201, v202
    v_max3_f32 v9, v9, v203, v204
    v_max3_f32 v9, v9, v205, v206
    v_max_f32 v9, v9, v207
    s_nop 1
    v_permlane16_swap_b32 v8, v9
    s_nop 1
    v_max_f32 v8, v8, v9
    v_mov_b32 v11, v8
    s_nop 1
    v_permlane32_swap_b32 v11, v8
    s_nop 1
    v_max_f32 v8, v8, v11
    v_max_f32 v7, v7, v8
    v_add_f32 v7, s32, v7
    v_ceil_f32 v7, v7
    v_sub_f32 v8, v181, v7
    v_cvt_i32_f32 v8, v8
    v_mov_b32 v181, v7
    v_ldexp_f32 v172, v172, v8
    v_mov_b32 v9, v8
    s_nop 1
    v_permlane16_swap_b32 v8, v9
    s_nop 1
    v_ldexp_f32 v64, v64, v8
    v_ldexp_f32 v65, v65, v8
    v_ldexp_f32 v66, v66, v8
    v_ldexp_f32 v67, v67, v8
    v_ldexp_f32 v68, v68, v8
    v_ldexp_f32 v69, v69, v8
    v_ldexp_f32 v70, v70, v8
    v_ldexp_f32 v71, v71, v8
    v_ldexp_f32 v72, v72, v9
    v_ldexp_f32 v73, v73, v9
    v_ldexp_f32 v74, v74, v9
    v_ldexp_f32 v75, v75, v9
    v_ldexp_f32 v76, v76, v9
    v_ldexp_f32 v77, v77, v9
    v_ldexp_f32 v78, v78, v9
    v_ldexp_f32 v79, v79, v9
    v_mov_b32 v11, v7
    s_nop 1
    v_permlane16_swap_b32 v7, v11
    s_nop 1
    v_sub_f32 v96, 0, v7
    v_sub_f32 v100, 0, v11
    v_mov_b32 v97, v96
    v_mov_b32 v101, v100
    v_mov_b32 v98, v96
    v_mov_b32 v102, v100
    v_mov_b32 v99, v96
    v_mov_b32 v103, v100
    v_add_f32 v192, v192, v96
    v_add_f32 v193, v193, v96
    v_add_f32 v194, v194, v96
    v_add_f32 v195, v195, v96
    v_add_f32 v196, v196, v96
    v_add_f32 v197, v197, v96
    v_add_f32 v198, v198, v96
    v_add_f32 v199, v199, v96
    v_add_f32 v200, v200, v100
    v_add_f32 v201, v201, v100
    v_add_f32 v202, v202, v100
    v_add_f32 v203, v203, v100
    v_add_f32 v204, v204, v100
    v_add_f32 v205, v205, v100
    v_add_f32 v206, v206, v100
    v_add_f32 v207, v207, v100
    v_exp_f32 v192, v192
    v_exp_f32 v193, v193
    v_exp_f32 v194, v194
    v_exp_f32 v195, v195
    v_exp_f32 v196, v196
    v_exp_f32 v197, v197
    v_exp_f32 v198, v198
    v_exp_f32 v199, v199
    v_exp_f32 v200, v200
    v_exp_f32 v201, v201
    v_exp_f32 v202, v202
    v_exp_f32 v203, v203
    v_exp_f32 v204, v204
    v_exp_f32 v205, v205
    v_exp_f32 v206, v206
    v_exp_f32 v207, v207
    s_nop 0
    v_cvt_pk_bf16_f32 v120, v192, v193
    v_cvt_pk_bf16_f32 v121, v194, v195
    v_cvt_pk_bf16_f32 v122, v196, v197
    v_cvt_pk_bf16_f32 v123, v198, v199
    v_cvt_pk_bf16_f32 v124, v200, v201
    v_cvt_pk_bf16_f32 v125, v202, v203
    v_cvt_pk_bf16_f32 v126, v204, v205
    v_cvt_pk_bf16_f32 v127, v206, v207
    s_nop 1
    v_mfma_f32_16x16x32_bf16 v[168:171], v[176:179], v[120:123], v[172:175]
    v_mfma_f32_16x16x32_bf16 v[168:171], v[208:211], v[124:127], v[168:171]
    v_mfma_f32_16x16x32_bf16 v[32:35], v[144:147], v[136:139], v[96:99]
    v_mfma_f32_16x16x32_bf16 v[40:43], v[144:147], v[140:143], v[100:103]
    v_mfma_f32_16x16x32_bf16 v[44:47], v[148:151], v[140:143], v[100:103]
    v_mfma_f32_16x16x32_bf16 v[36:39], v[148:151], v[136:139], v[96:99]
    s_branch attn_out_kernel_back2
attn_out_kernel_rare3:
    ds_read_b128 v[184:187], v2 offset:2048
    ds_read_b128 v[188:191], v2 offset:3072
    s_waitcnt lgkmcnt(0)
    v_mfma_f32_16x16x32_bf16 v[192:195], v[184:187], v[128:131], 0
    v_mfma_f32_16x16x32_bf16 v[200:203], v[184:187], v[132:135], 0
    v_mfma_f32_16x16x32_bf16 v[204:207], v[188:191], v[132:135], 0
    v_mfma_f32_16x16x32_bf16 v[196:199], v[188:191], v[128:131], 0
    v_log_f32 v7, v160
    v_subrev_f32 v8, s32, v180
    v_add_f32 v7, v7, v180
    v_max_f32 v7, v7, v8
    s_nop 7
    s_nop 7
    v_max3_f32 v8, v192, v193, v194
    v_max3_f32 v8, v8, v195, v196
    v_max3_f32 v8, v8, v197, v198
    v_max_f32 v8, v8, v199
    v_max3_f32 v9, v200, v201, v202
    v_max3_f32 v9, v9, v203, v204
    v_max3_f32 v9, v9, v205, v206
    v_max_f32 v9, v9, v207
    s_nop 1
    v_permlane16_swap_b32 v8, v9
    s_nop 1
    v_max_f32 v8, v8, v9
    v_mov_b32 v11, v8
    s_nop 1
    v_permlane32_swap_b32 v11, v8
    s_nop 1
    v_max_f32 v8, v8, v11
    v_max_f32 v7, v7, v8
    v_add_f32 v7, s32, v7
    v_ceil_f32 v7, v7
    v_sub_f32 v8, v180, v7
    v_cvt_i32_f32 v8, v8
    v_mov_b32 v180, v7
    v_ldexp_f32 v160, v160, v8
    v_mov_b32 v9, v8
    s_nop 1
    v_permlane16_swap_b32 v8, v9
    s_nop 1
    v_ldexp_f32 v48, v48, v8
    v_ldexp_f32 v49, v49, v8
    v_ldexp_f32 v50, v50, v8
    v_ldexp_f32 v51, v51, v8
    v_ldexp_f32 v52, v52, v8
    v_ldexp_f32 v53, v53, v8
    v_ldexp_f32 v54, v54, v8
    v_ldexp_f32 v55, v55, v8
    v_ldexp_f32 v56, v56, v9
    v_ldexp_f32 v57, v57, v9
    v_ldexp_f32 v58, v58, v9
    v_ldexp_f32 v59, v59, v9
    v_ldexp_f32 v60, v60, v9
    v_ldexp_f32 v61, v61, v9
    v_ldexp_f32 v62, v62, v9
    v_ldexp_f32 v63, v63, v9
    v_mov_b32 v11, v7
    s_nop 1
    v_permlane16_swap_b32 v7, v11
    s_nop 1
    v_sub_f32 v80, 0, v7
    v_sub_f32 v84, 0, v11
    v_mov_b32 v81, v80
    v_mov_b32 v85, v84
    v_mov_b32 v82, v80
    v_mov_b32 v86, v84
    v_mov_b32 v83, v80
    v_mov_b32 v87, v84
    v_add_f32 v192, v192, v80
    v_add_f32 v193, v193, v80
    v_add_f32 v194, v194, v80
    v_add_f32 v195, v195, v80
    v_add_f32 v196, v196, v80
    v_add_f32 v197, v197, v80
    v_add_f32 v198, v198, v80
    v_add_f32 v199, v199, v80
    v_add_f32 v200, v200, v84
    v_add_f32 v201, v201, v84
    v_add_f32 v202, v202, v84
    v_add_f32 v203, v203, v84
    v_add_f32 v204, v204, v84
    v_add_f32 v205, v205, v84
    v_add_f32 v206, v206, v84
    v_add_f32 v207, v207, v84
    v_exp_f32 v192, v192
    v_exp_f32 v193, v193
    v_exp_f32 v194, v194
    v_exp_f32 v195, v195
    v_exp_f32 v196, v196
    v_exp_f32 v197, v197
    v_exp_f32 v198, v198
    v_exp_f32 v199, v199
    v_exp_f32 v200, v200
    v_exp_f32 v201, v201
    v_exp_f32 v202, v202
    v_exp_f32 v203, v203
    v_exp_f32 v204, v204
    v_exp_f32 v205, v205
    v_exp_f32 v206, v206
    v_exp_f32 v207, v207
    s_nop 0
    v_cvt_pk_bf16_f32 v112, v192, v193
    v_cvt_pk_bf16_f32 v113, v194, v195
    v_cvt_pk_bf16_f32 v114, v196, v197
    v_cvt_pk_bf16_f32 v115, v198, v199
    v_cvt_pk_bf16_f32 v116, v200, v201
    v_cvt_pk_bf16_f32 v117, v202, v203
    v_cvt_pk_bf16_f32 v118, v204, v205
    v_cvt_pk_bf16_f32 v119, v206, v207
    s_nop 1
    v_mfma_f32_16x16x32_bf16 v[164:167], v[176:179], v[112:115], v[160:163]
    v_mfma_f32_16x16x32_bf16 v[164:167], v[208:211], v[116:119], v[164:167]
    v_mfma_f32_16x16x32_bf16 v[16:19], v[144:147], v[128:131], v[80:83]
    v_mfma_f32_16x16x32_bf16 v[24:27], v[144:147], v[132:135], v[84:87]
    v_mfma_f32_16x16x32_bf16 v[28:31], v[148:151], v[132:135], v[84:87]
    v_mfma_f32_16x16x32_bf16 v[20:23], v[148:151], v[128:131], v[80:83]
    s_branch attn_out_kernel_back3
attn_out_kernel_rare4:
    ds_read_b128 v[184:187], v2 offset:2048
    ds_read_b128 v[188:191], v2 offset:3072
    s_waitcnt lgkmcnt(0)
    v_mfma_f32_16x16x32_bf16 v[192:195], v[184:187], v[136:139], 0
    v_mfma_f32_16x16x32_bf16 v[200:203], v[184:187], v[140:143], 0
    v_mfma_f32_16x16x32_bf16 v[204:207], v[188:191], v[140:143], 0
    v_mfma_f32_16x16x32_bf16 v[196:199], v[188:191], v[136:139], 0
    v_log_f32 v7, v168
    v_subrev_f32 v8, s32, v181
    v_add_f32 v7, v7, v181
    v_max_f32 v7, v7, v8
    s_nop 7
    s_nop 7
    v_max3_f32 v8, v192, v193, v194
    v_max3_f32 v8, v8, v195, v196
    v_max3_f32 v8, v8, v197, v198
    v_max_f32 v8, v8, v199
    v_max3_f32 v9, v200, v201, v202
    v_max3_f32 v9, v9, v203, v204
    v_max3_f32 v9, v9, v205, v206
    v_max_f32 v9, v9, v207
    s_nop 1
    v_permlane16_swap_b32 v8, v9
    s_nop 1
    v_max_f32 v8, v8, v9
    v_mov_b32 v11, v8
    s_nop 1
    v_permlane32_swap_b32 v11, v8
    s_nop 1
    v_max_f32 v8, v8, v11
    v_max_f32 v7, v7, v8
    v_add_f32 v7, s32, v7
    v_ceil_f32 v7, v7
    v_sub_f32 v8, v181, v7
    v_cvt_i32_f32 v8, v8
    v_mov_b32 v181, v7
    v_ldexp_f32 v168, v168, v8
    v_mov_b32 v9, v8
    s_nop 1
    v_permlane16_swap_b32 v8, v9
    s_nop 1
    v_ldexp_f32 v64, v64, v8
    v_ldexp_f32 v65, v65, v8
    v_ldexp_f32 v66, v66, v8
    v_ldexp_f32 v67, v67, v8
    v_ldexp_f32 v68, v68, v8
    v_ldexp_f32 v69, v69, v8
    v_ldexp_f32 v70, v70, v8
    v_ldexp_f32 v71, v71, v8
    v_ldexp_f32 v72, v72, v9
    v_ldexp_f32 v73, v73, v9
    v_ldexp_f32 v74, v74, v9
    v_ldexp_f32 v75, v75, v9
    v_ldexp_f32 v76, v76, v9
    v_ldexp_f32 v77, v77, v9
    v_ldexp_f32 v78, v78, v9
    v_ldexp_f32 v79, v79, v9
    v_mov_b32 v11, v7
    s_nop 1
    v_permlane16_swap_b32 v7, v11
    s_nop 1
    v_sub_f32 v96, 0, v7
    v_sub_f32 v100, 0, v11
    v_mov_b32 v97, v96
    v_mov_b32 v101, v100
    v_mov_b32 v98, v96
    v_mov_b32 v102, v100
    v_mov_b32 v99, v96
    v_mov_b32 v103, v100
    v_add_f32 v192, v192, v96
    v_add_f32 v193, v193, v96
    v_add_f32 v194, v194, v96
    v_add_f32 v195, v195, v96
    v_add_f32 v196, v196, v96
    v_add_f32 v197, v197, v96
    v_add_f32 v198, v198, v96
    v_add_f32 v199, v199, v96
    v_add_f32 v200, v200, v100
    v_add_f32 v201, v201, v100
    v_add_f32 v202, v202, v100
    v_add_f32 v203, v203, v100
    v_add_f32 v204, v204, v100
    v_add_f32 v205, v205, v100
    v_add_f32 v206, v206, v100
    v_add_f32 v207, v207, v100
    v_exp_f32 v192, v192
    v_exp_f32 v193, v193
    v_exp_f32 v194, v194
    v_exp_f32 v195, v195
    v_exp_f32 v196, v196
    v_exp_f32 v197, v197
    v_exp_f32 v198, v198
    v_exp_f32 v199, v199
    v_exp_f32 v200, v200
    v_exp_f32 v201, v201
    v_exp_f32 v202, v202
    v_exp_f32 v203, v203
    v_exp_f32 v204, v204
    v_exp_f32 v205, v205
    v_exp_f32 v206, v206
    v_exp_f32 v207, v207
    s_nop 0
    v_cvt_pk_bf16_f32 v120, v192, v193
    v_cvt_pk_bf16_f32 v121, v194, v195
    v_cvt_pk_bf16_f32 v122, v196, v197
    v_cvt_pk_bf16_f32 v123, v198, v199
    v_cvt_pk_bf16_f32 v124, v200, v201
    v_cvt_pk_bf16_f32 v125, v202, v203
    v_cvt_pk_bf16_f32 v126, v204, v205
    v_cvt_pk_bf16_f32 v127, v206, v207
    s_nop 1
    v_mfma_f32_16x16x32_bf16 v[172:175], v[176:179], v[120:123], v[168:171]
    v_mfma_f32_16x16x32_bf16 v[172:175], v[208:211], v[124:127], v[172:175]
    v_mfma_f32_16x16x32_bf16 v[32:35], v[144:147], v[136:139], v[96:99]
    v_mfma_f32_16x16x32_bf16 v[40:43], v[144:147], v[140:143], v[100:103]
    v_mfma_f32_16x16x32_bf16 v[44:47], v[148:151], v[140:143], v[100:103]
    v_mfma_f32_16x16x32_bf16 v[36:39], v[148:151], v[136:139], v[96:99]
    s_branch attn_out_kernel_back4
attn_out_kernel_rare5:
    ds_read_b128 v[184:187], v2 offset:4096
    ds_read_b128 v[188:191], v2 offset:5120
    s_waitcnt lgkmcnt(0)
    v_mfma_f32_16x16x32_bf16 v[192:195], v[184:187], v[128:131], 0
    v_mfma_f32_16x16x32_bf16 v[200:203], v[184:187], v[132:135], 0
    v_mfma_f32_16x16x32_bf16 v[204:207], v[188:191], v[132:135], 0
    v_mfma_f32_16x16x32_bf16 v[196:199], v[188:191], v[128:131], 0
    v_log_f32 v7, v164
    v_subrev_f32 v8, s32, v180
    v_add_f32 v7, v7, v180
    v_max_f32 v7, v7, v8
    s_nop 7
    s_nop 7
    v_max3_f32 v8, v192, v193, v194
    v_max3_f32 v8, v8, v195, v196
    v_max3_f32 v8, v8, v197, v198
    v_max_f32 v8, v8, v199
    v_max3_f32 v9, v200, v201, v202
    v_max3_f32 v9, v9, v203, v204
    v_max3_f32 v9, v9, v205, v206
    v_max_f32 v9, v9, v207
    s_nop 1
    v_permlane16_swap_b32 v8, v9
    s_nop 1
    v_max_f32 v8, v8, v9
    v_mov_b32 v11, v8
    s_nop 1
    v_permlane32_swap_b32 v11, v8
    s_nop 1
    v_max_f32 v8, v8, v11
    v_max_f32 v7, v7, v8
    v_add_f32 v7, s32, v7
    v_ceil_f32 v7, v7
    v_sub_f32 v8, v180, v7
    v_cvt_i32_f32 v8, v8
    v_mov_b32 v180, v7
    v_ldexp_f32 v164, v164, v8
    v_mov_b32 v9, v8
    s_nop 1
    v_permlane16_swap_b32 v8, v9
    s_nop 1
    v_ldexp_f32 v48, v48, v8
    v_ldexp_f32 v49, v49, v8
    v_ldexp_f32 v50, v50, v8
    v_ldexp_f32 v51, v51, v8
    v_ldexp_f32 v52, v52, v8
    v_ldexp_f32 v53, v53, v8
    v_ldexp_f32 v54, v54, v8
    v_ldexp_f32 v55, v55, v8
    v_ldexp_f32 v56, v56, v9
    v_ldexp_f32 v57, v57, v9
    v_ldexp_f32 v58, v58, v9
    v_ldexp_f32 v59, v59, v9
    v_ldexp_f32 v60, v60, v9
    v_ldexp_f32 v61, v61, v9
    v_ldexp_f32 v62, v62, v9
    v_ldexp_f32 v63, v63, v9
    v_mov_b32 v11, v7
    s_nop 1
    v_permlane16_swap_b32 v7, v11
    s_nop 1
    v_sub_f32 v80, 0, v7
    v_sub_f32 v84, 0, v11
    v_mov_b32 v81, v80
    v_mov_b32 v85, v84
    v_mov_b32 v82, v80
    v_mov_b32 v86, v84
    v_mov_b32 v83, v80
    v_mov_b32 v87, v84
    v_add_f32 v192, v192, v80
    v_add_f32 v193, v193, v80
    v_add_f32 v194, v194, v80
    v_add_f32 v195, v195, v80
    v_add_f32 v196, v196, v80
    v_add_f32 v197, v197, v80
    v_add_f32 v198, v198, v80
    v_add_f32 v199, v199, v80
    v_add_f32 v200, v200, v84
    v_add_f32 v201, v201, v84
    v_add_f32 v202, v202, v84
    v_add_f32 v203, v203, v84
    v_add_f32 v204, v204, v84
    v_add_f32 v205, v205, v84
    v_add_f32 v206, v206, v84
    v_add_f32 v207, v207, v84
    v_exp_f32 v192, v192
    v_exp_f32 v193, v193
    v_exp_f32 v194, v194
    v_exp_f32 v195, v195
    v_exp_f32 v196, v196
    v_exp_f32 v197, v197
    v_exp_f32 v198, v198
    v_exp_f32 v199, v199
    v_exp_f32 v200, v200
    v_exp_f32 v201, v201
    v_exp_f32 v202, v202
    v_exp_f32 v203, v203
    v_exp_f32 v204, v204
    v_exp_f32 v205, v205
    v_exp_f32 v206, v206
    v_exp_f32 v207, v207
    s_nop 0
    v_cvt_pk_bf16_f32 v112, v192, v193
    v_cvt_pk_bf16_f32 v113, v194, v195
    v_cvt_pk_bf16_f32 v114, v196, v197
    v_cvt_pk_bf16_f32 v115, v198, v199
    v_cvt_pk_bf16_f32 v116, v200, v201
    v_cvt_pk_bf16_f32 v117, v202, v203
    v_cvt_pk_bf16_f32 v118, v204, v205
    v_cvt_pk_bf16_f32 v119, v206, v207
    s_nop 1
    v_mfma_f32_16x16x32_bf16 v[160:163], v[176:179], v[112:115], v[164:167]
    v_mfma_f32_16x16x32_bf16 v[160:163], v[208:211], v[116:119], v[160:163]
    v_mfma_f32_16x16x32_bf16 v[16:19], v[144:147], v[128:131], v[80:83]
    v_mfma_f32_16x16x32_bf16 v[24:27], v[144:147], v[132:135], v[84:87]
    v_mfma_f32_16x16x32_bf16 v[28:31], v[148:151], v[132:135], v[84:87]
    v_mfma_f32_16x16x32_bf16 v[20:23], v[148:151], v[128:131], v[80:83]
    s_branch attn_out_kernel_back5
attn_out_kernel_rare6:
    ds_read_b128 v[184:187], v2 offset:4096
    ds_read_b128 v[188:191], v2 offset:5120
    s_waitcnt lgkmcnt(0)
    v_mfma_f32_16x16x32_bf16 v[192:195], v[184:187], v[136:139], 0
    v_mfma_f32_16x16x32_bf16 v[200:203], v[184:187], v[140:143], 0
    v_mfma_f32_16x16x32_bf16 v[204:207], v[188:191], v[140:143], 0
    v_mfma_f32_16x16x32_bf16 v[196:199], v[188:191], v[136:139], 0
    v_log_f32 v7, v172
    v_subrev_f32 v8, s32, v181
    v_add_f32 v7, v7, v181
    v_max_f32 v7, v7, v8
    s_nop 7
    s_nop 7
    v_max3_f32 v8, v192, v193, v194
    v_max3_f32 v8, v8, v195, v196
    v_max3_f32 v8, v8, v197, v198
    v_max_f32 v8, v8, v199
    v_max3_f32 v9, v200, v201, v202
    v_max3_f32 v9, v9, v203, v204
    v_max3_f32 v9, v9, v205, v206
    v_max_f32 v9, v9, v207
    s_nop 1
    v_permlane16_swap_b32 v8, v9
    s_nop 1
    v_max_f32 v8, v8, v9
    v_mov_b32 v11, v8
    s_nop 1
    v_permlane32_swap_b32 v11, v8
    s_nop 1
    v_max_f32 v8, v8, v11
    v_max_f32 v7, v7, v8
    v_add_f32 v7, s32, v7
    v_ceil_f32 v7, v7
    v_sub_f32 v8, v181, v7
    v_cvt_i32_f32 v8, v8
    v_mov_b32 v181, v7
    v_ldexp_f32 v172, v172, v8
    v_mov_b32 v9, v8
    s_nop 1
    v_permlane16_swap_b32 v8, v9
    s_nop 1
    v_ldexp_f32 v64, v64, v8
    v_ldexp_f32 v65, v65, v8
    v_ldexp_f32 v66, v66, v8
    v_ldexp_f32 v67, v67, v8
    v_ldexp_f32 v68, v68, v8
    v_ldexp_f32 v69, v69, v8
    v_ldexp_f32 v70, v70, v8
    v_ldexp_f32 v71, v71, v8
    v_ldexp_f32 v72, v72, v9
    v_ldexp_f32 v73, v73, v9
    v_ldexp_f32 v74, v74, v9
    v_ldexp_f32 v75, v75, v9
    v_ldexp_f32 v76, v76, v9
    v_ldexp_f32 v77, v77, v9
    v_ldexp_f32 v78, v78, v9
    v_ldexp_f32 v79, v79, v9
    v_mov_b32 v11, v7
    s_nop 1
    v_permlane16_swap_b32 v7, v11
    s_nop 1
    v_sub_f32 v96, 0, v7
    v_sub_f32 v100, 0, v11
    v_mov_b32 v97, v96
    v_mov_b32 v101, v100
    v_mov_b32 v98, v96
    v_mov_b32 v102, v100
    v_mov_b32 v99, v96
    v_mov_b32 v103, v100
    v_add_f32 v192, v192, v96
    v_add_f32 v193, v193, v96
    v_add_f32 v194, v194, v96
    v_add_f32 v195, v195, v96
    v_add_f32 v196, v196, v96
    v_add_f32 v197, v197, v96
    v_add_f32 v198, v198, v96
    v_add_f32 v199, v199, v96
    v_add_f32 v200, v200, v100
    v_add_f32 v201, v201, v100
    v_add_f32 v202, v202, v100
    v_add_f32 v203, v203, v100
    v_add_f32 v204, v204, v100
    v_add_f32 v205, v205, v100
    v_add_f32 v206, v206, v100
    v_add_f32 v207, v207, v100
    v_exp_f32 v192, v192
    v_exp_f32 v193, v193
    v_exp_f32 v194, v194
    v_exp_f32 v195, v195
    v_exp_f32 v196, v196
    v_exp_f32 v197, v197
    v_exp_f32 v198, v198
    v_exp_f32 v199, v199
    v_exp_f32 v200, v200
    v_exp_f32 v201, v201
    v_exp_f32 v202, v202
    v_exp_f32 v203, v203
    v_exp_f32 v204, v204
    v_exp_f32 v205, v205
    v_exp_f32 v206, v206
    v_exp_f32 v207, v207
    s_nop 0
    v_cvt_pk_bf16_f32 v120, v192, v193
    v_cvt_pk_bf16_f32 v121, v194, v195
    v_cvt_pk_bf16_f32 v122, v196, v197
    v_cvt_pk_bf16_f32 v123, v198, v199
    v_cvt_pk_bf16_f32 v124, v200, v201
    v_cvt_pk_bf16_f32 v125, v202, v203
    v_cvt_pk_bf16_f32 v126, v204, v205
    v_cvt_pk_bf16_f32 v127, v206, v207
    s_nop 1
    v_mfma_f32_16x16x32_bf16 v[168:171], v[176:179], v[120:123], v[172:175]
    v_mfma_f32_16x16x32_bf16 v[168:171], v[208:211], v[124:127], v[168:171]
    v_mfma_f32_16x16x32_bf16 v[32:35], v[144:147], v[136:139], v[96:99]
    v_mfma_f32_16x16x32_bf16 v[40:43], v[144:147], v[140:143], v[100:103]
    v_mfma_f32_16x16x32_bf16 v[44:47], v[148:151], v[140:143], v[100:103]
    v_mfma_f32_16x16x32_bf16 v[36:39], v[148:151], v[136:139], v[96:99]
    s_branch attn_out_kernel_back6
attn_out_kernel_rare7:
    ds_read_b128 v[184:187], v2 offset:6144
    ds_read_b128 v[188:191], v2 offset:7168
    s_waitcnt lgkmcnt(0)
    v_mfma_f32_16x16x32_bf16 v[192:195], v[184:187], v[128:131], 0
    v_mfma_f32_16x16x32_bf16 v[200:203], v[184:187], v[132:135], 0
    v_mfma_f32_16x16x32_bf16 v[204:207], v[188:191], v[132:135], 0
    v_mfma_f32_16x16x32_bf16 v[196:199], v[188:191], v[128:131], 0
    v_log_f32 v7, v160
    v_subrev_f32 v8, s32, v180
    v_add_f32 v7, v7, v180
    v_max_f32 v7, v7, v8
    s_nop 7
    s_nop 7
    v_max3_f32 v8, v192, v193, v194
    v_max3_f32 v8, v8, v195, v196
    v_max3_f32 v8, v8, v197, v198
    v_max_f32 v8, v8, v199
    v_max3_f32 v9, v200, v201, v202
    v_max3_f32 v9, v9, v203, v204
    v_max3_f32 v9, v9, v205, v206
    v_max_f32 v9, v9, v207
    s_nop 1
    v_permlane16_swap_b32 v8, v9
    s_nop 1
    v_max_f32 v8, v8, v9
    v_mov_b32 v11, v8
    s_nop 1
    v_permlane32_swap_b32 v11, v8
    s_nop 1
    v_max_f32 v8, v8, v11
    v_max_f32 v7, v7, v8
    v_add_f32 v7, s32, v7
    v_ceil_f32 v7, v7
    v_sub_f32 v8, v180, v7
    v_cvt_i32_f32 v8, v8
    v_mov_b32 v180, v7
    v_ldexp_f32 v160, v160, v8
    v_mov_b32 v9, v8
    s_nop 1
    v_permlane16_swap_b32 v8, v9
    s_nop 1
    v_ldexp_f32 v48, v48, v8
    v_ldexp_f32 v49, v49, v8
    v_ldexp_f32 v50, v50, v8
    v_ldexp_f32 v51, v51, v8
    v_ldexp_f32 v52, v52, v8
    v_ldexp_f32 v53, v53, v8
    v_ldexp_f32 v54, v54, v8
    v_ldexp_f32 v55, v55, v8
    v_ldexp_f32 v56, v56, v9
    v_ldexp_f32 v57, v57, v9
    v_ldexp_f32 v58, v58, v9
    v_ldexp_f32 v59, v59, v9
    v_ldexp_f32 v60, v60, v9
    v_ldexp_f32 v61, v61, v9
    v_ldexp_f32 v62, v62, v9
    v_ldexp_f32 v63, v63, v9
    v_mov_b32 v11, v7
    s_nop 1
    v_permlane16_swap_b32 v7, v11
    s_nop 1
    v_sub_f32 v80, 0, v7
    v_sub_f32 v84, 0, v11
    v_mov_b32 v81, v80
    v_mov_b32 v85, v84
    v_mov_b32 v82, v80
    v_mov_b32 v86, v84
    v_mov_b32 v83, v80
    v_mov_b32 v87, v84
    v_add_f32 v192, v192, v80
    v_add_f32 v193, v193, v80
    v_add_f32 v194, v194, v80
    v_add_f32 v195, v195, v80
    v_add_f32 v196, v196, v80
    v_add_f32 v197, v197, v80
    v_add_f32 v198, v198, v80
    v_add_f32 v199, v199, v80
    v_add_f32 v200, v200, v84
    v_add_f32 v201, v201, v84
    v_add_f32 v202, v202, v84
    v_add_f32 v203, v203, v84
    v_add_f32 v204, v204, v84
    v_add_f32 v205, v205, v84
    v_add_f32 v206, v206, v84
    v_add_f32 v207, v207, v84
    v_exp_f32 v192, v192
    v_exp_f32 v193, v193
    v_exp_f32 v194, v194
    v_exp_f32 v195, v195
    v_exp_f32 v196, v196
    v_exp_f32 v197, v197
    v_exp_f32 v198, v198
    v_exp_f32 v199, v199
    v_exp_f32 v200, v200
    v_exp_f32 v201, v201
    v_exp_f32 v202, v202
    v_exp_f32 v203, v203
    v_exp_f32 v204, v204
    v_exp_f32 v205, v205
    v_exp_f32 v206, v206
    v_exp_f32 v207, v207
    s_nop 0
    v_cvt_pk_bf16_f32 v112, v192, v193
    v_cvt_pk_bf16_f32 v113, v194, v195
    v_cvt_pk_bf16_f32 v114, v196, v197
    v_cvt_pk_bf16_f32 v115, v198, v199
    v_cvt_pk_bf16_f32 v116, v200, v201
    v_cvt_pk_bf16_f32 v117, v202, v203
    v_cvt_pk_bf16_f32 v118, v204, v205
    v_cvt_pk_bf16_f32 v119, v206, v207
    s_nop 1
    v_mfma_f32_16x16x32_bf16 v[164:167], v[176:179], v[112:115], v[160:163]
    v_mfma_f32_16x16x32_bf16 v[164:167], v[208:211], v[116:119], v[164:167]
    v_mfma_f32_16x16x32_bf16 v[16:19], v[144:147], v[128:131], v[80:83]
    v_mfma_f32_16x16x32_bf16 v[24:27], v[144:147], v[132:135], v[84:87]
    v_mfma_f32_16x16x32_bf16 v[28:31], v[148:151], v[132:135], v[84:87]
    v_mfma_f32_16x16x32_bf16 v[20:23], v[148:151], v[128:131], v[80:83]
    s_branch attn_out_kernel_back7
attn_out_kernel_rare8:
    ds_read_b128 v[184:187], v2 offset:6144
    ds_read_b128 v[188:191], v2 offset:7168
    s_waitcnt lgkmcnt(0)
    v_mfma_f32_16x16x32_bf16 v[192:195], v[184:187], v[136:139], 0
    v_mfma_f32_16x16x32_bf16 v[200:203], v[184:187], v[140:143], 0
    v_mfma_f32_16x16x32_bf16 v[204:207], v[188:191], v[140:143], 0
    v_mfma_f32_16x16x32_bf16 v[196:199], v[188:191], v[136:139], 0
    v_log_f32 v7, v168
    v_subrev_f32 v8, s32, v181
    v_add_f32 v7, v7, v181
    v_max_f32 v7, v7, v8
    s_nop 7
    s_nop 7
    v_max3_f32 v8, v192, v193, v194
    v_max3_f32 v8, v8, v195, v196
    v_max3_f32 v8, v8, v197, v198
    v_max_f32 v8, v8, v199
    v_max3_f32 v9, v200, v201, v202
    v_max3_f32 v9, v9, v203, v204
    v_max3_f32 v9, v9, v205, v206
    v_max_f32 v9, v9, v207
    s_nop 1
    v_permlane16_swap_b32 v8, v9
    s_nop 1
    v_max_f32 v8, v8, v9
    v_mov_b32 v11, v8
    s_nop 1
    v_permlane32_swap_b32 v11, v8
    s_nop 1
    v_max_f32 v8, v8, v11
    v_max_f32 v7, v7, v8
    v_add_f32 v7, s32, v7
    v_ceil_f32 v7, v7
    v_sub_f32 v8, v181, v7
    v_cvt_i32_f32 v8, v8
    v_mov_b32 v181, v7
    v_ldexp_f32 v168, v168, v8
    v_mov_b32 v9, v8
    s_nop 1
    v_permlane16_swap_b32 v8, v9
    s_nop 1
    v_ldexp_f32 v64, v64, v8
    v_ldexp_f32 v65, v65, v8
    v_ldexp_f32 v66, v66, v8
    v_ldexp_f32 v67, v67, v8
    v_ldexp_f32 v68, v68, v8
    v_ldexp_f32 v69, v69, v8
    v_ldexp_f32 v70, v70, v8
    v_ldexp_f32 v71, v71, v8
    v_ldexp_f32 v72, v72, v9
    v_ldexp_f32 v73, v73, v9
    v_ldexp_f32 v74, v74, v9
    v_ldexp_f32 v75, v75, v9
    v_ldexp_f32 v76, v76, v9
    v_ldexp_f32 v77, v77, v9
    v_ldexp_f32 v78, v78, v9
    v_ldexp_f32 v79, v79, v9
    v_mov_b32 v11, v7
    s_nop 1
    v_permlane16_swap_b32 v7, v11
    s_nop 1
    v_sub_f32 v96, 0, v7
    v_sub_f32 v100, 0, v11
    v_mov_b32 v97, v96
    v_mov_b32 v101, v100
    v_mov_b32 v98, v96
    v_mov_b32 v102, v100
    v_mov_b32 v99, v96
    v_mov_b32 v103, v100
    v_add_f32 v192, v192, v96
    v_add_f32 v193, v193, v96
    v_add_f32 v194, v194, v96
    v_add_f32 v195, v195, v96
    v_add_f32 v196, v196, v96
    v_add_f32 v197, v197, v96
    v_add_f32 v198, v198, v96
    v_add_f32 v199, v199, v96
    v_add_f32 v200, v200, v100
    v_add_f32 v201, v201, v100
    v_add_f32 v202, v202, v100
    v_add_f32 v203, v203, v100
    v_add_f32 v204, v204, v100
    v_add_f32 v205, v205, v100
    v_add_f32 v206, v206, v100
    v_add_f32 v207, v207, v100
    v_exp_f32 v192, v192
    v_exp_f32 v193, v193
    v_exp_f32 v194, v194
    v_exp_f32 v195, v195
    v_exp_f32 v196, v196
    v_exp_f32 v197, v197
    v_exp_f32 v198, v198
    v_exp_f32 v199, v199
    v_exp_f32 v200, v200
    v_exp_f32 v201, v201
    v_exp_f32 v202, v202
    v_exp_f32 v203, v203
    v_exp_f32 v204, v204
    v_exp_f32 v205, v205
    v_exp_f32 v206, v206
    v_exp_f32 v207, v207
    s_nop 0
    v_cvt_pk_bf16_f32 v120, v192, v193
    v_cvt_pk_bf16_f32 v121, v194, v195
    v_cvt_pk_bf16_f32 v122, v196, v197
    v_cvt_pk_bf16_f32 v123, v198, v199
    v_cvt_pk_bf16_f32 v124, v200, v201
    v_cvt_pk_bf16_f32 v125, v202, v203
    v_cvt_pk_bf16_f32 v126, v204, v205
    v_cvt_pk_bf16_f32 v127, v206, v207
    s_nop 1
    v_mfma_f32_16x16x32_bf16 v[172:175], v[176:179], v[120:123], v[168:171]
    v_mfma_f32_16x16x32_bf16 v[172:175], v[208:211], v[124:127], v[172:175]
    v_mfma_f32_16x16x32_bf16 v[32:35], v[144:147], v[136:139], v[96:99]
    v_mfma_f32_16x16x32_bf16 v[40:43], v[144:147], v[140:143], v[100:103]
    v_mfma_f32_16x16x32_bf16 v[44:47], v[148:151], v[140:143], v[100:103]
    v_mfma_f32_16x16x32_bf16 v[36:39], v[148:151], v[136:139], v[96:99]
    s_branch attn_out_kernel_back8
attn_out_kernel_rare9:
    ds_read_b128 v[184:187], v2 offset:16384
    ds_read_b128 v[188:191], v2 offset:17408
    s_waitcnt lgkmcnt(0)
    v_mfma_f32_16x16x32_bf16 v[192:195], v[184:187], v[128:131], 0
    v_mfma_f32_16x16x32_bf16 v[200:203], v[184:187], v[132:135], 0
    v_mfma_f32_16x16x32_bf16 v[204:207], v[188:191], v[132:135], 0
    v_mfma_f32_16x16x32_bf16 v[196:199], v[188:191], v[128:131], 0
    v_log_f32 v7, v164
    v_subrev_f32 v8, s32, v180
    v_add_f32 v7, v7, v180
    v_max_f32 v7, v7, v8
    s_nop 7
    s_nop 7
    v_max3_f32 v8, v192, v193, v194
    v_max3_f32 v8, v8, v195, v196
    v_max3_f32 v8, v8, v197, v198
    v_max_f32 v8, v8, v199
    v_max3_f32 v9, v200, v201, v202
    v_max3_f32 v9, v9, v203, v204
    v_max3_f32 v9, v9, v205, v206
    v_max_f32 v9, v9, v207
    s_nop 1
    v_permlane16_swap_b32 v8, v9
    s_nop 1
    v_max_f32 v8, v8, v9
    v_mov_b32 v11, v8
    s_nop 1
    v_permlane32_swap_b32 v11, v8
    s_nop 1
    v_max_f32 v8, v8, v11
    v_max_f32 v7, v7, v8
    v_add_f32 v7, s32, v7
    v_ceil_f32 v7, v7
    v_sub_f32 v8, v180, v7
    v_cvt_i32_f32 v8, v8
    v_mov_b32 v180, v7
    v_ldexp_f32 v164, v164, v8
    v_mov_b32 v9, v8
    s_nop 1
    v_permlane16_swap_b32 v8, v9
    s_nop 1
    v_ldexp_f32 v48, v48, v8
    v_ldexp_f32 v49, v49, v8
    v_ldexp_f32 v50, v50, v8
    v_ldexp_f32 v51, v51, v8
    v_ldexp_f32 v52, v52, v8
    v_ldexp_f32 v53, v53, v8
    v_ldexp_f32 v54, v54, v8
    v_ldexp_f32 v55, v55, v8
    v_ldexp_f32 v56, v56, v9
    v_ldexp_f32 v57, v57, v9
    v_ldexp_f32 v58, v58, v9
    v_ldexp_f32 v59, v59, v9
    v_ldexp_f32 v60, v60, v9
    v_ldexp_f32 v61, v61, v9
    v_ldexp_f32 v62, v62, v9
    v_ldexp_f32 v63, v63, v9
    v_mov_b32 v11, v7
    s_nop 1
    v_permlane16_swap_b32 v7, v11
    s_nop 1
    v_sub_f32 v80, 0, v7
    v_sub_f32 v84, 0, v11
    v_mov_b32 v81, v80
    v_mov_b32 v85, v84
    v_mov_b32 v82, v80
    v_mov_b32 v86, v84
    v_mov_b32 v83, v80
    v_mov_b32 v87, v84
    v_add_f32 v192, v192, v80
    v_add_f32 v193, v193, v80
    v_add_f32 v194, v194, v80
    v_add_f32 v195, v195, v80
    v_add_f32 v196, v196, v80
    v_add_f32 v197, v197, v80
    v_add_f32 v198, v198, v80
    v_add_f32 v199, v199, v80
    v_add_f32 v200, v200, v84
    v_add_f32 v201, v201, v84
    v_add_f32 v202, v202, v84
    v_add_f32 v203, v203, v84
    v_add_f32 v204, v204, v84
    v_add_f32 v205, v205, v84
    v_add_f32 v206, v206, v84
    v_add_f32 v207, v207, v84
    v_exp_f32 v192, v192
    v_exp_f32 v193, v193
    v_exp_f32 v194, v194
    v_exp_f32 v195, v195
    v_exp_f32 v196, v196
    v_exp_f32 v197, v197
    v_exp_f32 v198, v198
    v_exp_f32 v199, v199
    v_exp_f32 v200, v200
    v_exp_f32 v201, v201
    v_exp_f32 v202, v202
    v_exp_f32 v203, v203
    v_exp_f32 v204, v204
    v_exp_f32 v205, v205
    v_exp_f32 v206, v206
    v_exp_f32 v207, v207
    s_nop 0
    v_cvt_pk_bf16_f32 v112, v192, v193
    v_cvt_pk_bf16_f32 v113, v194, v195
    v_cvt_pk_bf16_f32 v114, v196, v197
    v_cvt_pk_bf16_f32 v115, v198, v199
    v_cvt_pk_bf16_f32 v116, v200, v201
    v_cvt_pk_bf16_f32 v117, v202, v203
    v_cvt_pk_bf16_f32 v118, v204, v205
    v_cvt_pk_bf16_f32 v119, v206, v207
    s_nop 1
    v_mfma_f32_16x16x32_bf16 v[160:163], v[176:179], v[112:115], v[164:167]
    v_mfma_f32_16x16x32_bf16 v[160:163], v[208:211], v[116:119], v[160:163]
    v_mfma_f32_16x16x32_bf16 v[16:19], v[144:147], v[128:131], v[80:83]
    v_mfma_f32_16x16x32_bf16 v[24:27], v[144:147], v[132:135], v[84:87]
    v_mfma_f32_16x16x32_bf16 v[28:31], v[148:151], v[132:135], v[84:87]
    v_mfma_f32_16x16x32_bf16 v[20:23], v[148:151], v[128:131], v[80:83]
    s_branch attn_out_kernel_back9
attn_out_kernel_rare10:
    ds_read_b128 v[184:187], v2 offset:16384
    ds_read_b128 v[188:191], v2 offset:17408
    s_waitcnt lgkmcnt(0)
    v_mfma_f32_16x16x32_bf16 v[192:195], v[184:187], v[136:139], 0
    v_mfma_f32_16x16x32_bf16 v[200:203], v[184:187], v[140:143], 0
    v_mfma_f32_16x16x32_bf16 v[204:207], v[188:191], v[140:143], 0
    v_mfma_f32_16x16x32_bf16 v[196:199], v[188:191], v[136:139], 0
    v_log_f32 v7, v172
    v_subrev_f32 v8, s32, v181
    v_add_f32 v7, v7, v181
    v_max_f32 v7, v7, v8
    s_nop 7
    s_nop 7
    v_max3_f32 v8, v192, v193, v194
    v_max3_f32 v8, v8, v195, v196
    v_max3_f32 v8, v8, v197, v198
    v_max_f32 v8, v8, v199
    v_max3_f32 v9, v200, v201, v202
    v_max3_f32 v9, v9, v203, v204
    v_max3_f32 v9, v9, v205, v206
    v_max_f32 v9, v9, v207
    s_nop 1
    v_permlane16_swap_b32 v8, v9
    s_nop 1
    v_max_f32 v8, v8, v9
    v_mov_b32 v11, v8
    s_nop 1
    v_permlane32_swap_b32 v11, v8
    s_nop 1
    v_max_f32 v8, v8, v11
    v_max_f32 v7, v7, v8
    v_add_f32 v7, s32, v7
    v_ceil_f32 v7, v7
    v_sub_f32 v8, v181, v7
    v_cvt_i32_f32 v8, v8
    v_mov_b32 v181, v7
    v_ldexp_f32 v172, v172, v8
    v_mov_b32 v9, v8
    s_nop 1
    v_permlane16_swap_b32 v8, v9
    s_nop 1
    v_ldexp_f32 v64, v64, v8
    v_ldexp_f32 v65, v65, v8
    v_ldexp_f32 v66, v66, v8
    v_ldexp_f32 v67, v67, v8
    v_ldexp_f32 v68, v68, v8
    v_ldexp_f32 v69, v69, v8
    v_ldexp_f32 v70, v70, v8
    v_ldexp_f32 v71, v71, v8
    v_ldexp_f32 v72, v72, v9
    v_ldexp_f32 v73, v73, v9
    v_ldexp_f32 v74, v74, v9
    v_ldexp_f32 v75, v75, v9
    v_ldexp_f32 v76, v76, v9
    v_ldexp_f32 v77, v77, v9
    v_ldexp_f32 v78, v78, v9
    v_ldexp_f32 v79, v79, v9
    v_mov_b32 v11, v7
    s_nop 1
    v_permlane16_swap_b32 v7, v11
    s_nop 1
    v_sub_f32 v96, 0, v7
    v_sub_f32 v100, 0, v11
    v_mov_b32 v97, v96
    v_mov_b32 v101, v100
    v_mov_b32 v98, v96
    v_mov_b32 v102, v100
    v_mov_b32 v99, v96
    v_mov_b32 v103, v100
    v_add_f32 v192, v192, v96
    v_add_f32 v193, v193, v96
    v_add_f32 v194, v194, v96
    v_add_f32 v195, v195, v96
    v_add_f32 v196, v196, v96
    v_add_f32 v197, v197, v96
    v_add_f32 v198, v198, v96
    v_add_f32 v199, v199, v96
    v_add_f32 v200, v200, v100
    v_add_f32 v201, v201, v100
    v_add_f32 v202, v202, v100
    v_add_f32 v203, v203, v100
    v_add_f32 v204, v204, v100
    v_add_f32 v205, v205, v100
    v_add_f32 v206, v206, v100
    v_add_f32 v207, v207, v100
    v_exp_f32 v192, v192
    v_exp_f32 v193, v193
    v_exp_f32 v194, v194
    v_exp_f32 v195, v195
    v_exp_f32 v196, v196
    v_exp_f32 v197, v197
    v_exp_f32 v198, v198
    v_exp_f32 v199, v199
    v_exp_f32 v200, v200
    v_exp_f32 v201, v201
    v_exp_f32 v202, v202
    v_exp_f32 v203, v203
    v_exp_f32 v204, v204
    v_exp_f32 v205, v205
    v_exp_f32 v206, v206
    v_exp_f32 v207, v207
    s_nop 0
    v_cvt_pk_bf16_f32 v120, v192, v193
    v_cvt_pk_bf16_f32 v121, v194, v195
    v_cvt_pk_bf16_f32 v122, v196, v197
    v_cvt_pk_bf16_f32 v123, v198, v199
    v_cvt_pk_bf16_f32 v124, v200, v201
    v_cvt_pk_bf16_f32 v125, v202, v203
    v_cvt_pk_bf16_f32 v126, v204, v205
    v_cvt_pk_bf16_f32 v127, v206, v207
    s_nop 1
    v_mfma_f32_16x16x32_bf16 v[168:171], v[176:179], v[120:123], v[172:175]
    v_mfma_f32_16x16x32_bf16 v[168:171], v[208:211], v[124:127], v[168:171]
    v_mfma_f32_16x16x32_bf16 v[32:35], v[144:147], v[136:139], v[96:99]
    v_mfma_f32_16x16x32_bf16 v[40:43], v[144:147], v[140:143], v[100:103]
    v_mfma_f32_16x16x32_bf16 v[44:47], v[148:151], v[140:143], v[100:103]
    v_mfma_f32_16x16x32_bf16 v[36:39], v[148:151], v[136:139], v[96:99]
    s_branch attn_out_kernel_back10
attn_out_kernel_rare11:
    ds_read_b128 v[184:187], v2 offset:18432
    ds_read_b128 v[188:191], v2 offset:19456
    s_waitcnt lgkmcnt(0)
    v_mfma_f32_16x16x32_bf16 v[192:195], v[184:187], v[128:131], 0
    v_mfma_f32_16x16x32_bf16 v[200:203], v[184:187], v[132:135], 0
    v_mfma_f32_16x16x32_bf16 v[204:207], v[188:191], v[132:135], 0
    v_mfma_f32_16x16x32_bf16 v[196:199], v[188:191], v[128:131], 0
    v_log_f32 v7, v160
    v_subrev_f32 v8, s32, v180
    v_add_f32 v7, v7, v180
    v_max_f32 v7, v7, v8
    s_nop 7
    s_nop 7
    v_max3_f32 v8, v192, v193, v194
    v_max3_f32 v8, v8, v195, v196
    v_max3_f32 v8, v8, v197, v198
    v_max_f32 v8, v8, v199
    v_max3_f32 v9, v200, v201, v202
    v_max3_f32 v9, v9, v203, v204
    v_max3_f32 v9, v9, v205, v206
    v_max_f32 v9, v9, v207
    s_nop 1
    v_permlane16_swap_b32 v8, v9
    s_nop 1
    v_max_f32 v8, v8, v9
    v_mov_b32 v11, v8
    s_nop 1
    v_permlane32_swap_b32 v11, v8
    s_nop 1
    v_max_f32 v8, v8, v11
    v_max_f32 v7, v7, v8
    v_add_f32 v7, s32, v7
    v_ceil_f32 v7, v7
    v_sub_f32 v8, v180, v7
    v_cvt_i32_f32 v8, v8
    v_mov_b32 v180, v7
    v_ldexp_f32 v160, v160, v8
    v_mov_b32 v9, v8
    s_nop 1
    v_permlane16_swap_b32 v8, v9
    s_nop 1
    v_ldexp_f32 v48, v48, v8
    v_ldexp_f32 v49, v49, v8
    v_ldexp_f32 v50, v50, v8
    v_ldexp_f32 v51, v51, v8
    v_ldexp_f32 v52, v52, v8
    v_ldexp_f32 v53, v53, v8
    v_ldexp_f32 v54, v54, v8
    v_ldexp_f32 v55, v55, v8
    v_ldexp_f32 v56, v56, v9
    v_ldexp_f32 v57, v57, v9
    v_ldexp_f32 v58, v58, v9
    v_ldexp_f32 v59, v59, v9
    v_ldexp_f32 v60, v60, v9
    v_ldexp_f32 v61, v61, v9
    v_ldexp_f32 v62, v62, v9
    v_ldexp_f32 v63, v63, v9
    v_mov_b32 v11, v7
    s_nop 1
    v_permlane16_swap_b32 v7, v11
    s_nop 1
    v_sub_f32 v80, 0, v7
    v_sub_f32 v84, 0, v11
    v_mov_b32 v81, v80
    v_mov_b32 v85, v84
    v_mov_b32 v82, v80
    v_mov_b32 v86, v84
    v_mov_b32 v83, v80
    v_mov_b32 v87, v84
    v_add_f32 v192, v192, v80
    v_add_f32 v193, v193, v80
    v_add_f32 v194, v194, v80
    v_add_f32 v195, v195, v80
    v_add_f32 v196, v196, v80
    v_add_f32 v197, v197, v80
    v_add_f32 v198, v198, v80
    v_add_f32 v199, v199, v80
    v_add_f32 v200, v200, v84
    v_add_f32 v201, v201, v84
    v_add_f32 v202, v202, v84
    v_add_f32 v203, v203, v84
    v_add_f32 v204, v204, v84
    v_add_f32 v205, v205, v84
    v_add_f32 v206, v206, v84
    v_add_f32 v207, v207, v84
    v_exp_f32 v192, v192
    v_exp_f32 v193, v193
    v_exp_f32 v194, v194
    v_exp_f32 v195, v195
    v_exp_f32 v196, v196
    v_exp_f32 v197, v197
    v_exp_f32 v198, v198
    v_exp_f32 v199, v199
    v_exp_f32 v200, v200
    v_exp_f32 v201, v201
    v_exp_f32 v202, v202
    v_exp_f32 v203, v203
    v_exp_f32 v204, v204
    v_exp_f32 v205, v205
    v_exp_f32 v206, v206
    v_exp_f32 v207, v207
    s_nop 0
    v_cvt_pk_bf16_f32 v112, v192, v193
    v_cvt_pk_bf16_f32 v113, v194, v195
    v_cvt_pk_bf16_f32 v114, v196, v197
    v_cvt_pk_bf16_f32 v115, v198, v199
    v_cvt_pk_bf16_f32 v116, v200, v201
    v_cvt_pk_bf16_f32 v117, v202, v203
    v_cvt_pk_bf16_f32 v118, v204, v205
    v_cvt_pk_bf16_f32 v119, v206, v207
    s_nop 1
    v_mfma_f32_16x16x32_bf16 v[164:167], v[176:179], v[112:115], v[160:163]
    v_mfma_f32_16x16x32_bf16 v[164:167], v[208:211], v[116:119], v[164:167]
    v_mfma_f32_16x16x32_bf16 v[16:19], v[144:147], v[128:131], v[80:83]
    v_mfma_f32_16x16x32_bf16 v[24:27], v[144:147], v[132:135], v[84:87]
    v_mfma_f32_16x16x32_bf16 v[28:31], v[148:151], v[132:135], v[84:87]
    v_mfma_f32_16x16x32_bf16 v[20:23], v[148:151], v[128:131], v[80:83]
    s_branch attn_out_kernel_back11
attn_out_kernel_rare12:
    ds_read_b128 v[184:187], v2 offset:18432
    ds_read_b128 v[188:191], v2 offset:19456
    s_waitcnt lgkmcnt(0)
    v_mfma_f32_16x16x32_bf16 v[192:195], v[184:187], v[136:139], 0
    v_mfma_f32_16x16x32_bf16 v[200:203], v[184:187], v[140:143], 0
    v_mfma_f32_16x16x32_bf16 v[204:207], v[188:191], v[140:143], 0
    v_mfma_f32_16x16x32_bf16 v[196:199], v[188:191], v[136:139], 0
    v_log_f32 v7, v168
    v_subrev_f32 v8, s32, v181
    v_add_f32 v7, v7, v181
    v_max_f32 v7, v7, v8
    s_nop 7
    s_nop 7
    v_max3_f32 v8, v192, v193, v194
    v_max3_f32 v8, v8, v195, v196
    v_max3_f32 v8, v8, v197, v198
    v_max_f32 v8, v8, v199
    v_max3_f32 v9, v200, v201, v202
    v_max3_f32 v9, v9, v203, v204
    v_max3_f32 v9, v9, v205, v206
    v_max_f32 v9, v9, v207
    s_nop 1
    v_permlane16_swap_b32 v8, v9
    s_nop 1
    v_max_f32 v8, v8, v9
    v_mov_b32 v11, v8
    s_nop 1
    v_permlane32_swap_b32 v11, v8
    s_nop 1
    v_max_f32 v8, v8, v11
    v_max_f32 v7, v7, v8
    v_add_f32 v7, s32, v7
    v_ceil_f32 v7, v7
    v_sub_f32 v8, v181, v7
    v_cvt_i32_f32 v8, v8
    v_mov_b32 v181, v7
    v_ldexp_f32 v168, v168, v8
    v_mov_b32 v9, v8
    s_nop 1
    v_permlane16_swap_b32 v8, v9
    s_nop 1
    v_ldexp_f32 v64, v64, v8
    v_ldexp_f32 v65, v65, v8
    v_ldexp_f32 v66, v66, v8
    v_ldexp_f32 v67, v67, v8
    v_ldexp_f32 v68, v68, v8
    v_ldexp_f32 v69, v69, v8
    v_ldexp_f32 v70, v70, v8
    v_ldexp_f32 v71, v71, v8
    v_ldexp_f32 v72, v72, v9
    v_ldexp_f32 v73, v73, v9
    v_ldexp_f32 v74, v74, v9
    v_ldexp_f32 v75, v75, v9
    v_ldexp_f32 v76, v76, v9
    v_ldexp_f32 v77, v77, v9
    v_ldexp_f32 v78, v78, v9
    v_ldexp_f32 v79, v79, v9
    v_mov_b32 v11, v7
    s_nop 1
    v_permlane16_swap_b32 v7, v11
    s_nop 1
    v_sub_f32 v96, 0, v7
    v_sub_f32 v100, 0, v11
    v_mov_b32 v97, v96
    v_mov_b32 v101, v100
    v_mov_b32 v98, v96
    v_mov_b32 v102, v100
    v_mov_b32 v99, v96
    v_mov_b32 v103, v100
    v_add_f32 v192, v192, v96
    v_add_f32 v193, v193, v96
    v_add_f32 v194, v194, v96
    v_add_f32 v195, v195, v96
    v_add_f32 v196, v196, v96
    v_add_f32 v197, v197, v96
    v_add_f32 v198, v198, v96
    v_add_f32 v199, v199, v96
    v_add_f32 v200, v200, v100
    v_add_f32 v201, v201, v100
    v_add_f32 v202, v202, v100
    v_add_f32 v203, v203, v100
    v_add_f32 v204, v204, v100
    v_add_f32 v205, v205, v100
    v_add_f32 v206, v206, v100
    v_add_f32 v207, v207, v100
    v_exp_f32 v192, v192
    v_exp_f32 v193, v193
    v_exp_f32 v194, v194
    v_exp_f32 v195, v195
    v_exp_f32 v196, v196
    v_exp_f32 v197, v197
    v_exp_f32 v198, v198
    v_exp_f32 v199, v199
    v_exp_f32 v200, v200
    v_exp_f32 v201, v201
    v_exp_f32 v202, v202
    v_exp_f32 v203, v203
    v_exp_f32 v204, v204
    v_exp_f32 v205, v205
    v_exp_f32 v206, v206
    v_exp_f32 v207, v207
    s_nop 0
    v_cvt_pk_bf16_f32 v120, v192, v193
    v_cvt_pk_bf16_f32 v121, v194, v195
    v_cvt_pk_bf16_f32 v122, v196, v197
    v_cvt_pk_bf16_f32 v123, v198, v199
    v_cvt_pk_bf16_f32 v124, v200, v201
    v_cvt_pk_bf16_f32 v125, v202, v203
    v_cvt_pk_bf16_f32 v126, v204, v205
    v_cvt_pk_bf16_f32 v127, v206, v207
    s_nop 1
    v_mfma_f32_16x16x32_bf16 v[172:175], v[176:179], v[120:123], v[168:171]
    v_mfma_f32_16x16x32_bf16 v[172:175], v[208:211], v[124:127], v[172:175]
    v_mfma_f32_16x16x32_bf16 v[32:35], v[144:147], v[136:139], v[96:99]
    v_mfma_f32_16x16x32_bf16 v[40:43], v[144:147], v[140:143], v[100:103]
    v_mfma_f32_16x16x32_bf16 v[44:47], v[148:151], v[140:143], v[100:103]
    v_mfma_f32_16x16x32_bf16 v[36:39], v[148:151], v[136:139], v[96:99]
    s_branch attn_out_kernel_back12
attn_out_kernel_rare13:
    ds_read_b128 v[184:187], v2 offset:20480
    ds_read_b128 v[188:191], v2 offset:21504
    s_waitcnt lgkmcnt(0)
    v_mfma_f32_16x16x32_bf16 v[192:195], v[184:187], v[128:131], 0
    v_mfma_f32_16x16x32_bf16 v[200:203], v[184:187], v[132:135], 0
    v_mfma_f32_16x16x32_bf16 v[204:207], v[188:191], v[132:135], 0
    v_mfma_f32_16x16x32_bf16 v[196:199], v[188:191], v[128:131], 0
    v_log_f32 v7, v164
    v_subrev_f32 v8, s32, v180
    v_add_f32 v7, v7, v180
    v_max_f32 v7, v7, v8
    s_nop 7
    s_nop 7
    v_max3_f32 v8, v192, v193, v194
    v_max3_f32 v8, v8, v195, v196
    v_max3_f32 v8, v8, v197, v198
    v_max_f32 v8, v8, v199
    v_max3_f32 v9, v200, v201, v202
    v_max3_f32 v9, v9, v203, v204
    v_max3_f32 v9, v9, v205, v206
    v_max_f32 v9, v9, v207
    s_nop 1
    v_permlane16_swap_b32 v8, v9
    s_nop 1
    v_max_f32 v8, v8, v9
    v_mov_b32 v11, v8
    s_nop 1
    v_permlane32_swap_b32 v11, v8
    s_nop 1
    v_max_f32 v8, v8, v11
    v_max_f32 v7, v7, v8
    v_add_f32 v7, s32, v7
    v_ceil_f32 v7, v7
    v_sub_f32 v8, v180, v7
    v_cvt_i32_f32 v8, v8
    v_mov_b32 v180, v7
    v_ldexp_f32 v164, v164, v8
    v_mov_b32 v9, v8
    s_nop 1
    v_permlane16_swap_b32 v8, v9
    s_nop 1
    v_ldexp_f32 v48, v48, v8
    v_ldexp_f32 v49, v49, v8
    v_ldexp_f32 v50, v50, v8
    v_ldexp_f32 v51, v51, v8
    v_ldexp_f32 v52, v52, v8
    v_ldexp_f32 v53, v53, v8
    v_ldexp_f32 v54, v54, v8
    v_ldexp_f32 v55, v55, v8
    v_ldexp_f32 v56, v56, v9
    v_ldexp_f32 v57, v57, v9
    v_ldexp_f32 v58, v58, v9
    v_ldexp_f32 v59, v59, v9
    v_ldexp_f32 v60, v60, v9
    v_ldexp_f32 v61, v61, v9
    v_ldexp_f32 v62, v62, v9
    v_ldexp_f32 v63, v63, v9
    v_mov_b32 v11, v7
    s_nop 1
    v_permlane16_swap_b32 v7, v11
    s_nop 1
    v_sub_f32 v80, 0, v7
    v_sub_f32 v84, 0, v11
    v_mov_b32 v81, v80
    v_mov_b32 v85, v84
    v_mov_b32 v82, v80
    v_mov_b32 v86, v84
    v_mov_b32 v83, v80
    v_mov_b32 v87, v84
    v_add_f32 v192, v192, v80
    v_add_f32 v193, v193, v80
    v_add_f32 v194, v194, v80
    v_add_f32 v195, v195, v80
    v_add_f32 v196, v196, v80
    v_add_f32 v197, v197, v80
    v_add_f32 v198, v198, v80
    v_add_f32 v199, v199, v80
    v_add_f32 v200, v200, v84
    v_add_f32 v201, v201, v84
    v_add_f32 v202, v202, v84
    v_add_f32 v203, v203, v84
    v_add_f32 v204, v204, v84
    v_add_f32 v205, v205, v84
    v_add_f32 v206, v206, v84
    v_add_f32 v207, v207, v84
    v_exp_f32 v192, v192
    v_exp_f32 v193, v193
    v_exp_f32 v194, v194
    v_exp_f32 v195, v195
    v_exp_f32 v196, v196
    v_exp_f32 v197, v197
    v_exp_f32 v198, v198
    v_exp_f32 v199, v199
    v_exp_f32 v200, v200
    v_exp_f32 v201, v201
    v_exp_f32 v202, v202
    v_exp_f32 v203, v203
    v_exp_f32 v204, v204
    v_exp_f32 v205, v205
    v_exp_f32 v206, v206
    v_exp_f32 v207, v207
    s_nop 0
    v_cvt_pk_bf16_f32 v112, v192, v193
    v_cvt_pk_bf16_f32 v113, v194, v195
    v_cvt_pk_bf16_f32 v114, v196, v197
    v_cvt_pk_bf16_f32 v115, v198, v199
    v_cvt_pk_bf16_f32 v116, v200, v201
    v_cvt_pk_bf16_f32 v117, v202, v203
    v_cvt_pk_bf16_f32 v118, v204, v205
    v_cvt_pk_bf16_f32 v119, v206, v207
    s_nop 1
    v_mfma_f32_16x16x32_bf16 v[160:163], v[176:179], v[112:115], v[164:167]
    v_mfma_f32_16x16x32_bf16 v[160:163], v[208:211], v[116:119], v[160:163]
    v_mfma_f32_16x16x32_bf16 v[16:19], v[144:147], v[128:131], v[80:83]
    v_mfma_f32_16x16x32_bf16 v[24:27], v[144:147], v[132:135], v[84:87]
    v_mfma_f32_16x16x32_bf16 v[28:31], v[148:151], v[132:135], v[84:87]
    v_mfma_f32_16x16x32_bf16 v[20:23], v[148:151], v[128:131], v[80:83]
    s_branch attn_out_kernel_back13
attn_out_kernel_rare14:
    ds_read_b128 v[184:187], v2 offset:20480
    ds_read_b128 v[188:191], v2 offset:21504
    s_waitcnt lgkmcnt(0)
    v_mfma_f32_16x16x32_bf16 v[192:195], v[184:187], v[136:139], 0
    v_mfma_f32_16x16x32_bf16 v[200:203], v[184:187], v[140:143], 0
    v_mfma_f32_16x16x32_bf16 v[204:207], v[188:191], v[140:143], 0
    v_mfma_f32_16x16x32_bf16 v[196:199], v[188:191], v[136:139], 0
    v_log_f32 v7, v172
    v_subrev_f32 v8, s32, v181
    v_add_f32 v7, v7, v181
    v_max_f32 v7, v7, v8
    s_nop 7
    s_nop 7
    v_max3_f32 v8, v192, v193, v194
    v_max3_f32 v8, v8, v195, v196
    v_max3_f32 v8, v8, v197, v198
    v_max_f32 v8, v8, v199
    v_max3_f32 v9, v200, v201, v202
    v_max3_f32 v9, v9, v203, v204
    v_max3_f32 v9, v9, v205, v206
    v_max_f32 v9, v9, v207
    s_nop 1
    v_permlane16_swap_b32 v8, v9
    s_nop 1
    v_max_f32 v8, v8, v9
    v_mov_b32 v11, v8
    s_nop 1
    v_permlane32_swap_b32 v11, v8
    s_nop 1
    v_max_f32 v8, v8, v11
    v_max_f32 v7, v7, v8
    v_add_f32 v7, s32, v7
    v_ceil_f32 v7, v7
    v_sub_f32 v8, v181, v7
    v_cvt_i32_f32 v8, v8
    v_mov_b32 v181, v7
    v_ldexp_f32 v172, v172, v8
    v_mov_b32 v9, v8
    s_nop 1
    v_permlane16_swap_b32 v8, v9
    s_nop 1
    v_ldexp_f32 v64, v64, v8
    v_ldexp_f32 v65, v65, v8
    v_ldexp_f32 v66, v66, v8
    v_ldexp_f32 v67, v67, v8
    v_ldexp_f32 v68, v68, v8
    v_ldexp_f32 v69, v69, v8
    v_ldexp_f32 v70, v70, v8
    v_ldexp_f32 v71, v71, v8
    v_ldexp_f32 v72, v72, v9
    v_ldexp_f32 v73, v73, v9
    v_ldexp_f32 v74, v74, v9
    v_ldexp_f32 v75, v75, v9
    v_ldexp_f32 v76, v76, v9
    v_ldexp_f32 v77, v77, v9
    v_ldexp_f32 v78, v78, v9
    v_ldexp_f32 v79, v79, v9
    v_mov_b32 v11, v7
    s_nop 1
    v_permlane16_swap_b32 v7, v11
    s_nop 1
    v_sub_f32 v96, 0, v7
    v_sub_f32 v100, 0, v11
    v_mov_b32 v97, v96
    v_mov_b32 v101, v100
    v_mov_b32 v98, v96
    v_mov_b32 v102, v100
    v_mov_b32 v99, v96
    v_mov_b32 v103, v100
    v_add_f32 v192, v192, v96
    v_add_f32 v193, v193, v96
    v_add_f32 v194, v194, v96
    v_add_f32 v195, v195, v96
    v_add_f32 v196, v196, v96
    v_add_f32 v197, v197, v96
    v_add_f32 v198, v198, v96
    v_add_f32 v199, v199, v96
    v_add_f32 v200, v200, v100
    v_add_f32 v201, v201, v100
    v_add_f32 v202, v202, v100
    v_add_f32 v203, v203, v100
    v_add_f32 v204, v204, v100
    v_add_f32 v205, v205, v100
    v_add_f32 v206, v206, v100
    v_add_f32 v207, v207, v100
    v_exp_f32 v192, v192
    v_exp_f32 v193, v193
    v_exp_f32 v194, v194
    v_exp_f32 v195, v195
    v_exp_f32 v196, v196
    v_exp_f32 v197, v197
    v_exp_f32 v198, v198
    v_exp_f32 v199, v199
    v_exp_f32 v200, v200
    v_exp_f32 v201, v201
    v_exp_f32 v202, v202
    v_exp_f32 v203, v203
    v_exp_f32 v204, v204
    v_exp_f32 v205, v205
    v_exp_f32 v206, v206
    v_exp_f32 v207, v207
    s_nop 0
    v_cvt_pk_bf16_f32 v120, v192, v193
    v_cvt_pk_bf16_f32 v121, v194, v195
    v_cvt_pk_bf16_f32 v122, v196, v197
    v_cvt_pk_bf16_f32 v123, v198, v199
    v_cvt_pk_bf16_f32 v124, v200, v201
    v_cvt_pk_bf16_f32 v125, v202, v203
    v_cvt_pk_bf16_f32 v126, v204, v205
    v_cvt_pk_bf16_f32 v127, v206, v207
    s_nop 1
    v_mfma_f32_16x16x32_bf16 v[168:171], v[176:179], v[120:123], v[172:175]
    v_mfma_f32_16x16x32_bf16 v[168:171], v[208:211], v[124:127], v[168:171]
    v_mfma_f32_16x16x32_bf16 v[32:35], v[144:147], v[136:139], v[96:99]
    v_mfma_f32_16x16x32_bf16 v[40:43], v[144:147], v[140:143], v[100:103]
    v_mfma_f32_16x16x32_bf16 v[44:47], v[148:151], v[140:143], v[100:103]
    v_mfma_f32_16x16x32_bf16 v[36:39], v[148:151], v[136:139], v[96:99]
    s_branch attn_out_kernel_back14
attn_out_kernel_rare15:
    ds_read_b128 v[184:187], v2 offset:22528
    ds_read_b128 v[188:191], v2 offset:23552
    s_waitcnt lgkmcnt(0)
    v_mfma_f32_16x16x32_bf16 v[192:195], v[184:187], v[128:131], 0
    v_mfma_f32_16x16x32_bf16 v[200:203], v[184:187], v[132:135], 0
    v_mfma_f32_16x16x32_bf16 v[204:207], v[188:191], v[132:135], 0
    v_mfma_f32_16x16x32_bf16 v[196:199], v[188:191], v[128:131], 0
    v_log_f32 v7, v160
    v_subrev_f32 v8, s32, v180
    v_add_f32 v7, v7, v180
    v_max_f32 v7, v7, v8
    s_nop 7
    s_nop 7
    v_max3_f32 v8, v192, v193, v194
    v_max3_f32 v8, v8, v195, v196
    v_max3_f32 v8, v8, v197, v198
    v_max_f32 v8, v8, v199
    v_max3_f32 v9, v200, v201, v202
    v_max3_f32 v9, v9, v203, v204
    v_max3_f32 v9, v9, v205, v206
    v_max_f32 v9, v9, v207
    s_nop 1
    v_permlane16_swap_b32 v8, v9
    s_nop 1
    v_max_f32 v8, v8, v9
    v_mov_b32 v11, v8
    s_nop 1
    v_permlane32_swap_b32 v11, v8
    s_nop 1
    v_max_f32 v8, v8, v11
    v_max_f32 v7, v7, v8
    v_add_f32 v7, s32, v7
    v_ceil_f32 v7, v7
    v_sub_f32 v8, v180, v7
    v_cvt_i32_f32 v8, v8
    v_mov_b32 v180, v7
    v_ldexp_f32 v160, v160, v8
    v_mov_b32 v9, v8
    s_nop 1
    v_permlane16_swap_b32 v8, v9
    s_nop 1
    v_ldexp_f32 v48, v48, v8
    v_ldexp_f32 v49, v49, v8
    v_ldexp_f32 v50, v50, v8
    v_ldexp_f32 v51, v51, v8
    v_ldexp_f32 v52, v52, v8
    v_ldexp_f32 v53, v53, v8
    v_ldexp_f32 v54, v54, v8
    v_ldexp_f32 v55, v55, v8
    v_ldexp_f32 v56, v56, v9
    v_ldexp_f32 v57, v57, v9
    v_ldexp_f32 v58, v58, v9
    v_ldexp_f32 v59, v59, v9
    v_ldexp_f32 v60, v60, v9
    v_ldexp_f32 v61, v61, v9
    v_ldexp_f32 v62, v62, v9
    v_ldexp_f32 v63, v63, v9
    v_mov_b32 v11, v7
    s_nop 1
    v_permlane16_swap_b32 v7, v11
    s_nop 1
    v_sub_f32 v80, 0, v7
    v_sub_f32 v84, 0, v11
    v_mov_b32 v81, v80
    v_mov_b32 v85, v84
    v_mov_b32 v82, v80
    v_mov_b32 v86, v84
    v_mov_b32 v83, v80
    v_mov_b32 v87, v84
    v_add_f32 v192, v192, v80
    v_add_f32 v193, v193, v80
    v_add_f32 v194, v194, v80
    v_add_f32 v195, v195, v80
    v_add_f32 v196, v196, v80
    v_add_f32 v197, v197, v80
    v_add_f32 v198, v198, v80
    v_add_f32 v199, v199, v80
    v_add_f32 v200, v200, v84
    v_add_f32 v201, v201, v84
    v_add_f32 v202, v202, v84
    v_add_f32 v203, v203, v84
    v_add_f32 v204, v204, v84
    v_add_f32 v205, v205, v84
    v_add_f32 v206, v206, v84
    v_add_f32 v207, v207, v84
    v_exp_f32 v192, v192
    v_exp_f32 v193, v193
    v_exp_f32 v194, v194
    v_exp_f32 v195, v195
    v_exp_f32 v196, v196
    v_exp_f32 v197, v197
    v_exp_f32 v198, v198
    v_exp_f32 v199, v199
    v_exp_f32 v200, v200
    v_exp_f32 v201, v201
    v_exp_f32 v202, v202
    v_exp_f32 v203, v203
    v_exp_f32 v204, v204
    v_exp_f32 v205, v205
    v_exp_f32 v206, v206
    v_exp_f32 v207, v207
    s_nop 0
    v_cvt_pk_bf16_f32 v112, v192, v193
    v_cvt_pk_bf16_f32 v113, v194, v195
    v_cvt_pk_bf16_f32 v114, v196, v197
    v_cvt_pk_bf16_f32 v115, v198, v199
    v_cvt_pk_bf16_f32 v116, v200, v201
    v_cvt_pk_bf16_f32 v117, v202, v203
    v_cvt_pk_bf16_f32 v118, v204, v205
    v_cvt_pk_bf16_f32 v119, v206, v207
    s_nop 1
    v_mfma_f32_16x16x32_bf16 v[164:167], v[176:179], v[112:115], v[160:163]
    v_mfma_f32_16x16x32_bf16 v[164:167], v[208:211], v[116:119], v[164:167]
    v_mfma_f32_16x16x32_bf16 v[16:19], v[144:147], v[128:131], v[80:83]
    v_mfma_f32_16x16x32_bf16 v[24:27], v[144:147], v[132:135], v[84:87]
    v_mfma_f32_16x16x32_bf16 v[28:31], v[148:151], v[132:135], v[84:87]
    v_mfma_f32_16x16x32_bf16 v[20:23], v[148:151], v[128:131], v[80:83]
    s_branch attn_out_kernel_back15
attn_out_kernel_rare16:
    ds_read_b128 v[184:187], v2 offset:22528
    ds_read_b128 v[188:191], v2 offset:23552
    s_waitcnt lgkmcnt(0)
    v_mfma_f32_16x16x32_bf16 v[192:195], v[184:187], v[136:139], 0
    v_mfma_f32_16x16x32_bf16 v[200:203], v[184:187], v[140:143], 0
    v_mfma_f32_16x16x32_bf16 v[204:207], v[188:191], v[140:143], 0
    v_mfma_f32_16x16x32_bf16 v[196:199], v[188:191], v[136:139], 0
    v_log_f32 v7, v168
    v_subrev_f32 v8, s32, v181
    v_add_f32 v7, v7, v181
    v_max_f32 v7, v7, v8
    s_nop 7
    s_nop 7
    v_max3_f32 v8, v192, v193, v194
    v_max3_f32 v8, v8, v195, v196
    v_max3_f32 v8, v8, v197, v198
    v_max_f32 v8, v8, v199
    v_max3_f32 v9, v200, v201, v202
    v_max3_f32 v9, v9, v203, v204
    v_max3_f32 v9, v9, v205, v206
    v_max_f32 v9, v9, v207
    s_nop 1
    v_permlane16_swap_b32 v8, v9
    s_nop 1
    v_max_f32 v8, v8, v9
    v_mov_b32 v11, v8
    s_nop 1
    v_permlane32_swap_b32 v11, v8
    s_nop 1
    v_max_f32 v8, v8, v11
    v_max_f32 v7, v7, v8
    v_add_f32 v7, s32, v7
    v_ceil_f32 v7, v7
    v_sub_f32 v8, v181, v7
    v_cvt_i32_f32 v8, v8
    v_mov_b32 v181, v7
    v_ldexp_f32 v168, v168, v8
    v_mov_b32 v9, v8
    s_nop 1
    v_permlane16_swap_b32 v8, v9
    s_nop 1
    v_ldexp_f32 v64, v64, v8
    v_ldexp_f32 v65, v65, v8
    v_ldexp_f32 v66, v66, v8
    v_ldexp_f32 v67, v67, v8
    v_ldexp_f32 v68, v68, v8
    v_ldexp_f32 v69, v69, v8
    v_ldexp_f32 v70, v70, v8
    v_ldexp_f32 v71, v71, v8
    v_ldexp_f32 v72, v72, v9
    v_ldexp_f32 v73, v73, v9
    v_ldexp_f32 v74, v74, v9
    v_ldexp_f32 v75, v75, v9
    v_ldexp_f32 v76, v76, v9
    v_ldexp_f32 v77, v77, v9
    v_ldexp_f32 v78, v78, v9
    v_ldexp_f32 v79, v79, v9
    v_mov_b32 v11, v7
    s_nop 1
    v_permlane16_swap_b32 v7, v11
    s_nop 1
    v_sub_f32 v96, 0, v7
    v_sub_f32 v100, 0, v11
    v_mov_b32 v97, v96
    v_mov_b32 v101, v100
    v_mov_b32 v98, v96
    v_mov_b32 v102, v100
    v_mov_b32 v99, v96
    v_mov_b32 v103, v100
    v_add_f32 v192, v192, v96
    v_add_f32 v193, v193, v96
    v_add_f32 v194, v194, v96
    v_add_f32 v195, v195, v96
    v_add_f32 v196, v196, v96
    v_add_f32 v197, v197, v96
    v_add_f32 v198, v198, v96
    v_add_f32 v199, v199, v96
    v_add_f32 v200, v200, v100
    v_add_f32 v201, v201, v100
    v_add_f32 v202, v202, v100
    v_add_f32 v203, v203, v100
    v_add_f32 v204, v204, v100
    v_add_f32 v205, v205, v100
    v_add_f32 v206, v206, v100
    v_add_f32 v207, v207, v100
    v_exp_f32 v192, v192
    v_exp_f32 v193, v193
    v_exp_f32 v194, v194
    v_exp_f32 v195, v195
    v_exp_f32 v196, v196
    v_exp_f32 v197, v197
    v_exp_f32 v198, v198
    v_exp_f32 v199, v199
    v_exp_f32 v200, v200
    v_exp_f32 v201, v201
    v_exp_f32 v202, v202
    v_exp_f32 v203, v203
    v_exp_f32 v204, v204
    v_exp_f32 v205, v205
    v_exp_f32 v206, v206
    v_exp_f32 v207, v207
    s_nop 0
    v_cvt_pk_bf16_f32 v120, v192, v193
    v_cvt_pk_bf16_f32 v121, v194, v195
    v_cvt_pk_bf16_f32 v122, v196, v197
    v_cvt_pk_bf16_f32 v123, v198, v199
    v_cvt_pk_bf16_f32 v124, v200, v201
    v_cvt_pk_bf16_f32 v125, v202, v203
    v_cvt_pk_bf16_f32 v126, v204, v205
    v_cvt_pk_bf16_f32 v127, v206, v207
    s_nop 1
    v_mfma_f32_16x16x32_bf16 v[172:175], v[176:179], v[120:123], v[168:171]
    v_mfma_f32_16x16x32_bf16 v[172:175], v[208:211], v[124:127], v[172:175]
    v_mfma_f32_16x16x32_bf16 v[32:35], v[144:147], v[136:139], v[96:99]
    v_mfma_f32_16x16x32_bf16 v[40:43], v[144:147], v[140:143], v[100:103]
    v_mfma_f32_16x16x32_bf16 v[44:47], v[148:151], v[140:143], v[100:103]
    v_mfma_f32_16x16x32_bf16 v[36:39], v[148:151], v[136:139], v[96:99]
    s_branch attn_out_kernel_back16
attn_out_kernel_rare17:
    ds_read_b128 v[184:187], v2 offset:32768
    ds_read_b128 v[188:191], v2 offset:33792
    s_waitcnt lgkmcnt(0)
    v_mfma_f32_16x16x32_bf16 v[192:195], v[184:187], v[128:131], 0
    v_mfma_f32_16x16x32_bf16 v[200:203], v[184:187], v[132:135], 0
    v_mfma_f32_16x16x32_bf16 v[204:207], v[188:191], v[132:135], 0
    v_mfma_f32_16x16x32_bf16 v[196:199], v[188:191], v[128:131], 0
    v_log_f32 v7, v164
    v_subrev_f32 v8, s32, v180
    v_add_f32 v7, v7, v180
    v_max_f32 v7, v7, v8
    s_nop 7
    s_nop 7
    v_max3_f32 v8, v192, v193, v194
    v_max3_f32 v8, v8, v195, v196
    v_max3_f32 v8, v8, v197, v198
    v_max_f32 v8, v8, v199
    v_max3_f32 v9, v200, v201, v202
    v_max3_f32 v9, v9, v203, v204
    v_max3_f32 v9, v9, v205, v206
    v_max_f32 v9, v9, v207
    s_nop 1
    v_permlane16_swap_b32 v8, v9
    s_nop 1
    v_max_f32 v8, v8, v9
    v_mov_b32 v11, v8
    s_nop 1
    v_permlane32_swap_b32 v11, v8
    s_nop 1
    v_max_f32 v8, v8, v11
    v_max_f32 v7, v7, v8
    v_add_f32 v7, s32, v7
    v_ceil_f32 v7, v7
    v_sub_f32 v8, v180, v7
    v_cvt_i32_f32 v8, v8
    v_mov_b32 v180, v7
    v_ldexp_f32 v164, v164, v8
    v_mov_b32 v9, v8
    s_nop 1
    v_permlane16_swap_b32 v8, v9
    s_nop 1
    v_ldexp_f32 v48, v48, v8
    v_ldexp_f32 v49, v49, v8
    v_ldexp_f32 v50, v50, v8
    v_ldexp_f32 v51, v51, v8
    v_ldexp_f32 v52, v52, v8
    v_ldexp_f32 v53, v53, v8
    v_ldexp_f32 v54, v54, v8
    v_ldexp_f32 v55, v55, v8
    v_ldexp_f32 v56, v56, v9
    v_ldexp_f32 v57, v57, v9
    v_ldexp_f32 v58, v58, v9
    v_ldexp_f32 v59, v59, v9
    v_ldexp_f32 v60, v60, v9
    v_ldexp_f32 v61, v61, v9
    v_ldexp_f32 v62, v62, v9
    v_ldexp_f32 v63, v63, v9
    v_mov_b32 v11, v7
    s_nop 1
    v_permlane16_swap_b32 v7, v11
    s_nop 1
    v_sub_f32 v80, 0, v7
    v_sub_f32 v84, 0, v11
    v_mov_b32 v81, v80
    v_mov_b32 v85, v84
    v_mov_b32 v82, v80
    v_mov_b32 v86, v84
    v_mov_b32 v83, v80
    v_mov_b32 v87, v84
    v_add_f32 v192, v192, v80
    v_add_f32 v193, v193, v80
    v_add_f32 v194, v194, v80
    v_add_f32 v195, v195, v80
    v_add_f32 v196, v196, v80
    v_add_f32 v197, v197, v80
    v_add_f32 v198, v198, v80
    v_add_f32 v199, v199, v80
    v_add_f32 v200, v200, v84
    v_add_f32 v201, v201, v84
    v_add_f32 v202, v202, v84
    v_add_f32 v203, v203, v84
    v_add_f32 v204, v204, v84
    v_add_f32 v205, v205, v84
    v_add_f32 v206, v206, v84
    v_add_f32 v207, v207, v84
    v_exp_f32 v192, v192
    v_exp_f32 v193, v193
    v_exp_f32 v194, v194
    v_exp_f32 v195, v195
    v_exp_f32 v196, v196
    v_exp_f32 v197, v197
    v_exp_f32 v198, v198
    v_exp_f32 v199, v199
    v_exp_f32 v200, v200
    v_exp_f32 v201, v201
    v_exp_f32 v202, v202
    v_exp_f32 v203, v203
    v_exp_f32 v204, v204
    v_exp_f32 v205, v205
    v_exp_f32 v206, v206
    v_exp_f32 v207, v207
    s_nop 0
    v_cvt_pk_bf16_f32 v112, v192, v193
    v_cvt_pk_bf16_f32 v113, v194, v195
    v_cvt_pk_bf16_f32 v114, v196, v197
    v_cvt_pk_bf16_f32 v115, v198, v199
    v_cvt_pk_bf16_f32 v116, v200, v201
    v_cvt_pk_bf16_f32 v117, v202, v203
    v_cvt_pk_bf16_f32 v118, v204, v205
    v_cvt_pk_bf16_f32 v119, v206, v207
    s_nop 1
    v_mfma_f32_16x16x32_bf16 v[160:163], v[176:179], v[112:115], v[164:167]
    v_mfma_f32_16x16x32_bf16 v[160:163], v[208:211], v[116:119], v[160:163]
    v_mfma_f32_16x16x32_bf16 v[16:19], v[144:147], v[128:131], v[80:83]
    v_mfma_f32_16x16x32_bf16 v[24:27], v[144:147], v[132:135], v[84:87]
    v_mfma_f32_16x16x32_bf16 v[28:31], v[148:151], v[132:135], v[84:87]
    v_mfma_f32_16x16x32_bf16 v[20:23], v[148:151], v[128:131], v[80:83]
    s_branch attn_out_kernel_back17
attn_out_kernel_rare18:
    ds_read_b128 v[184:187], v2 offset:32768
    ds_read_b128 v[188:191], v2 offset:33792
    s_waitcnt lgkmcnt(0)
    v_mfma_f32_16x16x32_bf16 v[192:195], v[184:187], v[136:139], 0
    v_mfma_f32_16x16x32_bf16 v[200:203], v[184:187], v[140:143], 0
    v_mfma_f32_16x16x32_bf16 v[204:207], v[188:191], v[140:143], 0
    v_mfma_f32_16x16x32_bf16 v[196:199], v[188:191], v[136:139], 0
    v_log_f32 v7, v172
    v_subrev_f32 v8, s32, v181
    v_add_f32 v7, v7, v181
    v_max_f32 v7, v7, v8
    s_nop 7
    s_nop 7
    v_max3_f32 v8, v192, v193, v194
    v_max3_f32 v8, v8, v195, v196
    v_max3_f32 v8, v8, v197, v198
    v_max_f32 v8, v8, v199
    v_max3_f32 v9, v200, v201, v202
    v_max3_f32 v9, v9, v203, v204
    v_max3_f32 v9, v9, v205, v206
    v_max_f32 v9, v9, v207
    s_nop 1
    v_permlane16_swap_b32 v8, v9
    s_nop 1
    v_max_f32 v8, v8, v9
    v_mov_b32 v11, v8
    s_nop 1
    v_permlane32_swap_b32 v11, v8
    s_nop 1
    v_max_f32 v8, v8, v11
    v_max_f32 v7, v7, v8
    v_add_f32 v7, s32, v7
    v_ceil_f32 v7, v7
    v_sub_f32 v8, v181, v7
    v_cvt_i32_f32 v8, v8
    v_mov_b32 v181, v7
    v_ldexp_f32 v172, v172, v8
    v_mov_b32 v9, v8
    s_nop 1
    v_permlane16_swap_b32 v8, v9
    s_nop 1
    v_ldexp_f32 v64, v64, v8
    v_ldexp_f32 v65, v65, v8
    v_ldexp_f32 v66, v66, v8
    v_ldexp_f32 v67, v67, v8
    v_ldexp_f32 v68, v68, v8
    v_ldexp_f32 v69, v69, v8
    v_ldexp_f32 v70, v70, v8
    v_ldexp_f32 v71, v71, v8
    v_ldexp_f32 v72, v72, v9
    v_ldexp_f32 v73, v73, v9
    v_ldexp_f32 v74, v74, v9
    v_ldexp_f32 v75, v75, v9
    v_ldexp_f32 v76, v76, v9
    v_ldexp_f32 v77, v77, v9
    v_ldexp_f32 v78, v78, v9
    v_ldexp_f32 v79, v79, v9
    v_mov_b32 v11, v7
    s_nop 1
    v_permlane16_swap_b32 v7, v11
    s_nop 1
    v_sub_f32 v96, 0, v7
    v_sub_f32 v100, 0, v11
    v_mov_b32 v97, v96
    v_mov_b32 v101, v100
    v_mov_b32 v98, v96
    v_mov_b32 v102, v100
    v_mov_b32 v99, v96
    v_mov_b32 v103, v100
    v_add_f32 v192, v192, v96
    v_add_f32 v193, v193, v96
    v_add_f32 v194, v194, v96
    v_add_f32 v195, v195, v96
    v_add_f32 v196, v196, v96
    v_add_f32 v197, v197, v96
    v_add_f32 v198, v198, v96
    v_add_f32 v199, v199, v96
    v_add_f32 v200, v200, v100
    v_add_f32 v201, v201, v100
    v_add_f32 v202, v202, v100
    v_add_f32 v203, v203, v100
    v_add_f32 v204, v204, v100
    v_add_f32 v205, v205, v100
    v_add_f32 v206, v206, v100
    v_add_f32 v207, v207, v100
    v_exp_f32 v192, v192
    v_exp_f32 v193, v193
    v_exp_f32 v194, v194
    v_exp_f32 v195, v195
    v_exp_f32 v196, v196
    v_exp_f32 v197, v197
    v_exp_f32 v198, v198
    v_exp_f32 v199, v199
    v_exp_f32 v200, v200
    v_exp_f32 v201, v201
    v_exp_f32 v202, v202
    v_exp_f32 v203, v203
    v_exp_f32 v204, v204
    v_exp_f32 v205, v205
    v_exp_f32 v206, v206
    v_exp_f32 v207, v207
    s_nop 0
    v_cvt_pk_bf16_f32 v120, v192, v193
    v_cvt_pk_bf16_f32 v121, v194, v195
    v_cvt_pk_bf16_f32 v122, v196, v197
    v_cvt_pk_bf16_f32 v123, v198, v199
    v_cvt_pk_bf16_f32 v124, v200, v201
    v_cvt_pk_bf16_f32 v125, v202, v203
    v_cvt_pk_bf16_f32 v126, v204, v205
    v_cvt_pk_bf16_f32 v127, v206, v207
    s_nop 1
    v_mfma_f32_16x16x32_bf16 v[168:171], v[176:179], v[120:123], v[172:175]
    v_mfma_f32_16x16x32_bf16 v[168:171], v[208:211], v[124:127], v[168:171]
    v_mfma_f32_16x16x32_bf16 v[32:35], v[144:147], v[136:139], v[96:99]
    v_mfma_f32_16x16x32_bf16 v[40:43], v[144:147], v[140:143], v[100:103]
    v_mfma_f32_16x16x32_bf16 v[44:47], v[148:151], v[140:143], v[100:103]
    v_mfma_f32_16x16x32_bf16 v[36:39], v[148:151], v[136:139], v[96:99]
    s_branch attn_out_kernel_back18
attn_out_kernel_rare19:
    ds_read_b128 v[184:187], v2 offset:34816
    ds_read_b128 v[188:191], v2 offset:35840
    s_waitcnt lgkmcnt(0)
    v_mfma_f32_16x16x32_bf16 v[192:195], v[184:187], v[128:131], 0
    v_mfma_f32_16x16x32_bf16 v[200:203], v[184:187], v[132:135], 0
    v_mfma_f32_16x16x32_bf16 v[204:207], v[188:191], v[132:135], 0
    v_mfma_f32_16x16x32_bf16 v[196:199], v[188:191], v[128:131], 0
    v_log_f32 v7, v160
    v_subrev_f32 v8, s32, v180
    v_add_f32 v7, v7, v180
    v_max_f32 v7, v7, v8
    s_nop 7
    s_nop 7
    v_max3_f32 v8, v192, v193, v194
    v_max3_f32 v8, v8, v195, v196
    v_max3_f32 v8, v8, v197, v198
    v_max_f32 v8, v8, v199
    v_max3_f32 v9, v200, v201, v202
    v_max3_f32 v9, v9, v203, v204
    v_max3_f32 v9, v9, v205, v206
    v_max_f32 v9, v9, v207
    s_nop 1
    v_permlane16_swap_b32 v8, v9
    s_nop 1
    v_max_f32 v8, v8, v9
    v_mov_b32 v11, v8
    s_nop 1
    v_permlane32_swap_b32 v11, v8
    s_nop 1
    v_max_f32 v8, v8, v11
    v_max_f32 v7, v7, v8
    v_add_f32 v7, s32, v7
    v_ceil_f32 v7, v7
    v_sub_f32 v8, v180, v7
    v_cvt_i32_f32 v8, v8
    v_mov_b32 v180, v7
    v_ldexp_f32 v160, v160, v8
    v_mov_b32 v9, v8
    s_nop 1
    v_permlane16_swap_b32 v8, v9
    s_nop 1
    v_ldexp_f32 v48, v48, v8
    v_ldexp_f32 v49, v49, v8
    v_ldexp_f32 v50, v50, v8
    v_ldexp_f32 v51, v51, v8
    v_ldexp_f32 v52, v52, v8
    v_ldexp_f32 v53, v53, v8
    v_ldexp_f32 v54, v54, v8
    v_ldexp_f32 v55, v55, v8
    v_ldexp_f32 v56, v56, v9
    v_ldexp_f32 v57, v57, v9
    v_ldexp_f32 v58, v58, v9
    v_ldexp_f32 v59, v59, v9
    v_ldexp_f32 v60, v60, v9
    v_ldexp_f32 v61, v61, v9
    v_ldexp_f32 v62, v62, v9
    v_ldexp_f32 v63, v63, v9
    v_mov_b32 v11, v7
    s_nop 1
    v_permlane16_swap_b32 v7, v11
    s_nop 1
    v_sub_f32 v80, 0, v7
    v_sub_f32 v84, 0, v11
    v_mov_b32 v81, v80
    v_mov_b32 v85, v84
    v_mov_b32 v82, v80
    v_mov_b32 v86, v84
    v_mov_b32 v83, v80
    v_mov_b32 v87, v84
    v_add_f32 v192, v192, v80
    v_add_f32 v193, v193, v80
    v_add_f32 v194, v194, v80
    v_add_f32 v195, v195, v80
    v_add_f32 v196, v196, v80
    v_add_f32 v197, v197, v80
    v_add_f32 v198, v198, v80
    v_add_f32 v199, v199, v80
    v_add_f32 v200, v200, v84
    v_add_f32 v201, v201, v84
    v_add_f32 v202, v202, v84
    v_add_f32 v203, v203, v84
    v_add_f32 v204, v204, v84
    v_add_f32 v205, v205, v84
    v_add_f32 v206, v206, v84
    v_add_f32 v207, v207, v84
    v_exp_f32 v192, v192
    v_exp_f32 v193, v193
    v_exp_f32 v194, v194
    v_exp_f32 v195, v195
    v_exp_f32 v196, v196
    v_exp_f32 v197, v197
    v_exp_f32 v198, v198
    v_exp_f32 v199, v199
    v_exp_f32 v200, v200
    v_exp_f32 v201, v201
    v_exp_f32 v202, v202
    v_exp_f32 v203, v203
    v_exp_f32 v204, v204
    v_exp_f32 v205, v205
    v_exp_f32 v206, v206
    v_exp_f32 v207, v207
    s_nop 0
    v_cvt_pk_bf16_f32 v112, v192, v193
    v_cvt_pk_bf16_f32 v113, v194, v195
    v_cvt_pk_bf16_f32 v114, v196, v197
    v_cvt_pk_bf16_f32 v115, v198, v199
    v_cvt_pk_bf16_f32 v116, v200, v201
    v_cvt_pk_bf16_f32 v117, v202, v203
    v_cvt_pk_bf16_f32 v118, v204, v205
    v_cvt_pk_bf16_f32 v119, v206, v207
    s_nop 1
    v_mfma_f32_16x16x32_bf16 v[164:167], v[176:179], v[112:115], v[160:163]
    v_mfma_f32_16x16x32_bf16 v[164:167], v[208:211], v[116:119], v[164:167]
    v_mfma_f32_16x16x32_bf16 v[16:19], v[144:147], v[128:131], v[80:83]
    v_mfma_f32_16x16x32_bf16 v[24:27], v[144:147], v[132:135], v[84:87]
    v_mfma_f32_16x16x32_bf16 v[28:31], v[148:151], v[132:135], v[84:87]
    v_mfma_f32_16x16x32_bf16 v[20:23], v[148:151], v[128:131], v[80:83]
    s_branch attn_out_kernel_back19
attn_out_kernel_rare20:
    ds_read_b128 v[184:187], v2 offset:34816
    ds_read_b128 v[188:191], v2 offset:35840
    s_waitcnt lgkmcnt(0)
    v_mfma_f32_16x16x32_bf16 v[192:195], v[184:187], v[136:139], 0
    v_mfma_f32_16x16x32_bf16 v[200:203], v[184:187], v[140:143], 0
    v_mfma_f32_16x16x32_bf16 v[204:207], v[188:191], v[140:143], 0
    v_mfma_f32_16x16x32_bf16 v[196:199], v[188:191], v[136:139], 0
    v_log_f32 v7, v168
    v_subrev_f32 v8, s32, v181
    v_add_f32 v7, v7, v181
    v_max_f32 v7, v7, v8
    s_nop 7
    s_nop 7
    v_max3_f32 v8, v192, v193, v194
    v_max3_f32 v8, v8, v195, v196
    v_max3_f32 v8, v8, v197, v198
    v_max_f32 v8, v8, v199
    v_max3_f32 v9, v200, v201, v202
    v_max3_f32 v9, v9, v203, v204
    v_max3_f32 v9, v9, v205, v206
    v_max_f32 v9, v9, v207
    s_nop 1
    v_permlane16_swap_b32 v8, v9
    s_nop 1
    v_max_f32 v8, v8, v9
    v_mov_b32 v11, v8
    s_nop 1
    v_permlane32_swap_b32 v11, v8
    s_nop 1
    v_max_f32 v8, v8, v11
    v_max_f32 v7, v7, v8
    v_add_f32 v7, s32, v7
    v_ceil_f32 v7, v7
    v_sub_f32 v8, v181, v7
    v_cvt_i32_f32 v8, v8
    v_mov_b32 v181, v7
    v_ldexp_f32 v168, v168, v8
    v_mov_b32 v9, v8
    s_nop 1
    v_permlane16_swap_b32 v8, v9
    s_nop 1
    v_ldexp_f32 v64, v64, v8
    v_ldexp_f32 v65, v65, v8
    v_ldexp_f32 v66, v66, v8
    v_ldexp_f32 v67, v67, v8
    v_ldexp_f32 v68, v68, v8
    v_ldexp_f32 v69, v69, v8
    v_ldexp_f32 v70, v70, v8
    v_ldexp_f32 v71, v71, v8
    v_ldexp_f32 v72, v72, v9
    v_ldexp_f32 v73, v73, v9
    v_ldexp_f32 v74, v74, v9
    v_ldexp_f32 v75, v75, v9
    v_ldexp_f32 v76, v76, v9
    v_ldexp_f32 v77, v77, v9
    v_ldexp_f32 v78, v78, v9
    v_ldexp_f32 v79, v79, v9
    v_mov_b32 v11, v7
    s_nop 1
    v_permlane16_swap_b32 v7, v11
    s_nop 1
    v_sub_f32 v96, 0, v7
    v_sub_f32 v100, 0, v11
    v_mov_b32 v97, v96
    v_mov_b32 v101, v100
    v_mov_b32 v98, v96
    v_mov_b32 v102, v100
    v_mov_b32 v99, v96
    v_mov_b32 v103, v100
    v_add_f32 v192, v192, v96
    v_add_f32 v193, v193, v96
    v_add_f32 v194, v194, v96
    v_add_f32 v195, v195, v96
    v_add_f32 v196, v196, v96
    v_add_f32 v197, v197, v96
    v_add_f32 v198, v198, v96
    v_add_f32 v199, v199, v96
    v_add_f32 v200, v200, v100
    v_add_f32 v201, v201, v100
    v_add_f32 v202, v202, v100
    v_add_f32 v203, v203, v100
    v_add_f32 v204, v204, v100
    v_add_f32 v205, v205, v100
    v_add_f32 v206, v206, v100
    v_add_f32 v207, v207, v100
    v_exp_f32 v192, v192
    v_exp_f32 v193, v193
    v_exp_f32 v194, v194
    v_exp_f32 v195, v195
    v_exp_f32 v196, v196
    v_exp_f32 v197, v197
    v_exp_f32 v198, v198
    v_exp_f32 v199, v199
    v_exp_f32 v200, v200
    v_exp_f32 v201, v201
    v_exp_f32 v202, v202
    v_exp_f32 v203, v203
    v_exp_f32 v204, v204
    v_exp_f32 v205, v205
    v_exp_f32 v206, v206
    v_exp_f32 v207, v207
    s_nop 0
    v_cvt_pk_bf16_f32 v120, v192, v193
    v_cvt_pk_bf16_f32 v121, v194, v195
    v_cvt_pk_bf16_f32 v122, v196, v197
    v_cvt_pk_bf16_f32 v123, v198, v199
    v_cvt_pk_bf16_f32 v124, v200, v201
    v_cvt_pk_bf16_f32 v125, v202, v203
    v_cvt_pk_bf16_f32 v126, v204, v205
    v_cvt_pk_bf16_f32 v127, v206, v207
    s_nop 1
    v_mfma_f32_16x16x32_bf16 v[172:175], v[176:179], v[120:123], v[168:171]
    v_mfma_f32_16x16x32_bf16 v[172:175], v[208:211], v[124:127], v[172:175]
    v_mfma_f32_16x16x32_bf16 v[32:35], v[144:147], v[136:139], v[96:99]
    v_mfma_f32_16x16x32_bf16 v[40:43], v[144:147], v[140:143], v[100:103]
    v_mfma_f32_16x16x32_bf16 v[44:47], v[148:151], v[140:143], v[100:103]
    v_mfma_f32_16x16x32_bf16 v[36:39], v[148:151], v[136:139], v[96:99]
    s_branch attn_out_kernel_back20
attn_out_kernel_rare21:
    ds_read_b128 v[184:187], v2 offset:36864
    ds_read_b128 v[188:191], v2 offset:37888
    s_waitcnt lgkmcnt(0)
    v_mfma_f32_16x16x32_bf16 v[192:195], v[184:187], v[128:131], 0
    v_mfma_f32_16x16x32_bf16 v[200:203], v[184:187], v[132:135], 0
    v_mfma_f32_16x16x32_bf16 v[204:207], v[188:191], v[132:135], 0
    v_mfma_f32_16x16x32_bf16 v[196:199], v[188:191], v[128:131], 0
    v_log_f32 v7, v164
    v_subrev_f32 v8, s32, v180
    v_add_f32 v7, v7, v180
    v_max_f32 v7, v7, v8
    s_nop 7
    s_nop 7
    v_max3_f32 v8, v192, v193, v194
    v_max3_f32 v8, v8, v195, v196
    v_max3_f32 v8, v8, v197, v198
    v_max_f32 v8, v8, v199
    v_max3_f32 v9, v200, v201, v202
    v_max3_f32 v9, v9, v203, v204
    v_max3_f32 v9, v9, v205, v206
    v_max_f32 v9, v9, v207
    s_nop 1
    v_permlane16_swap_b32 v8, v9
    s_nop 1
    v_max_f32 v8, v8, v9
    v_mov_b32 v11, v8
    s_nop 1
    v_permlane32_swap_b32 v11, v8
    s_nop 1
    v_max_f32 v8, v8, v11
    v_max_f32 v7, v7, v8
    v_add_f32 v7, s32, v7
    v_ceil_f32 v7, v7
    v_sub_f32 v8, v180, v7
    v_cvt_i32_f32 v8, v8
    v_mov_b32 v180, v7
    v_ldexp_f32 v164, v164, v8
    v_mov_b32 v9, v8
    s_nop 1
    v_permlane16_swap_b32 v8, v9
    s_nop 1
    v_ldexp_f32 v48, v48, v8
    v_ldexp_f32 v49, v49, v8
    v_ldexp_f32 v50, v50, v8
    v_ldexp_f32 v51, v51, v8
    v_ldexp_f32 v52, v52, v8
    v_ldexp_f32 v53, v53, v8
    v_ldexp_f32 v54, v54, v8
    v_ldexp_f32 v55, v55, v8
    v_ldexp_f32 v56, v56, v9
    v_ldexp_f32 v57, v57, v9
    v_ldexp_f32 v58, v58, v9
    v_ldexp_f32 v59, v59, v9
    v_ldexp_f32 v60, v60, v9
    v_ldexp_f32 v61, v61, v9
    v_ldexp_f32 v62, v62, v9
    v_ldexp_f32 v63, v63, v9
    v_mov_b32 v11, v7
    s_nop 1
    v_permlane16_swap_b32 v7, v11
    s_nop 1
    v_sub_f32 v80, 0, v7
    v_sub_f32 v84, 0, v11
    v_mov_b32 v81, v80
    v_mov_b32 v85, v84
    v_mov_b32 v82, v80
    v_mov_b32 v86, v84
    v_mov_b32 v83, v80
    v_mov_b32 v87, v84
    v_add_f32 v192, v192, v80
    v_add_f32 v193, v193, v80
    v_add_f32 v194, v194, v80
    v_add_f32 v195, v195, v80
    v_add_f32 v196, v196, v80
    v_add_f32 v197, v197, v80
    v_add_f32 v198, v198, v80
    v_add_f32 v199, v199, v80
    v_add_f32 v200, v200, v84
    v_add_f32 v201, v201, v84
    v_add_f32 v202, v202, v84
    v_add_f32 v203, v203, v84
    v_add_f32 v204, v204, v84
    v_add_f32 v205, v205, v84
    v_add_f32 v206, v206, v84
    v_add_f32 v207, v207, v84
    v_exp_f32 v192, v192
    v_exp_f32 v193, v193
    v_exp_f32 v194, v194
    v_exp_f32 v195, v195
    v_exp_f32 v196, v196
    v_exp_f32 v197, v197
    v_exp_f32 v198, v198
    v_exp_f32 v199, v199
    v_exp_f32 v200, v200
    v_exp_f32 v201, v201
    v_exp_f32 v202, v202
    v_exp_f32 v203, v203
    v_exp_f32 v204, v204
    v_exp_f32 v205, v205
    v_exp_f32 v206, v206
    v_exp_f32 v207, v207
    s_nop 0
    v_cvt_pk_bf16_f32 v112, v192, v193
    v_cvt_pk_bf16_f32 v113, v194, v195
    v_cvt_pk_bf16_f32 v114, v196, v197
    v_cvt_pk_bf16_f32 v115, v198, v199
    v_cvt_pk_bf16_f32 v116, v200, v201
    v_cvt_pk_bf16_f32 v117, v202, v203
    v_cvt_pk_bf16_f32 v118, v204, v205
    v_cvt_pk_bf16_f32 v119, v206, v207
    s_nop 1
    v_mfma_f32_16x16x32_bf16 v[160:163], v[176:179], v[112:115], v[164:167]
    v_mfma_f32_16x16x32_bf16 v[160:163], v[208:211], v[116:119], v[160:163]
    v_mfma_f32_16x16x32_bf16 v[16:19], v[144:147], v[128:131], v[80:83]
    v_mfma_f32_16x16x32_bf16 v[24:27], v[144:147], v[132:135], v[84:87]
    v_mfma_f32_16x16x32_bf16 v[28:31], v[148:151], v[132:135], v[84:87]
    v_mfma_f32_16x16x32_bf16 v[20:23], v[148:151], v[128:131], v[80:83]
    s_branch attn_out_kernel_back21
attn_out_kernel_rare22:
    ds_read_b128 v[184:187], v2 offset:36864
    ds_read_b128 v[188:191], v2 offset:37888
    s_waitcnt lgkmcnt(0)
    v_mfma_f32_16x16x32_bf16 v[192:195], v[184:187], v[136:139], 0
    v_mfma_f32_16x16x32_bf16 v[200:203], v[184:187], v[140:143], 0
    v_mfma_f32_16x16x32_bf16 v[204:207], v[188:191], v[140:143], 0
    v_mfma_f32_16x16x32_bf16 v[196:199], v[188:191], v[136:139], 0
    v_log_f32 v7, v172
    v_subrev_f32 v8, s32, v181
    v_add_f32 v7, v7, v181
    v_max_f32 v7, v7, v8
    s_nop 7
    s_nop 7
    v_max3_f32 v8, v192, v193, v194
    v_max3_f32 v8, v8, v195, v196
    v_max3_f32 v8, v8, v197, v198
    v_max_f32 v8, v8, v199
    v_max3_f32 v9, v200, v201, v202
    v_max3_f32 v9, v9, v203, v204
    v_max3_f32 v9, v9, v205, v206
    v_max_f32 v9, v9, v207
    s_nop 1
    v_permlane16_swap_b32 v8, v9
    s_nop 1
    v_max_f32 v8, v8, v9
    v_mov_b32 v11, v8
    s_nop 1
    v_permlane32_swap_b32 v11, v8
    s_nop 1
    v_max_f32 v8, v8, v11
    v_max_f32 v7, v7, v8
    v_add_f32 v7, s32, v7
    v_ceil_f32 v7, v7
    v_sub_f32 v8, v181, v7
    v_cvt_i32_f32 v8, v8
    v_mov_b32 v181, v7
    v_ldexp_f32 v172, v172, v8
    v_mov_b32 v9, v8
    s_nop 1
    v_permlane16_swap_b32 v8, v9
    s_nop 1
    v_ldexp_f32 v64, v64, v8
    v_ldexp_f32 v65, v65, v8
    v_ldexp_f32 v66, v66, v8
    v_ldexp_f32 v67, v67, v8
    v_ldexp_f32 v68, v68, v8
    v_ldexp_f32 v69, v69, v8
    v_ldexp_f32 v70, v70, v8
    v_ldexp_f32 v71, v71, v8
    v_ldexp_f32 v72, v72, v9
    v_ldexp_f32 v73, v73, v9
    v_ldexp_f32 v74, v74, v9
    v_ldexp_f32 v75, v75, v9
    v_ldexp_f32 v76, v76, v9
    v_ldexp_f32 v77, v77, v9
    v_ldexp_f32 v78, v78, v9
    v_ldexp_f32 v79, v79, v9
    v_mov_b32 v11, v7
    s_nop 1
    v_permlane16_swap_b32 v7, v11
    s_nop 1
    v_sub_f32 v96, 0, v7
    v_sub_f32 v100, 0, v11
    v_mov_b32 v97, v96
    v_mov_b32 v101, v100
    v_mov_b32 v98, v96
    v_mov_b32 v102, v100
    v_mov_b32 v99, v96
    v_mov_b32 v103, v100
    v_add_f32 v192, v192, v96
    v_add_f32 v193, v193, v96
    v_add_f32 v194, v194, v96
    v_add_f32 v195, v195, v96
    v_add_f32 v196, v196, v96
    v_add_f32 v197, v197, v96
    v_add_f32 v198, v198, v96
    v_add_f32 v199, v199, v96
    v_add_f32 v200, v200, v100
    v_add_f32 v201, v201, v100
    v_add_f32 v202, v202, v100
    v_add_f32 v203, v203, v100
    v_add_f32 v204, v204, v100
    v_add_f32 v205, v205, v100
    v_add_f32 v206, v206, v100
    v_add_f32 v207, v207, v100
    v_exp_f32 v192, v192
    v_exp_f32 v193, v193
    v_exp_f32 v194, v194
    v_exp_f32 v195, v195
    v_exp_f32 v196, v196
    v_exp_f32 v197, v197
    v_exp_f32 v198, v198
    v_exp_f32 v199, v199
    v_exp_f32 v200, v200
    v_exp_f32 v201, v201
    v_exp_f32 v202, v202
    v_exp_f32 v203, v203
    v_exp_f32 v204, v204
    v_exp_f32 v205, v205
    v_exp_f32 v206, v206
    v_exp_f32 v207, v207
    s_nop 0
    v_cvt_pk_bf16_f32 v120, v192, v193
    v_cvt_pk_bf16_f32 v121, v194, v195
    v_cvt_pk_bf16_f32 v122, v196, v197
    v_cvt_pk_bf16_f32 v123, v198, v199
    v_cvt_pk_bf16_f32 v124, v200, v201
    v_cvt_pk_bf16_f32 v125, v202, v203
    v_cvt_pk_bf16_f32 v126, v204, v205
    v_cvt_pk_bf16_f32 v127, v206, v207
    s_nop 1
    v_mfma_f32_16x16x32_bf16 v[168:171], v[176:179], v[120:123], v[172:175]
    v_mfma_f32_16x16x32_bf16 v[168:171], v[208:211], v[124:127], v[168:171]
    v_mfma_f32_16x16x32_bf16 v[32:35], v[144:147], v[136:139], v[96:99]
    v_mfma_f32_16x16x32_bf16 v[40:43], v[144:147], v[140:143], v[100:103]
    v_mfma_f32_16x16x32_bf16 v[44:47], v[148:151], v[140:143], v[100:103]
    v_mfma_f32_16x16x32_bf16 v[36:39], v[148:151], v[136:139], v[96:99]
    s_branch attn_out_kernel_back22
attn_out_kernel_rare23:
    ds_read_b128 v[184:187], v2 offset:38912
    ds_read_b128 v[188:191], v2 offset:39936
    s_waitcnt lgkmcnt(0)
    v_mfma_f32_16x16x32_bf16 v[192:195], v[184:187], v[128:131], 0
    v_mfma_f32_16x16x32_bf16 v[200:203], v[184:187], v[132:135], 0
    v_mfma_f32_16x16x32_bf16 v[204:207], v[188:191], v[132:135], 0
    v_mfma_f32_16x16x32_bf16 v[196:199], v[188:191], v[128:131], 0
    v_log_f32 v7, v160
    v_subrev_f32 v8, s32, v180
    v_add_f32 v7, v7, v180
    v_max_f32 v7, v7, v8
    s_nop 7
    s_nop 7
    v_max3_f32 v8, v192, v193, v194
    v_max3_f32 v8, v8, v195, v196
    v_max3_f32 v8, v8, v197, v198
    v_max_f32 v8, v8, v199
    v_max3_f32 v9, v200, v201, v202
    v_max3_f32 v9, v9, v203, v204
    v_max3_f32 v9, v9, v205, v206
    v_max_f32 v9, v9, v207
    s_nop 1
    v_permlane16_swap_b32 v8, v9
    s_nop 1
    v_max_f32 v8, v8, v9
    v_mov_b32 v11, v8
    s_nop 1
    v_permlane32_swap_b32 v11, v8
    s_nop 1
    v_max_f32 v8, v8, v11
    v_max_f32 v7, v7, v8
    v_add_f32 v7, s32, v7
    v_ceil_f32 v7, v7
    v_sub_f32 v8, v180, v7
    v_cvt_i32_f32 v8, v8
    v_mov_b32 v180, v7
    v_ldexp_f32 v160, v160, v8
    v_mov_b32 v9, v8
    s_nop 1
    v_permlane16_swap_b32 v8, v9
    s_nop 1
    v_ldexp_f32 v48, v48, v8
    v_ldexp_f32 v49, v49, v8
    v_ldexp_f32 v50, v50, v8
    v_ldexp_f32 v51, v51, v8
    v_ldexp_f32 v52, v52, v8
    v_ldexp_f32 v53, v53, v8
    v_ldexp_f32 v54, v54, v8
    v_ldexp_f32 v55, v55, v8
    v_ldexp_f32 v56, v56, v9
    v_ldexp_f32 v57, v57, v9
    v_ldexp_f32 v58, v58, v9
    v_ldexp_f32 v59, v59, v9
    v_ldexp_f32 v60, v60, v9
    v_ldexp_f32 v61, v61, v9
    v_ldexp_f32 v62, v62, v9
    v_ldexp_f32 v63, v63, v9
    v_mov_b32 v11, v7
    s_nop 1
    v_permlane16_swap_b32 v7, v11
    s_nop 1
    v_sub_f32 v80, 0, v7
    v_sub_f32 v84, 0, v11
    v_mov_b32 v81, v80
    v_mov_b32 v85, v84
    v_mov_b32 v82, v80
    v_mov_b32 v86, v84
    v_mov_b32 v83, v80
    v_mov_b32 v87, v84
    v_add_f32 v192, v192, v80
    v_add_f32 v193, v193, v80
    v_add_f32 v194, v194, v80
    v_add_f32 v195, v195, v80
    v_add_f32 v196, v196, v80
    v_add_f32 v197, v197, v80
    v_add_f32 v198, v198, v80
    v_add_f32 v199, v199, v80
    v_add_f32 v200, v200, v84
    v_add_f32 v201, v201, v84
    v_add_f32 v202, v202, v84
    v_add_f32 v203, v203, v84
    v_add_f32 v204, v204, v84
    v_add_f32 v205, v205, v84
    v_add_f32 v206, v206, v84
    v_add_f32 v207, v207, v84
    v_exp_f32 v192, v192
    v_exp_f32 v193, v193
    v_exp_f32 v194, v194
    v_exp_f32 v195, v195
    v_exp_f32 v196, v196
    v_exp_f32 v197, v197
    v_exp_f32 v198, v198
    v_exp_f32 v199, v199
    v_exp_f32 v200, v200
    v_exp_f32 v201, v201
    v_exp_f32 v202, v202
    v_exp_f32 v203, v203
    v_exp_f32 v204, v204
    v_exp_f32 v205, v205
    v_exp_f32 v206, v206
    v_exp_f32 v207, v207
    s_nop 0
    v_cvt_pk_bf16_f32 v112, v192, v193
    v_cvt_pk_bf16_f32 v113, v194, v195
    v_cvt_pk_bf16_f32 v114, v196, v197
    v_cvt_pk_bf16_f32 v115, v198, v199
    v_cvt_pk_bf16_f32 v116, v200, v201
    v_cvt_pk_bf16_f32 v117, v202, v203
    v_cvt_pk_bf16_f32 v118, v204, v205
    v_cvt_pk_bf16_f32 v119, v206, v207
    s_nop 1
    v_mfma_f32_16x16x32_bf16 v[164:167], v[176:179], v[112:115], v[160:163]
    v_mfma_f32_16x16x32_bf16 v[164:167], v[208:211], v[116:119], v[164:167]
    v_mfma_f32_16x16x32_bf16 v[16:19], v[144:147], v[128:131], v[80:83]
    v_mfma_f32_16x16x32_bf16 v[24:27], v[144:147], v[132:135], v[84:87]
    v_mfma_f32_16x16x32_bf16 v[28:31], v[148:151], v[132:135], v[84:87]
    v_mfma_f32_16x16x32_bf16 v[20:23], v[148:151], v[128:131], v[80:83]
    s_branch attn_out_kernel_back23
attn_out_kernel_rare24:
    ds_read_b128 v[184:187], v2 offset:38912
    ds_read_b128 v[188:191], v2 offset:39936
    s_waitcnt lgkmcnt(0)
    v_mfma_f32_16x16x32_bf16 v[192:195], v[184:187], v[136:139], 0
    v_mfma_f32_16x16x32_bf16 v[200:203], v[184:187], v[140:143], 0
    v_mfma_f32_16x16x32_bf16 v[204:207], v[188:191], v[140:143], 0
    v_mfma_f32_16x16x32_bf16 v[196:199], v[188:191], v[136:139], 0
    v_log_f32 v7, v168
    v_subrev_f32 v8, s32, v181
    v_add_f32 v7, v7, v181
    v_max_f32 v7, v7, v8
    s_nop 7
    s_nop 7
    v_max3_f32 v8, v192, v193, v194
    v_max3_f32 v8, v8, v195, v196
    v_max3_f32 v8, v8, v197, v198
    v_max_f32 v8, v8, v199
    v_max3_f32 v9, v200, v201, v202
    v_max3_f32 v9, v9, v203, v204
    v_max3_f32 v9, v9, v205, v206
    v_max_f32 v9, v9, v207
    s_nop 1
    v_permlane16_swap_b32 v8, v9
    s_nop 1
    v_max_f32 v8, v8, v9
    v_mov_b32 v11, v8
    s_nop 1
    v_permlane32_swap_b32 v11, v8
    s_nop 1
    v_max_f32 v8, v8, v11
    v_max_f32 v7, v7, v8
    v_add_f32 v7, s32, v7
    v_ceil_f32 v7, v7
    v_sub_f32 v8, v181, v7
    v_cvt_i32_f32 v8, v8
    v_mov_b32 v181, v7
    v_ldexp_f32 v168, v168, v8
    v_mov_b32 v9, v8
    s_nop 1
    v_permlane16_swap_b32 v8, v9
    s_nop 1
    v_ldexp_f32 v64, v64, v8
    v_ldexp_f32 v65, v65, v8
    v_ldexp_f32 v66, v66, v8
    v_ldexp_f32 v67, v67, v8
    v_ldexp_f32 v68, v68, v8
    v_ldexp_f32 v69, v69, v8
    v_ldexp_f32 v70, v70, v8
    v_ldexp_f32 v71, v71, v8
    v_ldexp_f32 v72, v72, v9
    v_ldexp_f32 v73, v73, v9
    v_ldexp_f32 v74, v74, v9
    v_ldexp_f32 v75, v75, v9
    v_ldexp_f32 v76, v76, v9
    v_ldexp_f32 v77, v77, v9
    v_ldexp_f32 v78, v78, v9
    v_ldexp_f32 v79, v79, v9
    v_mov_b32 v11, v7
    s_nop 1
    v_permlane16_swap_b32 v7, v11
    s_nop 1
    v_sub_f32 v96, 0, v7
    v_sub_f32 v100, 0, v11
    v_mov_b32 v97, v96
    v_mov_b32 v101, v100
    v_mov_b32 v98, v96
    v_mov_b32 v102, v100
    v_mov_b32 v99, v96
    v_mov_b32 v103, v100
    v_add_f32 v192, v192, v96
    v_add_f32 v193, v193, v96
    v_add_f32 v194, v194, v96
    v_add_f32 v195, v195, v96
    v_add_f32 v196, v196, v96
    v_add_f32 v197, v197, v96
    v_add_f32 v198, v198, v96
    v_add_f32 v199, v199, v96
    v_add_f32 v200, v200, v100
    v_add_f32 v201, v201, v100
    v_add_f32 v202, v202, v100
    v_add_f32 v203, v203, v100
    v_add_f32 v204, v204, v100
    v_add_f32 v205, v205, v100
    v_add_f32 v206, v206, v100
    v_add_f32 v207, v207, v100
    v_exp_f32 v192, v192
    v_exp_f32 v193, v193
    v_exp_f32 v194, v194
    v_exp_f32 v195, v195
    v_exp_f32 v196, v196
    v_exp_f32 v197, v197
    v_exp_f32 v198, v198
    v_exp_f32 v199, v199
    v_exp_f32 v200, v200
    v_exp_f32 v201, v201
    v_exp_f32 v202, v202
    v_exp_f32 v203, v203
    v_exp_f32 v204, v204
    v_exp_f32 v205, v205
    v_exp_f32 v206, v206
    v_exp_f32 v207, v207
    s_nop 0
    v_cvt_pk_bf16_f32 v120, v192, v193
    v_cvt_pk_bf16_f32 v121, v194, v195
    v_cvt_pk_bf16_f32 v122, v196, v197
    v_cvt_pk_bf16_f32 v123, v198, v199
    v_cvt_pk_bf16_f32 v124, v200, v201
    v_cvt_pk_bf16_f32 v125, v202, v203
    v_cvt_pk_bf16_f32 v126, v204, v205
    v_cvt_pk_bf16_f32 v127, v206, v207
    s_nop 1
    v_mfma_f32_16x16x32_bf16 v[172:175], v[176:179], v[120:123], v[168:171]
    v_mfma_f32_16x16x32_bf16 v[172:175], v[208:211], v[124:127], v[172:175]
    v_mfma_f32_16x16x32_bf16 v[32:35], v[144:147], v[136:139], v[96:99]
    v_mfma_f32_16x16x32_bf16 v[40:43], v[144:147], v[140:143], v[100:103]
    v_mfma_f32_16x16x32_bf16 v[44:47], v[148:151], v[140:143], v[100:103]
    v_mfma_f32_16x16x32_bf16 v[36:39], v[148:151], v[136:139], v[96:99]
    s_branch attn_out_kernel_back24
attn_out_kernel_rare25:
    ds_read_b128 v[184:187], v2 offset:49152
    ds_read_b128 v[188:191], v2 offset:50176
    s_waitcnt lgkmcnt(0)
    v_mfma_f32_16x16x32_bf16 v[192:195], v[184:187], v[128:131], 0
    v_mfma_f32_16x16x32_bf16 v[200:203], v[184:187], v[132:135], 0
    v_mfma_f32_16x16x32_bf16 v[204:207], v[188:191], v[132:135], 0
    v_mfma_f32_16x16x32_bf16 v[196:199], v[188:191], v[128:131], 0
    v_log_f32 v7, v164
    v_subrev_f32 v8, s32, v180
    v_add_f32 v7, v7, v180
    v_max_f32 v7, v7, v8
    s_nop 7
    s_nop 7
    v_max3_f32 v8, v192, v193, v194
    v_max3_f32 v8, v8, v195, v196
    v_max3_f32 v8, v8, v197, v198
    v_max_f32 v8, v8, v199
    v_max3_f32 v9, v200, v201, v202
    v_max3_f32 v9, v9, v203, v204
    v_max3_f32 v9, v9, v205, v206
    v_max_f32 v9, v9, v207
    s_nop 1
    v_permlane16_swap_b32 v8, v9
    s_nop 1
    v_max_f32 v8, v8, v9
    v_mov_b32 v11, v8
    s_nop 1
    v_permlane32_swap_b32 v11, v8
    s_nop 1
    v_max_f32 v8, v8, v11
    v_max_f32 v7, v7, v8
    v_add_f32 v7, s32, v7
    v_ceil_f32 v7, v7
    v_sub_f32 v8, v180, v7
    v_cvt_i32_f32 v8, v8
    v_mov_b32 v180, v7
    v_ldexp_f32 v164, v164, v8
    v_mov_b32 v9, v8
    s_nop 1
    v_permlane16_swap_b32 v8, v9
    s_nop 1
    v_ldexp_f32 v48, v48, v8
    v_ldexp_f32 v49, v49, v8
    v_ldexp_f32 v50, v50, v8
    v_ldexp_f32 v51, v51, v8
    v_ldexp_f32 v52, v52, v8
    v_ldexp_f32 v53, v53, v8
    v_ldexp_f32 v54, v54, v8
    v_ldexp_f32 v55, v55, v8
    v_ldexp_f32 v56, v56, v9
    v_ldexp_f32 v57, v57, v9
    v_ldexp_f32 v58, v58, v9
    v_ldexp_f32 v59, v59, v9
    v_ldexp_f32 v60, v60, v9
    v_ldexp_f32 v61, v61, v9
    v_ldexp_f32 v62, v62, v9
    v_ldexp_f32 v63, v63, v9
    v_mov_b32 v11, v7
    s_nop 1
    v_permlane16_swap_b32 v7, v11
    s_nop 1
    v_sub_f32 v80, 0, v7
    v_sub_f32 v84, 0, v11
    v_mov_b32 v81, v80
    v_mov_b32 v85, v84
    v_mov_b32 v82, v80
    v_mov_b32 v86, v84
    v_mov_b32 v83, v80
    v_mov_b32 v87, v84
    v_add_f32 v192, v192, v80
    v_add_f32 v193, v193, v80
    v_add_f32 v194, v194, v80
    v_add_f32 v195, v195, v80
    v_add_f32 v196, v196, v80
    v_add_f32 v197, v197, v80
    v_add_f32 v198, v198, v80
    v_add_f32 v199, v199, v80
    v_add_f32 v200, v200, v84
    v_add_f32 v201, v201, v84
    v_add_f32 v202, v202, v84
    v_add_f32 v203, v203, v84
    v_add_f32 v204, v204, v84
    v_add_f32 v205, v205, v84
    v_add_f32 v206, v206, v84
    v_add_f32 v207, v207, v84
    v_exp_f32 v192, v192
    v_exp_f32 v193, v193
    v_exp_f32 v194, v194
    v_exp_f32 v195, v195
    v_exp_f32 v196, v196
    v_exp_f32 v197, v197
    v_exp_f32 v198, v198
    v_exp_f32 v199, v199
    v_exp_f32 v200, v200
    v_exp_f32 v201, v201
    v_exp_f32 v202, v202
    v_exp_f32 v203, v203
    v_exp_f32 v204, v204
    v_exp_f32 v205, v205
    v_exp_f32 v206, v206
    v_exp_f32 v207, v207
    s_nop 0
    v_cvt_pk_bf16_f32 v112, v192, v193
    v_cvt_pk_bf16_f32 v113, v194, v195
    v_cvt_pk_bf16_f32 v114, v196, v197
    v_cvt_pk_bf16_f32 v115, v198, v199
    v_cvt_pk_bf16_f32 v116, v200, v201
    v_cvt_pk_bf16_f32 v117, v202, v203
    v_cvt_pk_bf16_f32 v118, v204, v205
    v_cvt_pk_bf16_f32 v119, v206, v207
    s_nop 1
    v_mfma_f32_16x16x32_bf16 v[160:163], v[176:179], v[112:115], v[164:167]
    v_mfma_f32_16x16x32_bf16 v[160:163], v[208:211], v[116:119], v[160:163]
    v_mfma_f32_16x16x32_bf16 v[16:19], v[144:147], v[128:131], v[80:83]
    v_mfma_f32_16x16x32_bf16 v[24:27], v[144:147], v[132:135], v[84:87]
    v_mfma_f32_16x16x32_bf16 v[28:31], v[148:151], v[132:135], v[84:87]
    v_mfma_f32_16x16x32_bf16 v[20:23], v[148:151], v[128:131], v[80:83]
    s_branch attn_out_kernel_back25
attn_out_kernel_rare26:
    ds_read_b128 v[184:187], v2 offset:49152
    ds_read_b128 v[188:191], v2 offset:50176
    s_waitcnt lgkmcnt(0)
    v_mfma_f32_16x16x32_bf16 v[192:195], v[184:187], v[136:139], 0
    v_mfma_f32_16x16x32_bf16 v[200:203], v[184:187], v[140:143], 0
    v_mfma_f32_16x16x32_bf16 v[204:207], v[188:191], v[140:143], 0
    v_mfma_f32_16x16x32_bf16 v[196:199], v[188:191], v[136:139], 0
    v_log_f32 v7, v172
    v_subrev_f32 v8, s32, v181
    v_add_f32 v7, v7, v181
    v_max_f32 v7, v7, v8
    s_nop 7
    s_nop 7
    v_max3_f32 v8, v192, v193, v194
    v_max3_f32 v8, v8, v195, v196
    v_max3_f32 v8, v8, v197, v198
    v_max_f32 v8, v8, v199
    v_max3_f32 v9, v200, v201, v202
    v_max3_f32 v9, v9, v203, v204
    v_max3_f32 v9, v9, v205, v206
    v_max_f32 v9, v9, v207
    s_nop 1
    v_permlane16_swap_b32 v8, v9
    s_nop 1
    v_max_f32 v8, v8, v9
    v_mov_b32 v11, v8
    s_nop 1
    v_permlane32_swap_b32 v11, v8
    s_nop 1
    v_max_f32 v8, v8, v11
    v_max_f32 v7, v7, v8
    v_add_f32 v7, s32, v7
    v_ceil_f32 v7, v7
    v_sub_f32 v8, v181, v7
    v_cvt_i32_f32 v8, v8
    v_mov_b32 v181, v7
    v_ldexp_f32 v172, v172, v8
    v_mov_b32 v9, v8
    s_nop 1
    v_permlane16_swap_b32 v8, v9
    s_nop 1
    v_ldexp_f32 v64, v64, v8
    v_ldexp_f32 v65, v65, v8
    v_ldexp_f32 v66, v66, v8
    v_ldexp_f32 v67, v67, v8
    v_ldexp_f32 v68, v68, v8
    v_ldexp_f32 v69, v69, v8
    v_ldexp_f32 v70, v70, v8
    v_ldexp_f32 v71, v71, v8
    v_ldexp_f32 v72, v72, v9
    v_ldexp_f32 v73, v73, v9
    v_ldexp_f32 v74, v74, v9
    v_ldexp_f32 v75, v75, v9
    v_ldexp_f32 v76, v76, v9
    v_ldexp_f32 v77, v77, v9
    v_ldexp_f32 v78, v78, v9
    v_ldexp_f32 v79, v79, v9
    v_mov_b32 v11, v7
    s_nop 1
    v_permlane16_swap_b32 v7, v11
    s_nop 1
    v_sub_f32 v96, 0, v7
    v_sub_f32 v100, 0, v11
    v_mov_b32 v97, v96
    v_mov_b32 v101, v100
    v_mov_b32 v98, v96
    v_mov_b32 v102, v100
    v_mov_b32 v99, v96
    v_mov_b32 v103, v100
    v_add_f32 v192, v192, v96
    v_add_f32 v193, v193, v96
    v_add_f32 v194, v194, v96
    v_add_f32 v195, v195, v96
    v_add_f32 v196, v196, v96
    v_add_f32 v197, v197, v96
    v_add_f32 v198, v198, v96
    v_add_f32 v199, v199, v96
    v_add_f32 v200, v200, v100
    v_add_f32 v201, v201, v100
    v_add_f32 v202, v202, v100
    v_add_f32 v203, v203, v100
    v_add_f32 v204, v204, v100
    v_add_f32 v205, v205, v100
    v_add_f32 v206, v206, v100
    v_add_f32 v207, v207, v100
    v_exp_f32 v192, v192
    v_exp_f32 v193, v193
    v_exp_f32 v194, v194
    v_exp_f32 v195, v195
    v_exp_f32 v196, v196
    v_exp_f32 v197, v197
    v_exp_f32 v198, v198
    v_exp_f32 v199, v199
    v_exp_f32 v200, v200
    v_exp_f32 v201, v201
    v_exp_f32 v202, v202
    v_exp_f32 v203, v203
    v_exp_f32 v204, v204
    v_exp_f32 v205, v205
    v_exp_f32 v206, v206
    v_exp_f32 v207, v207
    s_nop 0
    v_cvt_pk_bf16_f32 v120, v192, v193
    v_cvt_pk_bf16_f32 v121, v194, v195
    v_cvt_pk_bf16_f32 v122, v196, v197
    v_cvt_pk_bf16_f32 v123, v198, v199
    v_cvt_pk_bf16_f32 v124, v200, v201
    v_cvt_pk_bf16_f32 v125, v202, v203
    v_cvt_pk_bf16_f32 v126, v204, v205
    v_cvt_pk_bf16_f32 v127, v206, v207
    s_nop 1
    v_mfma_f32_16x16x32_bf16 v[168:171], v[176:179], v[120:123], v[172:175]
    v_mfma_f32_16x16x32_bf16 v[168:171], v[208:211], v[124:127], v[168:171]
    v_mfma_f32_16x16x32_bf16 v[32:35], v[144:147], v[136:139], v[96:99]
    v_mfma_f32_16x16x32_bf16 v[40:43], v[144:147], v[140:143], v[100:103]
    v_mfma_f32_16x16x32_bf16 v[44:47], v[148:151], v[140:143], v[100:103]
    v_mfma_f32_16x16x32_bf16 v[36:39], v[148:151], v[136:139], v[96:99]
    s_branch attn_out_kernel_back26
attn_out_kernel_rare27:
    ds_read_b128 v[184:187], v2 offset:51200
    ds_read_b128 v[188:191], v2 offset:52224
    s_waitcnt lgkmcnt(0)
    v_mfma_f32_16x16x32_bf16 v[192:195], v[184:187], v[128:131], 0
    v_mfma_f32_16x16x32_bf16 v[200:203], v[184:187], v[132:135], 0
    v_mfma_f32_16x16x32_bf16 v[204:207], v[188:191], v[132:135], 0
    v_mfma_f32_16x16x32_bf16 v[196:199], v[188:191], v[128:131], 0
    v_log_f32 v7, v160
    v_subrev_f32 v8, s32, v180
    v_add_f32 v7, v7, v180
    v_max_f32 v7, v7, v8
    s_nop 7
    s_nop 7
    v_max3_f32 v8, v192, v193, v194
    v_max3_f32 v8, v8, v195, v196
    v_max3_f32 v8, v8, v197, v198
    v_max_f32 v8, v8, v199
    v_max3_f32 v9, v200, v201, v202
    v_max3_f32 v9, v9, v203, v204
    v_max3_f32 v9, v9, v205, v206
    v_max_f32 v9, v9, v207
    s_nop 1
    v_permlane16_swap_b32 v8, v9
    s_nop 1
    v_max_f32 v8, v8, v9
    v_mov_b32 v11, v8
    s_nop 1
    v_permlane32_swap_b32 v11, v8
    s_nop 1
    v_max_f32 v8, v8, v11
    v_max_f32 v7, v7, v8
    v_add_f32 v7, s32, v7
    v_ceil_f32 v7, v7
    v_sub_f32 v8, v180, v7
    v_cvt_i32_f32 v8, v8
    v_mov_b32 v180, v7
    v_ldexp_f32 v160, v160, v8
    v_mov_b32 v9, v8
    s_nop 1
    v_permlane16_swap_b32 v8, v9
    s_nop 1
    v_ldexp_f32 v48, v48, v8
    v_ldexp_f32 v49, v49, v8
    v_ldexp_f32 v50, v50, v8
    v_ldexp_f32 v51, v51, v8
    v_ldexp_f32 v52, v52, v8
    v_ldexp_f32 v53, v53, v8
    v_ldexp_f32 v54, v54, v8
    v_ldexp_f32 v55, v55, v8
    v_ldexp_f32 v56, v56, v9
    v_ldexp_f32 v57, v57, v9
    v_ldexp_f32 v58, v58, v9
    v_ldexp_f32 v59, v59, v9
    v_ldexp_f32 v60, v60, v9
    v_ldexp_f32 v61, v61, v9
    v_ldexp_f32 v62, v62, v9
    v_ldexp_f32 v63, v63, v9
    v_mov_b32 v11, v7
    s_nop 1
    v_permlane16_swap_b32 v7, v11
    s_nop 1
    v_sub_f32 v80, 0, v7
    v_sub_f32 v84, 0, v11
    v_mov_b32 v81, v80
    v_mov_b32 v85, v84
    v_mov_b32 v82, v80
    v_mov_b32 v86, v84
    v_mov_b32 v83, v80
    v_mov_b32 v87, v84
    v_add_f32 v192, v192, v80
    v_add_f32 v193, v193, v80
    v_add_f32 v194, v194, v80
    v_add_f32 v195, v195, v80
    v_add_f32 v196, v196, v80
    v_add_f32 v197, v197, v80
    v_add_f32 v198, v198, v80
    v_add_f32 v199, v199, v80
    v_add_f32 v200, v200, v84
    v_add_f32 v201, v201, v84
    v_add_f32 v202, v202, v84
    v_add_f32 v203, v203, v84
    v_add_f32 v204, v204, v84
    v_add_f32 v205, v205, v84
    v_add_f32 v206, v206, v84
    v_add_f32 v207, v207, v84
    v_exp_f32 v192, v192
    v_exp_f32 v193, v193
    v_exp_f32 v194, v194
    v_exp_f32 v195, v195
    v_exp_f32 v196, v196
    v_exp_f32 v197, v197
    v_exp_f32 v198, v198
    v_exp_f32 v199, v199
    v_exp_f32 v200, v200
    v_exp_f32 v201, v201
    v_exp_f32 v202, v202
    v_exp_f32 v203, v203
    v_exp_f32 v204, v204
    v_exp_f32 v205, v205
    v_exp_f32 v206, v206
    v_exp_f32 v207, v207
    s_nop 0
    v_cvt_pk_bf16_f32 v112, v192, v193
    v_cvt_pk_bf16_f32 v113, v194, v195
    v_cvt_pk_bf16_f32 v114, v196, v197
    v_cvt_pk_bf16_f32 v115, v198, v199
    v_cvt_pk_bf16_f32 v116, v200, v201
    v_cvt_pk_bf16_f32 v117, v202, v203
    v_cvt_pk_bf16_f32 v118, v204, v205
    v_cvt_pk_bf16_f32 v119, v206, v207
    s_nop 1
    v_mfma_f32_16x16x32_bf16 v[164:167], v[176:179], v[112:115], v[160:163]
    v_mfma_f32_16x16x32_bf16 v[164:167], v[208:211], v[116:119], v[164:167]
    v_mfma_f32_16x16x32_bf16 v[16:19], v[144:147], v[128:131], v[80:83]
    v_mfma_f32_16x16x32_bf16 v[24:27], v[144:147], v[132:135], v[84:87]
    v_mfma_f32_16x16x32_bf16 v[28:31], v[148:151], v[132:135], v[84:87]
    v_mfma_f32_16x16x32_bf16 v[20:23], v[148:151], v[128:131], v[80:83]
    s_branch attn_out_kernel_back27
attn_out_kernel_rare28:
    ds_read_b128 v[184:187], v2 offset:51200
    ds_read_b128 v[188:191], v2 offset:52224
    s_waitcnt lgkmcnt(0)
    v_mfma_f32_16x16x32_bf16 v[192:195], v[184:187], v[136:139], 0
    v_mfma_f32_16x16x32_bf16 v[200:203], v[184:187], v[140:143], 0
    v_mfma_f32_16x16x32_bf16 v[204:207], v[188:191], v[140:143], 0
    v_mfma_f32_16x16x32_bf16 v[196:199], v[188:191], v[136:139], 0
    v_log_f32 v7, v168
    v_subrev_f32 v8, s32, v181
    v_add_f32 v7, v7, v181
    v_max_f32 v7, v7, v8
    s_nop 7
    s_nop 7
    v_max3_f32 v8, v192, v193, v194
    v_max3_f32 v8, v8, v195, v196
    v_max3_f32 v8, v8, v197, v198
    v_max_f32 v8, v8, v199
    v_max3_f32 v9, v200, v201, v202
    v_max3_f32 v9, v9, v203, v204
    v_max3_f32 v9, v9, v205, v206
    v_max_f32 v9, v9, v207
    s_nop 1
    v_permlane16_swap_b32 v8, v9
    s_nop 1
    v_max_f32 v8, v8, v9
    v_mov_b32 v11, v8
    s_nop 1
    v_permlane32_swap_b32 v11, v8
    s_nop 1
    v_max_f32 v8, v8, v11
    v_max_f32 v7, v7, v8
    v_add_f32 v7, s32, v7
    v_ceil_f32 v7, v7
    v_sub_f32 v8, v181, v7
    v_cvt_i32_f32 v8, v8
    v_mov_b32 v181, v7
    v_ldexp_f32 v168, v168, v8
    v_mov_b32 v9, v8
    s_nop 1
    v_permlane16_swap_b32 v8, v9
    s_nop 1
    v_ldexp_f32 v64, v64, v8
    v_ldexp_f32 v65, v65, v8
    v_ldexp_f32 v66, v66, v8
    v_ldexp_f32 v67, v67, v8
    v_ldexp_f32 v68, v68, v8
    v_ldexp_f32 v69, v69, v8
    v_ldexp_f32 v70, v70, v8
    v_ldexp_f32 v71, v71, v8
    v_ldexp_f32 v72, v72, v9
    v_ldexp_f32 v73, v73, v9
    v_ldexp_f32 v74, v74, v9
    v_ldexp_f32 v75, v75, v9
    v_ldexp_f32 v76, v76, v9
    v_ldexp_f32 v77, v77, v9
    v_ldexp_f32 v78, v78, v9
    v_ldexp_f32 v79, v79, v9
    v_mov_b32 v11, v7
    s_nop 1
    v_permlane16_swap_b32 v7, v11
    s_nop 1
    v_sub_f32 v96, 0, v7
    v_sub_f32 v100, 0, v11
    v_mov_b32 v97, v96
    v_mov_b32 v101, v100
    v_mov_b32 v98, v96
    v_mov_b32 v102, v100
    v_mov_b32 v99, v96
    v_mov_b32 v103, v100
    v_add_f32 v192, v192, v96
    v_add_f32 v193, v193, v96
    v_add_f32 v194, v194, v96
    v_add_f32 v195, v195, v96
    v_add_f32 v196, v196, v96
    v_add_f32 v197, v197, v96
    v_add_f32 v198, v198, v96
    v_add_f32 v199, v199, v96
    v_add_f32 v200, v200, v100
    v_add_f32 v201, v201, v100
    v_add_f32 v202, v202, v100
    v_add_f32 v203, v203, v100
    v_add_f32 v204, v204, v100
    v_add_f32 v205, v205, v100
    v_add_f32 v206, v206, v100
    v_add_f32 v207, v207, v100
    v_exp_f32 v192, v192
    v_exp_f32 v193, v193
    v_exp_f32 v194, v194
    v_exp_f32 v195, v195
    v_exp_f32 v196, v196
    v_exp_f32 v197, v197
    v_exp_f32 v198, v198
    v_exp_f32 v199, v199
    v_exp_f32 v200, v200
    v_exp_f32 v201, v201
    v_exp_f32 v202, v202
    v_exp_f32 v203, v203
    v_exp_f32 v204, v204
    v_exp_f32 v205, v205
    v_exp_f32 v206, v206
    v_exp_f32 v207, v207
    s_nop 0
    v_cvt_pk_bf16_f32 v120, v192, v193
    v_cvt_pk_bf16_f32 v121, v194, v195
    v_cvt_pk_bf16_f32 v122, v196, v197
    v_cvt_pk_bf16_f32 v123, v198, v199
    v_cvt_pk_bf16_f32 v124, v200, v201
    v_cvt_pk_bf16_f32 v125, v202, v203
    v_cvt_pk_bf16_f32 v126, v204, v205
    v_cvt_pk_bf16_f32 v127, v206, v207
    s_nop 1
    v_mfma_f32_16x16x32_bf16 v[172:175], v[176:179], v[120:123], v[168:171]
    v_mfma_f32_16x16x32_bf16 v[172:175], v[208:211], v[124:127], v[172:175]
    v_mfma_f32_16x16x32_bf16 v[32:35], v[144:147], v[136:139], v[96:99]
    v_mfma_f32_16x16x32_bf16 v[40:43], v[144:147], v[140:143], v[100:103]
    v_mfma_f32_16x16x32_bf16 v[44:47], v[148:151], v[140:143], v[100:103]
    v_mfma_f32_16x16x32_bf16 v[36:39], v[148:151], v[136:139], v[96:99]
    s_branch attn_out_kernel_back28
attn_out_kernel_rare29:
    ds_read_b128 v[184:187], v2 offset:53248
    ds_read_b128 v[188:191], v2 offset:54272
    s_waitcnt lgkmcnt(0)
    v_mfma_f32_16x16x32_bf16 v[192:195], v[184:187], v[128:131], 0
    v_mfma_f32_16x16x32_bf16 v[200:203], v[184:187], v[132:135], 0
    v_mfma_f32_16x16x32_bf16 v[204:207], v[188:191], v[132:135], 0
    v_mfma_f32_16x16x32_bf16 v[196:199], v[188:191], v[128:131], 0
    v_log_f32 v7, v164
    v_subrev_f32 v8, s32, v180
    v_add_f32 v7, v7, v180
    v_max_f32 v7, v7, v8
    s_nop 7
    s_nop 7
    v_max3_f32 v8, v192, v193, v194
    v_max3_f32 v8, v8, v195, v196
    v_max3_f32 v8, v8, v197, v198
    v_max_f32 v8, v8, v199
    v_max3_f32 v9, v200, v201, v202
    v_max3_f32 v9, v9, v203, v204
    v_max3_f32 v9, v9, v205, v206
    v_max_f32 v9, v9, v207
    s_nop 1
    v_permlane16_swap_b32 v8, v9
    s_nop 1
    v_max_f32 v8, v8, v9
    v_mov_b32 v11, v8
    s_nop 1
    v_permlane32_swap_b32 v11, v8
    s_nop 1
    v_max_f32 v8, v8, v11
    v_max_f32 v7, v7, v8
    v_add_f32 v7, s32, v7
    v_ceil_f32 v7, v7
    v_sub_f32 v8, v180, v7
    v_cvt_i32_f32 v8, v8
    v_mov_b32 v180, v7
    v_ldexp_f32 v164, v164, v8
    v_mov_b32 v9, v8
    s_nop 1
    v_permlane16_swap_b32 v8, v9
    s_nop 1
    v_ldexp_f32 v48, v48, v8
    v_ldexp_f32 v49, v49, v8
    v_ldexp_f32 v50, v50, v8
    v_ldexp_f32 v51, v51, v8
    v_ldexp_f32 v52, v52, v8
    v_ldexp_f32 v53, v53, v8
    v_ldexp_f32 v54, v54, v8
    v_ldexp_f32 v55, v55, v8
    v_ldexp_f32 v56, v56, v9
    v_ldexp_f32 v57, v57, v9
    v_ldexp_f32 v58, v58, v9
    v_ldexp_f32 v59, v59, v9
    v_ldexp_f32 v60, v60, v9
    v_ldexp_f32 v61, v61, v9
    v_ldexp_f32 v62, v62, v9
    v_ldexp_f32 v63, v63, v9
    v_mov_b32 v11, v7
    s_nop 1
    v_permlane16_swap_b32 v7, v11
    s_nop 1
    v_sub_f32 v80, 0, v7
    v_sub_f32 v84, 0, v11
    v_mov_b32 v81, v80
    v_mov_b32 v85, v84
    v_mov_b32 v82, v80
    v_mov_b32 v86, v84
    v_mov_b32 v83, v80
    v_mov_b32 v87, v84
    v_add_f32 v192, v192, v80
    v_add_f32 v193, v193, v80
    v_add_f32 v194, v194, v80
    v_add_f32 v195, v195, v80
    v_add_f32 v196, v196, v80
    v_add_f32 v197, v197, v80
    v_add_f32 v198, v198, v80
    v_add_f32 v199, v199, v80
    v_add_f32 v200, v200, v84
    v_add_f32 v201, v201, v84
    v_add_f32 v202, v202, v84
    v_add_f32 v203, v203, v84
    v_add_f32 v204, v204, v84
    v_add_f32 v205, v205, v84
    v_add_f32 v206, v206, v84
    v_add_f32 v207, v207, v84
    v_exp_f32 v192, v192
    v_exp_f32 v193, v193
    v_exp_f32 v194, v194
    v_exp_f32 v195, v195
    v_exp_f32 v196, v196
    v_exp_f32 v197, v197
    v_exp_f32 v198, v198
    v_exp_f32 v199, v199
    v_exp_f32 v200, v200
    v_exp_f32 v201, v201
    v_exp_f32 v202, v202
    v_exp_f32 v203, v203
    v_exp_f32 v204, v204
    v_exp_f32 v205, v205
    v_exp_f32 v206, v206
    v_exp_f32 v207, v207
    s_nop 0
    v_cvt_pk_bf16_f32 v112, v192, v193
    v_cvt_pk_bf16_f32 v113, v194, v195
    v_cvt_pk_bf16_f32 v114, v196, v197
    v_cvt_pk_bf16_f32 v115, v198, v199
    v_cvt_pk_bf16_f32 v116, v200, v201
    v_cvt_pk_bf16_f32 v117, v202, v203
    v_cvt_pk_bf16_f32 v118, v204, v205
    v_cvt_pk_bf16_f32 v119, v206, v207
    s_nop 1
    v_mfma_f32_16x16x32_bf16 v[160:163], v[176:179], v[112:115], v[164:167]
    v_mfma_f32_16x16x32_bf16 v[160:163], v[208:211], v[116:119], v[160:163]
    v_mfma_f32_16x16x32_bf16 v[16:19], v[144:147], v[128:131], v[80:83]
    v_mfma_f32_16x16x32_bf16 v[24:27], v[144:147], v[132:135], v[84:87]
    v_mfma_f32_16x16x32_bf16 v[28:31], v[148:151], v[132:135], v[84:87]
    v_mfma_f32_16x16x32_bf16 v[20:23], v[148:151], v[128:131], v[80:83]
    s_branch attn_out_kernel_back29
attn_out_kernel_rare30:
    ds_read_b128 v[184:187], v2 offset:53248
    ds_read_b128 v[188:191], v2 offset:54272
    s_waitcnt lgkmcnt(0)
    v_mfma_f32_16x16x32_bf16 v[192:195], v[184:187], v[136:139], 0
    v_mfma_f32_16x16x32_bf16 v[200:203], v[184:187], v[140:143], 0
    v_mfma_f32_16x16x32_bf16 v[204:207], v[188:191], v[140:143], 0
    v_mfma_f32_16x16x32_bf16 v[196:199], v[188:191], v[136:139], 0
    v_log_f32 v7, v172
    v_subrev_f32 v8, s32, v181
    v_add_f32 v7, v7, v181
    v_max_f32 v7, v7, v8
    s_nop 7
    s_nop 7
    v_max3_f32 v8, v192, v193, v194
    v_max3_f32 v8, v8, v195, v196
    v_max3_f32 v8, v8, v197, v198
    v_max_f32 v8, v8, v199
    v_max3_f32 v9, v200, v201, v202
    v_max3_f32 v9, v9, v203, v204
    v_max3_f32 v9, v9, v205, v206
    v_max_f32 v9, v9, v207
    s_nop 1
    v_permlane16_swap_b32 v8, v9
    s_nop 1
    v_max_f32 v8, v8, v9
    v_mov_b32 v11, v8
    s_nop 1
    v_permlane32_swap_b32 v11, v8
    s_nop 1
    v_max_f32 v8, v8, v11
    v_max_f32 v7, v7, v8
    v_add_f32 v7, s32, v7
    v_ceil_f32 v7, v7
    v_sub_f32 v8, v181, v7
    v_cvt_i32_f32 v8, v8
    v_mov_b32 v181, v7
    v_ldexp_f32 v172, v172, v8
    v_mov_b32 v9, v8
    s_nop 1
    v_permlane16_swap_b32 v8, v9
    s_nop 1
    v_ldexp_f32 v64, v64, v8
    v_ldexp_f32 v65, v65, v8
    v_ldexp_f32 v66, v66, v8
    v_ldexp_f32 v67, v67, v8
    v_ldexp_f32 v68, v68, v8
    v_ldexp_f32 v69, v69, v8
    v_ldexp_f32 v70, v70, v8
    v_ldexp_f32 v71, v71, v8
    v_ldexp_f32 v72, v72, v9
    v_ldexp_f32 v73, v73, v9
    v_ldexp_f32 v74, v74, v9
    v_ldexp_f32 v75, v75, v9
    v_ldexp_f32 v76, v76, v9
    v_ldexp_f32 v77, v77, v9
    v_ldexp_f32 v78, v78, v9
    v_ldexp_f32 v79, v79, v9
    v_mov_b32 v11, v7
    s_nop 1
    v_permlane16_swap_b32 v7, v11
    s_nop 1
    v_sub_f32 v96, 0, v7
    v_sub_f32 v100, 0, v11
    v_mov_b32 v97, v96
    v_mov_b32 v101, v100
    v_mov_b32 v98, v96
    v_mov_b32 v102, v100
    v_mov_b32 v99, v96
    v_mov_b32 v103, v100
    v_add_f32 v192, v192, v96
    v_add_f32 v193, v193, v96
    v_add_f32 v194, v194, v96
    v_add_f32 v195, v195, v96
    v_add_f32 v196, v196, v96
    v_add_f32 v197, v197, v96
    v_add_f32 v198, v198, v96
    v_add_f32 v199, v199, v96
    v_add_f32 v200, v200, v100
    v_add_f32 v201, v201, v100
    v_add_f32 v202, v202, v100
    v_add_f32 v203, v203, v100
    v_add_f32 v204, v204, v100
    v_add_f32 v205, v205, v100
    v_add_f32 v206, v206, v100
    v_add_f32 v207, v207, v100
    v_exp_f32 v192, v192
    v_exp_f32 v193, v193
    v_exp_f32 v194, v194
    v_exp_f32 v195, v195
    v_exp_f32 v196, v196
    v_exp_f32 v197, v197
    v_exp_f32 v198, v198
    v_exp_f32 v199, v199
    v_exp_f32 v200, v200
    v_exp_f32 v201, v201
    v_exp_f32 v202, v202
    v_exp_f32 v203, v203
    v_exp_f32 v204, v204
    v_exp_f32 v205, v205
    v_exp_f32 v206, v206
    v_exp_f32 v207, v207
    s_nop 0
    v_cvt_pk_bf16_f32 v120, v192, v193
    v_cvt_pk_bf16_f32 v121, v194, v195
    v_cvt_pk_bf16_f32 v122, v196, v197
    v_cvt_pk_bf16_f32 v123, v198, v199
    v_cvt_pk_bf16_f32 v124, v200, v201
    v_cvt_pk_bf16_f32 v125, v202, v203
    v_cvt_pk_bf16_f32 v126, v204, v205
    v_cvt_pk_bf16_f32 v127, v206, v207
    s_nop 1
    v_mfma_f32_16x16x32_bf16 v[168:171], v[176:179], v[120:123], v[172:175]
    v_mfma_f32_16x16x32_bf16 v[168:171], v[208:211], v[124:127], v[168:171]
    v_mfma_f32_16x16x32_bf16 v[32:35], v[144:147], v[136:139], v[96:99]
    v_mfma_f32_16x16x32_bf16 v[40:43], v[144:147], v[140:143], v[100:103]
    v_mfma_f32_16x16x32_bf16 v[44:47], v[148:151], v[140:143], v[100:103]
    v_mfma_f32_16x16x32_bf16 v[36:39], v[148:151], v[136:139], v[96:99]
    s_branch attn_out_kernel_back30
attn_out_kernel_rare31:
    ds_read_b128 v[184:187], v2 offset:55296
    ds_read_b128 v[188:191], v2 offset:56320
    s_waitcnt lgkmcnt(0)
    v_mfma_f32_16x16x32_bf16 v[192:195], v[184:187], v[128:131], 0
    v_mfma_f32_16x16x32_bf16 v[200:203], v[184:187], v[132:135], 0
    v_mfma_f32_16x16x32_bf16 v[204:207], v[188:191], v[132:135], 0
    v_mfma_f32_16x16x32_bf16 v[196:199], v[188:191], v[128:131], 0
    v_log_f32 v7, v160
    v_subrev_f32 v8, s32, v180
    v_add_f32 v7, v7, v180
    v_max_f32 v7, v7, v8
    s_nop 7
    s_nop 7
    v_max3_f32 v8, v192, v193, v194
    v_max3_f32 v8, v8, v195, v196
    v_max3_f32 v8, v8, v197, v198
    v_max_f32 v8, v8, v199
    v_max3_f32 v9, v200, v201, v202
    v_max3_f32 v9, v9, v203, v204
    v_max3_f32 v9, v9, v205, v206
    v_max_f32 v9, v9, v207
    s_nop 1
    v_permlane16_swap_b32 v8, v9
    s_nop 1
    v_max_f32 v8, v8, v9
    v_mov_b32 v11, v8
    s_nop 1
    v_permlane32_swap_b32 v11, v8
    s_nop 1
    v_max_f32 v8, v8, v11
    v_max_f32 v7, v7, v8
    v_add_f32 v7, s32, v7
    v_ceil_f32 v7, v7
    v_sub_f32 v8, v180, v7
    v_cvt_i32_f32 v8, v8
    v_mov_b32 v180, v7
    v_ldexp_f32 v160, v160, v8
    v_mov_b32 v9, v8
    s_nop 1
    v_permlane16_swap_b32 v8, v9
    s_nop 1
    v_ldexp_f32 v48, v48, v8
    v_ldexp_f32 v49, v49, v8
    v_ldexp_f32 v50, v50, v8
    v_ldexp_f32 v51, v51, v8
    v_ldexp_f32 v52, v52, v8
    v_ldexp_f32 v53, v53, v8
    v_ldexp_f32 v54, v54, v8
    v_ldexp_f32 v55, v55, v8
    v_ldexp_f32 v56, v56, v9
    v_ldexp_f32 v57, v57, v9
    v_ldexp_f32 v58, v58, v9
    v_ldexp_f32 v59, v59, v9
    v_ldexp_f32 v60, v60, v9
    v_ldexp_f32 v61, v61, v9
    v_ldexp_f32 v62, v62, v9
    v_ldexp_f32 v63, v63, v9
    v_mov_b32 v11, v7
    s_nop 1
    v_permlane16_swap_b32 v7, v11
    s_nop 1
    v_sub_f32 v80, 0, v7
    v_sub_f32 v84, 0, v11
    v_mov_b32 v81, v80
    v_mov_b32 v85, v84
    v_mov_b32 v82, v80
    v_mov_b32 v86, v84
    v_mov_b32 v83, v80
    v_mov_b32 v87, v84
    v_add_f32 v192, v192, v80
    v_add_f32 v193, v193, v80
    v_add_f32 v194, v194, v80
    v_add_f32 v195, v195, v80
    v_add_f32 v196, v196, v80
    v_add_f32 v197, v197, v80
    v_add_f32 v198, v198, v80
    v_add_f32 v199, v199, v80
    v_add_f32 v200, v200, v84
    v_add_f32 v201, v201, v84
    v_add_f32 v202, v202, v84
    v_add_f32 v203, v203, v84
    v_add_f32 v204, v204, v84
    v_add_f32 v205, v205, v84
    v_add_f32 v206, v206, v84
    v_add_f32 v207, v207, v84
    v_exp_f32 v192, v192
    v_exp_f32 v193, v193
    v_exp_f32 v194, v194
    v_exp_f32 v195, v195
    v_exp_f32 v196, v196
    v_exp_f32 v197, v197
    v_exp_f32 v198, v198
    v_exp_f32 v199, v199
    v_exp_f32 v200, v200
    v_exp_f32 v201, v201
    v_exp_f32 v202, v202
    v_exp_f32 v203, v203
    v_exp_f32 v204, v204
    v_exp_f32 v205, v205
    v_exp_f32 v206, v206
    v_exp_f32 v207, v207
    s_nop 0
    v_cvt_pk_bf16_f32 v112, v192, v193
    v_cvt_pk_bf16_f32 v113, v194, v195
    v_cvt_pk_bf16_f32 v114, v196, v197
    v_cvt_pk_bf16_f32 v115, v198, v199
    v_cvt_pk_bf16_f32 v116, v200, v201
    v_cvt_pk_bf16_f32 v117, v202, v203
    v_cvt_pk_bf16_f32 v118, v204, v205
    v_cvt_pk_bf16_f32 v119, v206, v207
    s_nop 1
    v_mfma_f32_16x16x32_bf16 v[164:167], v[176:179], v[112:115], v[160:163]
    v_mfma_f32_16x16x32_bf16 v[164:167], v[208:211], v[116:119], v[164:167]
    v_mfma_f32_16x16x32_bf16 v[16:19], v[144:147], v[128:131], v[80:83]
    v_mfma_f32_16x16x32_bf16 v[24:27], v[144:147], v[132:135], v[84:87]
    v_mfma_f32_16x16x32_bf16 v[28:31], v[148:151], v[132:135], v[84:87]
    v_mfma_f32_16x16x32_bf16 v[20:23], v[148:151], v[128:131], v[80:83]
    s_branch attn_out_kernel_back31
attn_out_kernel_rare32:
    v_add_u32 v10, 0xc000, v2
    v_and_b32 v10, 0xffff, v10
    v_xor_b32 v11, 512, v10
    ds_read_b128 v[184:187], v10 offset:6144
    ds_read_b128 v[188:191], v10 offset:7168
    s_waitcnt lgkmcnt(0)
    v_mfma_f32_16x16x32_bf16 v[192:195], v[184:187], v[136:139], 0
    v_mfma_f32_16x16x32_bf16 v[200:203], v[184:187], v[140:143], 0
    v_mfma_f32_16x16x32_bf16 v[204:207], v[188:191], v[140:143], 0
    v_mfma_f32_16x16x32_bf16 v[196:199], v[188:191], v[136:139], 0
    v_log_f32 v7, v168
    v_subrev_f32 v8, s32, v181
    v_add_f32 v7, v7, v181
    v_max_f32 v7, v7, v8
    s_nop 7
    s_nop 7
    v_max3_f32 v8, v192, v193, v194
    v_max3_f32 v8, v8, v195, v196
    v_max3_f32 v8, v8, v197, v198
    v_max_f32 v8, v8, v199
    v_max3_f32 v9, v200, v201, v202
    v_max3_f32 v9, v9, v203, v204
    v_max3_f32 v9, v9, v205, v206
    v_max_f32 v9, v9, v207
    s_nop 1
    v_permlane16_swap_b32 v8, v9
    s_nop 1
    v_max_f32 v8, v8, v9
    v_mov_b32 v11, v8
    s_nop 1
    v_permlane32_swap_b32 v11, v8
    s_nop 1
    v_max_f32 v8, v8, v11
    v_max_f32 v7, v7, v8
    v_add_f32 v7, s32, v7
    v_ceil_f32 v7, v7
    v_sub_f32 v8, v181, v7
    v_cvt_i32_f32 v8, v8
    v_mov_b32 v181, v7
    v_ldexp_f32 v168, v168, v8
    v_mov_b32 v9, v8
    s_nop 1
    v_permlane16_swap_b32 v8, v9
    s_nop 1
    v_ldexp_f32 v64, v64, v8
    v_ldexp_f32 v65, v65, v8
    v_ldexp_f32 v66, v66, v8
    v_ldexp_f32 v67, v67, v8
    v_ldexp_f32 v68, v68, v8
    v_ldexp_f32 v69, v69, v8
    v_ldexp_f32 v70, v70, v8
    v_ldexp_f32 v71, v71, v8
    v_ldexp_f32 v72, v72, v9
    v_ldexp_f32 v73, v73, v9
    v_ldexp_f32 v74, v74, v9
    v_ldexp_f32 v75, v75, v9
    v_ldexp_f32 v76, v76, v9
    v_ldexp_f32 v77, v77, v9
    v_ldexp_f32 v78, v78, v9
    v_ldexp_f32 v79, v79, v9
    v_mov_b32 v11, v7
    s_nop 1
    v_permlane16_swap_b32 v7, v11
    s_nop 1
    v_sub_f32 v96, 0, v7
    v_sub_f32 v100, 0, v11
    v_mov_b32 v97, v96
    v_mov_b32 v101, v100
    v_mov_b32 v98, v96
    v_mov_b32 v102, v100
    v_mov_b32 v99, v96
    v_mov_b32 v103, v100
    v_add_f32 v192, v192, v96
    v_add_f32 v193, v193, v96
    v_add_f32 v194, v194, v96
    v_add_f32 v195, v195, v96
    v_add_f32 v196, v196, v96
    v_add_f32 v197, v197, v96
    v_add_f32 v198, v198, v96
    v_add_f32 v199, v199, v96
    v_add_f32 v200, v200, v100
    v_add_f32 v201, v201, v100
    v_add_f32 v202, v202, v100
    v_add_f32 v203, v203, v100
    v_add_f32 v204, v204, v100
    v_add_f32 v205, v205, v100
    v_add_f32 v206, v206, v100
    v_add_f32 v207, v207, v100
    v_exp_f32 v192, v192
    v_exp_f32 v193, v193
    v_exp_f32 v194, v194
    v_exp_f32 v195, v195
    v_exp_f32 v196, v196
    v_exp_f32 v197, v197
    v_exp_f32 v198, v198
    v_exp_f32 v199, v199
    v_exp_f32 v200, v200
    v_exp_f32 v201, v201
    v_exp_f32 v202, v202
    v_exp_f32 v203, v203
    v_exp_f32 v204, v204
    v_exp_f32 v205, v205
    v_exp_f32 v206, v206
    v_exp_f32 v207, v207
    s_nop 0
    v_cvt_pk_bf16_f32 v120, v192, v193
    v_cvt_pk_bf16_f32 v121, v194, v195
    v_cvt_pk_bf16_f32 v122, v196, v197
    v_cvt_pk_bf16_f32 v123, v198, v199
    v_cvt_pk_bf16_f32 v124, v200, v201
    v_cvt_pk_bf16_f32 v125, v202, v203
    v_cvt_pk_bf16_f32 v126, v204, v205
    v_cvt_pk_bf16_f32 v127, v206, v207
    s_nop 1
    v_mfma_f32_16x16x32_bf16 v[172:175], v[176:179], v[120:123], v[168:171]
    v_mfma_f32_16x16x32_bf16 v[172:175], v[208:211], v[124:127], v[172:175]
    s_branch attn_out_kernel_back32
attn_out_kernel_down:
    s_setprio 2
    s_lshl_b32 s27, s25, 17
    s_add_u32 s6, s4, 8388608
    s_addc_u32 s7, s5, 0
    s_add_u32 s6, s6, s27
    s_addc_u32 s7, s7, 0
    s_mov_b32 s12, s6
    s_and_b32 s13, s7, 0xffff
    s_mov_b32 s14, 131072
    s_mov_b32 s15, 0x20000
    s_add_u32 s6, s4, 12582912
    s_addc_u32 s7, s5, 0
    s_add_u32 s6, s6, s27
    s_addc_u32 s7, s7, 0
    s_mov_b32 s16, s6
    s_and_b32 s17, s7, 0xffff
    s_mov_b32 s18, 131072
    s_mov_b32 s19, 0x20000
    s_lshl_b32 s27, s24, 11
    v_lshlrev_b32 v3, 4, v0
    v_add_u32 v3, s27, v3
    v_mov_b32 v2, v3
    s_mov_b32 s31, s27
    v_bfe_u32 v4, v0, 4, 1
    v_lshlrev_b32 v4, 7, v4
    v_xor_b32 v3, v4, v3
    s_add_u32 m0, s31, 0
    s_nop 0
    buffer_load_dwordx4 v2, s[12:15], 0 offen lds
    buffer_load_dwordx4 v2, s[12:15], 0 offen offset:1024 lds
    s_add_u32 m0, s31, 8192
    s_nop 0
    buffer_load_dwordx4 v3, s[16:19], 0 offen lds
    buffer_load_dwordx4 v3, s[16:19], 0 offen offset:1024 lds
    v_add_u32 v2, 8192, v2
    v_add_u32 v3, 8192, v3
    s_and_b32 s27, s2, 7
    s_lshr_b32 s28, s2, 3
    s_lshr_b32 s48, s27, 1
    s_lshl_b32 s48, s48, 2
    s_and_b32 s3, s28, 3
    s_add_u32 s48, s48, s3
    s_and_b32 s49, s27, 1
    s_lshr_b32 s3, s28, 2
    s_lshl_b32 s3, s3, 1
    s_add_u32 s49, s49, s3
    s_lshl_b32 s50, s49, 7
    s_lshl_b32 s51, s48, 3
    s_lshl_b32 s3, s24, 1
    s_add_u32 s51, s51, s3
    s_add_u32 s6, s4, 16777216
    s_addc_u32 s7, s5, 0
    s_mov_b32 s36, s6
    s_and_b32 s37, s7, 0xffff
    s_mov_b32 s38, 14680064
    s_mov_b32 s39, 0x20000
    s_mov_b32 s40, s68
    s_and_b32 s41, s69, 0xffff
    s_mov_b32 s42, 7340032
    s_mov_b32 s43, 0x20000
    v_lshrrev_b32 v10, 4, v0
    v_bfe_u32 v11, v0, 2, 2
    v_lshl_add_u32 v4, v10, 2, v11
    v_lshlrev_b32 v4, 7, v4
    v_lshrrev_b32 v11, 1, v11
    v_and_b32 v10, 1, v10
    v_lshl_or_b32 v11, v10, 1, v11
    v_and_b32 v10, 1, v0
    v_lshl_add_u32 v4, v10, 4, v4
    v_bfe_u32 v10, v0, 1, 1
    v_lshl_add_u32 v4, v10, 3, v4
    v_add_u32 v4, 65536, v4
    v_xor_b32 v10, 3, v11
    v_lshl_add_u32 v8, v10, 5, v4
    v_xor_b32 v10, 2, v11
    v_lshl_add_u32 v7, v10, 5, v4
    v_xor_b32 v10, 1, v11
    v_lshl_add_u32 v5, v10, 5, v4
    v_xor_b32 v10, 0, v11
    v_lshl_add_u32 v4, v10, 5, v4
    v_lshrrev_b32 v10, 3, v0
    s_mul_i32 s27, s24, 56
    v_add_u32 v10, s27, v10
    s_mov_b32 s27, 2048
    v_mul_lo_u32 v6, v10, s27
    v_bfe_u32 v10, v0, 4, 2
    v_lshlrev_b32 v10, 1, v10
    v_and_b32 v11, 7, v0
    v_xor_b32 v10, v10, v11
    v_lshl_add_u32 v6, v10, 4, v6
    v_add_u32 v6, s50, v6
    s_mov_b32 s56, 0
    s_mov_b32 s57, 15360
    s_mov_b32 s58, 30720
    s_mov_b32 s59, 46080
    s_mov_b32 s60, 65536
    s_mov_b32 s61, 80896
    s_mov_b32 s62, 96256
    s_mul_i32 s66, s24, 7168
    s_add_u32 s66, s66, 65536
    s_mul_i32 s27, s51, 114688
    v_lshlrev_b32 v9, 4, v0
    v_add_u32 v9, s27, v9
    s_mov_b32 s64, 4096
    s_mov_b32 s8, 114688
    s_mov_b32 s9, 118784
    s_add_u32 m0, s66, 0
    s_nop 0
    buffer_load_dwordx4 v6, s[40:43], s56 offen offset:0 lds
    buffer_load_dwordx4 v6, s[40:43], s57 offen offset:1024 lds
    buffer_load_dwordx4 v6, s[40:43], s58 offen offset:2048 lds
    buffer_load_dwordx4 v6, s[40:43], s59 offen offset:3072 lds
    s_add_u32 m0, s66, 4096
    s_nop 0
    buffer_load_dwordx4 v6, s[40:43], s60 offen offset:0 lds
    buffer_load_dwordx4 v6, s[40:43], s61 offen offset:1024 lds
    buffer_load_dwordx4 v6, s[40:43], s62 offen offset:2048 lds
    v_add_u32 v6, 458752, v6
    s_waitcnt vmcnt(7)
    s_barrier
    buffer_load_dwordx4 v[48:51], v9, s[36:39], 0 offen offset:0
    buffer_load_dwordx4 v[52:55], v9, s[36:39], s8 offen offset:0
    buffer_load_dwordx4 v[56:59], v9, s[36:39], 0 offen offset:1024
    buffer_load_dwordx4 v[60:63], v9, s[36:39], s8 offen offset:1024
    buffer_load_dwordx4 v[64:67], v9, s[36:39], 0 offen offset:2048
    buffer_load_dwordx4 v[68:71], v9, s[36:39], s8 offen offset:2048
    buffer_load_dwordx4 v[72:75], v9, s[36:39], 0 offen offset:3072
    buffer_load_dwordx4 v[76:79], v9, s[36:39], s8 offen offset:3072
    buffer_load_dwordx4 v[80:83], v9, s[36:39], s64 offen offset:0
    buffer_load_dwordx4 v[84:87], v9, s[36:39], s9 offen offset:0
    buffer_load_dwordx4 v[88:91], v9, s[36:39], s64 offen offset:1024
    buffer_load_dwordx4 v[92:95], v9, s[36:39], s9 offen offset:1024
    buffer_load_dwordx4 v[96:99], v9, s[36:39], s64 offen offset:2048
    buffer_load_dwordx4 v[100:103], v9, s[36:39], s9 offen offset:2048
    v_add_u32 v9, 7168, v9
    s_waitcnt vmcnt(14)
    s_barrier
    ds_read_b64_tr_b16 v[160:161], v4 offset:0
    ds_read_b64_tr_b16 v[162:163], v4 offset:2048
    ds_read_b64_tr_b16 v[164:165], v4 offset:4096
    ds_read_b64_tr_b16 v[166:167], v4 offset:6144
    ds_read_b64_tr_b16 v[168:169], v5 offset:0
    ds_read_b64_tr_b16 v[170:171], v5 offset:2048
    ds_read_b64_tr_b16 v[172:173], v5 offset:4096
    ds_read_b64_tr_b16 v[174:175], v5 offset:6144
    ds_read_b64_tr_b16 v[176:177], v7 offset:0
    ds_read_b64_tr_b16 v[178:179], v7 offset:2048
    ds_read_b64_tr_b16 v[180:181], v7 offset:4096
    ds_read_b64_tr_b16 v[182:183], v7 offset:6144
    ds_read_b64_tr_b16 v[184:185], v8 offset:0
    ds_read_b64_tr_b16 v[186:187], v8 offset:2048
    s_waitcnt vmcnt(13)
    s_waitcnt lgkmcnt(12)
    v_mfma_f32_16x16x32_bf16 v[16:19], v[160:163], v[48:51], 0
    ds_read_b64_tr_b16 v[188:189], v8 offset:4096
    ds_read_b64_tr_b16 v[190:191], v8 offset:6144
    s_add_u32 m0, s31, 16384
    s_nop 0
    buffer_load_dwordx4 v2, s[12:15], 0 offen lds
    s_waitcnt vmcnt(12)
    s_waitcnt lgkmcnt(12)
    v_mfma_f32_16x16x32_bf16 v[16:19], v[164:167], v[56:59], v[16:19]
    buffer_load_dwordx4 v2, s[12:15], 0 offen offset:1024 lds
    s_waitcnt vmcnt(12)
    v_mfma_f32_16x16x32_bf16 v[20:23], v[164:167], v[60:63], 0
    v_mfma_f32_16x16x32_bf16 v[20:23], v[160:163], v[52:55], v[20:23]
    ds_read_b64_tr_b16 v[160:161], v4 offset:8192
    ds_read_b64_tr_b16 v[162:163], v4 offset:10240
    ds_read_b64_tr_b16 v[164:165], v4 offset:12288
    ds_read_b64_tr_b16 v[166:167], v4 offset:14336
    s_add_u32 m0, s31, 24576
    s_nop 0
    buffer_load_dwordx4 v3, s[16:19], 0 offen lds
    s_waitcnt lgkmcnt(14)
    v_mfma_f32_16x16x32_bf16 v[24:27], v[168:171], v[48:51], 0
    s_waitcnt lgkmcnt(12)
    v_mfma_f32_16x16x32_bf16 v[24:27], v[172:175], v[56:59], v[24:27]
    buffer_load_dwordx4 v3, s[16:19], 0 offen offset:1024 lds
    v_add_u32 v2, 8192, v2
    v_add_u32 v3, 8192, v3
    v_mfma_f32_16x16x32_bf16 v[28:31], v[172:175], v[60:63], 0
    v_mfma_f32_16x16x32_bf16 v[28:31], v[168:171], v[52:55], v[28:31]
    ds_read_b64_tr_b16 v[168:169], v5 offset:8192
    ds_read_b64_tr_b16 v[170:171], v5 offset:10240
    ds_read_b64_tr_b16 v[172:173], v5 offset:12288
    ds_read_b64_tr_b16 v[174:175], v5 offset:14336
    s_add_u32 m0, s66, 28672
    s_nop 0
    buffer_load_dwordx4 v6, s[40:43], s56 offen offset:0 lds
    s_waitcnt lgkmcnt(14)
    v_mfma_f32_16x16x32_bf16 v[32:35], v[176:179], v[48:51], 0
    buffer_load_dwordx4 v6, s[40:43], s57 offen offset:1024 lds
    s_waitcnt lgkmcnt(12)
    v_mfma_f32_16x16x32_bf16 v[32:35], v[180:183], v[56:59], v[32:35]
    v_mfma_f32_16x16x32_bf16 v[36:39], v[180:183], v[60:63], 0
    buffer_load_dwordx4 v6, s[40:43], s58 offen offset:2048 lds
    v_mfma_f32_16x16x32_bf16 v[36:39], v[176:179], v[52:55], v[36:39]
    ds_read_b64_tr_b16 v[176:177], v7 offset:8192
    ds_read_b64_tr_b16 v[178:179], v7 offset:10240
    ds_read_b64_tr_b16 v[180:181], v7 offset:12288
    ds_read_b64_tr_b16 v[182:183], v7 offset:14336
    s_waitcnt lgkmcnt(14)
    v_mfma_f32_16x16x32_bf16 v[40:43], v[184:187], v[48:51], 0
    buffer_load_dwordx4 v6, s[40:43], s59 offen offset:3072 lds
    s_waitcnt lgkmcnt(12)
    v_mfma_f32_16x16x32_bf16 v[40:43], v[188:191], v[56:59], v[40:43]
    v_mfma_f32_16x16x32_bf16 v[44:47], v[188:191], v[60:63], 0
    s_add_u32 m0, s66, 32768
    s_nop 0
    buffer_load_dwordx4 v6, s[40:43], s60 offen offset:0 lds
    v_mfma_f32_16x16x32_bf16 v[44:47], v[184:187], v[52:55], v[44:47]
    ds_read_b64_tr_b16 v[184:185], v8 offset:8192
    ds_read_b64_tr_b16 v[186:187], v8 offset:10240
    ds_read_b64_tr_b16 v[188:189], v8 offset:12288
    ds_read_b64_tr_b16 v[190:191], v8 offset:14336
    buffer_load_dwordx4 v6, s[40:43], s61 offen offset:1024 lds
    s_waitcnt vmcnt(19)
    s_waitcnt lgkmcnt(14)
    v_mfma_f32_16x16x32_bf16 v[16:19], v[160:163], v[64:67], v[16:19]
    s_waitcnt vmcnt(17)
    s_waitcnt lgkmcnt(12)
    v_mfma_f32_16x16x32_bf16 v[16:19], v[164:167], v[72:75], v[16:19]
    buffer_load_dwordx4 v6, s[40:43], s62 offen offset:2048 lds
    v_add_u32 v6, 458752, v6
    s_waitcnt vmcnt(17)
    v_mfma_f32_16x16x32_bf16 v[20:23], v[164:167], v[76:79], v[20:23]
    v_mfma_f32_16x16x32_bf16 v[20:23], v[160:163], v[68:71], v[20:23]
    ds_read_b64_tr_b16 v[160:161], v4 offset:16384
    ds_read_b64_tr_b16 v[162:163], v4 offset:18432
    ds_read_b64_tr_b16 v[164:165], v4 offset:20480
    ds_read_b64_tr_b16 v[166:167], v4 offset:22528
    buffer_load_dwordx4 v[104:107], v9, s[36:39], 0 offen offset:0
    s_waitcnt lgkmcnt(14)
    v_mfma_f32_16x16x32_bf16 v[24:27], v[168:171], v[64:67], v[24:27]
    s_waitcnt lgkmcnt(12)
    v_mfma_f32_16x16x32_bf16 v[24:27], v[172:175], v[72:75], v[24:27]
    buffer_load_dwordx4 v[108:111], v9, s[36:39], s8 offen offset:0
    v_mfma_f32_16x16x32_bf16 v[28:31], v[172:175], v[76:79], v[28:31]
    buffer_load_dwordx4 v[112:115], v9, s[36:39], 0 offen offset:1024
    v_mfma_f32_16x16x32_bf16 v[28:31], v[168:171], v[68:71], v[28:31]
    ds_read_b64_tr_b16 v[168:169], v4 offset:24576
    ds_read_b64_tr_b16 v[170:171], v4 offset:26624
    ds_read_b64_tr_b16 v[172:173], v5 offset:16384
    ds_read_b64_tr_b16 v[174:175], v5 offset:18432
    s_waitcnt lgkmcnt(14)
    v_mfma_f32_16x16x32_bf16 v[32:35], v[176:179], v[64:67], v[32:35]
    buffer_load_dwordx4 v[116:119], v9, s[36:39], s8 offen offset:1024
    s_waitcnt lgkmcnt(12)
    v_mfma_f32_16x16x32_bf16 v[32:35], v[180:183], v[72:75], v[32:35]
    v_mfma_f32_16x16x32_bf16 v[36:39], v[180:183], v[76:79], v[36:39]
    buffer_load_dwordx4 v[120:123], v9, s[36:39], 0 offen offset:2048
    v_mfma_f32_16x16x32_bf16 v[36:39], v[176:179], v[68:71], v[36:39]
    ds_read_b64_tr_b16 v[176:177], v5 offset:20480
    ds_read_b64_tr_b16 v[178:179], v5 offset:22528
    ds_read_b64_tr_b16 v[180:181], v5 offset:24576
    ds_read_b64_tr_b16 v[182:183], v5 offset:26624
    s_waitcnt lgkmcnt(14)
    v_mfma_f32_16x16x32_bf16 v[40:43], v[184:187], v[64:67], v[40:43]
    buffer_load_dwordx4 v[124:127], v9, s[36:39], s8 offen offset:2048
    s_waitcnt lgkmcnt(12)
    v_mfma_f32_16x16x32_bf16 v[40:43], v[188:191], v[72:75], v[40:43]
    buffer_load_dwordx4 v[128:131], v9, s[36:39], 0 offen offset:3072
    v_mfma_f32_16x16x32_bf16 v[44:47], v[188:191], v[76:79], v[44:47]
    v_mfma_f32_16x16x32_bf16 v[44:47], v[184:187], v[68:71], v[44:47]
    ds_read_b64_tr_b16 v[184:185], v7 offset:16384
    ds_read_b64_tr_b16 v[186:187], v7 offset:18432
    ds_read_b64_tr_b16 v[188:189], v7 offset:20480
    ds_read_b64_tr_b16 v[190:191], v7 offset:22528
    buffer_load_dwordx4 v[132:135], v9, s[36:39], s8 offen offset:3072
    s_waitcnt vmcnt(24)
    s_waitcnt lgkmcnt(14)
    v_mfma_f32_16x16x32_bf16 v[16:19], v[160:163], v[80:83], v[16:19]
    s_waitcnt vmcnt(22)
    s_waitcnt lgkmcnt(12)
    v_mfma_f32_16x16x32_bf16 v[16:19], v[164:167], v[88:91], v[16:19]
    buffer_load_dwordx4 v[136:139], v9, s[36:39], s64 offen offset:0
    s_waitcnt vmcnt(21)
    s_waitcnt lgkmcnt(10)
    v_mfma_f32_16x16x32_bf16 v[16:19], v[168:171], v[96:99], v[16:19]
    s_waitcnt vmcnt(20)
    v_mfma_f32_16x16x32_bf16 v[20:23], v[168:171], v[100:103], v[20:23]
    buffer_load_dwordx4 v[140:143], v9, s[36:39], s9 offen offset:0
    v_mfma_f32_16x16x32_bf16 v[20:23], v[164:167], v[92:95], v[20:23]
    buffer_load_dwordx4 v[144:147], v9, s[36:39], s64 offen offset:1024
    v_mfma_f32_16x16x32_bf16 v[20:23], v[160:163], v[84:87], v[20:23]
    ds_read_b64_tr_b16 v[160:161], v7 offset:24576
    ds_read_b64_tr_b16 v[162:163], v7 offset:26624
    ds_read_b64_tr_b16 v[164:165], v8 offset:16384
    ds_read_b64_tr_b16 v[166:167], v8 offset:18432
    s_waitcnt lgkmcnt(12)
    v_mfma_f32_16x16x32_bf16 v[24:27], v[172:175], v[80:83], v[24:27]
    ds_read_b64_tr_b16 v[168:169], v8 offset:20480
    ds_read_b64_tr_b16 v[170:171], v8 offset:22528
    buffer_load_dwordx4 v[148:151], v9, s[36:39], s9 offen offset:1024
    s_waitcnt lgkmcnt(12)
    v_mfma_f32_16x16x32_bf16 v[24:27], v[176:179], v[88:91], v[24:27]
    s_waitcnt lgkmcnt(10)
    v_mfma_f32_16x16x32_bf16 v[24:27], v[180:183], v[96:99], v[24:27]
    buffer_load_dwordx4 v[152:155], v9, s[36:39], s64 offen offset:2048
    v_mfma_f32_16x16x32_bf16 v[28:31], v[180:183], v[100:103], v[28:31]
    v_mfma_f32_16x16x32_bf16 v[28:31], v[176:179], v[92:95], v[28:31]
    buffer_load_dwordx4 v[156:159], v9, s[36:39], s9 offen offset:2048
    v_add_u32 v9, 7168, v9
    v_mfma_f32_16x16x32_bf16 v[28:31], v[172:175], v[84:87], v[28:31]
    ds_read_b64_tr_b16 v[172:173], v8 offset:24576
    ds_read_b64_tr_b16 v[174:175], v8 offset:26624
    s_add_u32 m0, s66, 57344
    s_nop 0
    buffer_load_dwordx4 v6, s[40:43], s56 offen offset:0 lds
    s_waitcnt lgkmcnt(10)
    v_mfma_f32_16x16x32_bf16 v[32:35], v[184:187], v[80:83], v[32:35]
    s_waitcnt lgkmcnt(8)
    v_mfma_f32_16x16x32_bf16 v[32:35], v[188:191], v[88:91], v[32:35]
    buffer_load_dwordx4 v6, s[40:43], s57 offen offset:1024 lds
    s_waitcnt lgkmcnt(6)
    v_mfma_f32_16x16x32_bf16 v[32:35], v[160:163], v[96:99], v[32:35]
    v_mfma_f32_16x16x32_bf16 v[36:39], v[160:163], v[100:103], v[36:39]
    buffer_load_dwordx4 v6, s[40:43], s58 offen offset:2048 lds
    v_mfma_f32_16x16x32_bf16 v[36:39], v[188:191], v[92:95], v[36:39]
    s_waitcnt vmcnt(17) lgkmcnt(0)
    s_barrier
    v_add_u32 v4, 28672, v4
    v_add_u32 v5, 28672, v5
    v_add_u32 v7, 28672, v7
    v_add_u32 v8, 28672, v8
    v_mfma_f32_16x16x32_bf16 v[36:39], v[184:187], v[84:87], v[36:39]
    ds_read_b64_tr_b16 v[176:177], v4 offset:0
    ds_read_b64_tr_b16 v[178:179], v4 offset:2048
    ds_read_b64_tr_b16 v[180:181], v4 offset:4096
    ds_read_b64_tr_b16 v[182:183], v4 offset:6144
    buffer_load_dwordx4 v6, s[40:43], s59 offen offset:3072 lds
    v_mfma_f32_16x16x32_bf16 v[40:43], v[164:167], v[80:83], v[40:43]
    ds_read_b64_tr_b16 v[184:185], v5 offset:0
    ds_read_b64_tr_b16 v[186:187], v5 offset:2048
    ds_read_b64_tr_b16 v[188:189], v5 offset:4096
    ds_read_b64_tr_b16 v[190:191], v5 offset:6144
    s_add_u32 m0, s66, 61440
    s_nop 0
    buffer_load_dwordx4 v6, s[40:43], s60 offen offset:0 lds
    v_mfma_f32_16x16x32_bf16 v[40:43], v[168:171], v[88:91], v[40:43]
    ds_read_b64_tr_b16 v[160:161], v7 offset:0
    ds_read_b64_tr_b16 v[162:163], v7 offset:2048
    v_mfma_f32_16x16x32_bf16 v[40:43], v[172:175], v[96:99], v[40:43]
    buffer_load_dwordx4 v6, s[40:43], s61 offen offset:1024 lds
    v_mfma_f32_16x16x32_bf16 v[44:47], v[172:175], v[100:103], v[44:47]
    v_mfma_f32_16x16x32_bf16 v[44:47], v[168:171], v[92:95], v[44:47]
    buffer_load_dwordx4 v6, s[40:43], s62 offen offset:2048 lds
    v_add_u32 v6, 458752, v6
    v_mfma_f32_16x16x32_bf16 v[44:47], v[164:167], v[84:87], v[44:47]
    ds_read_b64_tr_b16 v[164:165], v7 offset:4096
    ds_read_b64_tr_b16 v[166:167], v7 offset:6144
    ds_read_b64_tr_b16 v[168:169], v8 offset:0
    ds_read_b64_tr_b16 v[170:171], v8 offset:2048
    s_waitcnt vmcnt(20)
    s_waitcnt lgkmcnt(12)
    v_mfma_f32_16x16x32_bf16 v[16:19], v[176:179], v[104:107], v[16:19]
    ds_read_b64_tr_b16 v[172:173], v8 offset:4096
    ds_read_b64_tr_b16 v[174:175], v8 offset:6144
    s_add_u32 m0, s31, 32768
    s_nop 0
    buffer_load_dwordx4 v2, s[12:15], 0 offen lds
    s_waitcnt vmcnt(19)
    s_waitcnt lgkmcnt(12)
    v_mfma_f32_16x16x32_bf16 v[16:19], v[180:183], v[112:115], v[16:19]
    buffer_load_dwordx4 v2, s[12:15], 0 offen offset:1024 lds
    s_waitcnt vmcnt(19)
    v_mfma_f32_16x16x32_bf16 v[20:23], v[180:183], v[116:119], v[20:23]
    v_mfma_f32_16x16x32_bf16 v[20:23], v[176:179], v[108:111], v[20:23]
    ds_read_b64_tr_b16 v[176:177], v4 offset:8192
    ds_read_b64_tr_b16 v[178:179], v4 offset:10240
    ds_read_b64_tr_b16 v[180:181], v4 offset:12288
    ds_read_b64_tr_b16 v[182:183], v4 offset:14336
    s_add_u32 m0, s31, 40960
    s_nop 0
    buffer_load_dwordx4 v3, s[16:19], 0 offen lds
    s_waitcnt lgkmcnt(14)
    v_mfma_f32_16x16x32_bf16 v[24:27], v[184:187], v[104:107], v[24:27]
    s_waitcnt lgkmcnt(12)
    v_mfma_f32_16x16x32_bf16 v[24:27], v[188:191], v[112:115], v[24:27]
    buffer_load_dwordx4 v3, s[16:19], 0 offen offset:1024 lds
    v_add_u32 v2, 8192, v2
    v_add_u32 v3, 8192, v3
    v_mfma_f32_16x16x32_bf16 v[28:31], v[188:191], v[116:119], v[28:31]
    v_mfma_f32_16x16x32_bf16 v[28:31], v[184:187], v[108:111], v[28:31]
    ds_read_b64_tr_b16 v[184:185], v5 offset:8192
    ds_read_b64_tr_b16 v[186:187], v5 offset:10240
    ds_read_b64_tr_b16 v[188:189], v5 offset:12288
    ds_read_b64_tr_b16 v[190:191], v5 offset:14336
    buffer_load_dwordx4 v[48:51], v9, s[36:39], 0 offen offset:0
    s_waitcnt lgkmcnt(14)
    v_mfma_f32_16x16x32_bf16 v[32:35], v[160:163], v[104:107], v[32:35]
    s_waitcnt lgkmcnt(12)
    v_mfma_f32_16x16x32_bf16 v[32:35], v[164:167], v[112:115], v[32:35]
    buffer_load_dwordx4 v[52:55], v9, s[36:39], s8 offen offset:0
    v_mfma_f32_16x16x32_bf16 v[36:39], v[164:167], v[116:119], v[36:39]
    v_mfma_f32_16x16x32_bf16 v[36:39], v[160:163], v[108:111], v[36:39]
    ds_read_b64_tr_b16 v[160:161], v7 offset:8192
    ds_read_b64_tr_b16 v[162:163], v7 offset:10240
    ds_read_b64_tr_b16 v[164:165], v7 offset:12288
    ds_read_b64_tr_b16 v[166:167], v7 offset:14336
    buffer_load_dwordx4 v[56:59], v9, s[36:39], 0 offen offset:1024
    s_waitcnt lgkmcnt(14)
    v_mfma_f32_16x16x32_bf16 v[40:43], v[168:171], v[104:107], v[40:43]
    s_waitcnt lgkmcnt(12)
    v_mfma_f32_16x16x32_bf16 v[40:43], v[172:175], v[112:115], v[40:43]
    buffer_load_dwordx4 v[60:63], v9, s[36:39], s8 offen offset:1024
    v_mfma_f32_16x16x32_bf16 v[44:47], v[172:175], v[116:119], v[44:47]
    v_mfma_f32_16x16x32_bf16 v[44:47], v[168:171], v[108:111], v[44:47]
    ds_read_b64_tr_b16 v[168:169], v8 offset:8192
    ds_read_b64_tr_b16 v[170:171], v8 offset:10240
    ds_read_b64_tr_b16 v[172:173], v8 offset:12288
    ds_read_b64_tr_b16 v[174:175], v8 offset:14336
    buffer_load_dwordx4 v[64:67], v9, s[36:39], 0 offen offset:2048
    s_waitcnt vmcnt(25)
    s_waitcnt lgkmcnt(14)
    v_mfma_f32_16x16x32_bf16 v[16:19], v[176:179], v[120:123], v[16:19]
    s_waitcnt vmcnt(23)
    s_waitcnt lgkmcnt(12)
    v_mfma_f32_16x16x32_bf16 v[16:19], v[180:183], v[128:131], v[16:19]
    buffer_load_dwordx4 v[68:71], v9, s[36:39], s8 offen offset:2048
    s_waitcnt vmcnt(23)
    v_mfma_f32_16x16x32_bf16 v[20:23], v[180:183], v[132:135], v[20:23]
    v_mfma_f32_16x16x32_bf16 v[20:23], v[176:179], v[124:127], v[20:23]
    ds_read_b64_tr_b16 v[176:177], v4 offset:16384
    ds_read_b64_tr_b16 v[178:179], v4 offset:18432
    ds_read_b64_tr_b16 v[180:181], v4 offset:20480
    ds_read_b64_tr_b16 v[182:183], v4 offset:22528
    buffer_load_dwordx4 v[72:75], v9, s[36:39], 0 offen offset:3072
    s_waitcnt lgkmcnt(14)
    v_mfma_f32_16x16x32_bf16 v[24:27], v[184:187], v[120:123], v[24:27]
    s_waitcnt lgkmcnt(12)
    v_mfma_f32_16x16x32_bf16 v[24:27], v[188:191], v[128:131], v[24:27]
    buffer_load_dwordx4 v[76:79], v9, s[36:39], s8 offen offset:3072
    v_mfma_f32_16x16x32_bf16 v[28:31], v[188:191], v[132:135], v[28:31]
    v_mfma_f32_16x16x32_bf16 v[28:31], v[184:187], v[124:127], v[28:31]
    ds_read_b64_tr_b16 v[184:185], v4 offset:24576
    ds_read_b64_tr_b16 v[186:187], v4 offset:26624
    ds_read_b64_tr_b16 v[188:189], v5 offset:16384
    ds_read_b64_tr_b16 v[190:191], v5 offset:18432
    buffer_load_dwordx4 v[80:83], v9, s[36:39], s64 offen offset:0
    s_waitcnt lgkmcnt(14)
    v_mfma_f32_16x16x32_bf16 v[32:35], v[160:163], v[120:123], v[32:35]
    s_waitcnt lgkmcnt(12)
    v_mfma_f32_16x16x32_bf16 v[32:35], v[164:167], v[128:131], v[32:35]
    buffer_load_dwordx4 v[84:87], v9, s[36:39], s9 offen offset:0
    v_mfma_f32_16x16x32_bf16 v[36:39], v[164:167], v[132:135], v[36:39]
    v_mfma_f32_16x16x32_bf16 v[36:39], v[160:163], v[124:127], v[36:39]
    ds_read_b64_tr_b16 v[160:161], v5 offset:20480
    ds_read_b64_tr_b16 v[162:163], v5 offset:22528
    ds_read_b64_tr_b16 v[164:165], v5 offset:24576
    ds_read_b64_tr_b16 v[166:167], v5 offset:26624
    buffer_load_dwordx4 v[88:91], v9, s[36:39], s64 offen offset:1024
    s_waitcnt lgkmcnt(14)
    v_mfma_f32_16x16x32_bf16 v[40:43], v[168:171], v[120:123], v[40:43]
    buffer_load_dwordx4 v[92:95], v9, s[36:39], s9 offen offset:1024
    s_waitcnt lgkmcnt(12)
    v_mfma_f32_16x16x32_bf16 v[40:43], v[172:175], v[128:131], v[40:43]
    v_mfma_f32_16x16x32_bf16 v[44:47], v[172:175], v[132:135], v[44:47]
    buffer_load_dwordx4 v[96:99], v9, s[36:39], s64 offen offset:2048
    v_mfma_f32_16x16x32_bf16 v[44:47], v[168:171], v[124:127], v[44:47]
    ds_read_b64_tr_b16 v[168:169], v7 offset:16384
    ds_read_b64_tr_b16 v[170:171], v7 offset:18432
    ds_read_b64_tr_b16 v[172:173], v7 offset:20480
    ds_read_b64_tr_b16 v[174:175], v7 offset:22528
    s_waitcnt vmcnt(29)
    s_waitcnt lgkmcnt(14)
    v_mfma_f32_16x16x32_bf16 v[16:19], v[176:179], v[136:139], v[16:19]
    buffer_load_dwordx4 v[100:103], v9, s[36:39], s9 offen offset:2048
    v_add_u32 v9, 7168, v9
    s_waitcnt vmcnt(28)
    s_waitcnt lgkmcnt(12)
    v_mfma_f32_16x16x32_bf16 v[16:19], v[180:183], v[144:147], v[16:19]
    s_waitcnt vmcnt(26)
    s_waitcnt lgkmcnt(10)
    v_mfma_f32_16x16x32_bf16 v[16:19], v[184:187], v[152:155], v[16:19]
    s_add_u32 m0, s66, 0
    s_nop 0
    buffer_load_dwordx4 v6, s[40:43], s56 offen offset:0 lds
    s_waitcnt vmcnt(26)
    v_mfma_f32_16x16x32_bf16 v[20:23], v[184:187], v[156:159], v[20:23]
    v_mfma_f32_16x16x32_bf16 v[20:23], v[180:183], v[148:151], v[20:23]
    buffer_load_dwordx4 v6, s[40:43], s57 offen offset:1024 lds
    v_mfma_f32_16x16x32_bf16 v[20:23], v[176:179], v[140:143], v[20:23]
    ds_read_b64_tr_b16 v[176:177], v7 offset:24576
    ds_read_b64_tr_b16 v[178:179], v7 offset:26624
    ds_read_b64_tr_b16 v[180:181], v8 offset:16384
    ds_read_b64_tr_b16 v[182:183], v8 offset:18432
    s_waitcnt lgkmcnt(12)
    v_mfma_f32_16x16x32_bf16 v[24:27], v[188:191], v[136:139], v[24:27]
    ds_read_b64_tr_b16 v[184:185], v8 offset:20480
    ds_read_b64_tr_b16 v[186:187], v8 offset:22528
    buffer_load_dwordx4 v6, s[40:43], s58 offen offset:2048 lds
    s_waitcnt lgkmcnt(12)
    v_mfma_f32_16x16x32_bf16 v[24:27], v[160:163], v[144:147], v[24:27]
    s_waitcnt lgkmcnt(10)
    v_mfma_f32_16x16x32_bf16 v[24:27], v[164:167], v[152:155], v[24:27]
    buffer_load_dwordx4 v6, s[40:43], s59 offen offset:3072 lds
    v_mfma_f32_16x16x32_bf16 v[28:31], v[164:167], v[156:159], v[28:31]
    v_mfma_f32_16x16x32_bf16 v[28:31], v[160:163], v[148:151], v[28:31]
    s_add_u32 m0, s66, 4096
    s_nop 0
    buffer_load_dwordx4 v6, s[40:43], s60 offen offset:0 lds
    v_mfma_f32_16x16x32_bf16 v[28:31], v[188:191], v[140:143], v[28:31]
    ds_read_b64_tr_b16 v[188:189], v8 offset:24576
    ds_read_b64_tr_b16 v[190:191], v8 offset:26624
    s_waitcnt lgkmcnt(10)
    v_mfma_f32_16x16x32_bf16 v[32:35], v[168:171], v[136:139], v[32:35]
    buffer_load_dwordx4 v6, s[40:43], s61 offen offset:1024 lds
    s_waitcnt lgkmcnt(8)
    v_mfma_f32_16x16x32_bf16 v[32:35], v[172:175], v[144:147], v[32:35]
    s_waitcnt lgkmcnt(6)
    v_mfma_f32_16x16x32_bf16 v[32:35], v[176:179], v[152:155], v[32:35]
    buffer_load_dwordx4 v6, s[40:43], s62 offen offset:2048 lds
    v_add_u32 v6, 458752, v6
    v_mfma_f32_16x16x32_bf16 v[36:39], v[176:179], v[156:159], v[36:39]
    v_mfma_f32_16x16x32_bf16 v[36:39], v[172:175], v[148:151], v[36:39]
    s_add_u32 m0, s31, 49152
    s_nop 0
    buffer_load_dwordx4 v2, s[12:15], 0 offen lds
    s_waitcnt vmcnt(22) lgkmcnt(0)
    s_barrier
    v_add_u32 v4, 28672, v4
    v_add_u32 v5, 28672, v5
    v_add_u32 v7, 28672, v7
    v_add_u32 v8, 28672, v8
    v_mfma_f32_16x16x32_bf16 v[36:39], v[168:171], v[140:143], v[36:39]
    ds_read_b64_tr_b16 v[160:161], v4 offset:0
    ds_read_b64_tr_b16 v[162:163], v4 offset:2048
    ds_read_b64_tr_b16 v[164:165], v4 offset:4096
    ds_read_b64_tr_b16 v[166:167], v4 offset:6144
    v_mfma_f32_16x16x32_bf16 v[40:43], v[180:183], v[136:139], v[40:43]
    ds_read_b64_tr_b16 v[168:169], v5 offset:0
    ds_read_b64_tr_b16 v[170:171], v5 offset:2048
    ds_read_b64_tr_b16 v[172:173], v5 offset:4096
    ds_read_b64_tr_b16 v[174:175], v5 offset:6144
    buffer_load_dwordx4 v2, s[12:15], 0 offen offset:1024 lds
    v_mfma_f32_16x16x32_bf16 v[40:43], v[184:187], v[144:147], v[40:43]
    ds_read_b64_tr_b16 v[176:177], v7 offset:0
    ds_read_b64_tr_b16 v[178:179], v7 offset:2048
    v_mfma_f32_16x16x32_bf16 v[40:43], v[188:191], v[152:155], v[40:43]
    s_add_u32 m0, s31, 57344
    s_nop 0
    buffer_load_dwordx4 v3, s[16:19], 0 offen lds
    v_mfma_f32_16x16x32_bf16 v[44:47], v[188:191], v[156:159], v[44:47]
    v_mfma_f32_16x16x32_bf16 v[44:47], v[184:187], v[148:151], v[44:47]
    buffer_load_dwordx4 v3, s[16:19], 0 offen offset:1024 lds
    v_add_u32 v2, 8192, v2
    v_add_u32 v3, 8192, v3
    v_mfma_f32_16x16x32_bf16 v[44:47], v[180:183], v[140:143], v[44:47]
    ds_read_b64_tr_b16 v[180:181], v7 offset:4096
    ds_read_b64_tr_b16 v[182:183], v7 offset:6144
    ds_read_b64_tr_b16 v[184:185], v8 offset:0
    ds_read_b64_tr_b16 v[186:187], v8 offset:2048
    s_waitcnt vmcnt(24)
    s_waitcnt lgkmcnt(12)
    v_mfma_f32_16x16x32_bf16 v[16:19], v[160:163], v[48:51], v[16:19]
    ds_read_b64_tr_b16 v[188:189], v8 offset:4096
    ds_read_b64_tr_b16 v[190:191], v8 offset:6144
    buffer_load_dwordx4 v[104:107], v9, s[36:39], 0 offen offset:0
    s_waitcnt vmcnt(23)
    s_waitcnt lgkmcnt(12)
    v_mfma_f32_16x16x32_bf16 v[16:19], v[164:167], v[56:59], v[16:19]
    s_waitcnt vmcnt(22)
    v_mfma_f32_16x16x32_bf16 v[20:23], v[164:167], v[60:63], v[20:23]
    buffer_load_dwordx4 v[108:111], v9, s[36:39], s8 offen offset:0
    v_mfma_f32_16x16x32_bf16 v[20:23], v[160:163], v[52:55], v[20:23]
    ds_read_b64_tr_b16 v[160:161], v4 offset:8192
    ds_read_b64_tr_b16 v[162:163], v4 offset:10240
    ds_read_b64_tr_b16 v[164:165], v4 offset:12288
    ds_read_b64_tr_b16 v[166:167], v4 offset:14336
    s_waitcnt lgkmcnt(14)
    v_mfma_f32_16x16x32_bf16 v[24:27], v[168:171], v[48:51], v[24:27]
    buffer_load_dwordx4 v[112:115], v9, s[36:39], 0 offen offset:1024
    s_waitcnt lgkmcnt(12)
    v_mfma_f32_16x16x32_bf16 v[24:27], v[172:175], v[56:59], v[24:27]
    v_mfma_f32_16x16x32_bf16 v[28:31], v[172:175], v[60:63], v[28:31]
    buffer_load_dwordx4 v[116:119], v9, s[36:39], s8 offen offset:1024
    v_mfma_f32_16x16x32_bf16 v[28:31], v[168:171], v[52:55], v[28:31]
    ds_read_b64_tr_b16 v[168:169], v5 offset:8192
    ds_read_b64_tr_b16 v[170:171], v5 offset:10240
    ds_read_b64_tr_b16 v[172:173], v5 offset:12288
    ds_read_b64_tr_b16 v[174:175], v5 offset:14336
    s_waitcnt lgkmcnt(14)
    v_mfma_f32_16x16x32_bf16 v[32:35], v[176:179], v[48:51], v[32:35]
    buffer_load_dwordx4 v[120:123], v9, s[36:39], 0 offen offset:2048
    s_waitcnt lgkmcnt(12)
    v_mfma_f32_16x16x32_bf16 v[32:35], v[180:183], v[56:59], v[32:35]
    v_mfma_f32_16x16x32_bf16 v[36:39], v[180:183], v[60:63], v[36:39]
    v_mfma_f32_16x16x32_bf16 v[36:39], v[176:179], v[52:55], v[36:39]
    ds_read_b64_tr_b16 v[176:177], v7 offset:8192
    ds_read_b64_tr_b16 v[178:179], v7 offset:10240
    ds_read_b64_tr_b16 v[180:181], v7 offset:12288
    ds_read_b64_tr_b16 v[182:183], v7 offset:14336
    buffer_load_dwordx4 v[124:127], v9, s[36:39], s8 offen offset:2048
    s_waitcnt lgkmcnt(14)
    v_mfma_f32_16x16x32_bf16 v[40:43], v[184:187], v[48:51], v[40:43]
    s_waitcnt lgkmcnt(12)
    v_mfma_f32_16x16x32_bf16 v[40:43], v[188:191], v[56:59], v[40:43]
    buffer_load_dwordx4 v[128:131], v9, s[36:39], 0 offen offset:3072
    v_mfma_f32_16x16x32_bf16 v[44:47], v[188:191], v[60:63], v[44:47]
    v_mfma_f32_16x16x32_bf16 v[44:47], v[184:187], v[52:55], v[44:47]
    ds_read_b64_tr_b16 v[184:185], v8 offset:8192
    ds_read_b64_tr_b16 v[186:187], v8 offset:10240
    ds_read_b64_tr_b16 v[188:189], v8 offset:12288
    ds_read_b64_tr_b16 v[190:191], v8 offset:14336
    buffer_load_dwordx4 v[132:135], v9, s[36:39], s8 offen offset:3072
    s_waitcnt vmcnt(28)
    s_waitcnt lgkmcnt(14)
    v_mfma_f32_16x16x32_bf16 v[16:19], v[160:163], v[64:67], v[16:19]
    s_waitcnt vmcnt(26)
    s_waitcnt lgkmcnt(12)
    v_mfma_f32_16x16x32_bf16 v[16:19], v[164:167], v[72:75], v[16:19]
    buffer_load_dwordx4 v[136:139], v9, s[36:39], s64 offen offset:0
    s_waitcnt vmcnt(26)
    v_mfma_f32_16x16x32_bf16 v[20:23], v[164:167], v[76:79], v[20:23]
    v_mfma_f32_16x16x32_bf16 v[20:23], v[160:163], v[68:71], v[20:23]
    ds_read_b64_tr_b16 v[160:161], v4 offset:16384
    ds_read_b64_tr_b16 v[162:163], v4 offset:18432
    ds_read_b64_tr_b16 v[164:165], v4 offset:20480
    ds_read_b64_tr_b16 v[166:167], v4 offset:22528
    s_waitcnt lgkmcnt(14)
    v_mfma_f32_16x16x32_bf16 v[24:27], v[168:171], v[64:67], v[24:27]
    buffer_load_dwordx4 v[140:143], v9, s[36:39], s9 offen offset:0
    s_waitcnt lgkmcnt(12)
    v_mfma_f32_16x16x32_bf16 v[24:27], v[172:175], v[72:75], v[24:27]
    v_mfma_f32_16x16x32_bf16 v[28:31], v[172:175], v[76:79], v[28:31]
    buffer_load_dwordx4 v[144:147], v9, s[36:39], s64 offen offset:1024
    v_mfma_f32_16x16x32_bf16 v[28:31], v[168:171], v[68:71], v[28:31]
    ds_read_b64_tr_b16 v[168:169], v4 offset:24576
    ds_read_b64_tr_b16 v[170:171], v4 offset:26624
    ds_read_b64_tr_b16 v[172:173], v5 offset:16384
    ds_read_b64_tr_b16 v[174:175], v5 offset:18432
    s_waitcnt lgkmcnt(14)
    v_mfma_f32_16x16x32_bf16 v[32:35], v[176:179], v[64:67], v[32:35]
    buffer_load_dwordx4 v[148:151], v9, s[36:39], s9 offen offset:1024
    s_waitcnt lgkmcnt(12)
    v_mfma_f32_16x16x32_bf16 v[32:35], v[180:183], v[72:75], v[32:35]
    v_mfma_f32_16x16x32_bf16 v[36:39], v[180:183], v[76:79], v[36:39]
    buffer_load_dwordx4 v[152:155], v9, s[36:39], s64 offen offset:2048
    v_mfma_f32_16x16x32_bf16 v[36:39], v[176:179], v[68:71], v[36:39]
    ds_read_b64_tr_b16 v[176:177], v5 offset:20480
    ds_read_b64_tr_b16 v[178:179], v5 offset:22528
    ds_read_b64_tr_b16 v[180:181], v5 offset:24576
    ds_read_b64_tr_b16 v[182:183], v5 offset:26624
    s_waitcnt lgkmcnt(14)
    v_mfma_f32_16x16x32_bf16 v[40:43], v[184:187], v[64:67], v[40:43]
    s_waitcnt lgkmcnt(12)
    v_mfma_f32_16x16x32_bf16 v[40:43], v[188:191], v[72:75], v[40:43]
    buffer_load_dwordx4 v[156:159], v9, s[36:39], s9 offen offset:2048
    v_add_u32 v9, 7168, v9
    v_mfma_f32_16x16x32_bf16 v[44:47], v[188:191], v[76:79], v[44:47]
    v_mfma_f32_16x16x32_bf16 v[44:47], v[184:187], v[68:71], v[44:47]
    ds_read_b64_tr_b16 v[184:185], v7 offset:16384
    ds_read_b64_tr_b16 v[186:187], v7 offset:18432
    ds_read_b64_tr_b16 v[188:189], v7 offset:20480
    ds_read_b64_tr_b16 v[190:191], v7 offset:22528
    s_add_u32 m0, s66, 28672
    s_nop 0
    buffer_load_dwordx4 v6, s[40:43], s56 offen offset:0 lds
    s_waitcnt vmcnt(31)
    s_waitcnt lgkmcnt(14)
    v_mfma_f32_16x16x32_bf16 v[16:19], v[160:163], v[80:83], v[16:19]
    s_waitcnt vmcnt(29)
    s_waitcnt lgkmcnt(12)
    v_mfma_f32_16x16x32_bf16 v[16:19], v[164:167], v[88:91], v[16:19]
    buffer_load_dwordx4 v6, s[40:43], s57 offen offset:1024 lds
    s_waitcnt vmcnt(28)
    s_waitcnt lgkmcnt(10)
    v_mfma_f32_16x16x32_bf16 v[16:19], v[168:171], v[96:99], v[16:19]
    s_waitcnt vmcnt(27)
    v_mfma_f32_16x16x32_bf16 v[20:23], v[168:171], v[100:103], v[20:23]
    buffer_load_dwordx4 v6, s[40:43], s58 offen offset:2048 lds
    v_mfma_f32_16x16x32_bf16 v[20:23], v[164:167], v[92:95], v[20:23]
    v_mfma_f32_16x16x32_bf16 v[20:23], v[160:163], v[84:87], v[20:23]
    ds_read_b64_tr_b16 v[160:161], v7 offset:24576
    ds_read_b64_tr_b16 v[162:163], v7 offset:26624
    ds_read_b64_tr_b16 v[164:165], v8 offset:16384
    ds_read_b64_tr_b16 v[166:167], v8 offset:18432
    s_waitcnt lgkmcnt(12)
    v_mfma_f32_16x16x32_bf16 v[24:27], v[172:175], v[80:83], v[24:27]
    ds_read_b64_tr_b16 v[168:169], v8 offset:20480
    ds_read_b64_tr_b16 v[170:171], v8 offset:22528
    buffer_load_dwordx4 v6, s[40:43], s59 offen offset:3072 lds
    s_waitcnt lgkmcnt(12)
    v_mfma_f32_16x16x32_bf16 v[24:27], v[176:179], v[88:91], v[24:27]
    s_waitcnt lgkmcnt(10)
    v_mfma_f32_16x16x32_bf16 v[24:27], v[180:183], v[96:99], v[24:27]
    s_add_u32 m0, s66, 32768
    s_nop 0
    buffer_load_dwordx4 v6, s[40:43], s60 offen offset:0 lds
    v_mfma_f32_16x16x32_bf16 v[28:31], v[180:183], v[100:103], v[28:31]
    v_mfma_f32_16x16x32_bf16 v[28:31], v[176:179], v[92:95], v[28:31]
    buffer_load_dwordx4 v6, s[40:43], s61 offen offset:1024 lds
    v_mfma_f32_16x16x32_bf16 v[28:31], v[172:175], v[84:87], v[28:31]
    ds_read_b64_tr_b16 v[172:173], v8 offset:24576
    ds_read_b64_tr_b16 v[174:175], v8 offset:26624
    s_waitcnt lgkmcnt(10)
    v_mfma_f32_16x16x32_bf16 v[32:35], v[184:187], v[80:83], v[32:35]
    buffer_load_dwordx4 v6, s[40:43], s62 offen offset:2048 lds
    v_add_u32 v6, 458752, v6
    s_waitcnt lgkmcnt(8)
    v_mfma_f32_16x16x32_bf16 v[32:35], v[188:191], v[88:91], v[32:35]
    s_waitcnt lgkmcnt(6)
    v_mfma_f32_16x16x32_bf16 v[32:35], v[160:163], v[96:99], v[32:35]
    v_mfma_f32_16x16x32_bf16 v[36:39], v[160:163], v[100:103], v[36:39]
    s_add_u32 m0, s31, 0
    s_nop 0
    buffer_load_dwordx4 v2, s[12:15], 0 offen lds
    v_mfma_f32_16x16x32_bf16 v[36:39], v[188:191], v[92:95], v[36:39]
    s_waitcnt vmcnt(22) lgkmcnt(0)
    s_barrier
    v_subrev_u32 v4, 57344, v4
    v_subrev_u32 v5, 57344, v5
    v_subrev_u32 v7, 57344, v7
    v_subrev_u32 v8, 57344, v8
    v_mfma_f32_16x16x32_bf16 v[36:39], v[184:187], v[84:87], v[36:39]
    ds_read_b64_tr_b16 v[176:177], v4 offset:0
    ds_read_b64_tr_b16 v[178:179], v4 offset:2048
    ds_read_b64_tr_b16 v[180:181], v4 offset:4096
    ds_read_b64_tr_b16 v[182:183], v4 offset:6144
    buffer_load_dwordx4 v2, s[12:15], 0 offen offset:1024 lds
    v_mfma_f32_16x16x32_bf16 v[40:43], v[164:167], v[80:83], v[40:43]
    ds_read_b64_tr_b16 v[184:185], v5 offset:0
    ds_read_b64_tr_b16 v[186:187], v5 offset:2048
    ds_read_b64_tr_b16 v[188:189], v5 offset:4096
    ds_read_b64_tr_b16 v[190:191], v5 offset:6144
    v_mfma_f32_16x16x32_bf16 v[40:43], v[168:171], v[88:91], v[40:43]
    ds_read_b64_tr_b16 v[160:161], v7 offset:0
    ds_read_b64_tr_b16 v[162:163], v7 offset:2048
    s_add_u32 m0, s31, 8192
    s_nop 0
    buffer_load_dwordx4 v3, s[16:19], 0 offen lds
    v_mfma_f32_16x16x32_bf16 v[40:43], v[172:175], v[96:99], v[40:43]
    v_mfma_f32_16x16x32_bf16 v[44:47], v[172:175], v[100:103], v[44:47]
    buffer_load_dwordx4 v3, s[16:19], 0 offen offset:1024 lds
    v_add_u32 v2, 8192, v2
    v_add_u32 v3, 8192, v3
    v_mfma_f32_16x16x32_bf16 v[44:47], v[168:171], v[92:95], v[44:47]
    v_mfma_f32_16x16x32_bf16 v[44:47], v[164:167], v[84:87], v[44:47]
    ds_read_b64_tr_b16 v[164:165], v7 offset:4096
    ds_read_b64_tr_b16 v[166:167], v7 offset:6144
    ds_read_b64_tr_b16 v[168:169], v8 offset:0
    ds_read_b64_tr_b16 v[170:171], v8 offset:2048
    s_waitcnt vmcnt(24)
    s_waitcnt lgkmcnt(12)
    v_mfma_f32_16x16x32_bf16 v[16:19], v[176:179], v[104:107], v[16:19]
    ds_read_b64_tr_b16 v[172:173], v8 offset:4096
    ds_read_b64_tr_b16 v[174:175], v8 offset:6144
    buffer_load_dwordx4 v[48:51], v9, s[36:39], 0 offen offset:0
    s_waitcnt vmcnt(23)
    s_waitcnt lgkmcnt(12)
    v_mfma_f32_16x16x32_bf16 v[16:19], v[180:183], v[112:115], v[16:19]
    s_waitcnt vmcnt(22)
    v_mfma_f32_16x16x32_bf16 v[20:23], v[180:183], v[116:119], v[20:23]
    buffer_load_dwordx4 v[52:55], v9, s[36:39], s8 offen offset:0
    v_mfma_f32_16x16x32_bf16 v[20:23], v[176:179], v[108:111], v[20:23]
    ds_read_b64_tr_b16 v[176:177], v4 offset:8192
    ds_read_b64_tr_b16 v[178:179], v4 offset:10240
    ds_read_b64_tr_b16 v[180:181], v4 offset:12288
    ds_read_b64_tr_b16 v[182:183], v4 offset:14336
    s_waitcnt lgkmcnt(14)
    v_mfma_f32_16x16x32_bf16 v[24:27], v[184:187], v[104:107], v[24:27]
    buffer_load_dwordx4 v[56:59], v9, s[36:39], 0 offen offset:1024
    s_waitcnt lgkmcnt(12)
    v_mfma_f32_16x16x32_bf16 v[24:27], v[188:191], v[112:115], v[24:27]
    v_mfma_f32_16x16x32_bf16 v[28:31], v[188:191], v[116:119], v[28:31]
    buffer_load_dwordx4 v[60:63], v9, s[36:39], s8 offen offset:1024
    v_mfma_f32_16x16x32_bf16 v[28:31], v[184:187], v[108:111], v[28:31]
    ds_read_b64_tr_b16 v[184:185], v5 offset:8192
    ds_read_b64_tr_b16 v[186:187], v5 offset:10240
    ds_read_b64_tr_b16 v[188:189], v5 offset:12288
    ds_read_b64_tr_b16 v[190:191], v5 offset:14336
    s_waitcnt lgkmcnt(14)
    v_mfma_f32_16x16x32_bf16 v[32:35], v[160:163], v[104:107], v[32:35]
    buffer_load_dwordx4 v[64:67], v9, s[36:39], 0 offen offset:2048
    s_waitcnt lgkmcnt(12)
    v_mfma_f32_16x16x32_bf16 v[32:35], v[164:167], v[112:115], v[32:35]
    v_mfma_f32_16x16x32_bf16 v[36:39], v[164:167], v[116:119], v[36:39]
    v_mfma_f32_16x16x32_bf16 v[36:39], v[160:163], v[108:111], v[36:39]
    ds_read_b64_tr_b16 v[160:161], v7 offset:8192
    ds_read_b64_tr_b16 v[162:163], v7 offset:10240
    ds_read_b64_tr_b16 v[164:165], v7 offset:12288
    ds_read_b64_tr_b16 v[166:167], v7 offset:14336
    buffer_load_dwordx4 v[68:71], v9, s[36:39], s8 offen offset:2048
    s_waitcnt lgkmcnt(14)
    v_mfma_f32_16x16x32_bf16 v[40:43], v[168:171], v[104:107], v[40:43]
    s_waitcnt lgkmcnt(12)
    v_mfma_f32_16x16x32_bf16 v[40:43], v[172:175], v[112:115], v[40:43]
    buffer_load_dwordx4 v[72:75], v9, s[36:39], 0 offen offset:3072
    v_mfma_f32_16x16x32_bf16 v[44:47], v[172:175], v[116:119], v[44:47]
    v_mfma_f32_16x16x32_bf16 v[44:47], v[168:171], v[108:111], v[44:47]
    ds_read_b64_tr_b16 v[168:169], v8 offset:8192
    ds_read_b64_tr_b16 v[170:171], v8 offset:10240
    ds_read_b64_tr_b16 v[172:173], v8 offset:12288
    ds_read_b64_tr_b16 v[174:175], v8 offset:14336
    buffer_load_dwordx4 v[76:79], v9, s[36:39], s8 offen offset:3072
    s_waitcnt vmcnt(28)
    s_waitcnt lgkmcnt(14)
    v_mfma_f32_16x16x32_bf16 v[16:19], v[176:179], v[120:123], v[16:19]
    s_waitcnt vmcnt(26)
    s_waitcnt lgkmcnt(12)
    v_mfma_f32_16x16x32_bf16 v[16:19], v[180:183], v[128:131], v[16:19]
    buffer_load_dwordx4 v[80:83], v9, s[36:39], s64 offen offset:0
    s_waitcnt vmcnt(26)
    v_mfma_f32_16x16x32_bf16 v[20:23], v[180:183], v[132:135], v[20:23]
    v_mfma_f32_16x16x32_bf16 v[20:23], v[176:179], v[124:127], v[20:23]
    ds_read_b64_tr_b16 v[176:177], v4 offset:16384
    ds_read_b64_tr_b16 v[178:179], v4 offset:18432
    ds_read_b64_tr_b16 v[180:181], v4 offset:20480
    ds_read_b64_tr_b16 v[182:183], v4 offset:22528
    s_waitcnt lgkmcnt(14)
    v_mfma_f32_16x16x32_bf16 v[24:27], v[184:187], v[120:123], v[24:27]
    buffer_load_dwordx4 v[84:87], v9, s[36:39], s9 offen offset:0
    s_waitcnt lgkmcnt(12)
    v_mfma_f32_16x16x32_bf16 v[24:27], v[188:191], v[128:131], v[24:27]
    v_mfma_f32_16x16x32_bf16 v[28:31], v[188:191], v[132:135], v[28:31]
    buffer_load_dwordx4 v[88:91], v9, s[36:39], s64 offen offset:1024
    v_mfma_f32_16x16x32_bf16 v[28:31], v[184:187], v[124:127], v[28:31]
    ds_read_b64_tr_b16 v[184:185], v4 offset:24576
    ds_read_b64_tr_b16 v[186:187], v4 offset:26624
    ds_read_b64_tr_b16 v[188:189], v5 offset:16384
    ds_read_b64_tr_b16 v[190:191], v5 offset:18432
    s_waitcnt lgkmcnt(14)
    v_mfma_f32_16x16x32_bf16 v[32:35], v[160:163], v[120:123], v[32:35]
    buffer_load_dwordx4 v[92:95], v9, s[36:39], s9 offen offset:1024
    s_waitcnt lgkmcnt(12)
    v_mfma_f32_16x16x32_bf16 v[32:35], v[164:167], v[128:131], v[32:35]
    v_mfma_f32_16x16x32_bf16 v[36:39], v[164:167], v[132:135], v[36:39]
    buffer_load_dwordx4 v[96:99], v9, s[36:39], s64 offen offset:2048
    v_mfma_f32_16x16x32_bf16 v[36:39], v[160:163], v[124:127], v[36:39]
    ds_read_b64_tr_b16 v[160:161], v5 offset:20480
    ds_read_b64_tr_b16 v[162:163], v5 offset:22528
    ds_read_b64_tr_b16 v[164:165], v5 offset:24576
    ds_read_b64_tr_b16 v[166:167], v5 offset:26624
    s_waitcnt lgkmcnt(14)
    v_mfma_f32_16x16x32_bf16 v[40:43], v[168:171], v[120:123], v[40:43]
    s_waitcnt lgkmcnt(12)
    v_mfma_f32_16x16x32_bf16 v[40:43], v[172:175], v[128:131], v[40:43]
    buffer_load_dwordx4 v[100:103], v9, s[36:39], s9 offen offset:2048
    v_add_u32 v9, 7168, v9
    v_mfma_f32_16x16x32_bf16 v[44:47], v[172:175], v[132:135], v[44:47]
    v_mfma_f32_16x16x32_bf16 v[44:47], v[168:171], v[124:127], v[44:47]
    ds_read_b64_tr_b16 v[168:169], v7 offset:16384
    ds_read_b64_tr_b16 v[170:171], v7 offset:18432
    ds_read_b64_tr_b16 v[172:173], v7 offset:20480
    ds_read_b64_tr_b16 v[174:175], v7 offset:22528
    s_add_u32 m0, s66, 57344
    s_nop 0
    buffer_load_dwordx4 v6, s[40:43], s56 offen offset:0 lds
    s_waitcnt vmcnt(31)
    s_waitcnt lgkmcnt(14)
    v_mfma_f32_16x16x32_bf16 v[16:19], v[176:179], v[136:139], v[16:19]
    s_waitcnt vmcnt(29)
    s_waitcnt lgkmcnt(12)
    v_mfma_f32_16x16x32_bf16 v[16:19], v[180:183], v[144:147], v[16:19]
    buffer_load_dwordx4 v6, s[40:43], s57 offen offset:1024 lds
    s_waitcnt vmcnt(28)
    s_waitcnt lgkmcnt(10)
    v_mfma_f32_16x16x32_bf16 v[16:19], v[184:187], v[152:155], v[16:19]
    s_waitcnt vmcnt(27)
    v_mfma_f32_16x16x32_bf16 v[20:23], v[184:187], v[156:159], v[20:23]
    buffer_load_dwordx4 v6, s[40:43], s58 offen offset:2048 lds
    v_mfma_f32_16x16x32_bf16 v[20:23], v[180:183], v[148:151], v[20:23]
    v_mfma_f32_16x16x32_bf16 v[20:23], v[176:179], v[140:143], v[20:23]
    ds_read_b64_tr_b16 v[176:177], v7 offset:24576
    ds_read_b64_tr_b16 v[178:179], v7 offset:26624
    ds_read_b64_tr_b16 v[180:181], v8 offset:16384
    ds_read_b64_tr_b16 v[182:183], v8 offset:18432
    s_waitcnt lgkmcnt(12)
    v_mfma_f32_16x16x32_bf16 v[24:27], v[188:191], v[136:139], v[24:27]
    ds_read_b64_tr_b16 v[184:185], v8 offset:20480
    ds_read_b64_tr_b16 v[186:187], v8 offset:22528
    buffer_load_dwordx4 v6, s[40:43], s59 offen offset:3072 lds
    s_waitcnt lgkmcnt(12)
    v_mfma_f32_16x16x32_bf16 v[24:27], v[160:163], v[144:147], v[24:27]
    s_waitcnt lgkmcnt(10)
    v_mfma_f32_16x16x32_bf16 v[24:27], v[164:167], v[152:155], v[24:27]
    s_add_u32 m0, s66, 61440
    s_nop 0
    buffer_load_dwordx4 v6, s[40:43], s60 offen offset:0 lds
    v_mfma_f32_16x16x32_bf16 v[28:31], v[164:167], v[156:159], v[28:31]
    v_mfma_f32_16x16x32_bf16 v[28:31], v[160:163], v[148:151], v[28:31]
    buffer_load_dwordx4 v6, s[40:43], s61 offen offset:1024 lds
    v_mfma_f32_16x16x32_bf16 v[28:31], v[188:191], v[140:143], v[28:31]
    ds_read_b64_tr_b16 v[188:189], v8 offset:24576
    ds_read_b64_tr_b16 v[190:191], v8 offset:26624
    s_waitcnt lgkmcnt(10)
    v_mfma_f32_16x16x32_bf16 v[32:35], v[168:171], v[136:139], v[32:35]
    buffer_load_dwordx4 v6, s[40:43], s62 offen offset:2048 lds
    v_add_u32 v6, 458752, v6
    s_waitcnt lgkmcnt(8)
    v_mfma_f32_16x16x32_bf16 v[32:35], v[172:175], v[144:147], v[32:35]
    s_waitcnt lgkmcnt(6)
    v_mfma_f32_16x16x32_bf16 v[32:35], v[176:179], v[152:155], v[32:35]
    v_mfma_f32_16x16x32_bf16 v[36:39], v[176:179], v[156:159], v[36:39]
    s_add_u32 m0, s31, 16384
    s_nop 0
    buffer_load_dwordx4 v2, s[12:15], 0 offen lds
    v_mfma_f32_16x16x32_bf16 v[36:39], v[172:175], v[148:151], v[36:39]
    s_waitcnt vmcnt(22) lgkmcnt(0)
    s_barrier
    v_add_u32 v4, 28672, v4
    v_add_u32 v5, 28672, v5
    v_add_u32 v7, 28672, v7
    v_add_u32 v8, 28672, v8
    v_mfma_f32_16x16x32_bf16 v[36:39], v[168:171], v[140:143], v[36:39]
    ds_read_b64_tr_b16 v[160:161], v4 offset:0
    ds_read_b64_tr_b16 v[162:163], v4 offset:2048
    ds_read_b64_tr_b16 v[164:165], v4 offset:4096
    ds_read_b64_tr_b16 v[166:167], v4 offset:6144
    buffer_load_dwordx4 v2, s[12:15], 0 offen offset:1024 lds
    v_mfma_f32_16x16x32_bf16 v[40:43], v[180:183], v[136:139], v[40:43]
    ds_read_b64_tr_b16 v[168:169], v5 offset:0
    ds_read_b64_tr_b16 v[170:171], v5 offset:2048
    ds_read_b64_tr_b16 v[172:173], v5 offset:4096
    ds_read_b64_tr_b16 v[174:175], v5 offset:6144
    v_mfma_f32_16x16x32_bf16 v[40:43], v[184:187], v[144:147], v[40:43]
    ds_read_b64_tr_b16 v[176:177], v7 offset:0
    ds_read_b64_tr_b16 v[178:179], v7 offset:2048
    s_add_u32 m0, s31, 24576
    s_nop 0
    buffer_load_dwordx4 v3, s[16:19], 0 offen lds
    v_mfma_f32_16x16x32_bf16 v[40:43], v[188:191], v[152:155], v[40:43]
    v_mfma_f32_16x16x32_bf16 v[44:47], v[188:191], v[156:159], v[44:47]
    buffer_load_dwordx4 v3, s[16:19], 0 offen offset:1024 lds
    v_add_u32 v2, 8192, v2
    v_add_u32 v3, 8192, v3
    v_mfma_f32_16x16x32_bf16 v[44:47], v[184:187], v[148:151], v[44:47]
    v_mfma_f32_16x16x32_bf16 v[44:47], v[180:183], v[140:143], v[44:47]
    ds_read_b64_tr_b16 v[180:181], v7 offset:4096
    ds_read_b64_tr_b16 v[182:183], v7 offset:6144
    ds_read_b64_tr_b16 v[184:185], v8 offset:0
    ds_read_b64_tr_b16 v[186:187], v8 offset:2048
    s_waitcnt vmcnt(24)
    s_waitcnt lgkmcnt(12)
    v_mfma_f32_16x16x32_bf16 v[16:19], v[160:163], v[48:51], v[16:19]
    ds_read_b64_tr_b16 v[188:189], v8 offset:4096
    ds_read_b64_tr_b16 v[190:191], v8 offset:6144
    buffer_load_dwordx4 v[104:107], v9, s[36:39], 0 offen offset:0
    s_waitcnt vmcnt(23)
    s_waitcnt lgkmcnt(12)
    v_mfma_f32_16x16x32_bf16 v[16:19], v[164:167], v[56:59], v[16:19]
    s_waitcnt vmcnt(22)
    v_mfma_f32_16x16x32_bf16 v[20:23], v[164:167], v[60:63], v[20:23]
    buffer_load_dwordx4 v[108:111], v9, s[36:39], s8 offen offset:0
    v_mfma_f32_16x16x32_bf16 v[20:23], v[160:163], v[52:55], v[20:23]
    ds_read_b64_tr_b16 v[160:161], v4 offset:8192
    ds_read_b64_tr_b16 v[162:163], v4 offset:10240
    ds_read_b64_tr_b16 v[164:165], v4 offset:12288
    ds_read_b64_tr_b16 v[166:167], v4 offset:14336
    s_waitcnt lgkmcnt(14)
    v_mfma_f32_16x16x32_bf16 v[24:27], v[168:171], v[48:51], v[24:27]
    buffer_load_dwordx4 v[112:115], v9, s[36:39], 0 offen offset:1024
    s_waitcnt lgkmcnt(12)
    v_mfma_f32_16x16x32_bf16 v[24:27], v[172:175], v[56:59], v[24:27]
    v_mfma_f32_16x16x32_bf16 v[28:31], v[172:175], v[60:63], v[28:31]
    buffer_load_dwordx4 v[116:119], v9, s[36:39], s8 offen offset:1024
    v_mfma_f32_16x16x32_bf16 v[28:31], v[168:171], v[52:55], v[28:31]
    ds_read_b64_tr_b16 v[168:169], v5 offset:8192
    ds_read_b64_tr_b16 v[170:171], v5 offset:10240
    ds_read_b64_tr_b16 v[172:173], v5 offset:12288
    ds_read_b64_tr_b16 v[174:175], v5 offset:14336
    s_waitcnt lgkmcnt(14)
    v_mfma_f32_16x16x32_bf16 v[32:35], v[176:179], v[48:51], v[32:35]
    buffer_load_dwordx4 v[120:123], v9, s[36:39], 0 offen offset:2048
    s_waitcnt lgkmcnt(12)
    v_mfma_f32_16x16x32_bf16 v[32:35], v[180:183], v[56:59], v[32:35]
    v_mfma_f32_16x16x32_bf16 v[36:39], v[180:183], v[60:63], v[36:39]
    v_mfma_f32_16x16x32_bf16 v[36:39], v[176:179], v[52:55], v[36:39]
    ds_read_b64_tr_b16 v[176:177], v7 offset:8192
    ds_read_b64_tr_b16 v[178:179], v7 offset:10240
    ds_read_b64_tr_b16 v[180:181], v7 offset:12288
    ds_read_b64_tr_b16 v[182:183], v7 offset:14336
    buffer_load_dwordx4 v[124:127], v9, s[36:39], s8 offen offset:2048
    s_waitcnt lgkmcnt(14)
    v_mfma_f32_16x16x32_bf16 v[40:43], v[184:187], v[48:51], v[40:43]
    s_waitcnt lgkmcnt(12)
    v_mfma_f32_16x16x32_bf16 v[40:43], v[188:191], v[56:59], v[40:43]
    buffer_load_dwordx4 v[128:131], v9, s[36:39], 0 offen offset:3072
    v_mfma_f32_16x16x32_bf16 v[44:47], v[188:191], v[60:63], v[44:47]
    v_mfma_f32_16x16x32_bf16 v[44:47], v[184:187], v[52:55], v[44:47]
    ds_read_b64_tr_b16 v[184:185], v8 offset:8192
    ds_read_b64_tr_b16 v[186:187], v8 offset:10240
    ds_read_b64_tr_b16 v[188:189], v8 offset:12288
    ds_read_b64_tr_b16 v[190:191], v8 offset:14336
    buffer_load_dwordx4 v[132:135], v9, s[36:39], s8 offen offset:3072
    s_waitcnt vmcnt(28)
    s_waitcnt lgkmcnt(14)
    v_mfma_f32_16x16x32_bf16 v[16:19], v[160:163], v[64:67], v[16:19]
    s_waitcnt vmcnt(26)
    s_waitcnt lgkmcnt(12)
    v_mfma_f32_16x16x32_bf16 v[16:19], v[164:167], v[72:75], v[16:19]
    buffer_load_dwordx4 v[136:139], v9, s[36:39], s64 offen offset:0
    s_waitcnt vmcnt(26)
    v_mfma_f32_16x16x32_bf16 v[20:23], v[164:167], v[76:79], v[20:23]
    v_mfma_f32_16x16x32_bf16 v[20:23], v[160:163], v[68:71], v[20:23]
    ds_read_b64_tr_b16 v[160:161], v4 offset:16384
    ds_read_b64_tr_b16 v[162:163], v4 offset:18432
    ds_read_b64_tr_b16 v[164:165], v4 offset:20480
    ds_read_b64_tr_b16 v[166:167], v4 offset:22528
    s_waitcnt lgkmcnt(14)
    v_mfma_f32_16x16x32_bf16 v[24:27], v[168:171], v[64:67], v[24:27]
    buffer_load_dwordx4 v[140:143], v9, s[36:39], s9 offen offset:0
    s_waitcnt lgkmcnt(12)
    v_mfma_f32_16x16x32_bf16 v[24:27], v[172:175], v[72:75], v[24:27]
    v_mfma_f32_16x16x32_bf16 v[28:31], v[172:175], v[76:79], v[28:31]
    buffer_load_dwordx4 v[144:147], v9, s[36:39], s64 offen offset:1024
    v_mfma_f32_16x16x32_bf16 v[28:31], v[168:171], v[68:71], v[28:31]
    ds_read_b64_tr_b16 v[168:169], v4 offset:24576
    ds_read_b64_tr_b16 v[170:171], v4 offset:26624
    ds_read_b64_tr_b16 v[172:173], v5 offset:16384
    ds_read_b64_tr_b16 v[174:175], v5 offset:18432
    s_waitcnt lgkmcnt(14)
    v_mfma_f32_16x16x32_bf16 v[32:35], v[176:179], v[64:67], v[32:35]
    buffer_load_dwordx4 v[148:151], v9, s[36:39], s9 offen offset:1024
    s_waitcnt lgkmcnt(12)
    v_mfma_f32_16x16x32_bf16 v[32:35], v[180:183], v[72:75], v[32:35]
    v_mfma_f32_16x16x32_bf16 v[36:39], v[180:183], v[76:79], v[36:39]
    buffer_load_dwordx4 v[152:155], v9, s[36:39], s64 offen offset:2048
    v_mfma_f32_16x16x32_bf16 v[36:39], v[176:179], v[68:71], v[36:39]
    ds_read_b64_tr_b16 v[176:177], v5 offset:20480
    ds_read_b64_tr_b16 v[178:179], v5 offset:22528
    ds_read_b64_tr_b16 v[180:181], v5 offset:24576
    ds_read_b64_tr_b16 v[182:183], v5 offset:26624
    s_waitcnt lgkmcnt(14)
    v_mfma_f32_16x16x32_bf16 v[40:43], v[184:187], v[64:67], v[40:43]
    s_waitcnt lgkmcnt(12)
    v_mfma_f32_16x16x32_bf16 v[40:43], v[188:191], v[72:75], v[40:43]
    buffer_load_dwordx4 v[156:159], v9, s[36:39], s9 offen offset:2048
    v_add_u32 v9, 7168, v9
    v_mfma_f32_16x16x32_bf16 v[44:47], v[188:191], v[76:79], v[44:47]
    v_mfma_f32_16x16x32_bf16 v[44:47], v[184:187], v[68:71], v[44:47]
    ds_read_b64_tr_b16 v[184:185], v7 offset:16384
    ds_read_b64_tr_b16 v[186:187], v7 offset:18432
    ds_read_b64_tr_b16 v[188:189], v7 offset:20480
    ds_read_b64_tr_b16 v[190:191], v7 offset:22528
    s_add_u32 m0, s66, 0
    s_nop 0
    buffer_load_dwordx4 v6, s[40:43], s56 offen offset:0 lds
    s_waitcnt vmcnt(31)
    s_waitcnt lgkmcnt(14)
    v_mfma_f32_16x16x32_bf16 v[16:19], v[160:163], v[80:83], v[16:19]
    s_waitcnt vmcnt(29)
    s_waitcnt lgkmcnt(12)
    v_mfma_f32_16x16x32_bf16 v[16:19], v[164:167], v[88:91], v[16:19]
    buffer_load_dwordx4 v6, s[40:43], s57 offen offset:1024 lds
    s_waitcnt vmcnt(28)
    s_waitcnt lgkmcnt(10)
    v_mfma_f32_16x16x32_bf16 v[16:19], v[168:171], v[96:99], v[16:19]
    s_waitcnt vmcnt(27)
    v_mfma_f32_16x16x32_bf16 v[20:23], v[168:171], v[100:103], v[20:23]
    buffer_load_dwordx4 v6, s[40:43], s58 offen offset:2048 lds
    v_mfma_f32_16x16x32_bf16 v[20:23], v[164:167], v[92:95], v[20:23]
    v_mfma_f32_16x16x32_bf16 v[20:23], v[160:163], v[84:87], v[20:23]
    ds_read_b64_tr_b16 v[160:161], v7 offset:24576
    ds_read_b64_tr_b16 v[162:163], v7 offset:26624
    ds_read_b64_tr_b16 v[164:165], v8 offset:16384
    ds_read_b64_tr_b16 v[166:167], v8 offset:18432
    s_waitcnt lgkmcnt(12)
    v_mfma_f32_16x16x32_bf16 v[24:27], v[172:175], v[80:83], v[24:27]
    ds_read_b64_tr_b16 v[168:169], v8 offset:20480
    ds_read_b64_tr_b16 v[170:171], v8 offset:22528
    buffer_load_dwordx4 v6, s[40:43], s59 offen offset:3072 lds
    s_waitcnt lgkmcnt(12)
    v_mfma_f32_16x16x32_bf16 v[24:27], v[176:179], v[88:91], v[24:27]
    s_waitcnt lgkmcnt(10)
    v_mfma_f32_16x16x32_bf16 v[24:27], v[180:183], v[96:99], v[24:27]
    s_add_u32 m0, s66, 4096
    s_nop 0
    buffer_load_dwordx4 v6, s[40:43], s60 offen offset:0 lds
    v_mfma_f32_16x16x32_bf16 v[28:31], v[180:183], v[100:103], v[28:31]
    v_mfma_f32_16x16x32_bf16 v[28:31], v[176:179], v[92:95], v[28:31]
    buffer_load_dwordx4 v6, s[40:43], s61 offen offset:1024 lds
    v_mfma_f32_16x16x32_bf16 v[28:31], v[172:175], v[84:87], v[28:31]
    ds_read_b64_tr_b16 v[172:173], v8 offset:24576
    ds_read_b64_tr_b16 v[174:175], v8 offset:26624
    s_waitcnt lgkmcnt(10)
    v_mfma_f32_16x16x32_bf16 v[32:35], v[184:187], v[80:83], v[32:35]
    buffer_load_dwordx4 v6, s[40:43], s62 offen offset:2048 lds
    v_add_u32 v6, 458752, v6
    s_waitcnt lgkmcnt(8)
    v_mfma_f32_16x16x32_bf16 v[32:35], v[188:191], v[88:91], v[32:35]
    s_waitcnt lgkmcnt(6)
    v_mfma_f32_16x16x32_bf16 v[32:35], v[160:163], v[96:99], v[32:35]
    v_mfma_f32_16x16x32_bf16 v[36:39], v[160:163], v[100:103], v[36:39]
    s_add_u32 m0, s31, 32768
    s_nop 0
    buffer_load_dwordx4 v2, s[12:15], 0 offen lds
    v_mfma_f32_16x16x32_bf16 v[36:39], v[188:191], v[92:95], v[36:39]
    s_waitcnt vmcnt(22) lgkmcnt(0)
    s_barrier
    v_add_u32 v4, 28672, v4
    v_add_u32 v5, 28672, v5
    v_add_u32 v7, 28672, v7
    v_add_u32 v8, 28672, v8
    v_mfma_f32_16x16x32_bf16 v[36:39], v[184:187], v[84:87], v[36:39]
    ds_read_b64_tr_b16 v[176:177], v4 offset:0
    ds_read_b64_tr_b16 v[178:179], v4 offset:2048
    ds_read_b64_tr_b16 v[180:181], v4 offset:4096
    ds_read_b64_tr_b16 v[182:183], v4 offset:6144
    buffer_load_dwordx4 v2, s[12:15], 0 offen offset:1024 lds
    v_mfma_f32_16x16x32_bf16 v[40:43], v[164:167], v[80:83], v[40:43]
    ds_read_b64_tr_b16 v[184:185], v5 offset:0
    ds_read_b64_tr_b16 v[186:187], v5 offset:2048
    ds_read_b64_tr_b16 v[188:189], v5 offset:4096
    ds_read_b64_tr_b16 v[190:191], v5 offset:6144
    v_mfma_f32_16x16x32_bf16 v[40:43], v[168:171], v[88:91], v[40:43]
    ds_read_b64_tr_b16 v[160:161], v7 offset:0
    ds_read_b64_tr_b16 v[162:163], v7 offset:2048
    s_add_u32 m0, s31, 40960
    s_nop 0
    buffer_load_dwordx4 v3, s[16:19], 0 offen lds
    v_mfma_f32_16x16x32_bf16 v[40:43], v[172:175], v[96:99], v[40:43]
    v_mfma_f32_16x16x32_bf16 v[44:47], v[172:175], v[100:103], v[44:47]
    buffer_load_dwordx4 v3, s[16:19], 0 offen offset:1024 lds
    v_add_u32 v2, 8192, v2
    v_add_u32 v3, 8192, v3
    v_mfma_f32_16x16x32_bf16 v[44:47], v[168:171], v[92:95], v[44:47]
    v_mfma_f32_16x16x32_bf16 v[44:47], v[164:167], v[84:87], v[44:47]
    ds_read_b64_tr_b16 v[164:165], v7 offset:4096
    ds_read_b64_tr_b16 v[166:167], v7 offset:6144
    ds_read_b64_tr_b16 v[168:169], v8 offset:0
    ds_read_b64_tr_b16 v[170:171], v8 offset:2048
    s_waitcnt vmcnt(24)
    s_waitcnt lgkmcnt(12)
    v_mfma_f32_16x16x32_bf16 v[16:19], v[176:179], v[104:107], v[16:19]
    ds_read_b64_tr_b16 v[172:173], v8 offset:4096
    ds_read_b64_tr_b16 v[174:175], v8 offset:6144
    buffer_load_dwordx4 v[48:51], v9, s[36:39], 0 offen offset:0
    s_waitcnt vmcnt(23)
    s_waitcnt lgkmcnt(12)
    v_mfma_f32_16x16x32_bf16 v[16:19], v[180:183], v[112:115], v[16:19]
    s_waitcnt vmcnt(22)
    v_mfma_f32_16x16x32_bf16 v[20:23], v[180:183], v[116:119], v[20:23]
    buffer_load_dwordx4 v[52:55], v9, s[36:39], s8 offen offset:0
    v_mfma_f32_16x16x32_bf16 v[20:23], v[176:179], v[108:111], v[20:23]
    ds_read_b64_tr_b16 v[176:177], v4 offset:8192
    ds_read_b64_tr_b16 v[178:179], v4 offset:10240
    ds_read_b64_tr_b16 v[180:181], v4 offset:12288
    ds_read_b64_tr_b16 v[182:183], v4 offset:14336
    s_waitcnt lgkmcnt(14)
    v_mfma_f32_16x16x32_bf16 v[24:27], v[184:187], v[104:107], v[24:27]
    buffer_load_dwordx4 v[56:59], v9, s[36:39], 0 offen offset:1024
    s_waitcnt lgkmcnt(12)
    v_mfma_f32_16x16x32_bf16 v[24:27], v[188:191], v[112:115], v[24:27]
    v_mfma_f32_16x16x32_bf16 v[28:31], v[188:191], v[116:119], v[28:31]
    buffer_load_dwordx4 v[60:63], v9, s[36:39], s8 offen offset:1024
    v_mfma_f32_16x16x32_bf16 v[28:31], v[184:187], v[108:111], v[28:31]
    ds_read_b64_tr_b16 v[184:185], v5 offset:8192
    ds_read_b64_tr_b16 v[186:187], v5 offset:10240
    ds_read_b64_tr_b16 v[188:189], v5 offset:12288
    ds_read_b64_tr_b16 v[190:191], v5 offset:14336
    s_waitcnt lgkmcnt(14)
    v_mfma_f32_16x16x32_bf16 v[32:35], v[160:163], v[104:107], v[32:35]
    buffer_load_dwordx4 v[64:67], v9, s[36:39], 0 offen offset:2048
    s_waitcnt lgkmcnt(12)
    v_mfma_f32_16x16x32_bf16 v[32:35], v[164:167], v[112:115], v[32:35]
    v_mfma_f32_16x16x32_bf16 v[36:39], v[164:167], v[116:119], v[36:39]
    v_mfma_f32_16x16x32_bf16 v[36:39], v[160:163], v[108:111], v[36:39]
    ds_read_b64_tr_b16 v[160:161], v7 offset:8192
    ds_read_b64_tr_b16 v[162:163], v7 offset:10240
    ds_read_b64_tr_b16 v[164:165], v7 offset:12288
    ds_read_b64_tr_b16 v[166:167], v7 offset:14336
    buffer_load_dwordx4 v[68:71], v9, s[36:39], s8 offen offset:2048
    s_waitcnt lgkmcnt(14)
    v_mfma_f32_16x16x32_bf16 v[40:43], v[168:171], v[104:107], v[40:43]
    s_waitcnt lgkmcnt(12)
    v_mfma_f32_16x16x32_bf16 v[40:43], v[172:175], v[112:115], v[40:43]
    buffer_load_dwordx4 v[72:75], v9, s[36:39], 0 offen offset:3072
    v_mfma_f32_16x16x32_bf16 v[44:47], v[172:175], v[116:119], v[44:47]
    v_mfma_f32_16x16x32_bf16 v[44:47], v[168:171], v[108:111], v[44:47]
    ds_read_b64_tr_b16 v[168:169], v8 offset:8192
    ds_read_b64_tr_b16 v[170:171], v8 offset:10240
    ds_read_b64_tr_b16 v[172:173], v8 offset:12288
    ds_read_b64_tr_b16 v[174:175], v8 offset:14336
    buffer_load_dwordx4 v[76:79], v9, s[36:39], s8 offen offset:3072
    s_waitcnt vmcnt(28)
    s_waitcnt lgkmcnt(14)
    v_mfma_f32_16x16x32_bf16 v[16:19], v[176:179], v[120:123], v[16:19]
    s_waitcnt vmcnt(26)
    s_waitcnt lgkmcnt(12)
    v_mfma_f32_16x16x32_bf16 v[16:19], v[180:183], v[128:131], v[16:19]
    buffer_load_dwordx4 v[80:83], v9, s[36:39], s64 offen offset:0
    s_waitcnt vmcnt(26)
    v_mfma_f32_16x16x32_bf16 v[20:23], v[180:183], v[132:135], v[20:23]
    v_mfma_f32_16x16x32_bf16 v[20:23], v[176:179], v[124:127], v[20:23]
    ds_read_b64_tr_b16 v[176:177], v4 offset:16384
    ds_read_b64_tr_b16 v[178:179], v4 offset:18432
    ds_read_b64_tr_b16 v[180:181], v4 offset:20480
    ds_read_b64_tr_b16 v[182:183], v4 offset:22528
    s_waitcnt lgkmcnt(14)
    v_mfma_f32_16x16x32_bf16 v[24:27], v[184:187], v[120:123], v[24:27]
    buffer_load_dwordx4 v[84:87], v9, s[36:39], s9 offen offset:0
    s_waitcnt lgkmcnt(12)
    v_mfma_f32_16x16x32_bf16 v[24:27], v[188:191], v[128:131], v[24:27]
    v_mfma_f32_16x16x32_bf16 v[28:31], v[188:191], v[132:135], v[28:31]
    buffer_load_dwordx4 v[88:91], v9, s[36:39], s64 offen offset:1024
    v_mfma_f32_16x16x32_bf16 v[28:31], v[184:187], v[124:127], v[28:31]
    ds_read_b64_tr_b16 v[184:185], v4 offset:24576
    ds_read_b64_tr_b16 v[186:187], v4 offset:26624
    ds_read_b64_tr_b16 v[188:189], v5 offset:16384
    ds_read_b64_tr_b16 v[190:191], v5 offset:18432
    s_waitcnt lgkmcnt(14)
    v_mfma_f32_16x16x32_bf16 v[32:35], v[160:163], v[120:123], v[32:35]
    buffer_load_dwordx4 v[92:95], v9, s[36:39], s9 offen offset:1024
    s_waitcnt lgkmcnt(12)
    v_mfma_f32_16x16x32_bf16 v[32:35], v[164:167], v[128:131], v[32:35]
    v_mfma_f32_16x16x32_bf16 v[36:39], v[164:167], v[132:135], v[36:39]
    buffer_load_dwordx4 v[96:99], v9, s[36:39], s64 offen offset:2048
    v_mfma_f32_16x16x32_bf16 v[36:39], v[160:163], v[124:127], v[36:39]
    ds_read_b64_tr_b16 v[160:161], v5 offset:20480
    ds_read_b64_tr_b16 v[162:163], v5 offset:22528
    ds_read_b64_tr_b16 v[164:165], v5 offset:24576
    ds_read_b64_tr_b16 v[166:167], v5 offset:26624
    s_waitcnt lgkmcnt(14)
    v_mfma_f32_16x16x32_bf16 v[40:43], v[168:171], v[120:123], v[40:43]
    s_waitcnt lgkmcnt(12)
    v_mfma_f32_16x16x32_bf16 v[40:43], v[172:175], v[128:131], v[40:43]
    buffer_load_dwordx4 v[100:103], v9, s[36:39], s9 offen offset:2048
    v_add_u32 v9, 7168, v9
    v_mfma_f32_16x16x32_bf16 v[44:47], v[172:175], v[132:135], v[44:47]
    v_mfma_f32_16x16x32_bf16 v[44:47], v[168:171], v[124:127], v[44:47]
    ds_read_b64_tr_b16 v[168:169], v7 offset:16384
    ds_read_b64_tr_b16 v[170:171], v7 offset:18432
    ds_read_b64_tr_b16 v[172:173], v7 offset:20480
    ds_read_b64_tr_b16 v[174:175], v7 offset:22528
    s_add_u32 m0, s66, 28672
    s_nop 0
    buffer_load_dwordx4 v6, s[40:43], s56 offen offset:0 lds
    s_waitcnt vmcnt(31)
    s_waitcnt lgkmcnt(14)
    v_mfma_f32_16x16x32_bf16 v[16:19], v[176:179], v[136:139], v[16:19]
    s_waitcnt vmcnt(29)
    s_waitcnt lgkmcnt(12)
    v_mfma_f32_16x16x32_bf16 v[16:19], v[180:183], v[144:147], v[16:19]
    buffer_load_dwordx4 v6, s[40:43], s57 offen offset:1024 lds
    s_waitcnt vmcnt(28)
    s_waitcnt lgkmcnt(10)
    v_mfma_f32_16x16x32_bf16 v[16:19], v[184:187], v[152:155], v[16:19]
    s_waitcnt vmcnt(27)
    v_mfma_f32_16x16x32_bf16 v[20:23], v[184:187], v[156:159], v[20:23]
    buffer_load_dwordx4 v6, s[40:43], s58 offen offset:2048 lds
    v_mfma_f32_16x16x32_bf16 v[20:23], v[180:183], v[148:151], v[20:23]
    v_mfma_f32_16x16x32_bf16 v[20:23], v[176:179], v[140:143], v[20:23]
    ds_read_b64_tr_b16 v[176:177], v7 offset:24576
    ds_read_b64_tr_b16 v[178:179], v7 offset:26624
    ds_read_b64_tr_b16 v[180:181], v8 offset:16384
    ds_read_b64_tr_b16 v[182:183], v8 offset:18432
    s_waitcnt lgkmcnt(12)
    v_mfma_f32_16x16x32_bf16 v[24:27], v[188:191], v[136:139], v[24:27]
    ds_read_b64_tr_b16 v[184:185], v8 offset:20480
    ds_read_b64_tr_b16 v[186:187], v8 offset:22528
    buffer_load_dwordx4 v6, s[40:43], s59 offen offset:3072 lds
    s_waitcnt lgkmcnt(12)
    v_mfma_f32_16x16x32_bf16 v[24:27], v[160:163], v[144:147], v[24:27]
    s_waitcnt lgkmcnt(10)
    v_mfma_f32_16x16x32_bf16 v[24:27], v[164:167], v[152:155], v[24:27]
    s_add_u32 m0, s66, 32768
    s_nop 0
    buffer_load_dwordx4 v6, s[40:43], s60 offen offset:0 lds
    v_mfma_f32_16x16x32_bf16 v[28:31], v[164:167], v[156:159], v[28:31]
    v_mfma_f32_16x16x32_bf16 v[28:31], v[160:163], v[148:151], v[28:31]
    buffer_load_dwordx4 v6, s[40:43], s61 offen offset:1024 lds
    v_mfma_f32_16x16x32_bf16 v[28:31], v[188:191], v[140:143], v[28:31]
    ds_read_b64_tr_b16 v[188:189], v8 offset:24576
    ds_read_b64_tr_b16 v[190:191], v8 offset:26624
    s_waitcnt lgkmcnt(10)
    v_mfma_f32_16x16x32_bf16 v[32:35], v[168:171], v[136:139], v[32:35]
    buffer_load_dwordx4 v6, s[40:43], s62 offen offset:2048 lds
    v_add_u32 v6, 458752, v6
    s_waitcnt lgkmcnt(8)
    v_mfma_f32_16x16x32_bf16 v[32:35], v[172:175], v[144:147], v[32:35]
    s_waitcnt lgkmcnt(6)
    v_mfma_f32_16x16x32_bf16 v[32:35], v[176:179], v[152:155], v[32:35]
    v_mfma_f32_16x16x32_bf16 v[36:39], v[176:179], v[156:159], v[36:39]
    s_add_u32 m0, s31, 49152
    s_nop 0
    buffer_load_dwordx4 v2, s[12:15], 0 offen lds
    v_mfma_f32_16x16x32_bf16 v[36:39], v[172:175], v[148:151], v[36:39]
    s_waitcnt vmcnt(22) lgkmcnt(0)
    s_barrier
    v_subrev_u32 v4, 57344, v4
    v_subrev_u32 v5, 57344, v5
    v_subrev_u32 v7, 57344, v7
    v_subrev_u32 v8, 57344, v8
    v_mfma_f32_16x16x32_bf16 v[36:39], v[168:171], v[140:143], v[36:39]
    ds_read_b64_tr_b16 v[160:161], v4 offset:0
    ds_read_b64_tr_b16 v[162:163], v4 offset:2048
    ds_read_b64_tr_b16 v[164:165], v4 offset:4096
    ds_read_b64_tr_b16 v[166:167], v4 offset:6144
    buffer_load_dwordx4 v2, s[12:15], 0 offen offset:1024 lds
    v_mfma_f32_16x16x32_bf16 v[40:43], v[180:183], v[136:139], v[40:43]
    ds_read_b64_tr_b16 v[168:169], v5 offset:0
    ds_read_b64_tr_b16 v[170:171], v5 offset:2048
    ds_read_b64_tr_b16 v[172:173], v5 offset:4096
    ds_read_b64_tr_b16 v[174:175], v5 offset:6144
    v_mfma_f32_16x16x32_bf16 v[40:43], v[184:187], v[144:147], v[40:43]
    ds_read_b64_tr_b16 v[176:177], v7 offset:0
    ds_read_b64_tr_b16 v[178:179], v7 offset:2048
    s_add_u32 m0, s31, 57344
    s_nop 0
    buffer_load_dwordx4 v3, s[16:19], 0 offen lds
    v_mfma_f32_16x16x32_bf16 v[40:43], v[188:191], v[152:155], v[40:43]
    v_mfma_f32_16x16x32_bf16 v[44:47], v[188:191], v[156:159], v[44:47]
    buffer_load_dwordx4 v3, s[16:19], 0 offen offset:1024 lds
    v_add_u32 v2, 8192, v2
    v_add_u32 v3, 8192, v3
    v_mfma_f32_16x16x32_bf16 v[44:47], v[184:187], v[148:151], v[44:47]
    v_mfma_f32_16x16x32_bf16 v[44:47], v[180:183], v[140:143], v[44:47]
    ds_read_b64_tr_b16 v[180:181], v7 offset:4096
    ds_read_b64_tr_b16 v[182:183], v7 offset:6144
    ds_read_b64_tr_b16 v[184:185], v8 offset:0
    ds_read_b64_tr_b16 v[186:187], v8 offset:2048
    s_waitcnt vmcnt(24)
    s_waitcnt lgkmcnt(12)
    v_mfma_f32_16x16x32_bf16 v[16:19], v[160:163], v[48:51], v[16:19]
    ds_read_b64_tr_b16 v[188:189], v8 offset:4096
    ds_read_b64_tr_b16 v[190:191], v8 offset:6144
    buffer_load_dwordx4 v[104:107], v9, s[36:39], 0 offen offset:0
    s_waitcnt vmcnt(23)
    s_waitcnt lgkmcnt(12)
    v_mfma_f32_16x16x32_bf16 v[16:19], v[164:167], v[56:59], v[16:19]
    s_waitcnt vmcnt(22)
    v_mfma_f32_16x16x32_bf16 v[20:23], v[164:167], v[60:63], v[20:23]
    buffer_load_dwordx4 v[108:111], v9, s[36:39], s8 offen offset:0
    v_mfma_f32_16x16x32_bf16 v[20:23], v[160:163], v[52:55], v[20:23]
    ds_read_b64_tr_b16 v[160:161], v4 offset:8192
    ds_read_b64_tr_b16 v[162:163], v4 offset:10240
    ds_read_b64_tr_b16 v[164:165], v4 offset:12288
    ds_read_b64_tr_b16 v[166:167], v4 offset:14336
    s_waitcnt lgkmcnt(14)
    v_mfma_f32_16x16x32_bf16 v[24:27], v[168:171], v[48:51], v[24:27]
    buffer_load_dwordx4 v[112:115], v9, s[36:39], 0 offen offset:1024
    s_waitcnt lgkmcnt(12)
    v_mfma_f32_16x16x32_bf16 v[24:27], v[172:175], v[56:59], v[24:27]
    v_mfma_f32_16x16x32_bf16 v[28:31], v[172:175], v[60:63], v[28:31]
    buffer_load_dwordx4 v[116:119], v9, s[36:39], s8 offen offset:1024
    v_mfma_f32_16x16x32_bf16 v[28:31], v[168:171], v[52:55], v[28:31]
    ds_read_b64_tr_b16 v[168:169], v5 offset:8192
    ds_read_b64_tr_b16 v[170:171], v5 offset:10240
    ds_read_b64_tr_b16 v[172:173], v5 offset:12288
    ds_read_b64_tr_b16 v[174:175], v5 offset:14336
    s_waitcnt lgkmcnt(14)
    v_mfma_f32_16x16x32_bf16 v[32:35], v[176:179], v[48:51], v[32:35]
    buffer_load_dwordx4 v[120:123], v9, s[36:39], 0 offen offset:2048
    s_waitcnt lgkmcnt(12)
    v_mfma_f32_16x16x32_bf16 v[32:35], v[180:183], v[56:59], v[32:35]
    v_mfma_f32_16x16x32_bf16 v[36:39], v[180:183], v[60:63], v[36:39]
    v_mfma_f32_16x16x32_bf16 v[36:39], v[176:179], v[52:55], v[36:39]
    ds_read_b64_tr_b16 v[176:177], v7 offset:8192
    ds_read_b64_tr_b16 v[178:179], v7 offset:10240
    ds_read_b64_tr_b16 v[180:181], v7 offset:12288
    ds_read_b64_tr_b16 v[182:183], v7 offset:14336
    buffer_load_dwordx4 v[124:127], v9, s[36:39], s8 offen offset:2048
    s_waitcnt lgkmcnt(14)
    v_mfma_f32_16x16x32_bf16 v[40:43], v[184:187], v[48:51], v[40:43]
    s_waitcnt lgkmcnt(12)
    v_mfma_f32_16x16x32_bf16 v[40:43], v[188:191], v[56:59], v[40:43]
    buffer_load_dwordx4 v[128:131], v9, s[36:39], 0 offen offset:3072
    v_mfma_f32_16x16x32_bf16 v[44:47], v[188:191], v[60:63], v[44:47]
    v_mfma_f32_16x16x32_bf16 v[44:47], v[184:187], v[52:55], v[44:47]
    ds_read_b64_tr_b16 v[184:185], v8 offset:8192
    ds_read_b64_tr_b16 v[186:187], v8 offset:10240
    ds_read_b64_tr_b16 v[188:189], v8 offset:12288
    ds_read_b64_tr_b16 v[190:191], v8 offset:14336
    buffer_load_dwordx4 v[132:135], v9, s[36:39], s8 offen offset:3072
    s_waitcnt vmcnt(28)
    s_waitcnt lgkmcnt(14)
    v_mfma_f32_16x16x32_bf16 v[16:19], v[160:163], v[64:67], v[16:19]
    s_waitcnt vmcnt(26)
    s_waitcnt lgkmcnt(12)
    v_mfma_f32_16x16x32_bf16 v[16:19], v[164:167], v[72:75], v[16:19]
    buffer_load_dwordx4 v[136:139], v9, s[36:39], s64 offen offset:0
    s_waitcnt vmcnt(26)
    v_mfma_f32_16x16x32_bf16 v[20:23], v[164:167], v[76:79], v[20:23]
    v_mfma_f32_16x16x32_bf16 v[20:23], v[160:163], v[68:71], v[20:23]
    ds_read_b64_tr_b16 v[160:161], v4 offset:16384
    ds_read_b64_tr_b16 v[162:163], v4 offset:18432
    ds_read_b64_tr_b16 v[164:165], v4 offset:20480
    ds_read_b64_tr_b16 v[166:167], v4 offset:22528
    s_waitcnt lgkmcnt(14)
    v_mfma_f32_16x16x32_bf16 v[24:27], v[168:171], v[64:67], v[24:27]
    buffer_load_dwordx4 v[140:143], v9, s[36:39], s9 offen offset:0
    s_waitcnt lgkmcnt(12)
    v_mfma_f32_16x16x32_bf16 v[24:27], v[172:175], v[72:75], v[24:27]
    v_mfma_f32_16x16x32_bf16 v[28:31], v[172:175], v[76:79], v[28:31]
    buffer_load_dwordx4 v[144:147], v9, s[36:39], s64 offen offset:1024
    v_mfma_f32_16x16x32_bf16 v[28:31], v[168:171], v[68:71], v[28:31]
    ds_read_b64_tr_b16 v[168:169], v4 offset:24576
    ds_read_b64_tr_b16 v[170:171], v4 offset:26624
    ds_read_b64_tr_b16 v[172:173], v5 offset:16384
    ds_read_b64_tr_b16 v[174:175], v5 offset:18432
    s_waitcnt lgkmcnt(14)
    v_mfma_f32_16x16x32_bf16 v[32:35], v[176:179], v[64:67], v[32:35]
    buffer_load_dwordx4 v[148:151], v9, s[36:39], s9 offen offset:1024
    s_waitcnt lgkmcnt(12)
    v_mfma_f32_16x16x32_bf16 v[32:35], v[180:183], v[72:75], v[32:35]
    v_mfma_f32_16x16x32_bf16 v[36:39], v[180:183], v[76:79], v[36:39]
    buffer_load_dwordx4 v[152:155], v9, s[36:39], s64 offen offset:2048
    v_mfma_f32_16x16x32_bf16 v[36:39], v[176:179], v[68:71], v[36:39]
    ds_read_b64_tr_b16 v[176:177], v5 offset:20480
    ds_read_b64_tr_b16 v[178:179], v5 offset:22528
    ds_read_b64_tr_b16 v[180:181], v5 offset:24576
    ds_read_b64_tr_b16 v[182:183], v5 offset:26624
    s_waitcnt lgkmcnt(14)
    v_mfma_f32_16x16x32_bf16 v[40:43], v[184:187], v[64:67], v[40:43]
    s_waitcnt lgkmcnt(12)
    v_mfma_f32_16x16x32_bf16 v[40:43], v[188:191], v[72:75], v[40:43]
    buffer_load_dwordx4 v[156:159], v9, s[36:39], s9 offen offset:2048
    v_add_u32 v9, 7168, v9
    v_mfma_f32_16x16x32_bf16 v[44:47], v[188:191], v[76:79], v[44:47]
    v_mfma_f32_16x16x32_bf16 v[44:47], v[184:187], v[68:71], v[44:47]
    ds_read_b64_tr_b16 v[184:185], v7 offset:16384
    ds_read_b64_tr_b16 v[186:187], v7 offset:18432
    ds_read_b64_tr_b16 v[188:189], v7 offset:20480
    ds_read_b64_tr_b16 v[190:191], v7 offset:22528
    s_add_u32 m0, s66, 57344
    s_nop 0
    buffer_load_dwordx4 v6, s[40:43], s56 offen offset:0 lds
    s_waitcnt vmcnt(31)
    s_waitcnt lgkmcnt(14)
    v_mfma_f32_16x16x32_bf16 v[16:19], v[160:163], v[80:83], v[16:19]
    s_waitcnt vmcnt(29)
    s_waitcnt lgkmcnt(12)
    v_mfma_f32_16x16x32_bf16 v[16:19], v[164:167], v[88:91], v[16:19]
    buffer_load_dwordx4 v6, s[40:43], s57 offen offset:1024 lds
    s_waitcnt vmcnt(28)
    s_waitcnt lgkmcnt(10)
    v_mfma_f32_16x16x32_bf16 v[16:19], v[168:171], v[96:99], v[16:19]
    s_waitcnt vmcnt(27)
    v_mfma_f32_16x16x32_bf16 v[20:23], v[168:171], v[100:103], v[20:23]
    buffer_load_dwordx4 v6, s[40:43], s58 offen offset:2048 lds
    v_mfma_f32_16x16x32_bf16 v[20:23], v[164:167], v[92:95], v[20:23]
    v_mfma_f32_16x16x32_bf16 v[20:23], v[160:163], v[84:87], v[20:23]
    ds_read_b64_tr_b16 v[160:161], v7 offset:24576
    ds_read_b64_tr_b16 v[162:163], v7 offset:26624
    ds_read_b64_tr_b16 v[164:165], v8 offset:16384
    ds_read_b64_tr_b16 v[166:167], v8 offset:18432
    s_waitcnt lgkmcnt(12)
    v_mfma_f32_16x16x32_bf16 v[24:27], v[172:175], v[80:83], v[24:27]
    ds_read_b64_tr_b16 v[168:169], v8 offset:20480
    ds_read_b64_tr_b16 v[170:171], v8 offset:22528
    buffer_load_dwordx4 v6, s[40:43], s59 offen offset:3072 lds
    s_waitcnt lgkmcnt(12)
    v_mfma_f32_16x16x32_bf16 v[24:27], v[176:179], v[88:91], v[24:27]
    s_waitcnt lgkmcnt(10)
    v_mfma_f32_16x16x32_bf16 v[24:27], v[180:183], v[96:99], v[24:27]
    s_add_u32 m0, s66, 61440
    s_nop 0
    buffer_load_dwordx4 v6, s[40:43], s60 offen offset:0 lds
    v_mfma_f32_16x16x32_bf16 v[28:31], v[180:183], v[100:103], v[28:31]
    v_mfma_f32_16x16x32_bf16 v[28:31], v[176:179], v[92:95], v[28:31]
    buffer_load_dwordx4 v6, s[40:43], s61 offen offset:1024 lds
    v_mfma_f32_16x16x32_bf16 v[28:31], v[172:175], v[84:87], v[28:31]
    ds_read_b64_tr_b16 v[172:173], v8 offset:24576
    ds_read_b64_tr_b16 v[174:175], v8 offset:26624
    s_waitcnt lgkmcnt(10)
    v_mfma_f32_16x16x32_bf16 v[32:35], v[184:187], v[80:83], v[32:35]
    buffer_load_dwordx4 v6, s[40:43], s62 offen offset:2048 lds
    v_add_u32 v6, 458752, v6
    s_waitcnt lgkmcnt(8)
    v_mfma_f32_16x16x32_bf16 v[32:35], v[188:191], v[88:91], v[32:35]
    s_waitcnt lgkmcnt(6)
    v_mfma_f32_16x16x32_bf16 v[32:35], v[160:163], v[96:99], v[32:35]
    v_mfma_f32_16x16x32_bf16 v[36:39], v[160:163], v[100:103], v[36:39]
    s_add_u32 m0, s31, 0
    s_nop 0
    buffer_load_dwordx4 v2, s[12:15], 0 offen lds
    v_mfma_f32_16x16x32_bf16 v[36:39], v[188:191], v[92:95], v[36:39]
    s_waitcnt vmcnt(22) lgkmcnt(0)
    s_barrier
    v_add_u32 v4, 28672, v4
    v_add_u32 v5, 28672, v5
    v_add_u32 v7, 28672, v7
    v_add_u32 v8, 28672, v8
    v_mfma_f32_16x16x32_bf16 v[36:39], v[184:187], v[84:87], v[36:39]
    ds_read_b64_tr_b16 v[176:177], v4 offset:0
    ds_read_b64_tr_b16 v[178:179], v4 offset:2048
    ds_read_b64_tr_b16 v[180:181], v4 offset:4096
    ds_read_b64_tr_b16 v[182:183], v4 offset:6144
    buffer_load_dwordx4 v2, s[12:15], 0 offen offset:1024 lds
    v_mfma_f32_16x16x32_bf16 v[40:43], v[164:167], v[80:83], v[40:43]
    ds_read_b64_tr_b16 v[184:185], v5 offset:0
    ds_read_b64_tr_b16 v[186:187], v5 offset:2048
    ds_read_b64_tr_b16 v[188:189], v5 offset:4096
    ds_read_b64_tr_b16 v[190:191], v5 offset:6144
    v_mfma_f32_16x16x32_bf16 v[40:43], v[168:171], v[88:91], v[40:43]
    ds_read_b64_tr_b16 v[160:161], v7 offset:0
    ds_read_b64_tr_b16 v[162:163], v7 offset:2048
    s_add_u32 m0, s31, 8192
    s_nop 0
    buffer_load_dwordx4 v3, s[16:19], 0 offen lds
    v_mfma_f32_16x16x32_bf16 v[40:43], v[172:175], v[96:99], v[40:43]
    v_mfma_f32_16x16x32_bf16 v[44:47], v[172:175], v[100:103], v[44:47]
    buffer_load_dwordx4 v3, s[16:19], 0 offen offset:1024 lds
    v_add_u32 v2, 8192, v2
    v_add_u32 v3, 8192, v3
    v_mfma_f32_16x16x32_bf16 v[44:47], v[168:171], v[92:95], v[44:47]
    v_mfma_f32_16x16x32_bf16 v[44:47], v[164:167], v[84:87], v[44:47]
    ds_read_b64_tr_b16 v[164:165], v7 offset:4096
    ds_read_b64_tr_b16 v[166:167], v7 offset:6144
    ds_read_b64_tr_b16 v[168:169], v8 offset:0
    ds_read_b64_tr_b16 v[170:171], v8 offset:2048
    s_waitcnt vmcnt(24)
    s_waitcnt lgkmcnt(12)
    v_mfma_f32_16x16x32_bf16 v[16:19], v[176:179], v[104:107], v[16:19]
    ds_read_b64_tr_b16 v[172:173], v8 offset:4096
    ds_read_b64_tr_b16 v[174:175], v8 offset:6144
    buffer_load_dwordx4 v[48:51], v9, s[36:39], 0 offen offset:0
    s_waitcnt vmcnt(23)
    s_waitcnt lgkmcnt(12)
    v_mfma_f32_16x16x32_bf16 v[16:19], v[180:183], v[112:115], v[16:19]
    s_waitcnt vmcnt(22)
    v_mfma_f32_16x16x32_bf16 v[20:23], v[180:183], v[116:119], v[20:23]
    buffer_load_dwordx4 v[52:55], v9, s[36:39], s8 offen offset:0
    v_mfma_f32_16x16x32_bf16 v[20:23], v[176:179], v[108:111], v[20:23]
    ds_read_b64_tr_b16 v[176:177], v4 offset:8192
    ds_read_b64_tr_b16 v[178:179], v4 offset:10240
    ds_read_b64_tr_b16 v[180:181], v4 offset:12288
    ds_read_b64_tr_b16 v[182:183], v4 offset:14336
    s_waitcnt lgkmcnt(14)
    v_mfma_f32_16x16x32_bf16 v[24:27], v[184:187], v[104:107], v[24:27]
    buffer_load_dwordx4 v[56:59], v9, s[36:39], 0 offen offset:1024
    s_waitcnt lgkmcnt(12)
    v_mfma_f32_16x16x32_bf16 v[24:27], v[188:191], v[112:115], v[24:27]
    v_mfma_f32_16x16x32_bf16 v[28:31], v[188:191], v[116:119], v[28:31]
    buffer_load_dwordx4 v[60:63], v9, s[36:39], s8 offen offset:1024
    v_mfma_f32_16x16x32_bf16 v[28:31], v[184:187], v[108:111], v[28:31]
    ds_read_b64_tr_b16 v[184:185], v5 offset:8192
    ds_read_b64_tr_b16 v[186:187], v5 offset:10240
    ds_read_b64_tr_b16 v[188:189], v5 offset:12288
    ds_read_b64_tr_b16 v[190:191], v5 offset:14336
    s_waitcnt lgkmcnt(14)
    v_mfma_f32_16x16x32_bf16 v[32:35], v[160:163], v[104:107], v[32:35]
    buffer_load_dwordx4 v[64:67], v9, s[36:39], 0 offen offset:2048
    s_waitcnt lgkmcnt(12)
    v_mfma_f32_16x16x32_bf16 v[32:35], v[164:167], v[112:115], v[32:35]
    v_mfma_f32_16x16x32_bf16 v[36:39], v[164:167], v[116:119], v[36:39]
    v_mfma_f32_16x16x32_bf16 v[36:39], v[160:163], v[108:111], v[36:39]
    ds_read_b64_tr_b16 v[160:161], v7 offset:8192
    ds_read_b64_tr_b16 v[162:163], v7 offset:10240
    ds_read_b64_tr_b16 v[164:165], v7 offset:12288
    ds_read_b64_tr_b16 v[166:167], v7 offset:14336
    buffer_load_dwordx4 v[68:71], v9, s[36:39], s8 offen offset:2048
    s_waitcnt lgkmcnt(14)
    v_mfma_f32_16x16x32_bf16 v[40:43], v[168:171], v[104:107], v[40:43]
    s_waitcnt lgkmcnt(12)
    v_mfma_f32_16x16x32_bf16 v[40:43], v[172:175], v[112:115], v[40:43]
    buffer_load_dwordx4 v[72:75], v9, s[36:39], 0 offen offset:3072
    v_mfma_f32_16x16x32_bf16 v[44:47], v[172:175], v[116:119], v[44:47]
    v_mfma_f32_16x16x32_bf16 v[44:47], v[168:171], v[108:111], v[44:47]
    ds_read_b64_tr_b16 v[168:169], v8 offset:8192
    ds_read_b64_tr_b16 v[170:171], v8 offset:10240
    ds_read_b64_tr_b16 v[172:173], v8 offset:12288
    ds_read_b64_tr_b16 v[174:175], v8 offset:14336
    buffer_load_dwordx4 v[76:79], v9, s[36:39], s8 offen offset:3072
    s_waitcnt vmcnt(28)
    s_waitcnt lgkmcnt(14)
    v_mfma_f32_16x16x32_bf16 v[16:19], v[176:179], v[120:123], v[16:19]
    s_waitcnt vmcnt(26)
    s_waitcnt lgkmcnt(12)
    v_mfma_f32_16x16x32_bf16 v[16:19], v[180:183], v[128:131], v[16:19]
    buffer_load_dwordx4 v[80:83], v9, s[36:39], s64 offen offset:0
    s_waitcnt vmcnt(26)
    v_mfma_f32_16x16x32_bf16 v[20:23], v[180:183], v[132:135], v[20:23]
    v_mfma_f32_16x16x32_bf16 v[20:23], v[176:179], v[124:127], v[20:23]
    ds_read_b64_tr_b16 v[176:177], v4 offset:16384
    ds_read_b64_tr_b16 v[178:179], v4 offset:18432
    ds_read_b64_tr_b16 v[180:181], v4 offset:20480
    ds_read_b64_tr_b16 v[182:183], v4 offset:22528
    s_waitcnt lgkmcnt(14)
    v_mfma_f32_16x16x32_bf16 v[24:27], v[184:187], v[120:123], v[24:27]
    buffer_load_dwordx4 v[84:87], v9, s[36:39], s9 offen offset:0
    s_waitcnt lgkmcnt(12)
    v_mfma_f32_16x16x32_bf16 v[24:27], v[188:191], v[128:131], v[24:27]
    v_mfma_f32_16x16x32_bf16 v[28:31], v[188:191], v[132:135], v[28:31]
    buffer_load_dwordx4 v[88:91], v9, s[36:39], s64 offen offset:1024
    v_mfma_f32_16x16x32_bf16 v[28:31], v[184:187], v[124:127], v[28:31]
    ds_read_b64_tr_b16 v[184:185], v4 offset:24576
    ds_read_b64_tr_b16 v[186:187], v4 offset:26624
    ds_read_b64_tr_b16 v[188:189], v5 offset:16384
    ds_read_b64_tr_b16 v[190:191], v5 offset:18432
    s_waitcnt lgkmcnt(14)
    v_mfma_f32_16x16x32_bf16 v[32:35], v[160:163], v[120:123], v[32:35]
    buffer_load_dwordx4 v[92:95], v9, s[36:39], s9 offen offset:1024
    s_waitcnt lgkmcnt(12)
    v_mfma_f32_16x16x32_bf16 v[32:35], v[164:167], v[128:131], v[32:35]
    v_mfma_f32_16x16x32_bf16 v[36:39], v[164:167], v[132:135], v[36:39]
    buffer_load_dwordx4 v[96:99], v9, s[36:39], s64 offen offset:2048
    v_mfma_f32_16x16x32_bf16 v[36:39], v[160:163], v[124:127], v[36:39]
    ds_read_b64_tr_b16 v[160:161], v5 offset:20480
    ds_read_b64_tr_b16 v[162:163], v5 offset:22528
    ds_read_b64_tr_b16 v[164:165], v5 offset:24576
    ds_read_b64_tr_b16 v[166:167], v5 offset:26624
    s_waitcnt lgkmcnt(14)
    v_mfma_f32_16x16x32_bf16 v[40:43], v[168:171], v[120:123], v[40:43]
    s_waitcnt lgkmcnt(12)
    v_mfma_f32_16x16x32_bf16 v[40:43], v[172:175], v[128:131], v[40:43]
    buffer_load_dwordx4 v[100:103], v9, s[36:39], s9 offen offset:2048
    v_add_u32 v9, 7168, v9
    v_mfma_f32_16x16x32_bf16 v[44:47], v[172:175], v[132:135], v[44:47]
    v_mfma_f32_16x16x32_bf16 v[44:47], v[168:171], v[124:127], v[44:47]
    ds_read_b64_tr_b16 v[168:169], v7 offset:16384
    ds_read_b64_tr_b16 v[170:171], v7 offset:18432
    ds_read_b64_tr_b16 v[172:173], v7 offset:20480
    ds_read_b64_tr_b16 v[174:175], v7 offset:22528
    s_add_u32 m0, s66, 0
    s_nop 0
    buffer_load_dwordx4 v6, s[40:43], s56 offen offset:0 lds
    s_waitcnt vmcnt(31)
    s_waitcnt lgkmcnt(14)
    v_mfma_f32_16x16x32_bf16 v[16:19], v[176:179], v[136:139], v[16:19]
    s_waitcnt vmcnt(29)
    s_waitcnt lgkmcnt(12)
    v_mfma_f32_16x16x32_bf16 v[16:19], v[180:183], v[144:147], v[16:19]
    buffer_load_dwordx4 v6, s[40:43], s57 offen offset:1024 lds
    s_waitcnt vmcnt(28)
    s_waitcnt lgkmcnt(10)
    v_mfma_f32_16x16x32_bf16 v[16:19], v[184:187], v[152:155], v[16:19]
    s_waitcnt vmcnt(27)
    v_mfma_f32_16x16x32_bf16 v[20:23], v[184:187], v[156:159], v[20:23]
    buffer_load_dwordx4 v6, s[40:43], s58 offen offset:2048 lds
    v_mfma_f32_16x16x32_bf16 v[20:23], v[180:183], v[148:151], v[20:23]
    v_mfma_f32_16x16x32_bf16 v[20:23], v[176:179], v[140:143], v[20:23]
    ds_read_b64_tr_b16 v[176:177], v7 offset:24576
    ds_read_b64_tr_b16 v[178:179], v7 offset:26624
    ds_read_b64_tr_b16 v[180:181], v8 offset:16384
    ds_read_b64_tr_b16 v[182:183], v8 offset:18432
    s_waitcnt lgkmcnt(12)
    v_mfma_f32_16x16x32_bf16 v[24:27], v[188:191], v[136:139], v[24:27]
    ds_read_b64_tr_b16 v[184:185], v8 offset:20480
    ds_read_b64_tr_b16 v[186:187], v8 offset:22528
    buffer_load_dwordx4 v6, s[40:43], s59 offen offset:3072 lds
    s_waitcnt lgkmcnt(12)
    v_mfma_f32_16x16x32_bf16 v[24:27], v[160:163], v[144:147], v[24:27]
    s_waitcnt lgkmcnt(10)
    v_mfma_f32_16x16x32_bf16 v[24:27], v[164:167], v[152:155], v[24:27]
    s_add_u32 m0, s66, 4096
    s_nop 0
    buffer_load_dwordx4 v6, s[40:43], s60 offen offset:0 lds
    v_mfma_f32_16x16x32_bf16 v[28:31], v[164:167], v[156:159], v[28:31]
    v_mfma_f32_16x16x32_bf16 v[28:31], v[160:163], v[148:151], v[28:31]
    buffer_load_dwordx4 v6, s[40:43], s61 offen offset:1024 lds
    v_mfma_f32_16x16x32_bf16 v[28:31], v[188:191], v[140:143], v[28:31]
    ds_read_b64_tr_b16 v[188:189], v8 offset:24576
    ds_read_b64_tr_b16 v[190:191], v8 offset:26624
    s_waitcnt lgkmcnt(10)
    v_mfma_f32_16x16x32_bf16 v[32:35], v[168:171], v[136:139], v[32:35]
    buffer_load_dwordx4 v6, s[40:43], s62 offen offset:2048 lds
    v_add_u32 v6, 458752, v6
    s_waitcnt lgkmcnt(8)
    v_mfma_f32_16x16x32_bf16 v[32:35], v[172:175], v[144:147], v[32:35]
    s_waitcnt lgkmcnt(6)
    v_mfma_f32_16x16x32_bf16 v[32:35], v[176:179], v[152:155], v[32:35]
    v_mfma_f32_16x16x32_bf16 v[36:39], v[176:179], v[156:159], v[36:39]
    s_add_u32 m0, s31, 16384
    s_nop 0
    buffer_load_dwordx4 v2, s[12:15], 0 offen lds
    v_mfma_f32_16x16x32_bf16 v[36:39], v[172:175], v[148:151], v[36:39]
    s_waitcnt vmcnt(22) lgkmcnt(0)
    s_barrier
    v_add_u32 v4, 28672, v4
    v_add_u32 v5, 28672, v5
    v_add_u32 v7, 28672, v7
    v_add_u32 v8, 28672, v8
    v_mfma_f32_16x16x32_bf16 v[36:39], v[168:171], v[140:143], v[36:39]
    ds_read_b64_tr_b16 v[160:161], v4 offset:0
    ds_read_b64_tr_b16 v[162:163], v4 offset:2048
    ds_read_b64_tr_b16 v[164:165], v4 offset:4096
    ds_read_b64_tr_b16 v[166:167], v4 offset:6144
    buffer_load_dwordx4 v2, s[12:15], 0 offen offset:1024 lds
    v_mfma_f32_16x16x32_bf16 v[40:43], v[180:183], v[136:139], v[40:43]
    ds_read_b64_tr_b16 v[168:169], v5 offset:0
    ds_read_b64_tr_b16 v[170:171], v5 offset:2048
    ds_read_b64_tr_b16 v[172:173], v5 offset:4096
    ds_read_b64_tr_b16 v[174:175], v5 offset:6144
    v_mfma_f32_16x16x32_bf16 v[40:43], v[184:187], v[144:147], v[40:43]
    ds_read_b64_tr_b16 v[176:177], v7 offset:0
    ds_read_b64_tr_b16 v[178:179], v7 offset:2048
    s_add_u32 m0, s31, 24576
    s_nop 0
    buffer_load_dwordx4 v3, s[16:19], 0 offen lds
    v_mfma_f32_16x16x32_bf16 v[40:43], v[188:191], v[152:155], v[40:43]
    v_mfma_f32_16x16x32_bf16 v[44:47], v[188:191], v[156:159], v[44:47]
    buffer_load_dwordx4 v3, s[16:19], 0 offen offset:1024 lds
    v_add_u32 v2, 8192, v2
    v_add_u32 v3, 8192, v3
    v_mfma_f32_16x16x32_bf16 v[44:47], v[184:187], v[148:151], v[44:47]
    v_mfma_f32_16x16x32_bf16 v[44:47], v[180:183], v[140:143], v[44:47]
    ds_read_b64_tr_b16 v[180:181], v7 offset:4096
    ds_read_b64_tr_b16 v[182:183], v7 offset:6144
    ds_read_b64_tr_b16 v[184:185], v8 offset:0
    ds_read_b64_tr_b16 v[186:187], v8 offset:2048
    s_waitcnt vmcnt(24)
    s_waitcnt lgkmcnt(12)
    v_mfma_f32_16x16x32_bf16 v[16:19], v[160:163], v[48:51], v[16:19]
    ds_read_b64_tr_b16 v[188:189], v8 offset:4096
    ds_read_b64_tr_b16 v[190:191], v8 offset:6144
    buffer_load_dwordx4 v[104:107], v9, s[36:39], 0 offen offset:0
    s_waitcnt vmcnt(23)
    s_waitcnt lgkmcnt(12)
    v_mfma_f32_16x16x32_bf16 v[16:19], v[164:167], v[56:59], v[16:19]
    s_waitcnt vmcnt(22)
    v_mfma_f32_16x16x32_bf16 v[20:23], v[164:167], v[60:63], v[20:23]
    buffer_load_dwordx4 v[108:111], v9, s[36:39], s8 offen offset:0
    v_mfma_f32_16x16x32_bf16 v[20:23], v[160:163], v[52:55], v[20:23]
    ds_read_b64_tr_b16 v[160:161], v4 offset:8192
    ds_read_b64_tr_b16 v[162:163], v4 offset:10240
    ds_read_b64_tr_b16 v[164:165], v4 offset:12288
    ds_read_b64_tr_b16 v[166:167], v4 offset:14336
    s_waitcnt lgkmcnt(14)
    v_mfma_f32_16x16x32_bf16 v[24:27], v[168:171], v[48:51], v[24:27]
    buffer_load_dwordx4 v[112:115], v9, s[36:39], 0 offen offset:1024
    s_waitcnt lgkmcnt(12)
    v_mfma_f32_16x16x32_bf16 v[24:27], v[172:175], v[56:59], v[24:27]
    v_mfma_f32_16x16x32_bf16 v[28:31], v[172:175], v[60:63], v[28:31]
    buffer_load_dwordx4 v[116:119], v9, s[36:39], s8 offen offset:1024
    v_mfma_f32_16x16x32_bf16 v[28:31], v[168:171], v[52:55], v[28:31]
    ds_read_b64_tr_b16 v[168:169], v5 offset:8192
    ds_read_b64_tr_b16 v[170:171], v5 offset:10240
    ds_read_b64_tr_b16 v[172:173], v5 offset:12288
    ds_read_b64_tr_b16 v[174:175], v5 offset:14336
    s_waitcnt lgkmcnt(14)
    v_mfma_f32_16x16x32_bf16 v[32:35], v[176:179], v[48:51], v[32:35]
    buffer_load_dwordx4 v[120:123], v9, s[36:39], 0 offen offset:2048
    s_waitcnt lgkmcnt(12)
    v_mfma_f32_16x16x32_bf16 v[32:35], v[180:183], v[56:59], v[32:35]
    v_mfma_f32_16x16x32_bf16 v[36:39], v[180:183], v[60:63], v[36:39]
    v_mfma_f32_16x16x32_bf16 v[36:39], v[176:179], v[52:55], v[36:39]
    ds_read_b64_tr_b16 v[176:177], v7 offset:8192
    ds_read_b64_tr_b16 v[178:179], v7 offset:10240
    ds_read_b64_tr_b16 v[180:181], v7 offset:12288
    ds_read_b64_tr_b16 v[182:183], v7 offset:14336
    buffer_load_dwordx4 v[124:127], v9, s[36:39], s8 offen offset:2048
    s_waitcnt lgkmcnt(14)
    v_mfma_f32_16x16x32_bf16 v[40:43], v[184:187], v[48:51], v[40:43]
    s_waitcnt lgkmcnt(12)
    v_mfma_f32_16x16x32_bf16 v[40:43], v[188:191], v[56:59], v[40:43]
    buffer_load_dwordx4 v[128:131], v9, s[36:39], 0 offen offset:3072
    v_mfma_f32_16x16x32_bf16 v[44:47], v[188:191], v[60:63], v[44:47]
    v_mfma_f32_16x16x32_bf16 v[44:47], v[184:187], v[52:55], v[44:47]
    ds_read_b64_tr_b16 v[184:185], v8 offset:8192
    ds_read_b64_tr_b16 v[186:187], v8 offset:10240
    ds_read_b64_tr_b16 v[188:189], v8 offset:12288
    ds_read_b64_tr_b16 v[190:191], v8 offset:14336
    buffer_load_dwordx4 v[132:135], v9, s[36:39], s8 offen offset:3072
    s_waitcnt vmcnt(28)
    s_waitcnt lgkmcnt(14)
    v_mfma_f32_16x16x32_bf16 v[16:19], v[160:163], v[64:67], v[16:19]
    s_waitcnt vmcnt(26)
    s_waitcnt lgkmcnt(12)
    v_mfma_f32_16x16x32_bf16 v[16:19], v[164:167], v[72:75], v[16:19]
    buffer_load_dwordx4 v[136:139], v9, s[36:39], s64 offen offset:0
    s_waitcnt vmcnt(26)
    v_mfma_f32_16x16x32_bf16 v[20:23], v[164:167], v[76:79], v[20:23]
    v_mfma_f32_16x16x32_bf16 v[20:23], v[160:163], v[68:71], v[20:23]
    ds_read_b64_tr_b16 v[160:161], v4 offset:16384
    ds_read_b64_tr_b16 v[162:163], v4 offset:18432
    ds_read_b64_tr_b16 v[164:165], v4 offset:20480
    ds_read_b64_tr_b16 v[166:167], v4 offset:22528
    s_waitcnt lgkmcnt(14)
    v_mfma_f32_16x16x32_bf16 v[24:27], v[168:171], v[64:67], v[24:27]
    buffer_load_dwordx4 v[140:143], v9, s[36:39], s9 offen offset:0
    s_waitcnt lgkmcnt(12)
    v_mfma_f32_16x16x32_bf16 v[24:27], v[172:175], v[72:75], v[24:27]
    v_mfma_f32_16x16x32_bf16 v[28:31], v[172:175], v[76:79], v[28:31]
    buffer_load_dwordx4 v[144:147], v9, s[36:39], s64 offen offset:1024
    v_mfma_f32_16x16x32_bf16 v[28:31], v[168:171], v[68:71], v[28:31]
    ds_read_b64_tr_b16 v[168:169], v4 offset:24576
    ds_read_b64_tr_b16 v[170:171], v4 offset:26624
    ds_read_b64_tr_b16 v[172:173], v5 offset:16384
    ds_read_b64_tr_b16 v[174:175], v5 offset:18432
    s_waitcnt lgkmcnt(14)
    v_mfma_f32_16x16x32_bf16 v[32:35], v[176:179], v[64:67], v[32:35]
    buffer_load_dwordx4 v[148:151], v9, s[36:39], s9 offen offset:1024
    s_waitcnt lgkmcnt(12)
    v_mfma_f32_16x16x32_bf16 v[32:35], v[180:183], v[72:75], v[32:35]
    v_mfma_f32_16x16x32_bf16 v[36:39], v[180:183], v[76:79], v[36:39]
    buffer_load_dwordx4 v[152:155], v9, s[36:39], s64 offen offset:2048
    v_mfma_f32_16x16x32_bf16 v[36:39], v[176:179], v[68:71], v[36:39]
    ds_read_b64_tr_b16 v[176:177], v5 offset:20480
    ds_read_b64_tr_b16 v[178:179], v5 offset:22528
    ds_read_b64_tr_b16 v[180:181], v5 offset:24576
    ds_read_b64_tr_b16 v[182:183], v5 offset:26624
    s_waitcnt lgkmcnt(14)
    v_mfma_f32_16x16x32_bf16 v[40:43], v[184:187], v[64:67], v[40:43]
    s_waitcnt lgkmcnt(12)
    v_mfma_f32_16x16x32_bf16 v[40:43], v[188:191], v[72:75], v[40:43]
    buffer_load_dwordx4 v[156:159], v9, s[36:39], s9 offen offset:2048
    v_add_u32 v9, 7168, v9
    v_mfma_f32_16x16x32_bf16 v[44:47], v[188:191], v[76:79], v[44:47]
    v_mfma_f32_16x16x32_bf16 v[44:47], v[184:187], v[68:71], v[44:47]
    ds_read_b64_tr_b16 v[184:185], v7 offset:16384
    ds_read_b64_tr_b16 v[186:187], v7 offset:18432
    ds_read_b64_tr_b16 v[188:189], v7 offset:20480
    ds_read_b64_tr_b16 v[190:191], v7 offset:22528
    s_add_u32 m0, s66, 28672
    s_nop 0
    buffer_load_dwordx4 v6, s[40:43], s56 offen offset:0 lds
    s_waitcnt vmcnt(31)
    s_waitcnt lgkmcnt(14)
    v_mfma_f32_16x16x32_bf16 v[16:19], v[160:163], v[80:83], v[16:19]
    s_waitcnt vmcnt(29)
    s_waitcnt lgkmcnt(12)
    v_mfma_f32_16x16x32_bf16 v[16:19], v[164:167], v[88:91], v[16:19]
    buffer_load_dwordx4 v6, s[40:43], s57 offen offset:1024 lds
    s_waitcnt vmcnt(28)
    s_waitcnt lgkmcnt(10)
    v_mfma_f32_16x16x32_bf16 v[16:19], v[168:171], v[96:99], v[16:19]
    s_waitcnt vmcnt(27)
    v_mfma_f32_16x16x32_bf16 v[20:23], v[168:171], v[100:103], v[20:23]
    buffer_load_dwordx4 v6, s[40:43], s58 offen offset:2048 lds
    v_mfma_f32_16x16x32_bf16 v[20:23], v[164:167], v[92:95], v[20:23]
    v_mfma_f32_16x16x32_bf16 v[20:23], v[160:163], v[84:87], v[20:23]
    ds_read_b64_tr_b16 v[160:161], v7 offset:24576
    ds_read_b64_tr_b16 v[162:163], v7 offset:26624
    ds_read_b64_tr_b16 v[164:165], v8 offset:16384
    ds_read_b64_tr_b16 v[166:167], v8 offset:18432
    s_waitcnt lgkmcnt(12)
    v_mfma_f32_16x16x32_bf16 v[24:27], v[172:175], v[80:83], v[24:27]
    ds_read_b64_tr_b16 v[168:169], v8 offset:20480
    ds_read_b64_tr_b16 v[170:171], v8 offset:22528
    buffer_load_dwordx4 v6, s[40:43], s59 offen offset:3072 lds
    s_waitcnt lgkmcnt(12)
    v_mfma_f32_16x16x32_bf16 v[24:27], v[176:179], v[88:91], v[24:27]
    s_waitcnt lgkmcnt(10)
    v_mfma_f32_16x16x32_bf16 v[24:27], v[180:183], v[96:99], v[24:27]
    s_add_u32 m0, s66, 32768
    s_nop 0
    buffer_load_dwordx4 v6, s[40:43], s60 offen offset:0 lds
    v_mfma_f32_16x16x32_bf16 v[28:31], v[180:183], v[100:103], v[28:31]
    v_mfma_f32_16x16x32_bf16 v[28:31], v[176:179], v[92:95], v[28:31]
    buffer_load_dwordx4 v6, s[40:43], s61 offen offset:1024 lds
    v_mfma_f32_16x16x32_bf16 v[28:31], v[172:175], v[84:87], v[28:31]
    ds_read_b64_tr_b16 v[172:173], v8 offset:24576
    ds_read_b64_tr_b16 v[174:175], v8 offset:26624
    s_waitcnt lgkmcnt(10)
    v_mfma_f32_16x16x32_bf16 v[32:35], v[184:187], v[80:83], v[32:35]
    buffer_load_dwordx4 v6, s[40:43], s62 offen offset:2048 lds
    v_add_u32 v6, 458752, v6
    s_waitcnt lgkmcnt(8)
    v_mfma_f32_16x16x32_bf16 v[32:35], v[188:191], v[88:91], v[32:35]
    s_waitcnt lgkmcnt(6)
    v_mfma_f32_16x16x32_bf16 v[32:35], v[160:163], v[96:99], v[32:35]
    v_mfma_f32_16x16x32_bf16 v[36:39], v[160:163], v[100:103], v[36:39]
    s_add_u32 m0, s31, 32768
    s_nop 0
    buffer_load_dwordx4 v2, s[12:15], 0 offen lds
    v_mfma_f32_16x16x32_bf16 v[36:39], v[188:191], v[92:95], v[36:39]
    s_waitcnt vmcnt(22) lgkmcnt(0)
    s_barrier
    v_subrev_u32 v4, 57344, v4
    v_subrev_u32 v5, 57344, v5
    v_subrev_u32 v7, 57344, v7
    v_subrev_u32 v8, 57344, v8
    v_mfma_f32_16x16x32_bf16 v[36:39], v[184:187], v[84:87], v[36:39]
    ds_read_b64_tr_b16 v[176:177], v4 offset:0
    ds_read_b64_tr_b16 v[178:179], v4 offset:2048
    ds_read_b64_tr_b16 v[180:181], v4 offset:4096
    ds_read_b64_tr_b16 v[182:183], v4 offset:6144
    buffer_load_dwordx4 v2, s[12:15], 0 offen offset:1024 lds
    v_mfma_f32_16x16x32_bf16 v[40:43], v[164:167], v[80:83], v[40:43]
    ds_read_b64_tr_b16 v[184:185], v5 offset:0
    ds_read_b64_tr_b16 v[186:187], v5 offset:2048
    ds_read_b64_tr_b16 v[188:189], v5 offset:4096
    ds_read_b64_tr_b16 v[190:191], v5 offset:6144
    v_mfma_f32_16x16x32_bf16 v[40:43], v[168:171], v[88:91], v[40:43]
    ds_read_b64_tr_b16 v[160:161], v7 offset:0
    ds_read_b64_tr_b16 v[162:163], v7 offset:2048
    s_add_u32 m0, s31, 40960
    s_nop 0
    buffer_load_dwordx4 v3, s[16:19], 0 offen lds
    v_mfma_f32_16x16x32_bf16 v[40:43], v[172:175], v[96:99], v[40:43]
    v_mfma_f32_16x16x32_bf16 v[44:47], v[172:175], v[100:103], v[44:47]
    buffer_load_dwordx4 v3, s[16:19], 0 offen offset:1024 lds
    v_add_u32 v2, 8192, v2
    v_add_u32 v3, 8192, v3
    v_mfma_f32_16x16x32_bf16 v[44:47], v[168:171], v[92:95], v[44:47]
    v_mfma_f32_16x16x32_bf16 v[44:47], v[164:167], v[84:87], v[44:47]
    ds_read_b64_tr_b16 v[164:165], v7 offset:4096
    ds_read_b64_tr_b16 v[166:167], v7 offset:6144
    ds_read_b64_tr_b16 v[168:169], v8 offset:0
    ds_read_b64_tr_b16 v[170:171], v8 offset:2048
    s_waitcnt vmcnt(24)
    s_waitcnt lgkmcnt(12)
    v_mfma_f32_16x16x32_bf16 v[16:19], v[176:179], v[104:107], v[16:19]
    ds_read_b64_tr_b16 v[172:173], v8 offset:4096
    ds_read_b64_tr_b16 v[174:175], v8 offset:6144
    buffer_load_dwordx4 v[48:51], v9, s[36:39], 0 offen offset:0
    s_waitcnt vmcnt(23)
    s_waitcnt lgkmcnt(12)
    v_mfma_f32_16x16x32_bf16 v[16:19], v[180:183], v[112:115], v[16:19]
    s_waitcnt vmcnt(22)
    v_mfma_f32_16x16x32_bf16 v[20:23], v[180:183], v[116:119], v[20:23]
    buffer_load_dwordx4 v[52:55], v9, s[36:39], s8 offen offset:0
    v_mfma_f32_16x16x32_bf16 v[20:23], v[176:179], v[108:111], v[20:23]
    ds_read_b64_tr_b16 v[176:177], v4 offset:8192
    ds_read_b64_tr_b16 v[178:179], v4 offset:10240
    ds_read_b64_tr_b16 v[180:181], v4 offset:12288
    ds_read_b64_tr_b16 v[182:183], v4 offset:14336
    s_waitcnt lgkmcnt(14)
    v_mfma_f32_16x16x32_bf16 v[24:27], v[184:187], v[104:107], v[24:27]
    buffer_load_dwordx4 v[56:59], v9, s[36:39], 0 offen offset:1024
    s_waitcnt lgkmcnt(12)
    v_mfma_f32_16x16x32_bf16 v[24:27], v[188:191], v[112:115], v[24:27]
    v_mfma_f32_16x16x32_bf16 v[28:31], v[188:191], v[116:119], v[28:31]
    buffer_load_dwordx4 v[60:63], v9, s[36:39], s8 offen offset:1024
    v_mfma_f32_16x16x32_bf16 v[28:31], v[184:187], v[108:111], v[28:31]
    ds_read_b64_tr_b16 v[184:185], v5 offset:8192
    ds_read_b64_tr_b16 v[186:187], v5 offset:10240
    ds_read_b64_tr_b16 v[188:189], v5 offset:12288
    ds_read_b64_tr_b16 v[190:191], v5 offset:14336
    s_waitcnt lgkmcnt(14)
    v_mfma_f32_16x16x32_bf16 v[32:35], v[160:163], v[104:107], v[32:35]
    buffer_load_dwordx4 v[64:67], v9, s[36:39], 0 offen offset:2048
    s_waitcnt lgkmcnt(12)
    v_mfma_f32_16x16x32_bf16 v[32:35], v[164:167], v[112:115], v[32:35]
    v_mfma_f32_16x16x32_bf16 v[36:39], v[164:167], v[116:119], v[36:39]
    v_mfma_f32_16x16x32_bf16 v[36:39], v[160:163], v[108:111], v[36:39]
    ds_read_b64_tr_b16 v[160:161], v7 offset:8192
    ds_read_b64_tr_b16 v[162:163], v7 offset:10240
    ds_read_b64_tr_b16 v[164:165], v7 offset:12288
    ds_read_b64_tr_b16 v[166:167], v7 offset:14336
    buffer_load_dwordx4 v[68:71], v9, s[36:39], s8 offen offset:2048
    s_waitcnt lgkmcnt(14)
    v_mfma_f32_16x16x32_bf16 v[40:43], v[168:171], v[104:107], v[40:43]
    s_waitcnt lgkmcnt(12)
    v_mfma_f32_16x16x32_bf16 v[40:43], v[172:175], v[112:115], v[40:43]
    buffer_load_dwordx4 v[72:75], v9, s[36:39], 0 offen offset:3072
    v_mfma_f32_16x16x32_bf16 v[44:47], v[172:175], v[116:119], v[44:47]
    v_mfma_f32_16x16x32_bf16 v[44:47], v[168:171], v[108:111], v[44:47]
    ds_read_b64_tr_b16 v[168:169], v8 offset:8192
    ds_read_b64_tr_b16 v[170:171], v8 offset:10240
    ds_read_b64_tr_b16 v[172:173], v8 offset:12288
    ds_read_b64_tr_b16 v[174:175], v8 offset:14336
    buffer_load_dwordx4 v[76:79], v9, s[36:39], s8 offen offset:3072
    s_waitcnt vmcnt(28)
    s_waitcnt lgkmcnt(14)
    v_mfma_f32_16x16x32_bf16 v[16:19], v[176:179], v[120:123], v[16:19]
    s_waitcnt vmcnt(26)
    s_waitcnt lgkmcnt(12)
    v_mfma_f32_16x16x32_bf16 v[16:19], v[180:183], v[128:131], v[16:19]
    buffer_load_dwordx4 v[80:83], v9, s[36:39], s64 offen offset:0
    s_waitcnt vmcnt(26)
    v_mfma_f32_16x16x32_bf16 v[20:23], v[180:183], v[132:135], v[20:23]
    v_mfma_f32_16x16x32_bf16 v[20:23], v[176:179], v[124:127], v[20:23]
    ds_read_b64_tr_b16 v[176:177], v4 offset:16384
    ds_read_b64_tr_b16 v[178:179], v4 offset:18432
    ds_read_b64_tr_b16 v[180:181], v4 offset:20480
    ds_read_b64_tr_b16 v[182:183], v4 offset:22528
    s_waitcnt lgkmcnt(14)
    v_mfma_f32_16x16x32_bf16 v[24:27], v[184:187], v[120:123], v[24:27]
    buffer_load_dwordx4 v[84:87], v9, s[36:39], s9 offen offset:0
    s_waitcnt lgkmcnt(12)
    v_mfma_f32_16x16x32_bf16 v[24:27], v[188:191], v[128:131], v[24:27]
    v_mfma_f32_16x16x32_bf16 v[28:31], v[188:191], v[132:135], v[28:31]
    buffer_load_dwordx4 v[88:91], v9, s[36:39], s64 offen offset:1024
    v_mfma_f32_16x16x32_bf16 v[28:31], v[184:187], v[124:127], v[28:31]
    ds_read_b64_tr_b16 v[184:185], v4 offset:24576
    ds_read_b64_tr_b16 v[186:187], v4 offset:26624
    ds_read_b64_tr_b16 v[188:189], v5 offset:16384
    ds_read_b64_tr_b16 v[190:191], v5 offset:18432
    s_waitcnt lgkmcnt(14)
    v_mfma_f32_16x16x32_bf16 v[32:35], v[160:163], v[120:123], v[32:35]
    buffer_load_dwordx4 v[92:95], v9, s[36:39], s9 offen offset:1024
    s_waitcnt lgkmcnt(12)
    v_mfma_f32_16x16x32_bf16 v[32:35], v[164:167], v[128:131], v[32:35]
    v_mfma_f32_16x16x32_bf16 v[36:39], v[164:167], v[132:135], v[36:39]
    buffer_load_dwordx4 v[96:99], v9, s[36:39], s64 offen offset:2048
    v_mfma_f32_16x16x32_bf16 v[36:39], v[160:163], v[124:127], v[36:39]
    ds_read_b64_tr_b16 v[160:161], v5 offset:20480
    ds_read_b64_tr_b16 v[162:163], v5 offset:22528
    ds_read_b64_tr_b16 v[164:165], v5 offset:24576
    ds_read_b64_tr_b16 v[166:167], v5 offset:26624
    s_waitcnt lgkmcnt(14)
    v_mfma_f32_16x16x32_bf16 v[40:43], v[168:171], v[120:123], v[40:43]
    s_waitcnt lgkmcnt(12)
    v_mfma_f32_16x16x32_bf16 v[40:43], v[172:175], v[128:131], v[40:43]
    buffer_load_dwordx4 v[100:103], v9, s[36:39], s9 offen offset:2048
    v_add_u32 v9, 7168, v9
    v_mfma_f32_16x16x32_bf16 v[44:47], v[172:175], v[132:135], v[44:47]
    v_mfma_f32_16x16x32_bf16 v[44:47], v[168:171], v[124:127], v[44:47]
    ds_read_b64_tr_b16 v[168:169], v7 offset:16384
    ds_read_b64_tr_b16 v[170:171], v7 offset:18432
    ds_read_b64_tr_b16 v[172:173], v7 offset:20480
    ds_read_b64_tr_b16 v[174:175], v7 offset:22528
    s_add_u32 m0, s66, 57344
    s_nop 0
    buffer_load_dwordx4 v6, s[40:43], s56 offen offset:0 lds
    s_waitcnt vmcnt(31)
    s_waitcnt lgkmcnt(14)
    v_mfma_f32_16x16x32_bf16 v[16:19], v[176:179], v[136:139], v[16:19]
    s_waitcnt vmcnt(29)
    s_waitcnt lgkmcnt(12)
    v_mfma_f32_16x16x32_bf16 v[16:19], v[180:183], v[144:147], v[16:19]
    buffer_load_dwordx4 v6, s[40:43], s57 offen offset:1024 lds
    s_waitcnt vmcnt(28)
    s_waitcnt lgkmcnt(10)
    v_mfma_f32_16x16x32_bf16 v[16:19], v[184:187], v[152:155], v[16:19]
    s_waitcnt vmcnt(27)
    v_mfma_f32_16x16x32_bf16 v[20:23], v[184:187], v[156:159], v[20:23]
    buffer_load_dwordx4 v6, s[40:43], s58 offen offset:2048 lds
    v_mfma_f32_16x16x32_bf16 v[20:23], v[180:183], v[148:151], v[20:23]
    v_mfma_f32_16x16x32_bf16 v[20:23], v[176:179], v[140:143], v[20:23]
    ds_read_b64_tr_b16 v[176:177], v7 offset:24576
    ds_read_b64_tr_b16 v[178:179], v7 offset:26624
    ds_read_b64_tr_b16 v[180:181], v8 offset:16384
    ds_read_b64_tr_b16 v[182:183], v8 offset:18432
    s_waitcnt lgkmcnt(12)
    v_mfma_f32_16x16x32_bf16 v[24:27], v[188:191], v[136:139], v[24:27]
    ds_read_b64_tr_b16 v[184:185], v8 offset:20480
    ds_read_b64_tr_b16 v[186:187], v8 offset:22528
    buffer_load_dwordx4 v6, s[40:43], s59 offen offset:3072 lds
    s_waitcnt lgkmcnt(12)
    v_mfma_f32_16x16x32_bf16 v[24:27], v[160:163], v[144:147], v[24:27]
    s_waitcnt lgkmcnt(10)
    v_mfma_f32_16x16x32_bf16 v[24:27], v[164:167], v[152:155], v[24:27]
    s_add_u32 m0, s66, 61440
    s_nop 0
    buffer_load_dwordx4 v6, s[40:43], s60 offen offset:0 lds
    v_mfma_f32_16x16x32_bf16 v[28:31], v[164:167], v[156:159], v[28:31]
    v_mfma_f32_16x16x32_bf16 v[28:31], v[160:163], v[148:151], v[28:31]
    buffer_load_dwordx4 v6, s[40:43], s61 offen offset:1024 lds
    v_mfma_f32_16x16x32_bf16 v[28:31], v[188:191], v[140:143], v[28:31]
    ds_read_b64_tr_b16 v[188:189], v8 offset:24576
    ds_read_b64_tr_b16 v[190:191], v8 offset:26624
    s_waitcnt lgkmcnt(10)
    v_mfma_f32_16x16x32_bf16 v[32:35], v[168:171], v[136:139], v[32:35]
    buffer_load_dwordx4 v6, s[40:43], s62 offen offset:2048 lds
    v_add_u32 v6, 458752, v6
    s_waitcnt lgkmcnt(8)
    v_mfma_f32_16x16x32_bf16 v[32:35], v[172:175], v[144:147], v[32:35]
    s_waitcnt lgkmcnt(6)
    v_mfma_f32_16x16x32_bf16 v[32:35], v[176:179], v[152:155], v[32:35]
    v_mfma_f32_16x16x32_bf16 v[36:39], v[176:179], v[156:159], v[36:39]
    s_add_u32 m0, s31, 49152
    s_nop 0
    buffer_load_dwordx4 v2, s[12:15], 0 offen lds
    v_mfma_f32_16x16x32_bf16 v[36:39], v[172:175], v[148:151], v[36:39]
    s_waitcnt vmcnt(22) lgkmcnt(0)
    s_barrier
    v_add_u32 v4, 28672, v4
    v_add_u32 v5, 28672, v5
    v_add_u32 v7, 28672, v7
    v_add_u32 v8, 28672, v8
    v_mfma_f32_16x16x32_bf16 v[36:39], v[168:171], v[140:143], v[36:39]
    ds_read_b64_tr_b16 v[160:161], v4 offset:0
    ds_read_b64_tr_b16 v[162:163], v4 offset:2048
    ds_read_b64_tr_b16 v[164:165], v4 offset:4096
    ds_read_b64_tr_b16 v[166:167], v4 offset:6144
    buffer_load_dwordx4 v2, s[12:15], 0 offen offset:1024 lds
    v_mfma_f32_16x16x32_bf16 v[40:43], v[180:183], v[136:139], v[40:43]
    ds_read_b64_tr_b16 v[168:169], v5 offset:0
    ds_read_b64_tr_b16 v[170:171], v5 offset:2048
    ds_read_b64_tr_b16 v[172:173], v5 offset:4096
    ds_read_b64_tr_b16 v[174:175], v5 offset:6144
    v_mfma_f32_16x16x32_bf16 v[40:43], v[184:187], v[144:147], v[40:43]
    ds_read_b64_tr_b16 v[176:177], v7 offset:0
    ds_read_b64_tr_b16 v[178:179], v7 offset:2048
    s_add_u32 m0, s31, 57344
    s_nop 0
    buffer_load_dwordx4 v3, s[16:19], 0 offen lds
    v_mfma_f32_16x16x32_bf16 v[40:43], v[188:191], v[152:155], v[40:43]
    v_mfma_f32_16x16x32_bf16 v[44:47], v[188:191], v[156:159], v[44:47]
    buffer_load_dwordx4 v3, s[16:19], 0 offen offset:1024 lds
    v_add_u32 v2, 8192, v2
    v_add_u32 v3, 8192, v3
    v_mfma_f32_16x16x32_bf16 v[44:47], v[184:187], v[148:151], v[44:47]
    v_mfma_f32_16x16x32_bf16 v[44:47], v[180:183], v[140:143], v[44:47]
    ds_read_b64_tr_b16 v[180:181], v7 offset:4096
    ds_read_b64_tr_b16 v[182:183], v7 offset:6144
    ds_read_b64_tr_b16 v[184:185], v8 offset:0
    ds_read_b64_tr_b16 v[186:187], v8 offset:2048
    s_waitcnt vmcnt(24)
    s_waitcnt lgkmcnt(12)
    v_mfma_f32_16x16x32_bf16 v[16:19], v[160:163], v[48:51], v[16:19]
    ds_read_b64_tr_b16 v[188:189], v8 offset:4096
    ds_read_b64_tr_b16 v[190:191], v8 offset:6144
    buffer_load_dwordx4 v[104:107], v9, s[36:39], 0 offen offset:0
    s_waitcnt vmcnt(23)
    s_waitcnt lgkmcnt(12)
    v_mfma_f32_16x16x32_bf16 v[16:19], v[164:167], v[56:59], v[16:19]
    s_waitcnt vmcnt(22)
    v_mfma_f32_16x16x32_bf16 v[20:23], v[164:167], v[60:63], v[20:23]
    buffer_load_dwordx4 v[108:111], v9, s[36:39], s8 offen offset:0
    v_mfma_f32_16x16x32_bf16 v[20:23], v[160:163], v[52:55], v[20:23]
    ds_read_b64_tr_b16 v[160:161], v4 offset:8192
    ds_read_b64_tr_b16 v[162:163], v4 offset:10240
    ds_read_b64_tr_b16 v[164:165], v4 offset:12288
    ds_read_b64_tr_b16 v[166:167], v4 offset:14336
    s_waitcnt lgkmcnt(14)
    v_mfma_f32_16x16x32_bf16 v[24:27], v[168:171], v[48:51], v[24:27]
    buffer_load_dwordx4 v[112:115], v9, s[36:39], 0 offen offset:1024
    s_waitcnt lgkmcnt(12)
    v_mfma_f32_16x16x32_bf16 v[24:27], v[172:175], v[56:59], v[24:27]
    v_mfma_f32_16x16x32_bf16 v[28:31], v[172:175], v[60:63], v[28:31]
    buffer_load_dwordx4 v[116:119], v9, s[36:39], s8 offen offset:1024
    v_mfma_f32_16x16x32_bf16 v[28:31], v[168:171], v[52:55], v[28:31]
    ds_read_b64_tr_b16 v[168:169], v5 offset:8192
    ds_read_b64_tr_b16 v[170:171], v5 offset:10240
    ds_read_b64_tr_b16 v[172:173], v5 offset:12288
    ds_read_b64_tr_b16 v[174:175], v5 offset:14336
    s_waitcnt lgkmcnt(14)
    v_mfma_f32_16x16x32_bf16 v[32:35], v[176:179], v[48:51], v[32:35]
    buffer_load_dwordx4 v[120:123], v9, s[36:39], 0 offen offset:2048
    s_waitcnt lgkmcnt(12)
    v_mfma_f32_16x16x32_bf16 v[32:35], v[180:183], v[56:59], v[32:35]
    v_mfma_f32_16x16x32_bf16 v[36:39], v[180:183], v[60:63], v[36:39]
    v_mfma_f32_16x16x32_bf16 v[36:39], v[176:179], v[52:55], v[36:39]
    ds_read_b64_tr_b16 v[176:177], v7 offset:8192
    ds_read_b64_tr_b16 v[178:179], v7 offset:10240
    ds_read_b64_tr_b16 v[180:181], v7 offset:12288
    ds_read_b64_tr_b16 v[182:183], v7 offset:14336
    buffer_load_dwordx4 v[124:127], v9, s[36:39], s8 offen offset:2048
    s_waitcnt lgkmcnt(14)
    v_mfma_f32_16x16x32_bf16 v[40:43], v[184:187], v[48:51], v[40:43]
    s_waitcnt lgkmcnt(12)
    v_mfma_f32_16x16x32_bf16 v[40:43], v[188:191], v[56:59], v[40:43]
    buffer_load_dwordx4 v[128:131], v9, s[36:39], 0 offen offset:3072
    v_mfma_f32_16x16x32_bf16 v[44:47], v[188:191], v[60:63], v[44:47]
    v_mfma_f32_16x16x32_bf16 v[44:47], v[184:187], v[52:55], v[44:47]
    ds_read_b64_tr_b16 v[184:185], v8 offset:8192
    ds_read_b64_tr_b16 v[186:187], v8 offset:10240
    ds_read_b64_tr_b16 v[188:189], v8 offset:12288
    ds_read_b64_tr_b16 v[190:191], v8 offset:14336
    buffer_load_dwordx4 v[132:135], v9, s[36:39], s8 offen offset:3072
    s_waitcnt vmcnt(28)
    s_waitcnt lgkmcnt(14)
    v_mfma_f32_16x16x32_bf16 v[16:19], v[160:163], v[64:67], v[16:19]
    s_waitcnt vmcnt(26)
    s_waitcnt lgkmcnt(12)
    v_mfma_f32_16x16x32_bf16 v[16:19], v[164:167], v[72:75], v[16:19]
    buffer_load_dwordx4 v[136:139], v9, s[36:39], s64 offen offset:0
    s_waitcnt vmcnt(26)
    v_mfma_f32_16x16x32_bf16 v[20:23], v[164:167], v[76:79], v[20:23]
    v_mfma_f32_16x16x32_bf16 v[20:23], v[160:163], v[68:71], v[20:23]
    ds_read_b64_tr_b16 v[160:161], v4 offset:16384
    ds_read_b64_tr_b16 v[162:163], v4 offset:18432
    ds_read_b64_tr_b16 v[164:165], v4 offset:20480
    ds_read_b64_tr_b16 v[166:167], v4 offset:22528
    s_waitcnt lgkmcnt(14)
    v_mfma_f32_16x16x32_bf16 v[24:27], v[168:171], v[64:67], v[24:27]
    buffer_load_dwordx4 v[140:143], v9, s[36:39], s9 offen offset:0
    s_waitcnt lgkmcnt(12)
    v_mfma_f32_16x16x32_bf16 v[24:27], v[172:175], v[72:75], v[24:27]
    v_mfma_f32_16x16x32_bf16 v[28:31], v[172:175], v[76:79], v[28:31]
    buffer_load_dwordx4 v[144:147], v9, s[36:39], s64 offen offset:1024
    v_mfma_f32_16x16x32_bf16 v[28:31], v[168:171], v[68:71], v[28:31]
    ds_read_b64_tr_b16 v[168:169], v4 offset:24576
    ds_read_b64_tr_b16 v[170:171], v4 offset:26624
    ds_read_b64_tr_b16 v[172:173], v5 offset:16384
    ds_read_b64_tr_b16 v[174:175], v5 offset:18432
    s_waitcnt lgkmcnt(14)
    v_mfma_f32_16x16x32_bf16 v[32:35], v[176:179], v[64:67], v[32:35]
    buffer_load_dwordx4 v[148:151], v9, s[36:39], s9 offen offset:1024
    s_waitcnt lgkmcnt(12)
    v_mfma_f32_16x16x32_bf16 v[32:35], v[180:183], v[72:75], v[32:35]
    v_mfma_f32_16x16x32_bf16 v[36:39], v[180:183], v[76:79], v[36:39]
    buffer_load_dwordx4 v[152:155], v9, s[36:39], s64 offen offset:2048
    v_mfma_f32_16x16x32_bf16 v[36:39], v[176:179], v[68:71], v[36:39]
    ds_read_b64_tr_b16 v[176:177], v5 offset:20480
    ds_read_b64_tr_b16 v[178:179], v5 offset:22528
    ds_read_b64_tr_b16 v[180:181], v5 offset:24576
    ds_read_b64_tr_b16 v[182:183], v5 offset:26624
    s_waitcnt lgkmcnt(14)
    v_mfma_f32_16x16x32_bf16 v[40:43], v[184:187], v[64:67], v[40:43]
    s_waitcnt lgkmcnt(12)
    v_mfma_f32_16x16x32_bf16 v[40:43], v[188:191], v[72:75], v[40:43]
    buffer_load_dwordx4 v[156:159], v9, s[36:39], s9 offen offset:2048
    v_add_u32 v9, 7168, v9
    v_mfma_f32_16x16x32_bf16 v[44:47], v[188:191], v[76:79], v[44:47]
    v_mfma_f32_16x16x32_bf16 v[44:47], v[184:187], v[68:71], v[44:47]
    ds_read_b64_tr_b16 v[184:185], v7 offset:16384
    ds_read_b64_tr_b16 v[186:187], v7 offset:18432
    ds_read_b64_tr_b16 v[188:189], v7 offset:20480
    ds_read_b64_tr_b16 v[190:191], v7 offset:22528
    s_add_u32 m0, s66, 0
    s_nop 0
    buffer_load_dwordx4 v6, s[40:43], s56 offen offset:0 lds
    s_waitcnt vmcnt(31)
    s_waitcnt lgkmcnt(14)
    v_mfma_f32_16x16x32_bf16 v[16:19], v[160:163], v[80:83], v[16:19]
    s_waitcnt vmcnt(29)
    s_waitcnt lgkmcnt(12)
    v_mfma_f32_16x16x32_bf16 v[16:19], v[164:167], v[88:91], v[16:19]
    buffer_load_dwordx4 v6, s[40:43], s57 offen offset:1024 lds
    s_waitcnt vmcnt(28)
    s_waitcnt lgkmcnt(10)
    v_mfma_f32_16x16x32_bf16 v[16:19], v[168:171], v[96:99], v[16:19]
    s_waitcnt vmcnt(27)
    v_mfma_f32_16x16x32_bf16 v[20:23], v[168:171], v[100:103], v[20:23]
    buffer_load_dwordx4 v6, s[40:43], s58 offen offset:2048 lds
    v_mfma_f32_16x16x32_bf16 v[20:23], v[164:167], v[92:95], v[20:23]
    v_mfma_f32_16x16x32_bf16 v[20:23], v[160:163], v[84:87], v[20:23]
    ds_read_b64_tr_b16 v[160:161], v7 offset:24576
    ds_read_b64_tr_b16 v[162:163], v7 offset:26624
    ds_read_b64_tr_b16 v[164:165], v8 offset:16384
    ds_read_b64_tr_b16 v[166:167], v8 offset:18432
    s_waitcnt lgkmcnt(12)
    v_mfma_f32_16x16x32_bf16 v[24:27], v[172:175], v[80:83], v[24:27]
    ds_read_b64_tr_b16 v[168:169], v8 offset:20480
    ds_read_b64_tr_b16 v[170:171], v8 offset:22528
    buffer_load_dwordx4 v6, s[40:43], s59 offen offset:3072 lds
    s_waitcnt lgkmcnt(12)
    v_mfma_f32_16x16x32_bf16 v[24:27], v[176:179], v[88:91], v[24:27]
    s_waitcnt lgkmcnt(10)
    v_mfma_f32_16x16x32_bf16 v[24:27], v[180:183], v[96:99], v[24:27]
    s_add_u32 m0, s66, 4096
    s_nop 0
    buffer_load_dwordx4 v6, s[40:43], s60 offen offset:0 lds
    v_mfma_f32_16x16x32_bf16 v[28:31], v[180:183], v[100:103], v[28:31]
    v_mfma_f32_16x16x32_bf16 v[28:31], v[176:179], v[92:95], v[28:31]
    buffer_load_dwordx4 v6, s[40:43], s61 offen offset:1024 lds
    v_mfma_f32_16x16x32_bf16 v[28:31], v[172:175], v[84:87], v[28:31]
    ds_read_b64_tr_b16 v[172:173], v8 offset:24576
    ds_read_b64_tr_b16 v[174:175], v8 offset:26624
    s_waitcnt lgkmcnt(10)
    v_mfma_f32_16x16x32_bf16 v[32:35], v[184:187], v[80:83], v[32:35]
    buffer_load_dwordx4 v6, s[40:43], s62 offen offset:2048 lds
    v_add_u32 v6, 458752, v6
    s_waitcnt lgkmcnt(8)
    v_mfma_f32_16x16x32_bf16 v[32:35], v[188:191], v[88:91], v[32:35]
    s_waitcnt lgkmcnt(6)
    v_mfma_f32_16x16x32_bf16 v[32:35], v[160:163], v[96:99], v[32:35]
    v_mfma_f32_16x16x32_bf16 v[36:39], v[160:163], v[100:103], v[36:39]
    s_add_u32 m0, s31, 0
    s_nop 0
    buffer_load_dwordx4 v2, s[12:15], 0 offen lds
    v_mfma_f32_16x16x32_bf16 v[36:39], v[188:191], v[92:95], v[36:39]
    s_waitcnt vmcnt(22) lgkmcnt(0)
    s_barrier
    v_add_u32 v4, 28672, v4
    v_add_u32 v5, 28672, v5
    v_add_u32 v7, 28672, v7
    v_add_u32 v8, 28672, v8
    v_mfma_f32_16x16x32_bf16 v[36:39], v[184:187], v[84:87], v[36:39]
    ds_read_b64_tr_b16 v[176:177], v4 offset:0
    ds_read_b64_tr_b16 v[178:179], v4 offset:2048
    ds_read_b64_tr_b16 v[180:181], v4 offset:4096
    ds_read_b64_tr_b16 v[182:183], v4 offset:6144
    buffer_load_dwordx4 v2, s[12:15], 0 offen offset:1024 lds
    v_mfma_f32_16x16x32_bf16 v[40:43], v[164:167], v[80:83], v[40:43]
    ds_read_b64_tr_b16 v[184:185], v5 offset:0
    ds_read_b64_tr_b16 v[186:187], v5 offset:2048
    ds_read_b64_tr_b16 v[188:189], v5 offset:4096
    ds_read_b64_tr_b16 v[190:191], v5 offset:6144
    v_mfma_f32_16x16x32_bf16 v[40:43], v[168:171], v[88:91], v[40:43]
    ds_read_b64_tr_b16 v[160:161], v7 offset:0
    ds_read_b64_tr_b16 v[162:163], v7 offset:2048
    s_add_u32 m0, s31, 8192
    s_nop 0
    buffer_load_dwordx4 v3, s[16:19], 0 offen lds
    v_mfma_f32_16x16x32_bf16 v[40:43], v[172:175], v[96:99], v[40:43]
    v_mfma_f32_16x16x32_bf16 v[44:47], v[172:175], v[100:103], v[44:47]
    buffer_load_dwordx4 v3, s[16:19], 0 offen offset:1024 lds
    v_add_u32 v2, 8192, v2
    v_add_u32 v3, 8192, v3
    v_mfma_f32_16x16x32_bf16 v[44:47], v[168:171], v[92:95], v[44:47]
    v_mfma_f32_16x16x32_bf16 v[44:47], v[164:167], v[84:87], v[44:47]
    ds_read_b64_tr_b16 v[164:165], v7 offset:4096
    ds_read_b64_tr_b16 v[166:167], v7 offset:6144
    ds_read_b64_tr_b16 v[168:169], v8 offset:0
    ds_read_b64_tr_b16 v[170:171], v8 offset:2048
    s_waitcnt vmcnt(24)
    s_waitcnt lgkmcnt(12)
    v_mfma_f32_16x16x32_bf16 v[16:19], v[176:179], v[104:107], v[16:19]
    ds_read_b64_tr_b16 v[172:173], v8 offset:4096
    ds_read_b64_tr_b16 v[174:175], v8 offset:6144
    buffer_load_dwordx4 v[48:51], v9, s[36:39], 0 offen offset:0
    s_waitcnt vmcnt(23)
    s_waitcnt lgkmcnt(12)
    v_mfma_f32_16x16x32_bf16 v[16:19], v[180:183], v[112:115], v[16:19]
    s_waitcnt vmcnt(22)
    v_mfma_f32_16x16x32_bf16 v[20:23], v[180:183], v[116:119], v[20:23]
    buffer_load_dwordx4 v[52:55], v9, s[36:39], s8 offen offset:0
    v_mfma_f32_16x16x32_bf16 v[20:23], v[176:179], v[108:111], v[20:23]
    ds_read_b64_tr_b16 v[176:177], v4 offset:8192
    ds_read_b64_tr_b16 v[178:179], v4 offset:10240
    ds_read_b64_tr_b16 v[180:181], v4 offset:12288
    ds_read_b64_tr_b16 v[182:183], v4 offset:14336
    s_waitcnt lgkmcnt(14)
    v_mfma_f32_16x16x32_bf16 v[24:27], v[184:187], v[104:107], v[24:27]
    buffer_load_dwordx4 v[56:59], v9, s[36:39], 0 offen offset:1024
    s_waitcnt lgkmcnt(12)
    v_mfma_f32_16x16x32_bf16 v[24:27], v[188:191], v[112:115], v[24:27]
    v_mfma_f32_16x16x32_bf16 v[28:31], v[188:191], v[116:119], v[28:31]
    buffer_load_dwordx4 v[60:63], v9, s[36:39], s8 offen offset:1024
    v_mfma_f32_16x16x32_bf16 v[28:31], v[184:187], v[108:111], v[28:31]
    ds_read_b64_tr_b16 v[184:185], v5 offset:8192
    ds_read_b64_tr_b16 v[186:187], v5 offset:10240
    ds_read_b64_tr_b16 v[188:189], v5 offset:12288
    ds_read_b64_tr_b16 v[190:191], v5 offset:14336
    s_waitcnt lgkmcnt(14)
    v_mfma_f32_16x16x32_bf16 v[32:35], v[160:163], v[104:107], v[32:35]
    buffer_load_dwordx4 v[64:67], v9, s[36:39], 0 offen offset:2048
    s_waitcnt lgkmcnt(12)
    v_mfma_f32_16x16x32_bf16 v[32:35], v[164:167], v[112:115], v[32:35]
    v_mfma_f32_16x16x32_bf16 v[36:39], v[164:167], v[116:119], v[36:39]
    v_mfma_f32_16x16x32_bf16 v[36:39], v[160:163], v[108:111], v[36:39]
    ds_read_b64_tr_b16 v[160:161], v7 offset:8192
    ds_read_b64_tr_b16 v[162:163], v7 offset:10240
    ds_read_b64_tr_b16 v[164:165], v7 offset:12288
    ds_read_b64_tr_b16 v[166:167], v7 offset:14336
    buffer_load_dwordx4 v[68:71], v9, s[36:39], s8 offen offset:2048
    s_waitcnt lgkmcnt(14)
    v_mfma_f32_16x16x32_bf16 v[40:43], v[168:171], v[104:107], v[40:43]
    s_waitcnt lgkmcnt(12)
    v_mfma_f32_16x16x32_bf16 v[40:43], v[172:175], v[112:115], v[40:43]
    buffer_load_dwordx4 v[72:75], v9, s[36:39], 0 offen offset:3072
    v_mfma_f32_16x16x32_bf16 v[44:47], v[172:175], v[116:119], v[44:47]
    v_mfma_f32_16x16x32_bf16 v[44:47], v[168:171], v[108:111], v[44:47]
    ds_read_b64_tr_b16 v[168:169], v8 offset:8192
    ds_read_b64_tr_b16 v[170:171], v8 offset:10240
    ds_read_b64_tr_b16 v[172:173], v8 offset:12288
    ds_read_b64_tr_b16 v[174:175], v8 offset:14336
    buffer_load_dwordx4 v[76:79], v9, s[36:39], s8 offen offset:3072
    s_waitcnt vmcnt(28)
    s_waitcnt lgkmcnt(14)
    v_mfma_f32_16x16x32_bf16 v[16:19], v[176:179], v[120:123], v[16:19]
    s_waitcnt vmcnt(26)
    s_waitcnt lgkmcnt(12)
    v_mfma_f32_16x16x32_bf16 v[16:19], v[180:183], v[128:131], v[16:19]
    buffer_load_dwordx4 v[80:83], v9, s[36:39], s64 offen offset:0
    s_waitcnt vmcnt(26)
    v_mfma_f32_16x16x32_bf16 v[20:23], v[180:183], v[132:135], v[20:23]
    v_mfma_f32_16x16x32_bf16 v[20:23], v[176:179], v[124:127], v[20:23]
    ds_read_b64_tr_b16 v[176:177], v4 offset:16384
    ds_read_b64_tr_b16 v[178:179], v4 offset:18432
    ds_read_b64_tr_b16 v[180:181], v4 offset:20480
    ds_read_b64_tr_b16 v[182:183], v4 offset:22528
    s_waitcnt lgkmcnt(14)
    v_mfma_f32_16x16x32_bf16 v[24:27], v[184:187], v[120:123], v[24:27]
    buffer_load_dwordx4 v[84:87], v9, s[36:39], s9 offen offset:0
    s_waitcnt lgkmcnt(12)
    v_mfma_f32_16x16x32_bf16 v[24:27], v[188:191], v[128:131], v[24:27]
    v_mfma_f32_16x16x32_bf16 v[28:31], v[188:191], v[132:135], v[28:31]
    buffer_load_dwordx4 v[88:91], v9, s[36:39], s64 offen offset:1024
    v_mfma_f32_16x16x32_bf16 v[28:31], v[184:187], v[124:127], v[28:31]
    ds_read_b64_tr_b16 v[184:185], v4 offset:24576
    ds_read_b64_tr_b16 v[186:187], v4 offset:26624
    ds_read_b64_tr_b16 v[188:189], v5 offset:16384
    ds_read_b64_tr_b16 v[190:191], v5 offset:18432
    s_waitcnt lgkmcnt(14)
    v_mfma_f32_16x16x32_bf16 v[32:35], v[160:163], v[120:123], v[32:35]
    buffer_load_dwordx4 v[92:95], v9, s[36:39], s9 offen offset:1024
    s_waitcnt lgkmcnt(12)
    v_mfma_f32_16x16x32_bf16 v[32:35], v[164:167], v[128:131], v[32:35]
    v_mfma_f32_16x16x32_bf16 v[36:39], v[164:167], v[132:135], v[36:39]
    buffer_load_dwordx4 v[96:99], v9, s[36:39], s64 offen offset:2048
    v_mfma_f32_16x16x32_bf16 v[36:39], v[160:163], v[124:127], v[36:39]
    ds_read_b64_tr_b16 v[160:161], v5 offset:20480
    ds_read_b64_tr_b16 v[162:163], v5 offset:22528
    ds_read_b64_tr_b16 v[164:165], v5 offset:24576
    ds_read_b64_tr_b16 v[166:167], v5 offset:26624
    s_waitcnt lgkmcnt(14)
    v_mfma_f32_16x16x32_bf16 v[40:43], v[168:171], v[120:123], v[40:43]
    s_waitcnt lgkmcnt(12)
    v_mfma_f32_16x16x32_bf16 v[40:43], v[172:175], v[128:131], v[40:43]
    buffer_load_dwordx4 v[100:103], v9, s[36:39], s9 offen offset:2048
    v_add_u32 v9, 7168, v9
    v_mfma_f32_16x16x32_bf16 v[44:47], v[172:175], v[132:135], v[44:47]
    v_mfma_f32_16x16x32_bf16 v[44:47], v[168:171], v[124:127], v[44:47]
    ds_read_b64_tr_b16 v[168:169], v7 offset:16384
    ds_read_b64_tr_b16 v[170:171], v7 offset:18432
    ds_read_b64_tr_b16 v[172:173], v7 offset:20480
    ds_read_b64_tr_b16 v[174:175], v7 offset:22528
    s_add_u32 m0, s66, 28672
    s_nop 0
    buffer_load_dwordx4 v6, s[40:43], s56 offen offset:0 lds
    s_waitcnt vmcnt(31)
    s_waitcnt lgkmcnt(14)
    v_mfma_f32_16x16x32_bf16 v[16:19], v[176:179], v[136:139], v[16:19]
    s_waitcnt vmcnt(29)
    s_waitcnt lgkmcnt(12)
    v_mfma_f32_16x16x32_bf16 v[16:19], v[180:183], v[144:147], v[16:19]
    buffer_load_dwordx4 v6, s[40:43], s57 offen offset:1024 lds
    s_waitcnt vmcnt(28)
    s_waitcnt lgkmcnt(10)
    v_mfma_f32_16x16x32_bf16 v[16:19], v[184:187], v[152:155], v[16:19]
    s_waitcnt vmcnt(27)
    v_mfma_f32_16x16x32_bf16 v[20:23], v[184:187], v[156:159], v[20:23]
    buffer_load_dwordx4 v6, s[40:43], s58 offen offset:2048 lds
    v_mfma_f32_16x16x32_bf16 v[20:23], v[180:183], v[148:151], v[20:23]
    v_mfma_f32_16x16x32_bf16 v[20:23], v[176:179], v[140:143], v[20:23]
    ds_read_b64_tr_b16 v[176:177], v7 offset:24576
    ds_read_b64_tr_b16 v[178:179], v7 offset:26624
    ds_read_b64_tr_b16 v[180:181], v8 offset:16384
    ds_read_b64_tr_b16 v[182:183], v8 offset:18432
    s_waitcnt lgkmcnt(12)
    v_mfma_f32_16x16x32_bf16 v[24:27], v[188:191], v[136:139], v[24:27]
    ds_read_b64_tr_b16 v[184:185], v8 offset:20480
    ds_read_b64_tr_b16 v[186:187], v8 offset:22528
    buffer_load_dwordx4 v6, s[40:43], s59 offen offset:3072 lds
    s_waitcnt lgkmcnt(12)
    v_mfma_f32_16x16x32_bf16 v[24:27], v[160:163], v[144:147], v[24:27]
    s_waitcnt lgkmcnt(10)
    v_mfma_f32_16x16x32_bf16 v[24:27], v[164:167], v[152:155], v[24:27]
    s_add_u32 m0, s66, 32768
    s_nop 0
    buffer_load_dwordx4 v6, s[40:43], s60 offen offset:0 lds
    v_mfma_f32_16x16x32_bf16 v[28:31], v[164:167], v[156:159], v[28:31]
    v_mfma_f32_16x16x32_bf16 v[28:31], v[160:163], v[148:151], v[28:31]
    buffer_load_dwordx4 v6, s[40:43], s61 offen offset:1024 lds
    v_mfma_f32_16x16x32_bf16 v[28:31], v[188:191], v[140:143], v[28:31]
    ds_read_b64_tr_b16 v[188:189], v8 offset:24576
    ds_read_b64_tr_b16 v[190:191], v8 offset:26624
    s_waitcnt lgkmcnt(10)
    v_mfma_f32_16x16x32_bf16 v[32:35], v[168:171], v[136:139], v[32:35]
    buffer_load_dwordx4 v6, s[40:43], s62 offen offset:2048 lds
    v_add_u32 v6, 458752, v6
    s_waitcnt lgkmcnt(8)
    v_mfma_f32_16x16x32_bf16 v[32:35], v[172:175], v[144:147], v[32:35]
    s_waitcnt lgkmcnt(6)
    v_mfma_f32_16x16x32_bf16 v[32:35], v[176:179], v[152:155], v[32:35]
    v_mfma_f32_16x16x32_bf16 v[36:39], v[176:179], v[156:159], v[36:39]
    s_add_u32 m0, s31, 16384
    s_nop 0
    buffer_load_dwordx4 v2, s[12:15], 0 offen lds
    v_mfma_f32_16x16x32_bf16 v[36:39], v[172:175], v[148:151], v[36:39]
    s_waitcnt vmcnt(22) lgkmcnt(0)
    s_barrier
    v_subrev_u32 v4, 57344, v4
    v_subrev_u32 v5, 57344, v5
    v_subrev_u32 v7, 57344, v7
    v_subrev_u32 v8, 57344, v8
    v_mfma_f32_16x16x32_bf16 v[36:39], v[168:171], v[140:143], v[36:39]
    ds_read_b64_tr_b16 v[160:161], v4 offset:0
    ds_read_b64_tr_b16 v[162:163], v4 offset:2048
    ds_read_b64_tr_b16 v[164:165], v4 offset:4096
    ds_read_b64_tr_b16 v[166:167], v4 offset:6144
    buffer_load_dwordx4 v2, s[12:15], 0 offen offset:1024 lds
    v_mfma_f32_16x16x32_bf16 v[40:43], v[180:183], v[136:139], v[40:43]
    ds_read_b64_tr_b16 v[168:169], v5 offset:0
    ds_read_b64_tr_b16 v[170:171], v5 offset:2048
    ds_read_b64_tr_b16 v[172:173], v5 offset:4096
    ds_read_b64_tr_b16 v[174:175], v5 offset:6144
    v_mfma_f32_16x16x32_bf16 v[40:43], v[184:187], v[144:147], v[40:43]
    ds_read_b64_tr_b16 v[176:177], v7 offset:0
    ds_read_b64_tr_b16 v[178:179], v7 offset:2048
    s_add_u32 m0, s31, 24576
    s_nop 0
    buffer_load_dwordx4 v3, s[16:19], 0 offen lds
    v_mfma_f32_16x16x32_bf16 v[40:43], v[188:191], v[152:155], v[40:43]
    v_mfma_f32_16x16x32_bf16 v[44:47], v[188:191], v[156:159], v[44:47]
    buffer_load_dwordx4 v3, s[16:19], 0 offen offset:1024 lds
    v_add_u32 v2, 8192, v2
    v_add_u32 v3, 8192, v3
    v_mfma_f32_16x16x32_bf16 v[44:47], v[184:187], v[148:151], v[44:47]
    v_mfma_f32_16x16x32_bf16 v[44:47], v[180:183], v[140:143], v[44:47]
    ds_read_b64_tr_b16 v[180:181], v7 offset:4096
    ds_read_b64_tr_b16 v[182:183], v7 offset:6144
    ds_read_b64_tr_b16 v[184:185], v8 offset:0
    ds_read_b64_tr_b16 v[186:187], v8 offset:2048
    s_waitcnt vmcnt(24)
    s_waitcnt lgkmcnt(12)
    v_mfma_f32_16x16x32_bf16 v[16:19], v[160:163], v[48:51], v[16:19]
    ds_read_b64_tr_b16 v[188:189], v8 offset:4096
    ds_read_b64_tr_b16 v[190:191], v8 offset:6144
    buffer_load_dwordx4 v[104:107], v9, s[36:39], 0 offen offset:0
    s_waitcnt vmcnt(23)
    s_waitcnt lgkmcnt(12)
    v_mfma_f32_16x16x32_bf16 v[16:19], v[164:167], v[56:59], v[16:19]
    s_mov_b32 s44, s44
    s_waitcnt vmcnt(22)
    v_mfma_f32_16x16x32_bf16 v[20:23], v[164:167], v[60:63], v[20:23]
    s_and_b32 s45, s45, 0xffff
    v_mfma_f32_16x16x32_bf16 v[20:23], v[160:163], v[52:55], v[20:23]
    ds_read_b64_tr_b16 v[160:161], v4 offset:8192
    ds_read_b64_tr_b16 v[162:163], v4 offset:10240
    ds_read_b64_tr_b16 v[164:165], v4 offset:12288
    ds_read_b64_tr_b16 v[166:167], v4 offset:14336
    buffer_load_dwordx4 v[108:111], v9, s[36:39], s8 offen offset:0
    s_waitcnt lgkmcnt(14)
    v_mfma_f32_16x16x32_bf16 v[24:27], v[168:171], v[48:51], v[24:27]
    s_mov_b32 s46, 2097152
    s_waitcnt lgkmcnt(12)
    v_mfma_f32_16x16x32_bf16 v[24:27], v[172:175], v[56:59], v[24:27]
    buffer_load_dwordx4 v[112:115], v9, s[36:39], 0 offen offset:1024
    v_mfma_f32_16x16x32_bf16 v[28:31], v[172:175], v[60:63], v[28:31]
    s_mov_b32 s47, 0x20000
    v_mfma_f32_16x16x32_bf16 v[28:31], v[168:171], v[52:55], v[28:31]
    ds_read_b64_tr_b16 v[168:169], v5 offset:8192
    ds_read_b64_tr_b16 v[170:171], v5 offset:10240
    ds_read_b64_tr_b16 v[172:173], v5 offset:12288
    ds_read_b64_tr_b16 v[174:175], v5 offset:14336
    buffer_load_dwordx4 v[116:119], v9, s[36:39], s8 offen offset:1024
    s_waitcnt lgkmcnt(14)
    v_mfma_f32_16x16x32_bf16 v[32:35], v[176:179], v[48:51], v[32:35]
    s_mov_b32 s72, s72
    s_waitcnt lgkmcnt(12)
    v_mfma_f32_16x16x32_bf16 v[32:35], v[180:183], v[56:59], v[32:35]
    buffer_load_dwordx4 v[120:123], v9, s[36:39], 0 offen offset:2048
    v_mfma_f32_16x16x32_bf16 v[36:39], v[180:183], v[60:63], v[36:39]
    s_and_b32 s73, s73, 0xffff
    v_mfma_f32_16x16x32_bf16 v[36:39], v[176:179], v[52:55], v[36:39]
    ds_read_b64_tr_b16 v[176:177], v7 offset:8192
    ds_read_b64_tr_b16 v[178:179], v7 offset:10240
    ds_read_b64_tr_b16 v[180:181], v7 offset:12288
    ds_read_b64_tr_b16 v[182:183], v7 offset:14336
    buffer_load_dwordx4 v[124:127], v9, s[36:39], s8 offen offset:2048
    s_waitcnt lgkmcnt(14)
    v_mfma_f32_16x16x32_bf16 v[40:43], v[184:187], v[48:51], v[40:43]
    s_mov_b32 s74, 4194304
    s_waitcnt lgkmcnt(12)
    v_mfma_f32_16x16x32_bf16 v[40:43], v[188:191], v[56:59], v[40:43]
    v_mfma_f32_16x16x32_bf16 v[44:47], v[188:191], v[60:63], v[44:47]
    buffer_load_dwordx4 v[128:131], v9, s[36:39], 0 offen offset:3072
    v_mfma_f32_16x16x32_bf16 v[44:47], v[184:187], v[52:55], v[44:47]
    ds_read_b64_tr_b16 v[184:185], v8 offset:8192
    ds_read_b64_tr_b16 v[186:187], v8 offset:10240
    ds_read_b64_tr_b16 v[188:189], v8 offset:12288
    ds_read_b64_tr_b16 v[190:191], v8 offset:14336
    s_mov_b32 s75, 0x20000
    s_waitcnt vmcnt(27)
    s_waitcnt lgkmcnt(14)
    v_mfma_f32_16x16x32_bf16 v[16:19], v[160:163], v[64:67], v[16:19]
    buffer_load_dwordx4 v[132:135], v9, s[36:39], s8 offen offset:3072
    s_waitcnt vmcnt(26)
    s_waitcnt lgkmcnt(12)
    v_mfma_f32_16x16x32_bf16 v[16:19], v[164:167], v[72:75], v[16:19]
    v_lshrrev_b32 v11, 3, v0
    s_waitcnt vmcnt(25)
    v_mfma_f32_16x16x32_bf16 v[20:23], v[164:167], v[76:79], v[20:23]
    buffer_load_dwordx4 v[136:139], v9, s[36:39], s64 offen offset:0
    v_mfma_f32_16x16x32_bf16 v[20:23], v[160:163], v[68:71], v[20:23]
    ds_read_b64_tr_b16 v[160:161], v4 offset:16384
    ds_read_b64_tr_b16 v[162:163], v4 offset:18432
    ds_read_b64_tr_b16 v[164:165], v4 offset:20480
    ds_read_b64_tr_b16 v[166:167], v4 offset:22528
    s_lshl_b32 s3, s24, 5
    s_waitcnt lgkmcnt(14)
    v_mfma_f32_16x16x32_bf16 v[24:27], v[168:171], v[64:67], v[24:27]
    buffer_load_dwordx4 v[140:143], v9, s[36:39], s9 offen offset:0
    s_waitcnt lgkmcnt(12)
    v_mfma_f32_16x16x32_bf16 v[24:27], v[172:175], v[72:75], v[24:27]
    v_add_u32 v12, s3, v11
    v_mfma_f32_16x16x32_bf16 v[28:31], v[172:175], v[76:79], v[28:31]
    buffer_load_dwordx4 v[144:147], v9, s[36:39], s64 offen offset:1024
    v_mfma_f32_16x16x32_bf16 v[28:31], v[168:171], v[68:71], v[28:31]
    ds_read_b64_tr_b16 v[168:169], v4 offset:24576
    ds_read_b64_tr_b16 v[170:171], v4 offset:26624
    ds_read_b64_tr_b16 v[172:173], v5 offset:16384
    ds_read_b64_tr_b16 v[174:175], v5 offset:18432
    v_lshlrev_b32 v13, 11, v12
    s_waitcnt lgkmcnt(14)
    v_mfma_f32_16x16x32_bf16 v[32:35], v[176:179], v[64:67], v[32:35]
    buffer_load_dwordx4 v[148:151], v9, s[36:39], s9 offen offset:1024
    s_waitcnt lgkmcnt(12)
    v_mfma_f32_16x16x32_bf16 v[32:35], v[180:183], v[72:75], v[32:35]
    v_bfe_u32 v12, v0, 4, 2
    v_mfma_f32_16x16x32_bf16 v[36:39], v[180:183], v[76:79], v[36:39]
    buffer_load_dwordx4 v[152:155], v9, s[36:39], s64 offen offset:2048
    v_mfma_f32_16x16x32_bf16 v[36:39], v[176:179], v[68:71], v[36:39]
    ds_read_b64_tr_b16 v[176:177], v5 offset:20480
    ds_read_b64_tr_b16 v[178:179], v5 offset:22528
    ds_read_b64_tr_b16 v[180:181], v5 offset:24576
    ds_read_b64_tr_b16 v[182:183], v5 offset:26624
    s_waitcnt lgkmcnt(14)
    v_mfma_f32_16x16x32_bf16 v[40:43], v[184:187], v[64:67], v[40:43]
    v_lshlrev_b32 v12, 1, v12
    s_waitcnt lgkmcnt(12)
    v_mfma_f32_16x16x32_bf16 v[40:43], v[188:191], v[72:75], v[40:43]
    v_and_b32 v15, 7, v0
    v_mfma_f32_16x16x32_bf16 v[44:47], v[188:191], v[76:79], v[44:47]
    buffer_load_dwordx4 v[156:159], v9, s[36:39], s9 offen offset:2048
    v_add_u32 v9, 7168, v9
    v_mfma_f32_16x16x32_bf16 v[44:47], v[184:187], v[68:71], v[44:47]
    ds_read_b64_tr_b16 v[184:185], v7 offset:16384
    ds_read_b64_tr_b16 v[186:187], v7 offset:18432
    ds_read_b64_tr_b16 v[188:189], v7 offset:20480
    ds_read_b64_tr_b16 v[190:191], v7 offset:22528
    v_xor_b32 v12, v12, v15
    s_waitcnt vmcnt(30)
    s_waitcnt lgkmcnt(14)
    v_mfma_f32_16x16x32_bf16 v[16:19], v[160:163], v[80:83], v[16:19]
    s_add_u32 m0, s66, 57344
    s_nop 0
    buffer_load_dwordx4 v6, s[40:43], s56 offen offset:0 lds
    s_waitcnt vmcnt(29)
    s_waitcnt lgkmcnt(12)
    v_mfma_f32_16x16x32_bf16 v[16:19], v[164:167], v[88:91], v[16:19]
    v_lshl_add_u32 v13, v12, 4, v13
    s_waitcnt vmcnt(27)
    s_waitcnt lgkmcnt(10)
    v_mfma_f32_16x16x32_bf16 v[16:19], v[168:171], v[96:99], v[16:19]
    buffer_load_dwordx4 v6, s[40:43], s57 offen offset:1024 lds
    s_waitcnt vmcnt(27)
    v_mfma_f32_16x16x32_bf16 v[20:23], v[168:171], v[100:103], v[20:23]
    v_add_u32 v13, s50, v13
    v_mfma_f32_16x16x32_bf16 v[20:23], v[164:167], v[92:95], v[20:23]
    buffer_load_dwordx4 v6, s[40:43], s58 offen offset:2048 lds
    v_mfma_f32_16x16x32_bf16 v[20:23], v[160:163], v[84:87], v[20:23]
    ds_read_b64_tr_b16 v[160:161], v7 offset:24576
    ds_read_b64_tr_b16 v[162:163], v7 offset:26624
    ds_read_b64_tr_b16 v[164:165], v8 offset:16384
    ds_read_b64_tr_b16 v[166:167], v8 offset:18432
    s_lshl_b32 s63, s24, 12
    s_waitcnt lgkmcnt(12)
    v_mfma_f32_16x16x32_bf16 v[24:27], v[172:175], v[80:83], v[24:27]
    ds_read_b64_tr_b16 v[168:169], v8 offset:20480
    ds_read_b64_tr_b16 v[170:171], v8 offset:22528
    buffer_load_dwordx4 v6, s[40:43], s59 offen offset:3072 lds
    s_waitcnt lgkmcnt(12)
    v_mfma_f32_16x16x32_bf16 v[24:27], v[176:179], v[88:91], v[24:27]
    s_lshl_b32 s3, s51, 4
    s_waitcnt lgkmcnt(10)
    v_mfma_f32_16x16x32_bf16 v[24:27], v[180:183], v[96:99], v[24:27]
    s_add_u32 m0, s66, 61440
    s_nop 0
    buffer_load_dwordx4 v6, s[40:43], s60 offen offset:0 lds
    v_mfma_f32_16x16x32_bf16 v[28:31], v[180:183], v[100:103], v[28:31]
    v_mfma_f32_16x16x32_bf16 v[28:31], v[176:179], v[92:95], v[28:31]
    v_add_u32 v12, s3, v11
    v_mfma_f32_16x16x32_bf16 v[28:31], v[172:175], v[84:87], v[28:31]
    ds_read_b64_tr_b16 v[172:173], v8 offset:24576
    ds_read_b64_tr_b16 v[174:175], v8 offset:26624
    buffer_load_dwordx4 v6, s[40:43], s61 offen offset:1024 lds
    s_waitcnt lgkmcnt(10)
    v_mfma_f32_16x16x32_bf16 v[32:35], v[184:187], v[80:83], v[32:35]
    v_lshlrev_b32 v14, 11, v12
    s_waitcnt lgkmcnt(8)
    v_mfma_f32_16x16x32_bf16 v[32:35], v[188:191], v[88:91], v[32:35]
    buffer_load_dwordx4 v6, s[40:43], s62 offen offset:2048 lds
    v_add_u32 v6, 458752, v6
    s_waitcnt lgkmcnt(6)
    v_mfma_f32_16x16x32_bf16 v[32:35], v[160:163], v[96:99], v[32:35]
    v_lshrrev_b32 v12, 4, v0
    v_mfma_f32_16x16x32_bf16 v[36:39], v[160:163], v[100:103], v[36:39]
    s_add_u32 m0, s31, 32768
    s_nop 0
    buffer_load_dwordx4 v2, s[12:15], 0 offen lds
    v_mfma_f32_16x16x32_bf16 v[36:39], v[188:191], v[92:95], v[36:39]
    v_xor_b32 v12, v12, v15
    s_waitcnt vmcnt(22) lgkmcnt(0)
    s_barrier
    v_add_u32 v4, 28672, v4
    v_add_u32 v5, 28672, v5
    v_add_u32 v7, 28672, v7
    v_add_u32 v8, 28672, v8
    v_mfma_f32_16x16x32_bf16 v[36:39], v[184:187], v[84:87], v[36:39]
    ds_read_b64_tr_b16 v[176:177], v4 offset:0
    ds_read_b64_tr_b16 v[178:179], v4 offset:2048
    ds_read_b64_tr_b16 v[180:181], v4 offset:4096
    ds_read_b64_tr_b16 v[182:183], v4 offset:6144
    buffer_load_dwordx4 v2, s[12:15], 0 offen offset:1024 lds
    v_mfma_f32_16x16x32_bf16 v[40:43], v[164:167], v[80:83], v[40:43]
    ds_read_b64_tr_b16 v[184:185], v5 offset:0
    ds_read_b64_tr_b16 v[186:187], v5 offset:2048
    ds_read_b64_tr_b16 v[188:189], v5 offset:4096
    ds_read_b64_tr_b16 v[190:191], v5 offset:6144
    v_lshl_add_u32 v14, v12, 4, v14
    v_mfma_f32_16x16x32_bf16 v[40:43], v[168:171], v[88:91], v[40:43]
    ds_read_b64_tr_b16 v[160:161], v7 offset:0
    ds_read_b64_tr_b16 v[162:163], v7 offset:2048
    s_add_u32 m0, s31, 40960
    s_nop 0
    buffer_load_dwordx4 v3, s[16:19], 0 offen lds
    v_mfma_f32_16x16x32_bf16 v[40:43], v[172:175], v[96:99], v[40:43]
    v_add_u32 v14, s50, v14
    v_mfma_f32_16x16x32_bf16 v[44:47], v[172:175], v[100:103], v[44:47]
    buffer_load_dwordx4 v3, s[16:19], 0 offen offset:1024 lds
    v_add_u32 v2, 8192, v2
    v_add_u32 v3, 8192, v3
    v_mfma_f32_16x16x32_bf16 v[44:47], v[168:171], v[92:95], v[44:47]
    s_mov_b32 s52, 98304
    s_cmp_ge_u32 s24, 2
    s_cselect_b32 s52, 147456, s52
    s_lshl_b32 s3, s24, 12
    s_add_u32 s52, s52, s3
    v_mfma_f32_16x16x32_bf16 v[44:47], v[164:167], v[84:87], v[44:47]
    ds_read_b64_tr_b16 v[164:165], v7 offset:4096
    ds_read_b64_tr_b16 v[166:167], v7 offset:6144
    ds_read_b64_tr_b16 v[168:169], v8 offset:0
    ds_read_b64_tr_b16 v[170:171], v8 offset:2048
    s_waitcnt vmcnt(24)
    s_waitcnt lgkmcnt(12)
    v_mfma_f32_16x16x32_bf16 v[16:19], v[176:179], v[104:107], v[16:19]
    ds_read_b64_tr_b16 v[172:173], v8 offset:4096
    ds_read_b64_tr_b16 v[174:175], v8 offset:6144
    buffer_load_dwordx4 v[48:51], v9, s[36:39], 0 offen offset:0
    s_waitcnt vmcnt(23)
    s_waitcnt lgkmcnt(12)
    v_mfma_f32_16x16x32_bf16 v[16:19], v[180:183], v[112:115], v[16:19]
    s_waitcnt vmcnt(22)
    v_mfma_f32_16x16x32_bf16 v[20:23], v[180:183], v[116:119], v[20:23]
    buffer_load_dwordx4 v[52:55], v9, s[36:39], s8 offen offset:0
    v_mfma_f32_16x16x32_bf16 v[20:23], v[176:179], v[108:111], v[20:23]
    ds_read_b64_tr_b16 v[176:177], v4 offset:8192
    ds_read_b64_tr_b16 v[178:179], v4 offset:10240
    ds_read_b64_tr_b16 v[180:181], v4 offset:12288
    ds_read_b64_tr_b16 v[182:183], v4 offset:14336
    s_waitcnt lgkmcnt(14)
    v_mfma_f32_16x16x32_bf16 v[24:27], v[184:187], v[104:107], v[24:27]
    buffer_load_dwordx4 v[56:59], v9, s[36:39], 0 offen offset:1024
    s_waitcnt lgkmcnt(12)
    v_mfma_f32_16x16x32_bf16 v[24:27], v[188:191], v[112:115], v[24:27]
    v_mfma_f32_16x16x32_bf16 v[28:31], v[188:191], v[116:119], v[28:31]
    buffer_load_dwordx4 v[60:63], v9, s[36:39], s8 offen offset:1024
    v_mfma_f32_16x16x32_bf16 v[28:31], v[184:187], v[108:111], v[28:31]
    ds_read_b64_tr_b16 v[184:185], v5 offset:8192
    ds_read_b64_tr_b16 v[186:187], v5 offset:10240
    ds_read_b64_tr_b16 v[188:189], v5 offset:12288
    ds_read_b64_tr_b16 v[190:191], v5 offset:14336
    s_waitcnt lgkmcnt(14)
    v_mfma_f32_16x16x32_bf16 v[32:35], v[160:163], v[104:107], v[32:35]
    buffer_load_dwordx4 v[64:67], v9, s[36:39], 0 offen offset:2048
    s_waitcnt lgkmcnt(12)
    v_mfma_f32_16x16x32_bf16 v[32:35], v[164:167], v[112:115], v[32:35]
    v_mfma_f32_16x16x32_bf16 v[36:39], v[164:167], v[116:119], v[36:39]
    v_mfma_f32_16x16x32_bf16 v[36:39], v[160:163], v[108:111], v[36:39]
    ds_read_b64_tr_b16 v[160:161], v7 offset:8192
    ds_read_b64_tr_b16 v[162:163], v7 offset:10240
    ds_read_b64_tr_b16 v[164:165], v7 offset:12288
    ds_read_b64_tr_b16 v[166:167], v7 offset:14336
    buffer_load_dwordx4 v[68:71], v9, s[36:39], s8 offen offset:2048
    s_waitcnt lgkmcnt(14)
    v_mfma_f32_16x16x32_bf16 v[40:43], v[168:171], v[104:107], v[40:43]
    s_waitcnt lgkmcnt(12)
    v_mfma_f32_16x16x32_bf16 v[40:43], v[172:175], v[112:115], v[40:43]
    buffer_load_dwordx4 v[72:75], v9, s[36:39], 0 offen offset:3072
    v_mfma_f32_16x16x32_bf16 v[44:47], v[172:175], v[116:119], v[44:47]
    v_mfma_f32_16x16x32_bf16 v[44:47], v[168:171], v[108:111], v[44:47]
    ds_read_b64_tr_b16 v[168:169], v8 offset:8192
    ds_read_b64_tr_b16 v[170:171], v8 offset:10240
    ds_read_b64_tr_b16 v[172:173], v8 offset:12288
    ds_read_b64_tr_b16 v[174:175], v8 offset:14336
    buffer_load_dwordx4 v[76:79], v9, s[36:39], s8 offen offset:3072
    s_waitcnt vmcnt(28)
    s_waitcnt lgkmcnt(14)
    v_mfma_f32_16x16x32_bf16 v[16:19], v[176:179], v[120:123], v[16:19]
    s_waitcnt vmcnt(26)
    s_waitcnt lgkmcnt(12)
    v_mfma_f32_16x16x32_bf16 v[16:19], v[180:183], v[128:131], v[16:19]
    buffer_load_dwordx4 v[80:83], v9, s[36:39], s64 offen offset:0
    s_waitcnt vmcnt(26)
    v_mfma_f32_16x16x32_bf16 v[20:23], v[180:183], v[132:135], v[20:23]
    v_mfma_f32_16x16x32_bf16 v[20:23], v[176:179], v[124:127], v[20:23]
    ds_read_b64_tr_b16 v[176:177], v4 offset:16384
    ds_read_b64_tr_b16 v[178:179], v4 offset:18432
    ds_read_b64_tr_b16 v[180:181], v4 offset:20480
    ds_read_b64_tr_b16 v[182:183], v4 offset:22528
    s_waitcnt lgkmcnt(14)
    v_mfma_f32_16x16x32_bf16 v[24:27], v[184:187], v[120:123], v[24:27]
    buffer_load_dwordx4 v[84:87], v9, s[36:39], s9 offen offset:0
    s_waitcnt lgkmcnt(12)
    v_mfma_f32_16x16x32_bf16 v[24:27], v[188:191], v[128:131], v[24:27]
    v_mfma_f32_16x16x32_bf16 v[28:31], v[188:191], v[132:135], v[28:31]
    buffer_load_dwordx4 v[88:91], v9, s[36:39], s64 offen offset:1024
    v_mfma_f32_16x16x32_bf16 v[28:31], v[184:187], v[124:127], v[28:31]
    ds_read_b64_tr_b16 v[184:185], v4 offset:24576
    ds_read_b64_tr_b16 v[186:187], v4 offset:26624
    ds_read_b64_tr_b16 v[188:189], v5 offset:16384
    ds_read_b64_tr_b16 v[190:191], v5 offset:18432
    s_waitcnt lgkmcnt(14)
    v_mfma_f32_16x16x32_bf16 v[32:35], v[160:163], v[120:123], v[32:35]
    buffer_load_dwordx4 v[92:95], v9, s[36:39], s9 offen offset:1024
    s_waitcnt lgkmcnt(12)
    v_mfma_f32_16x16x32_bf16 v[32:35], v[164:167], v[128:131], v[32:35]
    v_mfma_f32_16x16x32_bf16 v[36:39], v[164:167], v[132:135], v[36:39]
    buffer_load_dwordx4 v[96:99], v9, s[36:39], s64 offen offset:2048
    v_mfma_f32_16x16x32_bf16 v[36:39], v[160:163], v[124:127], v[36:39]
    ds_read_b64_tr_b16 v[160:161], v5 offset:20480
    ds_read_b64_tr_b16 v[162:163], v5 offset:22528
    ds_read_b64_tr_b16 v[164:165], v5 offset:24576
    ds_read_b64_tr_b16 v[166:167], v5 offset:26624
    s_waitcnt lgkmcnt(14)
    v_mfma_f32_16x16x32_bf16 v[40:43], v[168:171], v[120:123], v[40:43]
    s_waitcnt lgkmcnt(12)
    v_mfma_f32_16x16x32_bf16 v[40:43], v[172:175], v[128:131], v[40:43]
    buffer_load_dwordx4 v[100:103], v9, s[36:39], s9 offen offset:2048
    v_add_u32 v9, 7168, v9
    v_mfma_f32_16x16x32_bf16 v[44:47], v[172:175], v[132:135], v[44:47]
    v_mfma_f32_16x16x32_bf16 v[44:47], v[168:171], v[124:127], v[44:47]
    ds_read_b64_tr_b16 v[168:169], v7 offset:16384
    ds_read_b64_tr_b16 v[170:171], v7 offset:18432
    ds_read_b64_tr_b16 v[172:173], v7 offset:20480
    ds_read_b64_tr_b16 v[174:175], v7 offset:22528
    s_add_u32 m0, s66, 0
    s_nop 0
    buffer_load_dwordx4 v6, s[40:43], s56 offen offset:0 lds
    s_waitcnt vmcnt(31)
    s_waitcnt lgkmcnt(14)
    v_mfma_f32_16x16x32_bf16 v[16:19], v[176:179], v[136:139], v[16:19]
    s_waitcnt vmcnt(29)
    s_waitcnt lgkmcnt(12)
    v_mfma_f32_16x16x32_bf16 v[16:19], v[180:183], v[144:147], v[16:19]
    buffer_load_dwordx4 v6, s[40:43], s57 offen offset:1024 lds
    s_waitcnt vmcnt(28)
    s_waitcnt lgkmcnt(10)
    v_mfma_f32_16x16x32_bf16 v[16:19], v[184:187], v[152:155], v[16:19]
    s_waitcnt vmcnt(27)
    v_mfma_f32_16x16x32_bf16 v[20:23], v[184:187], v[156:159], v[20:23]
    buffer_load_dwordx4 v6, s[40:43], s58 offen offset:2048 lds
    v_mfma_f32_16x16x32_bf16 v[20:23], v[180:183], v[148:151], v[20:23]
    v_mfma_f32_16x16x32_bf16 v[20:23], v[176:179], v[140:143], v[20:23]
    ds_read_b64_tr_b16 v[176:177], v7 offset:24576
    ds_read_b64_tr_b16 v[178:179], v7 offset:26624
    ds_read_b64_tr_b16 v[180:181], v8 offset:16384
    ds_read_b64_tr_b16 v[182:183], v8 offset:18432
    s_waitcnt lgkmcnt(12)
    v_mfma_f32_16x16x32_bf16 v[24:27], v[188:191], v[136:139], v[24:27]
    ds_read_b64_tr_b16 v[184:185], v8 offset:20480
    ds_read_b64_tr_b16 v[186:187], v8 offset:22528
    buffer_load_dwordx4 v6, s[40:43], s59 offen offset:3072 lds
    s_waitcnt lgkmcnt(12)
    v_mfma_f32_16x16x32_bf16 v[24:27], v[160:163], v[144:147], v[24:27]
    s_waitcnt lgkmcnt(10)
    v_mfma_f32_16x16x32_bf16 v[24:27], v[164:167], v[152:155], v[24:27]
    s_add_u32 m0, s66, 4096
    s_nop 0
    buffer_load_dwordx4 v6, s[40:43], s60 offen offset:0 lds
    v_mfma_f32_16x16x32_bf16 v[28:31], v[164:167], v[156:159], v[28:31]
    v_mfma_f32_16x16x32_bf16 v[28:31], v[160:163], v[148:151], v[28:31]
    buffer_load_dwordx4 v6, s[40:43], s61 offen offset:1024 lds
    v_mfma_f32_16x16x32_bf16 v[28:31], v[188:191], v[140:143], v[28:31]
    ds_read_b64_tr_b16 v[188:189], v8 offset:24576
    ds_read_b64_tr_b16 v[190:191], v8 offset:26624
    s_waitcnt lgkmcnt(10)
    v_mfma_f32_16x16x32_bf16 v[32:35], v[168:171], v[136:139], v[32:35]
    buffer_load_dwordx4 v6, s[40:43], s62 offen offset:2048 lds
    v_add_u32 v6, 458752, v6
    s_waitcnt lgkmcnt(8)
    v_mfma_f32_16x16x32_bf16 v[32:35], v[172:175], v[144:147], v[32:35]
    s_waitcnt lgkmcnt(6)
    v_mfma_f32_16x16x32_bf16 v[32:35], v[176:179], v[152:155], v[32:35]
    v_mfma_f32_16x16x32_bf16 v[36:39], v[176:179], v[156:159], v[36:39]
    s_add_u32 m0, s31, 49152
    s_nop 0
    buffer_load_dwordx4 v2, s[12:15], 0 offen lds
    v_mfma_f32_16x16x32_bf16 v[36:39], v[172:175], v[148:151], v[36:39]
    s_waitcnt vmcnt(22) lgkmcnt(0)
    s_barrier
    v_add_u32 v4, 28672, v4
    v_add_u32 v5, 28672, v5
    v_add_u32 v7, 28672, v7
    v_add_u32 v8, 28672, v8
    v_mfma_f32_16x16x32_bf16 v[36:39], v[168:171], v[140:143], v[36:39]
    ds_read_b64_tr_b16 v[160:161], v4 offset:0
    ds_read_b64_tr_b16 v[162:163], v4 offset:2048
    ds_read_b64_tr_b16 v[164:165], v4 offset:4096
    ds_read_b64_tr_b16 v[166:167], v4 offset:6144
    buffer_load_dwordx4 v2, s[12:15], 0 offen offset:1024 lds
    v_mfma_f32_16x16x32_bf16 v[40:43], v[180:183], v[136:139], v[40:43]
    ds_read_b64_tr_b16 v[168:169], v5 offset:0
    ds_read_b64_tr_b16 v[170:171], v5 offset:2048
    ds_read_b64_tr_b16 v[172:173], v5 offset:4096
    ds_read_b64_tr_b16 v[174:175], v5 offset:6144
    v_mfma_f32_16x16x32_bf16 v[40:43], v[184:187], v[144:147], v[40:43]
    ds_read_b64_tr_b16 v[176:177], v7 offset:0
    ds_read_b64_tr_b16 v[178:179], v7 offset:2048
    s_add_u32 m0, s31, 57344
    s_nop 0
    buffer_load_dwordx4 v3, s[16:19], 0 offen lds
    v_mfma_f32_16x16x32_bf16 v[40:43], v[188:191], v[152:155], v[40:43]
    v_mfma_f32_16x16x32_bf16 v[44:47], v[188:191], v[156:159], v[44:47]
    buffer_load_dwordx4 v3, s[16:19], 0 offen offset:1024 lds
    v_add_u32 v2, 8192, v2
    v_add_u32 v3, 8192, v3
    v_mfma_f32_16x16x32_bf16 v[44:47], v[184:187], v[148:151], v[44:47]
    v_mfma_f32_16x16x32_bf16 v[44:47], v[180:183], v[140:143], v[44:47]
    ds_read_b64_tr_b16 v[180:181], v7 offset:4096
    ds_read_b64_tr_b16 v[182:183], v7 offset:6144
    ds_read_b64_tr_b16 v[184:185], v8 offset:0
    ds_read_b64_tr_b16 v[186:187], v8 offset:2048
    s_waitcnt vmcnt(24)
    s_waitcnt lgkmcnt(12)
    v_mfma_f32_16x16x32_bf16 v[16:19], v[160:163], v[48:51], v[16:19]
    ds_read_b64_tr_b16 v[188:189], v8 offset:4096
    ds_read_b64_tr_b16 v[190:191], v8 offset:6144
    buffer_load_dwordx4 v[104:107], v9, s[36:39], 0 offen offset:0
    s_waitcnt vmcnt(23)
    s_waitcnt lgkmcnt(12)
    v_mfma_f32_16x16x32_bf16 v[16:19], v[164:167], v[56:59], v[16:19]
    s_waitcnt vmcnt(22)
    v_mfma_f32_16x16x32_bf16 v[20:23], v[164:167], v[60:63], v[20:23]
    buffer_load_dwordx4 v[108:111], v9, s[36:39], s8 offen offset:0
    v_mfma_f32_16x16x32_bf16 v[20:23], v[160:163], v[52:55], v[20:23]
    ds_read_b64_tr_b16 v[160:161], v4 offset:8192
    ds_read_b64_tr_b16 v[162:163], v4 offset:10240
    ds_read_b64_tr_b16 v[164:165], v4 offset:12288
    ds_read_b64_tr_b16 v[166:167], v4 offset:14336
    s_waitcnt lgkmcnt(14)
    v_mfma_f32_16x16x32_bf16 v[24:27], v[168:171], v[48:51], v[24:27]
    buffer_load_dwordx4 v[112:115], v9, s[36:39], 0 offen offset:1024
    s_waitcnt lgkmcnt(12)
    v_mfma_f32_16x16x32_bf16 v[24:27], v[172:175], v[56:59], v[24:27]
    v_mfma_f32_16x16x32_bf16 v[28:31], v[172:175], v[60:63], v[28:31]
    buffer_load_dwordx4 v[116:119], v9, s[36:39], s8 offen offset:1024
    v_mfma_f32_16x16x32_bf16 v[28:31], v[168:171], v[52:55], v[28:31]
    ds_read_b64_tr_b16 v[168:169], v5 offset:8192
    ds_read_b64_tr_b16 v[170:171], v5 offset:10240
    ds_read_b64_tr_b16 v[172:173], v5 offset:12288
    ds_read_b64_tr_b16 v[174:175], v5 offset:14336
    s_waitcnt lgkmcnt(14)
    v_mfma_f32_16x16x32_bf16 v[32:35], v[176:179], v[48:51], v[32:35]
    buffer_load_dwordx4 v[120:123], v9, s[36:39], 0 offen offset:2048
    s_waitcnt lgkmcnt(12)
    v_mfma_f32_16x16x32_bf16 v[32:35], v[180:183], v[56:59], v[32:35]
    v_mfma_f32_16x16x32_bf16 v[36:39], v[180:183], v[60:63], v[36:39]
    buffer_load_dwordx4 v[124:127], v9, s[36:39], s8 offen offset:2048
    v_mfma_f32_16x16x32_bf16 v[36:39], v[176:179], v[52:55], v[36:39]
    ds_read_b64_tr_b16 v[176:177], v7 offset:8192
    ds_read_b64_tr_b16 v[178:179], v7 offset:10240
    ds_read_b64_tr_b16 v[180:181], v7 offset:12288
    ds_read_b64_tr_b16 v[182:183], v7 offset:14336
    s_waitcnt lgkmcnt(14)
    v_mfma_f32_16x16x32_bf16 v[40:43], v[184:187], v[48:51], v[40:43]
    buffer_load_dwordx4 v[128:131], v9, s[36:39], 0 offen offset:3072
    s_waitcnt lgkmcnt(12)
    v_mfma_f32_16x16x32_bf16 v[40:43], v[188:191], v[56:59], v[40:43]
    v_mfma_f32_16x16x32_bf16 v[44:47], v[188:191], v[60:63], v[44:47]
    v_mfma_f32_16x16x32_bf16 v[44:47], v[184:187], v[52:55], v[44:47]
    ds_read_b64_tr_b16 v[184:185], v8 offset:8192
    ds_read_b64_tr_b16 v[186:187], v8 offset:10240
    ds_read_b64_tr_b16 v[188:189], v8 offset:12288
    ds_read_b64_tr_b16 v[190:191], v8 offset:14336
    buffer_load_dwordx4 v[132:135], v9, s[36:39], s8 offen offset:3072
    s_waitcnt vmcnt(28)
    s_waitcnt lgkmcnt(14)
    v_mfma_f32_16x16x32_bf16 v[16:19], v[160:163], v[64:67], v[16:19]
    s_waitcnt vmcnt(26)
    s_waitcnt lgkmcnt(12)
    v_mfma_f32_16x16x32_bf16 v[16:19], v[164:167], v[72:75], v[16:19]
    buffer_load_dwordx4 v[136:139], v9, s[36:39], s64 offen offset:0
    s_waitcnt vmcnt(26)
    v_mfma_f32_16x16x32_bf16 v[20:23], v[164:167], v[76:79], v[20:23]
    v_mfma_f32_16x16x32_bf16 v[20:23], v[160:163], v[68:71], v[20:23]
    ds_read_b64_tr_b16 v[160:161], v4 offset:16384
    ds_read_b64_tr_b16 v[162:163], v4 offset:18432
    ds_read_b64_tr_b16 v[164:165], v4 offset:20480
    ds_read_b64_tr_b16 v[166:167], v4 offset:22528
    buffer_load_dwordx4 v[140:143], v9, s[36:39], s9 offen offset:0
    s_waitcnt lgkmcnt(14)
    v_mfma_f32_16x16x32_bf16 v[24:27], v[168:171], v[64:67], v[24:27]
    s_waitcnt lgkmcnt(12)
    v_mfma_f32_16x16x32_bf16 v[24:27], v[172:175], v[72:75], v[24:27]
    buffer_load_dwordx4 v[144:147], v9, s[36:39], s64 offen offset:1024
    v_mfma_f32_16x16x32_bf16 v[28:31], v[172:175], v[76:79], v[28:31]
    v_mfma_f32_16x16x32_bf16 v[28:31], v[168:171], v[68:71], v[28:31]
    ds_read_b64_tr_b16 v[168:169], v4 offset:24576
    ds_read_b64_tr_b16 v[170:171], v4 offset:26624
    ds_read_b64_tr_b16 v[172:173], v5 offset:16384
    ds_read_b64_tr_b16 v[174:175], v5 offset:18432
    buffer_load_dwordx4 v[148:151], v9, s[36:39], s9 offen offset:1024
    s_waitcnt lgkmcnt(14)
    v_mfma_f32_16x16x32_bf16 v[32:35], v[176:179], v[64:67], v[32:35]
    s_waitcnt lgkmcnt(12)
    v_mfma_f32_16x16x32_bf16 v[32:35], v[180:183], v[72:75], v[32:35]
    buffer_load_dwordx4 v[152:155], v9, s[36:39], s64 offen offset:2048
    v_mfma_f32_16x16x32_bf16 v[36:39], v[180:183], v[76:79], v[36:39]
    v_mfma_f32_16x16x32_bf16 v[36:39], v[176:179], v[68:71], v[36:39]
    ds_read_b64_tr_b16 v[176:177], v5 offset:20480
    ds_read_b64_tr_b16 v[178:179], v5 offset:22528
    ds_read_b64_tr_b16 v[180:181], v5 offset:24576
    ds_read_b64_tr_b16 v[182:183], v5 offset:26624
    s_waitcnt lgkmcnt(14)
    v_mfma_f32_16x16x32_bf16 v[40:43], v[184:187], v[64:67], v[40:43]
    buffer_load_dwordx4 v[156:159], v9, s[36:39], s9 offen offset:2048
    v_add_u32 v9, 7168, v9
    s_waitcnt lgkmcnt(12)
    v_mfma_f32_16x16x32_bf16 v[40:43], v[188:191], v[72:75], v[40:43]
    v_mfma_f32_16x16x32_bf16 v[44:47], v[188:191], v[76:79], v[44:47]
    s_add_u32 m0, s63, 0
    s_nop 0
    buffer_load_dwordx4 v13, s[44:47], s56 offen offset:0 lds
    v_mfma_f32_16x16x32_bf16 v[44:47], v[184:187], v[68:71], v[44:47]
    ds_read_b64_tr_b16 v[184:185], v7 offset:16384
    ds_read_b64_tr_b16 v[186:187], v7 offset:18432
    ds_read_b64_tr_b16 v[188:189], v7 offset:20480
    ds_read_b64_tr_b16 v[190:191], v7 offset:22528
    s_waitcnt vmcnt(31)
    s_waitcnt lgkmcnt(14)
    v_mfma_f32_16x16x32_bf16 v[16:19], v[160:163], v[80:83], v[16:19]
    buffer_load_dwordx4 v13, s[44:47], s57 offen offset:1024 lds
    s_waitcnt vmcnt(30)
    s_waitcnt lgkmcnt(12)
    v_mfma_f32_16x16x32_bf16 v[16:19], v[164:167], v[88:91], v[16:19]
    s_waitcnt vmcnt(28)
    s_waitcnt lgkmcnt(10)
    v_mfma_f32_16x16x32_bf16 v[16:19], v[168:171], v[96:99], v[16:19]
    buffer_load_dwordx4 v13, s[44:47], s58 offen offset:2048 lds
    s_waitcnt vmcnt(28)
    v_mfma_f32_16x16x32_bf16 v[20:23], v[168:171], v[100:103], v[20:23]
    v_mfma_f32_16x16x32_bf16 v[20:23], v[164:167], v[92:95], v[20:23]
    buffer_load_dwordx4 v13, s[44:47], s59 offen offset:3072 lds
    v_add_u32 v13, 262144, v13
    v_mfma_f32_16x16x32_bf16 v[20:23], v[160:163], v[84:87], v[20:23]
    ds_read_b64_tr_b16 v[160:161], v7 offset:24576
    ds_read_b64_tr_b16 v[162:163], v7 offset:26624
    ds_read_b64_tr_b16 v[164:165], v8 offset:16384
    ds_read_b64_tr_b16 v[166:167], v8 offset:18432
    s_waitcnt lgkmcnt(12)
    v_mfma_f32_16x16x32_bf16 v[24:27], v[172:175], v[80:83], v[24:27]
    ds_read_b64_tr_b16 v[168:169], v8 offset:20480
    ds_read_b64_tr_b16 v[170:171], v8 offset:22528
    s_add_u32 m0, s63, 106496
    s_nop 0
    buffer_load_dwordx4 v13, s[44:47], s56 offen offset:0 lds
    s_waitcnt lgkmcnt(12)
    v_mfma_f32_16x16x32_bf16 v[24:27], v[176:179], v[88:91], v[24:27]
    s_waitcnt lgkmcnt(10)
    v_mfma_f32_16x16x32_bf16 v[24:27], v[180:183], v[96:99], v[24:27]
    buffer_load_dwordx4 v13, s[44:47], s57 offen offset:1024 lds
    v_mfma_f32_16x16x32_bf16 v[28:31], v[180:183], v[100:103], v[28:31]
    v_mfma_f32_16x16x32_bf16 v[28:31], v[176:179], v[92:95], v[28:31]
    v_mfma_f32_16x16x32_bf16 v[28:31], v[172:175], v[84:87], v[28:31]
    ds_read_b64_tr_b16 v[172:173], v8 offset:24576
    ds_read_b64_tr_b16 v[174:175], v8 offset:26624
    buffer_load_dwordx4 v13, s[44:47], s58 offen offset:2048 lds
    s_waitcnt lgkmcnt(10)
    v_mfma_f32_16x16x32_bf16 v[32:35], v[184:187], v[80:83], v[32:35]
    s_waitcnt lgkmcnt(8)
    v_mfma_f32_16x16x32_bf16 v[32:35], v[188:191], v[88:91], v[32:35]
    buffer_load_dwordx4 v13, s[44:47], s59 offen offset:3072 lds
    v_add_u32 v13, 262144, v13
    s_waitcnt lgkmcnt(6)
    v_mfma_f32_16x16x32_bf16 v[32:35], v[160:163], v[96:99], v[32:35]
    v_mfma_f32_16x16x32_bf16 v[36:39], v[160:163], v[100:103], v[36:39]
    s_mov_b32 m0, s52
    s_nop 0
    buffer_load_dwordx4 v14, s[72:75], s56 offen offset:0 lds
    v_mfma_f32_16x16x32_bf16 v[36:39], v[188:191], v[92:95], v[36:39]
    s_waitcnt vmcnt(23) lgkmcnt(0)
    s_barrier
    v_subrev_u32 v4, 57344, v4
    v_subrev_u32 v5, 57344, v5
    v_subrev_u32 v7, 57344, v7
    v_subrev_u32 v8, 57344, v8
    v_mfma_f32_16x16x32_bf16 v[36:39], v[184:187], v[84:87], v[36:39]
    ds_read_b64_tr_b16 v[176:177], v4 offset:0
    ds_read_b64_tr_b16 v[178:179], v4 offset:2048
    ds_read_b64_tr_b16 v[180:181], v4 offset:4096
    ds_read_b64_tr_b16 v[182:183], v4 offset:6144
    buffer_load_dwordx4 v14, s[72:75], s57 offen offset:1024 lds
    v_mfma_f32_16x16x32_bf16 v[40:43], v[164:167], v[80:83], v[40:43]
    ds_read_b64_tr_b16 v[184:185], v5 offset:0
    ds_read_b64_tr_b16 v[186:187], v5 offset:2048
    ds_read_b64_tr_b16 v[188:189], v5 offset:4096
    ds_read_b64_tr_b16 v[190:191], v5 offset:6144
    v_mfma_f32_16x16x32_bf16 v[40:43], v[168:171], v[88:91], v[40:43]
    ds_read_b64_tr_b16 v[160:161], v7 offset:0
    ds_read_b64_tr_b16 v[162:163], v7 offset:2048
    buffer_load_dwordx4 v14, s[72:75], s58 offen offset:2048 lds
    v_mfma_f32_16x16x32_bf16 v[40:43], v[172:175], v[96:99], v[40:43]
    v_mfma_f32_16x16x32_bf16 v[44:47], v[172:175], v[100:103], v[44:47]
    buffer_load_dwordx4 v14, s[72:75], s59 offen offset:3072 lds
    v_mfma_f32_16x16x32_bf16 v[44:47], v[168:171], v[92:95], v[44:47]
    v_mfma_f32_16x16x32_bf16 v[44:47], v[164:167], v[84:87], v[44:47]
    ds_read_b64_tr_b16 v[164:165], v7 offset:4096
    ds_read_b64_tr_b16 v[166:167], v7 offset:6144
    ds_read_b64_tr_b16 v[168:169], v8 offset:0
    ds_read_b64_tr_b16 v[170:171], v8 offset:2048
    s_waitcnt vmcnt(25)
    s_waitcnt lgkmcnt(12)
    v_mfma_f32_16x16x32_bf16 v[16:19], v[176:179], v[104:107], v[16:19]
    ds_read_b64_tr_b16 v[172:173], v8 offset:4096
    ds_read_b64_tr_b16 v[174:175], v8 offset:6144
    s_add_u32 m0, s63, 16384
    s_nop 0
    buffer_load_dwordx4 v13, s[44:47], s56 offen offset:0 lds
    s_waitcnt vmcnt(24)
    s_waitcnt lgkmcnt(12)
    v_mfma_f32_16x16x32_bf16 v[16:19], v[180:183], v[112:115], v[16:19]
    s_waitcnt vmcnt(23)
    v_mfma_f32_16x16x32_bf16 v[20:23], v[180:183], v[116:119], v[20:23]
    v_mfma_f32_16x16x32_bf16 v[20:23], v[176:179], v[108:111], v[20:23]
    ds_read_b64_tr_b16 v[176:177], v4 offset:8192
    ds_read_b64_tr_b16 v[178:179], v4 offset:10240
    ds_read_b64_tr_b16 v[180:181], v4 offset:12288
    ds_read_b64_tr_b16 v[182:183], v4 offset:14336
    s_waitcnt lgkmcnt(14)
    v_mfma_f32_16x16x32_bf16 v[24:27], v[184:187], v[104:107], v[24:27]
    buffer_load_dwordx4 v13, s[44:47], s57 offen offset:1024 lds
    s_waitcnt lgkmcnt(12)
    v_mfma_f32_16x16x32_bf16 v[24:27], v[188:191], v[112:115], v[24:27]
    v_mfma_f32_16x16x32_bf16 v[28:31], v[188:191], v[116:119], v[28:31]
    v_mfma_f32_16x16x32_bf16 v[28:31], v[184:187], v[108:111], v[28:31]
    ds_read_b64_tr_b16 v[184:185], v5 offset:8192
    ds_read_b64_tr_b16 v[186:187], v5 offset:10240
    ds_read_b64_tr_b16 v[188:189], v5 offset:12288
    ds_read_b64_tr_b16 v[190:191], v5 offset:14336
    s_waitcnt lgkmcnt(14)
    v_mfma_f32_16x16x32_bf16 v[32:35], v[160:163], v[104:107], v[32:35]
    s_waitcnt lgkmcnt(12)
    v_mfma_f32_16x16x32_bf16 v[32:35], v[164:167], v[112:115], v[32:35]
    buffer_load_dwordx4 v13, s[44:47], s58 offen offset:2048 lds
    v_mfma_f32_16x16x32_bf16 v[36:39], v[164:167], v[116:119], v[36:39]
    v_mfma_f32_16x16x32_bf16 v[36:39], v[160:163], v[108:111], v[36:39]
    ds_read_b64_tr_b16 v[160:161], v7 offset:8192
    ds_read_b64_tr_b16 v[162:163], v7 offset:10240
    ds_read_b64_tr_b16 v[164:165], v7 offset:12288
    ds_read_b64_tr_b16 v[166:167], v7 offset:14336
    s_waitcnt lgkmcnt(14)
    v_mfma_f32_16x16x32_bf16 v[40:43], v[168:171], v[104:107], v[40:43]
    s_waitcnt lgkmcnt(12)
    v_mfma_f32_16x16x32_bf16 v[40:43], v[172:175], v[112:115], v[40:43]
    v_mfma_f32_16x16x32_bf16 v[44:47], v[172:175], v[116:119], v[44:47]
    buffer_load_dwordx4 v13, s[44:47], s59 offen offset:3072 lds
    v_add_u32 v13, 262144, v13
    v_mfma_f32_16x16x32_bf16 v[44:47], v[168:171], v[108:111], v[44:47]
    ds_read_b64_tr_b16 v[168:169], v8 offset:8192
    ds_read_b64_tr_b16 v[170:171], v8 offset:10240
    ds_read_b64_tr_b16 v[172:173], v8 offset:12288
    ds_read_b64_tr_b16 v[174:175], v8 offset:14336
    s_waitcnt vmcnt(25)
    s_waitcnt lgkmcnt(14)
    v_mfma_f32_16x16x32_bf16 v[16:19], v[176:179], v[120:123], v[16:19]
    s_waitcnt vmcnt(23)
    s_waitcnt lgkmcnt(12)
    v_mfma_f32_16x16x32_bf16 v[16:19], v[180:183], v[128:131], v[16:19]
    s_waitcnt vmcnt(22)
    v_mfma_f32_16x16x32_bf16 v[20:23], v[180:183], v[132:135], v[20:23]
    s_add_u32 m0, s63, 122880
    s_nop 0
    buffer_load_dwordx4 v13, s[44:47], s56 offen offset:0 lds
    v_mfma_f32_16x16x32_bf16 v[20:23], v[176:179], v[124:127], v[20:23]
    ds_read_b64_tr_b16 v[176:177], v4 offset:16384
    ds_read_b64_tr_b16 v[178:179], v4 offset:18432
    ds_read_b64_tr_b16 v[180:181], v4 offset:20480
    ds_read_b64_tr_b16 v[182:183], v4 offset:22528
    s_waitcnt lgkmcnt(14)
    v_mfma_f32_16x16x32_bf16 v[24:27], v[184:187], v[120:123], v[24:27]
    s_waitcnt lgkmcnt(12)
    v_mfma_f32_16x16x32_bf16 v[24:27], v[188:191], v[128:131], v[24:27]
    v_mfma_f32_16x16x32_bf16 v[28:31], v[188:191], v[132:135], v[28:31]
    v_mfma_f32_16x16x32_bf16 v[28:31], v[184:187], v[124:127], v[28:31]
    ds_read_b64_tr_b16 v[184:185], v4 offset:24576
    ds_read_b64_tr_b16 v[186:187], v4 offset:26624
    ds_read_b64_tr_b16 v[188:189], v5 offset:16384
    ds_read_b64_tr_b16 v[190:191], v5 offset:18432
    buffer_load_dwordx4 v13, s[44:47], s57 offen offset:1024 lds
    s_waitcnt lgkmcnt(14)
    v_mfma_f32_16x16x32_bf16 v[32:35], v[160:163], v[120:123], v[32:35]
    s_waitcnt lgkmcnt(12)
    v_mfma_f32_16x16x32_bf16 v[32:35], v[164:167], v[128:131], v[32:35]
    v_mfma_f32_16x16x32_bf16 v[36:39], v[164:167], v[132:135], v[36:39]
    v_mfma_f32_16x16x32_bf16 v[36:39], v[160:163], v[124:127], v[36:39]
    ds_read_b64_tr_b16 v[160:161], v5 offset:20480
    ds_read_b64_tr_b16 v[162:163], v5 offset:22528
    ds_read_b64_tr_b16 v[164:165], v5 offset:24576
    ds_read_b64_tr_b16 v[166:167], v5 offset:26624
    s_waitcnt lgkmcnt(14)
    v_mfma_f32_16x16x32_bf16 v[40:43], v[168:171], v[120:123], v[40:43]
    buffer_load_dwordx4 v13, s[44:47], s58 offen offset:2048 lds
    s_waitcnt lgkmcnt(12)
    v_mfma_f32_16x16x32_bf16 v[40:43], v[172:175], v[128:131], v[40:43]
    v_mfma_f32_16x16x32_bf16 v[44:47], v[172:175], v[132:135], v[44:47]
    v_mfma_f32_16x16x32_bf16 v[44:47], v[168:171], v[124:127], v[44:47]
    ds_read_b64_tr_b16 v[168:169], v7 offset:16384
    ds_read_b64_tr_b16 v[170:171], v7 offset:18432
    ds_read_b64_tr_b16 v[172:173], v7 offset:20480
    ds_read_b64_tr_b16 v[174:175], v7 offset:22528
    s_waitcnt vmcnt(24)
    s_waitcnt lgkmcnt(14)
    v_mfma_f32_16x16x32_bf16 v[16:19], v[176:179], v[136:139], v[16:19]
    buffer_load_dwordx4 v13, s[44:47], s59 offen offset:3072 lds
    v_add_u32 v13, 262144, v13
    s_waitcnt vmcnt(23)
    s_waitcnt lgkmcnt(12)
    v_mfma_f32_16x16x32_bf16 v[16:19], v[180:183], v[144:147], v[16:19]
    s_waitcnt vmcnt(21)
    s_waitcnt lgkmcnt(10)
    v_mfma_f32_16x16x32_bf16 v[16:19], v[184:187], v[152:155], v[16:19]
    s_waitcnt vmcnt(20)
    v_mfma_f32_16x16x32_bf16 v[20:23], v[184:187], v[156:159], v[20:23]
    v_mfma_f32_16x16x32_bf16 v[20:23], v[180:183], v[148:151], v[20:23]
    v_mfma_f32_16x16x32_bf16 v[20:23], v[176:179], v[140:143], v[20:23]
    ds_read_b64_tr_b16 v[176:177], v7 offset:24576
    ds_read_b64_tr_b16 v[178:179], v7 offset:26624
    ds_read_b64_tr_b16 v[180:181], v8 offset:16384
    ds_read_b64_tr_b16 v[182:183], v8 offset:18432
    s_add_u32 m0, s63, 139264
    s_nop 0
    buffer_load_dwordx4 v13, s[44:47], s56 offen offset:0 lds
    s_waitcnt lgkmcnt(12)
    v_mfma_f32_16x16x32_bf16 v[24:27], v[188:191], v[136:139], v[24:27]
    ds_read_b64_tr_b16 v[184:185], v8 offset:20480
    ds_read_b64_tr_b16 v[186:187], v8 offset:22528
    s_waitcnt lgkmcnt(12)
    v_mfma_f32_16x16x32_bf16 v[24:27], v[160:163], v[144:147], v[24:27]
    s_waitcnt lgkmcnt(10)
    v_mfma_f32_16x16x32_bf16 v[24:27], v[164:167], v[152:155], v[24:27]
    v_mfma_f32_16x16x32_bf16 v[28:31], v[164:167], v[156:159], v[28:31]
    v_mfma_f32_16x16x32_bf16 v[28:31], v[160:163], v[148:151], v[28:31]
    buffer_load_dwordx4 v13, s[44:47], s57 offen offset:1024 lds
    v_mfma_f32_16x16x32_bf16 v[28:31], v[188:191], v[140:143], v[28:31]
    ds_read_b64_tr_b16 v[188:189], v8 offset:24576
    ds_read_b64_tr_b16 v[190:191], v8 offset:26624
    s_waitcnt lgkmcnt(10)
    v_mfma_f32_16x16x32_bf16 v[32:35], v[168:171], v[136:139], v[32:35]
    s_waitcnt lgkmcnt(8)
    v_mfma_f32_16x16x32_bf16 v[32:35], v[172:175], v[144:147], v[32:35]
    s_waitcnt lgkmcnt(6)
    v_mfma_f32_16x16x32_bf16 v[32:35], v[176:179], v[152:155], v[32:35]
    buffer_load_dwordx4 v13, s[44:47], s58 offen offset:2048 lds
    v_mfma_f32_16x16x32_bf16 v[36:39], v[176:179], v[156:159], v[36:39]
    v_mfma_f32_16x16x32_bf16 v[36:39], v[172:175], v[148:151], v[36:39]
    s_waitcnt lgkmcnt(0)
    s_barrier
    v_mfma_f32_16x16x32_bf16 v[36:39], v[168:171], v[140:143], v[36:39]
    v_mfma_f32_16x16x32_bf16 v[40:43], v[180:183], v[136:139], v[40:43]
    v_mfma_f32_16x16x32_bf16 v[40:43], v[184:187], v[144:147], v[40:43]
    buffer_load_dwordx4 v13, s[44:47], s59 offen offset:3072 lds
    v_add_u32 v13, 262144, v13
    v_mfma_f32_16x16x32_bf16 v[40:43], v[188:191], v[152:155], v[40:43]
    v_mfma_f32_16x16x32_bf16 v[44:47], v[188:191], v[156:159], v[44:47]
    v_mfma_f32_16x16x32_bf16 v[44:47], v[184:187], v[148:151], v[44:47]
    v_mfma_f32_16x16x32_bf16 v[44:47], v[180:183], v[140:143], v[44:47]
    s_add_u32 m0, s63, 32768
    s_nop 0
    buffer_load_dwordx4 v13, s[44:47], s56 offen offset:0 lds
    buffer_load_dwordx4 v13, s[44:47], s57 offen offset:1024 lds
    buffer_load_dwordx4 v13, s[44:47], s58 offen offset:2048 lds
    buffer_load_dwordx4 v13, s[44:47], s59 offen offset:3072 lds
    v_add_u32 v13, 262144, v13
    s_add_u32 m0, s63, 65536
    s_nop 0
    buffer_load_dwordx4 v13, s[44:47], s56 offen offset:0 lds
    buffer_load_dwordx4 v13, s[44:47], s57 offen offset:1024 lds
    buffer_load_dwordx4 v13, s[44:47], s58 offen offset:2048 lds
    buffer_load_dwordx4 v13, s[44:47], s59 offen offset:3072 lds
    v_add_u32 v13, 262144, v13
    s_add_u32 m0, s63, 81920
    s_nop 0
    buffer_load_dwordx4 v13, s[44:47], s56 offen offset:0 lds
    buffer_load_dwordx4 v13, s[44:47], s57 offen offset:1024 lds
    buffer_load_dwordx4 v13, s[44:47], s58 offen offset:2048 lds
    buffer_load_dwordx4 v13, s[44:47], s59 offen offset:3072 lds
    v_add_u32 v13, 262144, v13
    s_nop 7
    v_permlane16_swap_b32 v16, v20
    v_permlane16_swap_b32 v17, v21
    v_permlane16_swap_b32 v18, v22
    v_permlane16_swap_b32 v19, v23
    v_permlane16_swap_b32 v24, v28
    v_permlane16_swap_b32 v25, v29
    v_permlane16_swap_b32 v26, v30
    v_permlane16_swap_b32 v27, v31
    v_permlane16_swap_b32 v32, v36
    v_permlane16_swap_b32 v33, v37
    v_permlane16_swap_b32 v34, v38
    v_permlane16_swap_b32 v35, v39
    v_permlane16_swap_b32 v40, v44
    v_permlane16_swap_b32 v41, v45
    v_permlane16_swap_b32 v42, v46
    v_permlane16_swap_b32 v43, v47
    v_mul_f32 v48, 0xbfb8aa3b, v16
    v_mul_f32 v49, 0xbfb8aa3b, v17
    v_mul_f32 v50, 0xbfb8aa3b, v18
    v_mul_f32 v51, 0xbfb8aa3b, v19
    v_mul_f32 v52, 0xbfb8aa3b, v20
    v_mul_f32 v53, 0xbfb8aa3b, v21
    v_mul_f32 v54, 0xbfb8aa3b, v22
    v_mul_f32 v55, 0xbfb8aa3b, v23
    v_exp_f32 v48, v48
    v_exp_f32 v49, v49
    v_exp_f32 v50, v50
    v_exp_f32 v51, v51
    v_exp_f32 v52, v52
    v_exp_f32 v53, v53
    v_exp_f32 v54, v54
    v_exp_f32 v55, v55
    v_add_f32 v48, 1.0, v48
    v_add_f32 v49, 1.0, v49
    v_add_f32 v50, 1.0, v50
    v_add_f32 v51, 1.0, v51
    v_add_f32 v52, 1.0, v52
    v_add_f32 v53, 1.0, v53
    v_add_f32 v54, 1.0, v54
    v_add_f32 v55, 1.0, v55
    v_rcp_f32 v48, v48
    v_rcp_f32 v49, v49
    v_rcp_f32 v50, v50
    v_rcp_f32 v51, v51
    v_rcp_f32 v52, v52
    v_rcp_f32 v53, v53
    v_rcp_f32 v54, v54
    v_rcp_f32 v55, v55
    v_mul_f32 v16, v16, v48
    v_mul_f32 v17, v17, v49
    v_mul_f32 v18, v18, v50
    v_mul_f32 v19, v19, v51
    v_mul_f32 v20, v20, v52
    v_mul_f32 v21, v21, v53
    v_mul_f32 v22, v22, v54
    v_mul_f32 v23, v23, v55
    v_cvt_pk_bf16_f32 v16, v16, v17
    v_cvt_pk_bf16_f32 v17, v18, v19
    v_cvt_pk_bf16_f32 v18, v20, v21
    v_cvt_pk_bf16_f32 v19, v22, v23
    v_mul_f32 v56, 0xbfb8aa3b, v24
    v_mul_f32 v57, 0xbfb8aa3b, v25
    v_mul_f32 v58, 0xbfb8aa3b, v26
    v_mul_f32 v59, 0xbfb8aa3b, v27
    v_mul_f32 v60, 0xbfb8aa3b, v28
    v_mul_f32 v61, 0xbfb8aa3b, v29
    v_mul_f32 v62, 0xbfb8aa3b, v30
    v_mul_f32 v63, 0xbfb8aa3b, v31
    v_exp_f32 v56, v56
    v_exp_f32 v57, v57
    v_exp_f32 v58, v58
    v_exp_f32 v59, v59
    v_exp_f32 v60, v60
    v_exp_f32 v61, v61
    v_exp_f32 v62, v62
    v_exp_f32 v63, v63
    v_add_f32 v56, 1.0, v56
    v_add_f32 v57, 1.0, v57
    v_add_f32 v58, 1.0, v58
    v_add_f32 v59, 1.0, v59
    v_add_f32 v60, 1.0, v60
    v_add_f32 v61, 1.0, v61
    v_add_f32 v62, 1.0, v62
    v_add_f32 v63, 1.0, v63
    v_rcp_f32 v56, v56
    v_rcp_f32 v57, v57
    v_rcp_f32 v58, v58
    v_rcp_f32 v59, v59
    v_rcp_f32 v60, v60
    v_rcp_f32 v61, v61
    v_rcp_f32 v62, v62
    v_rcp_f32 v63, v63
    v_mul_f32 v24, v24, v56
    v_mul_f32 v25, v25, v57
    v_mul_f32 v26, v26, v58
    v_mul_f32 v27, v27, v59
    v_mul_f32 v28, v28, v60
    v_mul_f32 v29, v29, v61
    v_mul_f32 v30, v30, v62
    v_mul_f32 v31, v31, v63
    v_cvt_pk_bf16_f32 v20, v24, v25
    v_cvt_pk_bf16_f32 v21, v26, v27
    v_cvt_pk_bf16_f32 v22, v28, v29
    v_cvt_pk_bf16_f32 v23, v30, v31
    v_mul_f32 v64, 0xbfb8aa3b, v32
    v_mul_f32 v65, 0xbfb8aa3b, v33
    v_mul_f32 v66, 0xbfb8aa3b, v34
    v_mul_f32 v67, 0xbfb8aa3b, v35
    v_mul_f32 v68, 0xbfb8aa3b, v36
    v_mul_f32 v69, 0xbfb8aa3b, v37
    v_mul_f32 v70, 0xbfb8aa3b, v38
    v_mul_f32 v71, 0xbfb8aa3b, v39
    v_exp_f32 v64, v64
    v_exp_f32 v65, v65
    v_exp_f32 v66, v66
    v_exp_f32 v67, v67
    v_exp_f32 v68, v68
    v_exp_f32 v69, v69
    v_exp_f32 v70, v70
    v_exp_f32 v71, v71
    v_add_f32 v64, 1.0, v64
    v_add_f32 v65, 1.0, v65
    v_add_f32 v66, 1.0, v66
    v_add_f32 v67, 1.0, v67
    v_add_f32 v68, 1.0, v68
    v_add_f32 v69, 1.0, v69
    v_add_f32 v70, 1.0, v70
    v_add_f32 v71, 1.0, v71
    v_rcp_f32 v64, v64
    v_rcp_f32 v65, v65
    v_rcp_f32 v66, v66
    v_rcp_f32 v67, v67
    v_rcp_f32 v68, v68
    v_rcp_f32 v69, v69
    v_rcp_f32 v70, v70
    v_rcp_f32 v71, v71
    v_mul_f32 v32, v32, v64
    v_mul_f32 v33, v33, v65
    v_mul_f32 v34, v34, v66
    v_mul_f32 v35, v35, v67
    v_mul_f32 v36, v36, v68
    v_mul_f32 v37, v37, v69
    v_mul_f32 v38, v38, v70
    v_mul_f32 v39, v39, v71
    v_cvt_pk_bf16_f32 v32, v32, v33
    v_cvt_pk_bf16_f32 v33, v34, v35
    v_cvt_pk_bf16_f32 v34, v36, v37
    v_cvt_pk_bf16_f32 v35, v38, v39
    v_mul_f32 v72, 0xbfb8aa3b, v40
    v_mul_f32 v73, 0xbfb8aa3b, v41
    v_mul_f32 v74, 0xbfb8aa3b, v42
    v_mul_f32 v75, 0xbfb8aa3b, v43
    v_mul_f32 v76, 0xbfb8aa3b, v44
    v_mul_f32 v77, 0xbfb8aa3b, v45
    v_mul_f32 v78, 0xbfb8aa3b, v46
    v_mul_f32 v79, 0xbfb8aa3b, v47
    v_exp_f32 v72, v72
    v_exp_f32 v73, v73
    v_exp_f32 v74, v74
    v_exp_f32 v75, v75
    v_exp_f32 v76, v76
    v_exp_f32 v77, v77
    v_exp_f32 v78, v78
    v_exp_f32 v79, v79
    v_add_f32 v72, 1.0, v72
    v_add_f32 v73, 1.0, v73
    v_add_f32 v74, 1.0, v74
    v_add_f32 v75, 1.0, v75
    v_add_f32 v76, 1.0, v76
    v_add_f32 v77, 1.0, v77
    v_add_f32 v78, 1.0, v78
    v_add_f32 v79, 1.0, v79
    v_rcp_f32 v72, v72
    v_rcp_f32 v73, v73
    v_rcp_f32 v74, v74
    v_rcp_f32 v75, v75
    v_rcp_f32 v76, v76
    v_rcp_f32 v77, v77
    v_rcp_f32 v78, v78
    v_rcp_f32 v79, v79
    v_mul_f32 v40, v40, v72
    v_mul_f32 v41, v41, v73
    v_mul_f32 v42, v42, v74
    v_mul_f32 v43, v43, v75
    v_mul_f32 v44, v44, v76
    v_mul_f32 v45, v45, v77
    v_mul_f32 v46, v46, v78
    v_mul_f32 v47, v47, v79
    v_cvt_pk_bf16_f32 v36, v40, v41
    v_cvt_pk_bf16_f32 v37, v42, v43
    v_cvt_pk_bf16_f32 v38, v44, v45
    v_cvt_pk_bf16_f32 v39, v46, v47
    v_and_b32 v11, 31, v0
    v_lshrrev_b32 v12, 1, v11
    v_and_b32 v12, 3, v12
    v_lshlrev_b32 v12, 4, v12
    v_lshl_add_u32 v12, v11, 7, v12
    v_lshrrev_b32 v11, 5, v0
    v_lshl_add_u32 v12, v11, 3, v12
    v_add_u32 v12, s52, v12
    s_waitcnt vmcnt(24)
    v_xor_b32 v11, 0, v12
    ds_read_b64 v[24:25], v11
    v_xor_b32 v11, 16, v12
    ds_read_b64 v[26:27], v11
    v_xor_b32 v11, 32, v12
    ds_read_b64 v[28:29], v11
    v_xor_b32 v11, 48, v12
    ds_read_b64 v[30:31], v11
    v_xor_b32 v11, 64, v12
    ds_read_b64 v[40:41], v11
    v_xor_b32 v11, 80, v12
    ds_read_b64 v[42:43], v11
    v_xor_b32 v11, 96, v12
    ds_read_b64 v[44:45], v11
    v_xor_b32 v11, 112, v12
    ds_read_b64 v[46:47], v11
    s_add_u32 s6, s4, 33554432
    s_addc_u32 s7, s5, 0
    s_mov_b32 s20, s6
    s_and_b32 s21, s7, 0xffff
    s_mov_b32 s22, 4194304
    s_mov_b32 s23, 0x20000
    s_add_u32 s6, s4, 43122688
    s_addc_u32 s7, s5, 0
    s_mov_b32 s76, s6
    s_and_b32 s77, s7, 0xffff
    s_mov_b32 s78, 32768
    s_mov_b32 s79, 0x20000
    v_lshrrev_b32 v11, 4, v0
    v_bfe_u32 v12, v0, 2, 2
    v_lshl_add_u32 v4, v11, 2, v12
    v_lshlrev_b32 v4, 7, v4
    v_lshrrev_b32 v12, 1, v12
    v_and_b32 v11, 1, v11
    v_lshl_or_b32 v12, v11, 1, v12
    v_lshl_add_u32 v4, v12, 5, v4
    v_and_b32 v11, 1, v0
    v_lshl_add_u32 v4, v11, 4, v4
    v_bfe_u32 v11, v0, 1, 1
    v_lshl_add_u32 v4, v11, 3, v4
    v_xor_b32 v5, 64, v4
    s_lshl_b32 s28, s51, 15
    v_lshlrev_b32 v9, 4, v0
    v_add_u32 v9, s28, v9
    s_mov_b32 s53, 106496
    s_mov_b32 s54, -90112
    s_mov_b32 s55, 106496
    s_lshl_b32 s28, s24, 12
    s_add_u32 s28, s28, 49152
    v_lshlrev_b32 v11, 4, v0
    v_add_u32 v2, s28, v11
    v_add_u32 v3, s52, v11
    v_and_b32 v11, 31, v0
    v_bfe_u32 v12, v0, 1, 2
    v_lshrrev_b32 v8, 4, v0
    v_and_b32 v8, 2, v8
    v_xor_b32 v12, v12, v8
    v_lshlrev_b32 v12, 4, v12
    v_lshl_add_u32 v6, v11, 6, v12
    v_add_u32 v6, s52, v6
    v_lshrrev_b32 v11, 2, v0
    v_bfe_u32 v12, v0, 3, 2
    v_and_b32 v8, 3, v0
    v_xor_b32 v12, v12, v8
    v_lshlrev_b32 v12, 4, v12
    v_lshl_add_u32 v8, v11, 6, v12
    v_add_u32 v8, s52, v8
    s_lshl_b32 s27, s51, 4
    v_add_u32 v11, s27, v11
    v_lshlrev_b32 v10, 11, v11
    v_and_b32 v11, 3, v0
    v_lshl_add_u32 v10, v11, 4, v10
    s_add_u32 s27, s50, 0
    v_add_u32 v10, s27, v10
    s_mov_b32 s36, s70
    s_and_b32 s37, s71, 0xffff
    s_mov_b32 s38, 4194304
    s_mov_b32 s39, 0x20000
    s_mov_b32 s67, 32768
    s_lshl_b32 s27, s48, 11
    v_lshrrev_b32 v11, 3, v0
    v_lshlrev_b32 v11, 8, v11
    v_and_b32 v12, 7, v0
    v_lshl_add_u32 v11, v12, 2, v11
    v_add_u32 v15, s27, v11
    s_waitcnt lgkmcnt(0)
    v_lshlrev_b32 v11, 4, v0
    v_add_u32 v11, s52, v11
    ds_write_b128 v11, v[32:35] offset:0
    ds_write_b128 v11, v[36:39] offset:1024
    ds_write_b128 v11, v[40:43] offset:2048
    ds_write_b128 v11, v[44:47] offset:3072
    s_waitcnt vmcnt(0) lgkmcnt(0)
    s_setprio 0
    s_cmp_lg_u32 s24, 0
    s_cbranch_scc1 attn_out_kernel_go
    s_mov_b32 s65, 0x4000
    buffer_load_dword v14, v15, s[76:79], 0 offen sc1
    s_sleep 2
attn_out_kernel_poll:
    buffer_load_dword v13, v15, s[76:79], 0 offen sc1
    s_waitcnt vmcnt(1)
    v_cmp_ne_u32 vcc, 1, v14
    s_cbranch_vccz attn_out_kernel_got
    s_sleep 2
    buffer_load_dword v14, v15, s[76:79], 0 offen sc1
    s_waitcnt vmcnt(1)
    v_cmp_ne_u32 vcc, 1, v13
    s_cbranch_vccz attn_out_kernel_got
    s_sleep 2
    s_sub_u32 s65, s65, 1
    s_cmp_lg_u32 s65, 0
    s_cbranch_scc1 attn_out_kernel_poll
attn_out_kernel_got:
attn_out_kernel_go:
    s_barrier
attn_out_kernel_proj:
    v_xor_b32 v40, 32, v4
    v_xor_b32 v41, 32, v5
    s_mov_b32 s11, 0x8000
    buffer_load_dwordx4 v[80:83], v9, s[20:23], 0 offen offset:0 sc1
    buffer_load_dwordx4 v[84:87], v9, s[20:23], s11 offen offset:0 sc1
    buffer_load_dwordx4 v[88:91], v9, s[20:23], 0 offen offset:1024 sc1
    buffer_load_dwordx4 v[92:95], v9, s[20:23], s11 offen offset:1024 sc1
    buffer_load_dwordx4 v[96:99], v9, s[20:23], 0 offen offset:2048 sc1
    buffer_load_dwordx4 v[100:103], v9, s[20:23], s11 offen offset:2048 sc1
    ds_read_b64_tr_b16 v[208:209], v4 offset:0
    ds_read_b64_tr_b16 v[210:211], v4 offset:2048
    ds_read_b64_tr_b16 v[212:213], v40 offset:0
    ds_read_b64_tr_b16 v[214:215], v40 offset:2048
    ds_read_b64_tr_b16 v[216:217], v5 offset:0
    ds_read_b64_tr_b16 v[218:219], v5 offset:2048
    ds_read_b64_tr_b16 v[220:221], v41 offset:0
    ds_read_b64_tr_b16 v[222:223], v41 offset:2048
    ds_read_b64_tr_b16 v[224:225], v4 offset:4096
    ds_read_b64_tr_b16 v[226:227], v4 offset:6144
    ds_read_b64_tr_b16 v[228:229], v40 offset:4096
    ds_read_b64_tr_b16 v[230:231], v40 offset:6144
    ds_read_b64_tr_b16 v[232:233], v5 offset:4096
    ds_read_b64_tr_b16 v[234:235], v5 offset:6144
    s_waitcnt vmcnt(5)
    s_waitcnt lgkmcnt(12)
    v_mfma_f32_16x16x32_bf16 v[48:51], v[208:211], v[80:83], 0
    ds_read_b64_tr_b16 v[236:237], v41 offset:4096
    ds_read_b64_tr_b16 v[238:239], v41 offset:6144
    buffer_load_dwordx4 v[104:107], v9, s[20:23], 0 offen offset:3072 sc1
    s_waitcnt vmcnt(5)
    v_mfma_f32_16x16x32_bf16 v[52:55], v[208:211], v[84:87], 0
    ds_read_b64_tr_b16 v[208:209], v4 offset:8192
    ds_read_b64_tr_b16 v[210:211], v4 offset:10240
    s_waitcnt lgkmcnt(14)
    v_mfma_f32_16x16x32_bf16 v[56:59], v[212:215], v[80:83], 0
    v_mfma_f32_16x16x32_bf16 v[60:63], v[212:215], v[84:87], 0
    ds_read_b64_tr_b16 v[212:213], v40 offset:8192
    ds_read_b64_tr_b16 v[214:215], v40 offset:10240
    s_waitcnt lgkmcnt(14)
    v_mfma_f32_16x16x32_bf16 v[64:67], v[216:219], v[80:83], 0
    buffer_load_dwordx4 v[108:111], v9, s[20:23], s11 offen offset:3072 sc1
    v_add_u32 v9, 4096, v9
    v_mfma_f32_16x16x32_bf16 v[68:71], v[216:219], v[84:87], 0
    ds_read_b64_tr_b16 v[216:217], v5 offset:8192
    ds_read_b64_tr_b16 v[218:219], v5 offset:10240
    s_waitcnt lgkmcnt(14)
    v_mfma_f32_16x16x32_bf16 v[72:75], v[220:223], v[80:83], 0
    v_mfma_f32_16x16x32_bf16 v[76:79], v[220:223], v[84:87], 0
    ds_read_b64_tr_b16 v[220:221], v41 offset:8192
    ds_read_b64_tr_b16 v[222:223], v41 offset:10240
    s_waitcnt vmcnt(5)
    s_waitcnt lgkmcnt(14)
    v_mfma_f32_16x16x32_bf16 v[48:51], v[224:227], v[88:91], v[48:51]
    buffer_load_dwordx4 v[112:115], v9, s[20:23], 0 offen offset:0 sc1
    s_waitcnt vmcnt(5)
    v_mfma_f32_16x16x32_bf16 v[52:55], v[224:227], v[92:95], v[52:55]
    ds_read_b64_tr_b16 v[224:225], v4 offset:12288
    ds_read_b64_tr_b16 v[226:227], v4 offset:14336
    s_waitcnt lgkmcnt(14)
    v_mfma_f32_16x16x32_bf16 v[56:59], v[228:231], v[88:91], v[56:59]
    v_mfma_f32_16x16x32_bf16 v[60:63], v[228:231], v[92:95], v[60:63]
    ds_read_b64_tr_b16 v[228:229], v40 offset:12288
    ds_read_b64_tr_b16 v[230:231], v40 offset:14336
    s_waitcnt lgkmcnt(14)
    v_mfma_f32_16x16x32_bf16 v[64:67], v[232:235], v[88:91], v[64:67]
    buffer_load_dwordx4 v[116:119], v9, s[20:23], s11 offen offset:0 sc1
    v_mfma_f32_16x16x32_bf16 v[68:71], v[232:235], v[92:95], v[68:71]
    ds_read_b64_tr_b16 v[232:233], v5 offset:12288
    ds_read_b64_tr_b16 v[234:235], v5 offset:14336
    s_waitcnt lgkmcnt(14)
    v_mfma_f32_16x16x32_bf16 v[72:75], v[236:239], v[88:91], v[72:75]
    v_mfma_f32_16x16x32_bf16 v[76:79], v[236:239], v[92:95], v[76:79]
    ds_read_b64_tr_b16 v[236:237], v41 offset:12288
    ds_read_b64_tr_b16 v[238:239], v41 offset:14336
    s_waitcnt vmcnt(5)
    s_waitcnt lgkmcnt(14)
    v_mfma_f32_16x16x32_bf16 v[48:51], v[208:211], v[96:99], v[48:51]
    buffer_load_dwordx4 v[120:123], v9, s[20:23], 0 offen offset:1024 sc1
    s_waitcnt vmcnt(5)
    v_mfma_f32_16x16x32_bf16 v[52:55], v[208:211], v[100:103], v[52:55]
    s_waitcnt lgkmcnt(12)
    v_mfma_f32_16x16x32_bf16 v[56:59], v[212:215], v[96:99], v[56:59]
    v_mfma_f32_16x16x32_bf16 v[60:63], v[212:215], v[100:103], v[60:63]
    s_waitcnt lgkmcnt(10)
    v_mfma_f32_16x16x32_bf16 v[64:67], v[216:219], v[96:99], v[64:67]
    buffer_load_dwordx4 v[124:127], v9, s[20:23], s11 offen offset:1024 sc1
    v_mfma_f32_16x16x32_bf16 v[68:71], v[216:219], v[100:103], v[68:71]
    s_waitcnt lgkmcnt(8)
    v_mfma_f32_16x16x32_bf16 v[72:75], v[220:223], v[96:99], v[72:75]
    v_mfma_f32_16x16x32_bf16 v[76:79], v[220:223], v[100:103], v[76:79]
    s_waitcnt vmcnt(5)
    s_waitcnt lgkmcnt(6)
    v_mfma_f32_16x16x32_bf16 v[48:51], v[224:227], v[104:107], v[48:51]
    buffer_load_dwordx4 v[128:131], v9, s[20:23], 0 offen offset:2048 sc1
    s_waitcnt vmcnt(5)
    v_mfma_f32_16x16x32_bf16 v[52:55], v[224:227], v[108:111], v[52:55]
    s_waitcnt lgkmcnt(4)
    v_mfma_f32_16x16x32_bf16 v[56:59], v[228:231], v[104:107], v[56:59]
    v_mfma_f32_16x16x32_bf16 v[60:63], v[228:231], v[108:111], v[60:63]
    s_waitcnt lgkmcnt(2)
    v_mfma_f32_16x16x32_bf16 v[64:67], v[232:235], v[104:107], v[64:67]
    buffer_load_dwordx4 v[132:135], v9, s[20:23], s11 offen offset:2048 sc1
    v_mfma_f32_16x16x32_bf16 v[68:71], v[232:235], v[108:111], v[68:71]
    s_waitcnt lgkmcnt(0)
    v_mfma_f32_16x16x32_bf16 v[72:75], v[236:239], v[104:107], v[72:75]
    v_mfma_f32_16x16x32_bf16 v[76:79], v[236:239], v[108:111], v[76:79]
    v_add_u32 v4, s53, v4
    v_add_u32 v40, s53, v40
    v_add_u32 v5, s53, v5
    v_add_u32 v41, s53, v41
    ds_read_b64_tr_b16 v[208:209], v4 offset:0
    ds_read_b64_tr_b16 v[210:211], v4 offset:2048
    ds_read_b64_tr_b16 v[212:213], v40 offset:0
    ds_read_b64_tr_b16 v[214:215], v40 offset:2048
    ds_read_b64_tr_b16 v[216:217], v5 offset:0
    ds_read_b64_tr_b16 v[218:219], v5 offset:2048
    ds_read_b64_tr_b16 v[220:221], v41 offset:0
    ds_read_b64_tr_b16 v[222:223], v41 offset:2048
    ds_read_b64_tr_b16 v[224:225], v4 offset:4096
    ds_read_b64_tr_b16 v[226:227], v4 offset:6144
    ds_read_b64_tr_b16 v[228:229], v40 offset:4096
    ds_read_b64_tr_b16 v[230:231], v40 offset:6144
    ds_read_b64_tr_b16 v[232:233], v5 offset:4096
    ds_read_b64_tr_b16 v[234:235], v5 offset:6144
    s_waitcnt vmcnt(5)
    s_waitcnt lgkmcnt(12)
    v_mfma_f32_16x16x32_bf16 v[48:51], v[208:211], v[112:115], v[48:51]
    ds_read_b64_tr_b16 v[236:237], v41 offset:4096
    ds_read_b64_tr_b16 v[238:239], v41 offset:6144
    buffer_load_dwordx4 v[136:139], v9, s[20:23], 0 offen offset:3072 sc1
    s_waitcnt vmcnt(5)
    v_mfma_f32_16x16x32_bf16 v[52:55], v[208:211], v[116:119], v[52:55]
    ds_read_b64_tr_b16 v[208:209], v4 offset:8192
    ds_read_b64_tr_b16 v[210:211], v4 offset:10240
    s_waitcnt lgkmcnt(14)
    v_mfma_f32_16x16x32_bf16 v[56:59], v[212:215], v[112:115], v[56:59]
    v_mfma_f32_16x16x32_bf16 v[60:63], v[212:215], v[116:119], v[60:63]
    ds_read_b64_tr_b16 v[212:213], v40 offset:8192
    ds_read_b64_tr_b16 v[214:215], v40 offset:10240
    s_waitcnt lgkmcnt(14)
    v_mfma_f32_16x16x32_bf16 v[64:67], v[216:219], v[112:115], v[64:67]
    buffer_load_dwordx4 v[140:143], v9, s[20:23], s11 offen offset:3072 sc1
    v_add_u32 v9, 4096, v9
    v_mfma_f32_16x16x32_bf16 v[68:71], v[216:219], v[116:119], v[68:71]
    ds_read_b64_tr_b16 v[216:217], v5 offset:8192
    ds_read_b64_tr_b16 v[218:219], v5 offset:10240
    s_waitcnt lgkmcnt(14)
    v_mfma_f32_16x16x32_bf16 v[72:75], v[220:223], v[112:115], v[72:75]
    v_mfma_f32_16x16x32_bf16 v[76:79], v[220:223], v[116:119], v[76:79]
    ds_read_b64_tr_b16 v[220:221], v41 offset:8192
    ds_read_b64_tr_b16 v[222:223], v41 offset:10240
    s_waitcnt vmcnt(5)
    s_waitcnt lgkmcnt(14)
    v_mfma_f32_16x16x32_bf16 v[48:51], v[224:227], v[120:123], v[48:51]
    buffer_load_dwordx4 v[144:147], v9, s[20:23], 0 offen offset:0 sc1
    s_waitcnt vmcnt(5)
    v_mfma_f32_16x16x32_bf16 v[52:55], v[224:227], v[124:127], v[52:55]
    ds_read_b64_tr_b16 v[224:225], v4 offset:12288
    ds_read_b64_tr_b16 v[226:227], v4 offset:14336
    s_waitcnt lgkmcnt(14)
    v_mfma_f32_16x16x32_bf16 v[56:59], v[228:231], v[120:123], v[56:59]
    v_mfma_f32_16x16x32_bf16 v[60:63], v[228:231], v[124:127], v[60:63]
    ds_read_b64_tr_b16 v[228:229], v40 offset:12288
    ds_read_b64_tr_b16 v[230:231], v40 offset:14336
    s_waitcnt lgkmcnt(14)
    v_mfma_f32_16x16x32_bf16 v[64:67], v[232:235], v[120:123], v[64:67]
    buffer_load_dwordx4 v[148:151], v9, s[20:23], s11 offen offset:0 sc1
    v_mfma_f32_16x16x32_bf16 v[68:71], v[232:235], v[124:127], v[68:71]
    ds_read_b64_tr_b16 v[232:233], v5 offset:12288
    ds_read_b64_tr_b16 v[234:235], v5 offset:14336
    s_waitcnt lgkmcnt(14)
    v_mfma_f32_16x16x32_bf16 v[72:75], v[236:239], v[120:123], v[72:75]
    v_mfma_f32_16x16x32_bf16 v[76:79], v[236:239], v[124:127], v[76:79]
    ds_read_b64_tr_b16 v[236:237], v41 offset:12288
    ds_read_b64_tr_b16 v[238:239], v41 offset:14336
    s_waitcnt vmcnt(5)
    s_waitcnt lgkmcnt(14)
    v_mfma_f32_16x16x32_bf16 v[48:51], v[208:211], v[128:131], v[48:51]
    buffer_load_dwordx4 v[152:155], v9, s[20:23], 0 offen offset:1024 sc1
    s_waitcnt vmcnt(5)
    v_mfma_f32_16x16x32_bf16 v[52:55], v[208:211], v[132:135], v[52:55]
    s_waitcnt lgkmcnt(12)
    v_mfma_f32_16x16x32_bf16 v[56:59], v[212:215], v[128:131], v[56:59]
    v_mfma_f32_16x16x32_bf16 v[60:63], v[212:215], v[132:135], v[60:63]
    s_waitcnt lgkmcnt(10)
    v_mfma_f32_16x16x32_bf16 v[64:67], v[216:219], v[128:131], v[64:67]
    buffer_load_dwordx4 v[156:159], v9, s[20:23], s11 offen offset:1024 sc1
    v_mfma_f32_16x16x32_bf16 v[68:71], v[216:219], v[132:135], v[68:71]
    s_waitcnt lgkmcnt(8)
    v_mfma_f32_16x16x32_bf16 v[72:75], v[220:223], v[128:131], v[72:75]
    v_mfma_f32_16x16x32_bf16 v[76:79], v[220:223], v[132:135], v[76:79]
    s_waitcnt vmcnt(5)
    s_waitcnt lgkmcnt(6)
    v_mfma_f32_16x16x32_bf16 v[48:51], v[224:227], v[136:139], v[48:51]
    buffer_load_dwordx4 v[160:163], v9, s[20:23], 0 offen offset:2048 sc1
    s_waitcnt vmcnt(5)
    v_mfma_f32_16x16x32_bf16 v[52:55], v[224:227], v[140:143], v[52:55]
    s_waitcnt lgkmcnt(4)
    v_mfma_f32_16x16x32_bf16 v[56:59], v[228:231], v[136:139], v[56:59]
    v_mfma_f32_16x16x32_bf16 v[60:63], v[228:231], v[140:143], v[60:63]
    s_waitcnt lgkmcnt(2)
    v_mfma_f32_16x16x32_bf16 v[64:67], v[232:235], v[136:139], v[64:67]
    buffer_load_dwordx4 v[164:167], v9, s[20:23], s11 offen offset:2048 sc1
    v_mfma_f32_16x16x32_bf16 v[68:71], v[232:235], v[140:143], v[68:71]
    s_waitcnt lgkmcnt(0)
    v_mfma_f32_16x16x32_bf16 v[72:75], v[236:239], v[136:139], v[72:75]
    v_mfma_f32_16x16x32_bf16 v[76:79], v[236:239], v[140:143], v[76:79]
    v_add_u32 v4, s54, v4
    v_add_u32 v40, s54, v40
    v_add_u32 v5, s54, v5
    v_add_u32 v41, s54, v41
    ds_read_b64_tr_b16 v[208:209], v4 offset:0
    ds_read_b64_tr_b16 v[210:211], v4 offset:2048
    ds_read_b64_tr_b16 v[212:213], v40 offset:0
    ds_read_b64_tr_b16 v[214:215], v40 offset:2048
    ds_read_b64_tr_b16 v[216:217], v5 offset:0
    ds_read_b64_tr_b16 v[218:219], v5 offset:2048
    ds_read_b64_tr_b16 v[220:221], v41 offset:0
    ds_read_b64_tr_b16 v[222:223], v41 offset:2048
    ds_read_b64_tr_b16 v[224:225], v4 offset:4096
    ds_read_b64_tr_b16 v[226:227], v4 offset:6144
    ds_read_b64_tr_b16 v[228:229], v40 offset:4096
    ds_read_b64_tr_b16 v[230:231], v40 offset:6144
    ds_read_b64_tr_b16 v[232:233], v5 offset:4096
    ds_read_b64_tr_b16 v[234:235], v5 offset:6144
    s_waitcnt vmcnt(5)
    s_waitcnt lgkmcnt(12)
    v_mfma_f32_16x16x32_bf16 v[48:51], v[208:211], v[144:147], v[48:51]
    ds_read_b64_tr_b16 v[236:237], v41 offset:4096
    ds_read_b64_tr_b16 v[238:239], v41 offset:6144
    buffer_load_dwordx4 v[168:171], v9, s[20:23], 0 offen offset:3072 sc1
    s_waitcnt vmcnt(5)
    v_mfma_f32_16x16x32_bf16 v[52:55], v[208:211], v[148:151], v[52:55]
    ds_read_b64_tr_b16 v[208:209], v4 offset:8192
    ds_read_b64_tr_b16 v[210:211], v4 offset:10240
    s_waitcnt lgkmcnt(14)
    v_mfma_f32_16x16x32_bf16 v[56:59], v[212:215], v[144:147], v[56:59]
    v_mfma_f32_16x16x32_bf16 v[60:63], v[212:215], v[148:151], v[60:63]
    ds_read_b64_tr_b16 v[212:213], v40 offset:8192
    ds_read_b64_tr_b16 v[214:215], v40 offset:10240
    s_waitcnt lgkmcnt(14)
    v_mfma_f32_16x16x32_bf16 v[64:67], v[216:219], v[144:147], v[64:67]
    buffer_load_dwordx4 v[172:175], v9, s[20:23], s11 offen offset:3072 sc1
    v_add_u32 v9, 4096, v9
    v_mfma_f32_16x16x32_bf16 v[68:71], v[216:219], v[148:151], v[68:71]
    ds_read_b64_tr_b16 v[216:217], v5 offset:8192
    ds_read_b64_tr_b16 v[218:219], v5 offset:10240
    s_waitcnt lgkmcnt(14)
    v_mfma_f32_16x16x32_bf16 v[72:75], v[220:223], v[144:147], v[72:75]
    v_mfma_f32_16x16x32_bf16 v[76:79], v[220:223], v[148:151], v[76:79]
    ds_read_b64_tr_b16 v[220:221], v41 offset:8192
    ds_read_b64_tr_b16 v[222:223], v41 offset:10240
    s_waitcnt vmcnt(5)
    s_waitcnt lgkmcnt(14)
    v_mfma_f32_16x16x32_bf16 v[48:51], v[224:227], v[152:155], v[48:51]
    buffer_load_dwordx4 v[176:179], v9, s[20:23], 0 offen offset:0 sc1
    s_waitcnt vmcnt(5)
    v_mfma_f32_16x16x32_bf16 v[52:55], v[224:227], v[156:159], v[52:55]
    ds_read_b64_tr_b16 v[224:225], v4 offset:12288
    ds_read_b64_tr_b16 v[226:227], v4 offset:14336
    s_waitcnt lgkmcnt(14)
    v_mfma_f32_16x16x32_bf16 v[56:59], v[228:231], v[152:155], v[56:59]
    v_mfma_f32_16x16x32_bf16 v[60:63], v[228:231], v[156:159], v[60:63]
    ds_read_b64_tr_b16 v[228:229], v40 offset:12288
    ds_read_b64_tr_b16 v[230:231], v40 offset:14336
    s_waitcnt lgkmcnt(14)
    v_mfma_f32_16x16x32_bf16 v[64:67], v[232:235], v[152:155], v[64:67]
    buffer_load_dwordx4 v[180:183], v9, s[20:23], s11 offen offset:0 sc1
    v_mfma_f32_16x16x32_bf16 v[68:71], v[232:235], v[156:159], v[68:71]
    ds_read_b64_tr_b16 v[232:233], v5 offset:12288
    ds_read_b64_tr_b16 v[234:235], v5 offset:14336
    s_waitcnt lgkmcnt(14)
    v_mfma_f32_16x16x32_bf16 v[72:75], v[236:239], v[152:155], v[72:75]
    v_mfma_f32_16x16x32_bf16 v[76:79], v[236:239], v[156:159], v[76:79]
    ds_read_b64_tr_b16 v[236:237], v41 offset:12288
    ds_read_b64_tr_b16 v[238:239], v41 offset:14336
    s_waitcnt vmcnt(5)
    s_waitcnt lgkmcnt(14)
    v_mfma_f32_16x16x32_bf16 v[48:51], v[208:211], v[160:163], v[48:51]
    buffer_load_dwordx4 v[184:187], v9, s[20:23], 0 offen offset:1024 sc1
    s_waitcnt vmcnt(5)
    v_mfma_f32_16x16x32_bf16 v[52:55], v[208:211], v[164:167], v[52:55]
    s_waitcnt lgkmcnt(12)
    v_mfma_f32_16x16x32_bf16 v[56:59], v[212:215], v[160:163], v[56:59]
    v_mfma_f32_16x16x32_bf16 v[60:63], v[212:215], v[164:167], v[60:63]
    s_waitcnt lgkmcnt(10)
    v_mfma_f32_16x16x32_bf16 v[64:67], v[216:219], v[160:163], v[64:67]
    buffer_load_dwordx4 v[188:191], v9, s[20:23], s11 offen offset:1024 sc1
    v_mfma_f32_16x16x32_bf16 v[68:71], v[216:219], v[164:167], v[68:71]
    s_waitcnt lgkmcnt(8)
    v_mfma_f32_16x16x32_bf16 v[72:75], v[220:223], v[160:163], v[72:75]
    v_mfma_f32_16x16x32_bf16 v[76:79], v[220:223], v[164:167], v[76:79]
    s_waitcnt vmcnt(5)
    s_waitcnt lgkmcnt(6)
    v_mfma_f32_16x16x32_bf16 v[48:51], v[224:227], v[168:171], v[48:51]
    buffer_load_dwordx4 v[192:195], v9, s[20:23], 0 offen offset:2048 sc1
    s_waitcnt vmcnt(5)
    v_mfma_f32_16x16x32_bf16 v[52:55], v[224:227], v[172:175], v[52:55]
    s_waitcnt lgkmcnt(4)
    v_mfma_f32_16x16x32_bf16 v[56:59], v[228:231], v[168:171], v[56:59]
    v_mfma_f32_16x16x32_bf16 v[60:63], v[228:231], v[172:175], v[60:63]
    s_waitcnt lgkmcnt(2)
    v_mfma_f32_16x16x32_bf16 v[64:67], v[232:235], v[168:171], v[64:67]
    buffer_load_dwordx4 v[196:199], v9, s[20:23], s11 offen offset:2048 sc1
    v_mfma_f32_16x16x32_bf16 v[68:71], v[232:235], v[172:175], v[68:71]
    s_waitcnt lgkmcnt(0)
    v_mfma_f32_16x16x32_bf16 v[72:75], v[236:239], v[168:171], v[72:75]
    v_mfma_f32_16x16x32_bf16 v[76:79], v[236:239], v[172:175], v[76:79]
    v_add_u32 v4, s55, v4
    v_add_u32 v40, s55, v40
    v_add_u32 v5, s55, v5
    v_add_u32 v41, s55, v41
    ds_read_b64_tr_b16 v[208:209], v4 offset:0
    ds_read_b64_tr_b16 v[210:211], v4 offset:2048
    ds_read_b64_tr_b16 v[212:213], v40 offset:0
    ds_read_b64_tr_b16 v[214:215], v40 offset:2048
    ds_read_b64_tr_b16 v[216:217], v5 offset:0
    ds_read_b64_tr_b16 v[218:219], v5 offset:2048
    ds_read_b64_tr_b16 v[220:221], v41 offset:0
    ds_read_b64_tr_b16 v[222:223], v41 offset:2048
    ds_read_b64_tr_b16 v[224:225], v4 offset:4096
    ds_read_b64_tr_b16 v[226:227], v4 offset:6144
    ds_read_b64_tr_b16 v[228:229], v40 offset:4096
    ds_read_b64_tr_b16 v[230:231], v40 offset:6144
    ds_read_b64_tr_b16 v[232:233], v5 offset:4096
    ds_read_b64_tr_b16 v[234:235], v5 offset:6144
    s_waitcnt vmcnt(5)
    s_waitcnt lgkmcnt(12)
    v_mfma_f32_16x16x32_bf16 v[48:51], v[208:211], v[176:179], v[48:51]
    ds_read_b64_tr_b16 v[236:237], v41 offset:4096
    ds_read_b64_tr_b16 v[238:239], v41 offset:6144
    buffer_load_dwordx4 v[200:203], v9, s[20:23], 0 offen offset:3072 sc1
    s_waitcnt vmcnt(5)
    v_mfma_f32_16x16x32_bf16 v[52:55], v[208:211], v[180:183], v[52:55]
    ds_read_b64_tr_b16 v[208:209], v4 offset:8192
    ds_read_b64_tr_b16 v[210:211], v4 offset:10240
    s_waitcnt lgkmcnt(14)
    v_mfma_f32_16x16x32_bf16 v[56:59], v[212:215], v[176:179], v[56:59]
    v_mfma_f32_16x16x32_bf16 v[60:63], v[212:215], v[180:183], v[60:63]
    ds_read_b64_tr_b16 v[212:213], v40 offset:8192
    ds_read_b64_tr_b16 v[214:215], v40 offset:10240
    s_waitcnt lgkmcnt(14)
    v_mfma_f32_16x16x32_bf16 v[64:67], v[216:219], v[176:179], v[64:67]
    v_mfma_f32_16x16x32_bf16 v[68:71], v[216:219], v[180:183], v[68:71]
    ds_read_b64_tr_b16 v[216:217], v5 offset:8192
    ds_read_b64_tr_b16 v[218:219], v5 offset:10240
    s_waitcnt lgkmcnt(14)
    v_mfma_f32_16x16x32_bf16 v[72:75], v[220:223], v[176:179], v[72:75]
    v_mfma_f32_16x16x32_bf16 v[76:79], v[220:223], v[180:183], v[76:79]
    ds_read_b64_tr_b16 v[220:221], v41 offset:8192
    ds_read_b64_tr_b16 v[222:223], v41 offset:10240
    s_waitcnt vmcnt(4)
    s_waitcnt lgkmcnt(14)
    v_mfma_f32_16x16x32_bf16 v[48:51], v[224:227], v[184:187], v[48:51]
    s_waitcnt vmcnt(3)
    v_mfma_f32_16x16x32_bf16 v[52:55], v[224:227], v[188:191], v[52:55]
    ds_read_b64_tr_b16 v[224:225], v4 offset:12288
    ds_read_b64_tr_b16 v[226:227], v4 offset:14336
    s_waitcnt lgkmcnt(14)
    v_mfma_f32_16x16x32_bf16 v[56:59], v[228:231], v[184:187], v[56:59]
    v_mfma_f32_16x16x32_bf16 v[60:63], v[228:231], v[188:191], v[60:63]
    ds_read_b64_tr_b16 v[228:229], v40 offset:12288
    ds_read_b64_tr_b16 v[230:231], v40 offset:14336
    s_waitcnt lgkmcnt(14)
    v_mfma_f32_16x16x32_bf16 v[64:67], v[232:235], v[184:187], v[64:67]
    v_mfma_f32_16x16x32_bf16 v[68:71], v[232:235], v[188:191], v[68:71]
    ds_read_b64_tr_b16 v[232:233], v5 offset:12288
    ds_read_b64_tr_b16 v[234:235], v5 offset:14336
    s_waitcnt lgkmcnt(14)
    v_mfma_f32_16x16x32_bf16 v[72:75], v[236:239], v[184:187], v[72:75]
    v_mfma_f32_16x16x32_bf16 v[76:79], v[236:239], v[188:191], v[76:79]
    ds_read_b64_tr_b16 v[236:237], v41 offset:12288
    ds_read_b64_tr_b16 v[238:239], v41 offset:14336
    s_waitcnt vmcnt(2)
    s_waitcnt lgkmcnt(14)
    v_mfma_f32_16x16x32_bf16 v[48:51], v[208:211], v[192:195], v[48:51]
    buffer_load_dwordx4 v[204:207], v9, s[20:23], s11 offen offset:3072 sc1
    v_add_u32 v9, 4096, v9
    s_waitcnt vmcnt(2)
    v_mfma_f32_16x16x32_bf16 v[52:55], v[208:211], v[196:199], v[52:55]
    s_waitcnt lgkmcnt(12)
    v_mfma_f32_16x16x32_bf16 v[56:59], v[212:215], v[192:195], v[56:59]
    v_mfma_f32_16x16x32_bf16 v[60:63], v[212:215], v[196:199], v[60:63]
    s_waitcnt lgkmcnt(10)
    v_mfma_f32_16x16x32_bf16 v[64:67], v[216:219], v[192:195], v[64:67]
    v_mfma_f32_16x16x32_bf16 v[68:71], v[216:219], v[196:199], v[68:71]
    s_waitcnt lgkmcnt(8)
    v_mfma_f32_16x16x32_bf16 v[72:75], v[220:223], v[192:195], v[72:75]
    v_mfma_f32_16x16x32_bf16 v[76:79], v[220:223], v[196:199], v[76:79]
    s_waitcnt vmcnt(1)
    s_waitcnt lgkmcnt(6)
    v_mfma_f32_16x16x32_bf16 v[48:51], v[224:227], v[200:203], v[48:51]
    s_waitcnt vmcnt(0)
    v_mfma_f32_16x16x32_bf16 v[52:55], v[224:227], v[204:207], v[52:55]
    s_waitcnt lgkmcnt(4)
    v_mfma_f32_16x16x32_bf16 v[56:59], v[228:231], v[200:203], v[56:59]
    v_mfma_f32_16x16x32_bf16 v[60:63], v[228:231], v[204:207], v[60:63]
    s_waitcnt lgkmcnt(2)
    v_mfma_f32_16x16x32_bf16 v[64:67], v[232:235], v[200:203], v[64:67]
    v_mfma_f32_16x16x32_bf16 v[68:71], v[232:235], v[204:207], v[68:71]
    s_waitcnt lgkmcnt(0)
    v_mfma_f32_16x16x32_bf16 v[72:75], v[236:239], v[200:203], v[72:75]
    v_mfma_f32_16x16x32_bf16 v[76:79], v[236:239], v[204:207], v[76:79]
    s_nop 7
    v_permlane16_swap_b32 v48, v52
    v_permlane16_swap_b32 v49, v53
    v_permlane16_swap_b32 v50, v54
    v_permlane16_swap_b32 v51, v55
    v_permlane16_swap_b32 v56, v60
    v_permlane16_swap_b32 v57, v61
    v_permlane16_swap_b32 v58, v62
    v_permlane16_swap_b32 v59, v63
    v_permlane16_swap_b32 v64, v68
    v_permlane16_swap_b32 v65, v69
    v_permlane16_swap_b32 v66, v70
    v_permlane16_swap_b32 v67, v71
    v_permlane16_swap_b32 v72, v76
    v_permlane16_swap_b32 v73, v77
    v_permlane16_swap_b32 v74, v78
    v_permlane16_swap_b32 v75, v79
    v_lshlrev_b32 v32, 16, v16
    v_and_b32 v33, 0xffff0000, v16
    v_lshlrev_b32 v34, 16, v17
    v_and_b32 v35, 0xffff0000, v17
    v_lshlrev_b32 v36, 16, v18
    v_and_b32 v37, 0xffff0000, v18
    v_lshlrev_b32 v38, 16, v19
    v_and_b32 v39, 0xffff0000, v19
    v_lshlrev_b32 v40, 16, v20
    v_and_b32 v41, 0xffff0000, v20
    v_lshlrev_b32 v42, 16, v21
    v_and_b32 v43, 0xffff0000, v21
    v_lshlrev_b32 v44, 16, v22
    v_and_b32 v45, 0xffff0000, v22
    v_lshlrev_b32 v46, 16, v23
    v_and_b32 v47, 0xffff0000, v23
    ds_write_b128 v2, v[64:67] offset:0
    ds_write_b128 v2, v[68:71] offset:1024
    ds_write_b128 v2, v[72:75] offset:2048
    ds_write_b128 v2, v[76:79] offset:3072
    v_lshlrev_b32 v240, 16, v24
    v_and_b32 v241, 0xffff0000, v24
    v_lshlrev_b32 v242, 16, v25
    v_and_b32 v243, 0xffff0000, v25
    v_lshlrev_b32 v244, 16, v26
    v_and_b32 v245, 0xffff0000, v26
    v_lshlrev_b32 v246, 16, v27
    v_and_b32 v247, 0xffff0000, v27
    v_lshlrev_b32 v248, 16, v28
    v_and_b32 v249, 0xffff0000, v28
    v_lshlrev_b32 v250, 16, v29
    v_and_b32 v251, 0xffff0000, v29
    v_lshlrev_b32 v252, 16, v30
    v_and_b32 v253, 0xffff0000, v30
    v_lshlrev_b32 v254, 16, v31
    v_and_b32 v255, 0xffff0000, v31
    s_waitcnt lgkmcnt(0)
    s_barrier
    ds_read_b128 v[80:83], v3 offset:0
    ds_read_b128 v[84:87], v3 offset:1024
    ds_read_b128 v[88:91], v3 offset:2048
    ds_read_b128 v[92:95], v3 offset:3072
    s_waitcnt lgkmcnt(3)
    v_add_f32 v48, v48, v80
    v_add_f32 v49, v49, v81
    v_add_f32 v50, v50, v82
    v_add_f32 v51, v51, v83
    v_fma_f32 v48, v48, v32, v240
    v_fma_f32 v49, v49, v33, v241
    v_fma_f32 v50, v50, v34, v242
    v_fma_f32 v51, v51, v35, v243
    v_cvt_pk_bf16_f32 v208, v48, v49
    v_cvt_pk_bf16_f32 v209, v50, v51
    s_waitcnt lgkmcnt(2)
    v_add_f32 v52, v52, v84
    v_add_f32 v53, v53, v85
    v_add_f32 v54, v54, v86
    v_add_f32 v55, v55, v87
    v_fma_f32 v52, v52, v36, v244
    v_fma_f32 v53, v53, v37, v245
    v_fma_f32 v54, v54, v38, v246
    v_fma_f32 v55, v55, v39, v247
    v_cvt_pk_bf16_f32 v212, v52, v53
    v_cvt_pk_bf16_f32 v213, v54, v55
    s_waitcnt lgkmcnt(1)
    v_add_f32 v56, v56, v88
    v_add_f32 v57, v57, v89
    v_add_f32 v58, v58, v90
    v_add_f32 v59, v59, v91
    v_fma_f32 v56, v56, v40, v248
    v_fma_f32 v57, v57, v41, v249
    v_fma_f32 v58, v58, v42, v250
    v_fma_f32 v59, v59, v43, v251
    v_cvt_pk_bf16_f32 v210, v56, v57
    v_cvt_pk_bf16_f32 v211, v58, v59
    s_waitcnt lgkmcnt(0)
    v_add_f32 v60, v60, v92
    v_add_f32 v61, v61, v93
    v_add_f32 v62, v62, v94
    v_add_f32 v63, v63, v95
    v_fma_f32 v60, v60, v44, v252
    v_fma_f32 v61, v61, v45, v253
    v_fma_f32 v62, v62, v46, v254
    v_fma_f32 v63, v63, v47, v255
    v_cvt_pk_bf16_f32 v214, v60, v61
    v_cvt_pk_bf16_f32 v215, v62, v63
    v_xor_b32 v7, 16, v6
    s_nop 0
    v_permlane32_swap_b32 v208, v210
    v_permlane32_swap_b32 v209, v211
    v_permlane32_swap_b32 v212, v214
    v_permlane32_swap_b32 v213, v215
    s_nop 1
    ds_write_b128 v6, v[208:211]
    ds_write_b128 v7, v[212:215]
    s_waitcnt lgkmcnt(0)
    ds_read_b128 v[80:83], v8
    ds_read_b128 v[84:87], v8 offset:1024
    s_waitcnt lgkmcnt(1)
    buffer_store_dwordx4 v[80:83], v10, s[36:39], 0 offen sc1
    s_waitcnt lgkmcnt(0)
    buffer_store_dwordx4 v[84:87], v10, s[36:39], s67 offen sc1
attn_out_kernel_end:
    s_endpgm
.section .rodata,"a"
.p2align 6
.amdhsa_kernel gemm1_kernel
  .amdhsa_next_free_vgpr 512
  .amdhsa_next_free_sgpr 102
  .amdhsa_accum_offset 256
  .amdhsa_group_segment_fixed_size 0
  .amdhsa_kernarg_size 80
  .amdhsa_user_sgpr_count 2
  .amdhsa_user_sgpr_kernarg_segment_ptr 1
  .amdhsa_system_sgpr_workgroup_id_x 1
  .amdhsa_float_denorm_mode_32 3
.end_amdhsa_kernel
.p2align 6
.amdhsa_kernel attn_out_kernel
  .amdhsa_next_free_vgpr 256
  .amdhsa_next_free_sgpr 102
  .amdhsa_accum_offset 256
  .amdhsa_group_segment_fixed_size 0
  .amdhsa_kernarg_size 80
  .amdhsa_user_sgpr_count 2
  .amdhsa_user_sgpr_kernarg_segment_ptr 1
  .amdhsa_system_sgpr_workgroup_id_x 1
  .amdhsa_float_denorm_mode_32 3
.end_amdhsa_kernel
```
